```python
import torch

def _softmax(x, axis=-1):
    return torch.softmax(x, dim=axis)
def _gelu(x):
    return torch.nn.functional.gelu(x, approximate="tanh")
def _silu(x):
    return torch.nn.functional.silu(x)
def _sigmoid(x):
    return torch.sigmoid(x)
def _layernorm(x, axis=-1, eps=1e-5):
    m = x.mean(dim=axis, keepdim=True)
    v = x.var(dim=axis, keepdim=True, unbiased=False)
    return (x - m) / torch.sqrt(v + eps)
def _scatter_add(tgt, idx, src, axis=0):
    return tgt.clone().index_add_(axis, idx, src)
def _segment_sum(src, seg, n):
    out = torch.zeros((n,) + src.shape[1:], dtype=src.dtype)
    return out.index_add_(0, seg, src)
def _pad(x, pw):
    flat = tuple(v for pair in reversed(pw) for v in pair)
    return torch.nn.functional.pad(x, flat)

kernel_name = 'interleave_layers__spectral_gfnet__glu_gated_reglu__prompt'

def setup_inputs():

    _w = (lambda a: (lambda t: t.to(torch.bfloat16) if t.is_floating_point() else t)(torch.as_tensor(a)))
    def _A_setup():
        B, S, D = 1, 2048, 512
        Df = D // 2 + 1
        return {
            "x": _w((lambda *s: torch.randn(*s, dtype=torch.bfloat16) * 0.05)(B, S, D)),
            "w_r": _w((lambda *s: torch.randn(*s, dtype=torch.bfloat16) * 0.4)(S, Df) * 0.02),
            "w_i": _w((lambda *s: torch.randn(*s, dtype=torch.bfloat16) * 0.4)(S, Df) * 0.02),
        }
    _A_in = _A_setup()

    def _B_setup():
        B, S, D, F = 1, 2048, 512, 1376
        return {
            "x": _w((lambda *s: torch.randn(*s, dtype=torch.bfloat16) * 0.05)(B, S, D)),
            "W_gate": _w((lambda *s: torch.randn(*s, dtype=torch.bfloat16) * 0.2)(D, F) * (2.0 / D) ** 0.5),
            "W_up": _w((lambda *s: torch.randn(*s, dtype=torch.bfloat16) * 0.2)(D, F) * (2.0 / D) ** 0.5),
            "W_down": _w((lambda *s: torch.randn(*s, dtype=torch.bfloat16) * 0.2)(F, D) * (1.0 / F) ** 0.5),
        }
    _B_in = _B_setup()

    return {
        "A_x": _A_in["x"],
        "A_w_r": _A_in["w_r"],
        "A_w_i": _A_in["w_i"],
        "B_x": _B_in["x"],
        "B_W_gate": _B_in["W_gate"],
        "B_W_up": _B_in["W_up"],
        "B_W_down": _B_in["W_down"],
    }

def reference(A_x, A_w_r, A_w_i, B_x, B_W_gate, B_W_up, B_W_down):
    def _A_ref(x, w_r, w_i):
        B, S, D = x.shape
        X = (lambda x, axes=(-2,-1): torch.fft.rfft2(x.float(), dim=axes))(x, axes=(-2, -1))
        W = w_r + 1j * w_i
        X = X * W
        y = (lambda x, s, axes=(-2,-1): torch.fft.irfft2(x, s=s, dim=axes).to(torch.bfloat16))(X, (S, D), axes=(-2, -1))
        return y

    def _B_ref(x, W_gate, W_up, W_down):
        gate = torch.einsum("bsd,df->bsf", x, W_gate)
        up = torch.einsum("bsd,df->bsf", x, W_up)
        gate = gate * (lambda x, dt: x.to(dt))(gate > 0, gate.dtype)
        h = gate * up
        return torch.einsum("bsf,fd->bsd", h, W_down)

    x = A_x
    x = x + _A_ref(_layernorm(x, axis=-1), A_w_r, A_w_i)
    x = x + _B_ref(_layernorm(x, axis=-1), B_W_gate, B_W_up, B_W_down)
    x = x + _A_ref(_layernorm(x, axis=-1), A_w_r, A_w_i)
    x = x + _B_ref(_layernorm(x, axis=-1), B_W_gate, B_W_up, B_W_down)
    return x
```

```asm
; @launch grid=(256,1,1) block=(256,1,1) lds=163840
.amdgcn_target "amdgcn-amd-amdhsa--gfx950"
.text
.globl interleave_layers__spectral_gfnet__glu_gated_reglu__prompt_kernel
.p2align 8
.type interleave_layers__spectral_gfnet__glu_gated_reglu__prompt_kernel,@function
interleave_layers__spectral_gfnet__glu_gated_reglu__prompt_kernel:
    s_load_dwordx16 s[16:31], s[0:1], 0
    s_load_dwordx4 s[32:35], s[0:1], 64
    s_cmp_ge_u32 s2, 256
    s_cbranch_scc1 L_exit
    s_getpc_b64 s[6:7]
    s_lshr_b32 s5, s2, 3
    s_lshl_b32 s5, s5, 7
    v_min_u32 v2, 21, v0
    v_lshl_add_u32 v2, v2, 12, s5
    global_load_dword v236, v2, s[6:7]
    v_and_b32 v1, 63, v0
    v_lshrrev_b32 v2, 6, v0
    s_nop 0
    v_readfirstlane_b32 s3, v2
    s_lshr_b32 s5, s2, 3
    s_and_b32 s52, s2, 7
    s_mov_b32 s48, 0
    s_mov_b32 s6, 0
    s_mov_b32 s7, 8
    s_mov_b32 s56, 64
    s_cmp_ge_u32 s5, 8
    s_cselect_b32 s48, 1, s48
    s_cselect_b32 s6, 8, s6
    s_cselect_b32 s7, 11, s7
    s_cselect_b32 s56, 86, s56
    s_cmp_ge_u32 s5, 19
    s_cselect_b32 s48, 2, s48
    s_cselect_b32 s6, 19, s6
    s_cselect_b32 s7, 6, s7
    s_cselect_b32 s56, 43, s56
    s_cmp_ge_u32 s5, 25
    s_cselect_b32 s48, 3, s48
    s_cselect_b32 s6, 25, s6
    s_cselect_b32 s7, 7, s7
    s_cselect_b32 s56, 56, s56
    s_mul_i32 s47, s52, s7
    s_add_u32 s47, s47, s5
    s_sub_u32 s47, s47, s6
    s_add_u32 s6, s5, 39
    s_add_u32 s7, s5, 38
    s_cmp_eq_u32 s48, 1
    s_cselect_b32 s6, s6, s7
    s_cmp_ge_u32 s47, s56
    s_cselect_b32 s48, 3, s48
    s_cselect_b32 s47, s6, s47
    s_cmp_lg_u32 s48, 0
    s_cbranch_scc1 L_h234
    s_bfe_u32 s56, s47, 0x30002
    s_lshl_b32 s56, s56, 18
    s_lshr_b32 s6, s47, 5
    s_lshl_b32 s6, s6, 14
    s_add_u32 s56, s56, s6
    s_and_b32 s6, s47, 3
    s_lshl_b32 s6, s6, 12
    s_add_u32 s56, s56, s6
    s_and_b32 s6, s3, 2
    s_lshl_b32 s6, s6, 10
    s_add_u32 s56, s56, s6
    s_and_b32 s6, s3, 1
    s_lshl_b32 s6, s6, 17
    s_add_u32 s56, s56, s6
    v_lshlrev_b32 v4, 4, v1
    s_mul_i32 s59, s3, 8256
    s_lshl_b32 s5, s3, 13
    s_lshl_b32 s60, s47, 15
    s_add_u32 s60, s60, s5
    s_add_u32 s61, s60, 4096
    v_mov_b32 v84, 1
    v_mov_b32 v85, 1
    v_mov_b32 v86, 1
    v_mov_b32 v87, 1
    s_waitcnt lgkmcnt(0)
    s_mov_b32 s12, s34
    s_mov_b32 s13, s35
    s_mov_b32 s14, 2097152
    s_mov_b32 s15, 0x20000
    s_mov_b32 s8, s16
    s_mov_b32 s9, s17
    s_mov_b32 s10, 2097152
    s_mov_b32 s11, 0x20000
    s_add_u32 m0, s59, 0
    s_add_u32 s7, s56, 0
    buffer_load_dwordx4 v4, s[8:11], s7 offen  lds
    s_add_u32 m0, s59, 1032
    s_add_u32 s7, s56, 32768
    buffer_load_dwordx4 v4, s[8:11], s7 offen  lds
    s_add_u32 m0, s59, 2064
    s_add_u32 s7, s56, 65536
    buffer_load_dwordx4 v4, s[8:11], s7 offen  lds
    s_add_u32 m0, s59, 3096
    s_add_u32 s7, s56, 98304
    buffer_load_dwordx4 v4, s[8:11], s7 offen  lds
    s_add_u32 m0, s59, 4128
    s_add_u32 s7, s56, 1024
    buffer_load_dwordx4 v4, s[8:11], s7 offen  lds
    s_add_u32 m0, s59, 5160
    s_add_u32 s7, s56, 33792
    buffer_load_dwordx4 v4, s[8:11], s7 offen  lds
    s_add_u32 m0, s59, 6192
    s_add_u32 s7, s56, 66560
    buffer_load_dwordx4 v4, s[8:11], s7 offen  lds
    s_add_u32 m0, s59, 7224
    s_add_u32 s7, s56, 99328
    buffer_load_dwordx4 v4, s[8:11], s7 offen  lds
    s_branch L_t1
L_h234:
    s_cmp_lg_u32 s48, 3
    s_cbranch_scc1 L_h23
    v_lshrrev_b32 v2, 5, v1
    v_mul_u32_u24 v2, 514, v2
    v_and_b32 v3, 31, v1
    v_lshl_add_u32 v2, v3, 4, v2
    s_and_b32 s5, s47, 32
    s_bfe_u32 s6, s47, 0x10004
    s_lshl_b32 s6, s6, 2
    s_add_u32 s5, s5, s6
    s_and_b32 s6, s47, 1
    s_lshl_b32 s6, s6, 4
    s_add_u32 s5, s5, s6
    s_and_b32 s6, s47, 14
    s_lshl_b32 s6, s6, 7
    s_add_u32 s5, s5, s6
    s_lshl_b32 s62, s3, 6
    s_add_u32 s5, s5, s62
    s_mul_i32 s63, s5, 514
    s_add_u32 s63, s63, 2
    s_mul_i32 s64, s3, 2112
    s_waitcnt lgkmcnt(0)
    s_mov_b32 s8, s18
    s_mov_b32 s9, s19
    s_mov_b32 s10, 1052672
    s_mov_b32 s11, 0x20000
    s_mov_b32 s12, s20
    s_mov_b32 s13, s21
    s_mov_b32 s14, 1052672
    s_mov_b32 s15, 0x20000
    s_add_u32 s5, s63, 0
    s_add_u32 m0, s64, 0
    s_nop 0
    buffer_load_dwordx4 v2, s[8:11], s5 offen  lds
    s_add_u32 m0, s64, 1056
    s_nop 0
    buffer_load_dwordx4 v2, s[12:15], s5 offen  lds
    s_add_u32 s5, s63, 1028
    s_add_u32 m0, s64, 8448
    s_nop 0
    buffer_load_dwordx4 v2, s[8:11], s5 offen  lds
    s_add_u32 m0, s64, 9504
    s_nop 0
    buffer_load_dwordx4 v2, s[12:15], s5 offen  lds
    s_add_u32 s5, s63, 4112
    s_add_u32 m0, s64, 16896
    s_nop 0
    buffer_load_dwordx4 v2, s[8:11], s5 offen  lds
    s_add_u32 m0, s64, 17952
    s_nop 0
    buffer_load_dwordx4 v2, s[12:15], s5 offen  lds
    s_add_u32 s5, s63, 5140
    s_add_u32 m0, s64, 25344
    s_nop 0
    buffer_load_dwordx4 v2, s[8:11], s5 offen  lds
    s_add_u32 m0, s64, 26400
    s_nop 0
    buffer_load_dwordx4 v2, s[12:15], s5 offen  lds
    s_branch L_t4
L_h23:
    s_waitcnt lgkmcnt(0)
    s_add_u32 s96, s34, 17301504
    s_addc_u32 s97, s35, 0
    s_mov_b32 s98, 153728
    s_mov_b32 s99, 0x20000
    s_load_dword s36, s[96:97], 153600
    s_getpc_b64 s[6:7]
pc_1:
    s_add_u32 s6, s6, L_tasks - pc_1
    s_addc_u32 s7, s7, 0
    s_lshl_b32 s5, s2, 2
    s_load_dword s45, s[6:7], s5
    s_mov_b32 s38, 0xffff0000
    s_mov_b32 s40, 0x00010001
    s_mov_b32 s41, 0xfffefffe
    s_cmp_eq_u32 s48, 2
    s_cbranch_scc1 L_t2
    v_and_b32 v56, 3, v1
    v_bfe_u32 v57, v1, 3, 2
    v_lshl_add_u32 v56, v57, 2, v56
    v_bfe_u32 v57, v1, 2, 1
    v_cvt_f32_u32 v58, v56
    v_mul_f32 v58, 0x3d000000, v58
    v_cvt_f32_u32 v59, v57
    v_mul_f32 v59, 0x3e800000, v59
    v_and_b32 v60, 31, v1
    v_cmp_eq_u32 vcc, 4, v60
    v_lshrrev_b32 v60, 1, v1
    v_and_b32 v60, 16, v60
    v_cndmask_b32 v58, v58, 0.5, vcc
    v_cndmask_b32 v59, v59, 0, vcc
    v_cvt_f32_u32 v60, v60
    v_fmac_f32 v59, v60, v58
    s_mov_b32 s5, 0x3d800000
    v_add_f32 v104, v58, v58
    v_add_f32 v89, v59, v58
    v_add_f32 v90, v59, v104
    v_add_f32 v91, v89, v104
    v_cos_f32 v104, v104
    v_cos_f32 v88, v59
    v_cos_f32 v89, v89
    v_cos_f32 v90, v90
    v_cos_f32 v91, v91
    v_add_f32 v104, v104, v104
    v_mul_f32 v88, s5, v88
    v_mul_f32 v89, s5, v89
    v_mul_f32 v90, s5, v90
    v_mul_f32 v91, s5, v91
    v_cvt_pk_bf16_f32 v16, v88, v89
    v_pk_fma_f32 v[92:93], v[90:91], v[104:105], v[88:89] op_sel_hi:[1,0,1] neg_lo:[0,0,1] neg_hi:[0,0,1]
    v_cvt_pk_bf16_f32 v17, v90, v91
    v_pk_fma_f32 v[94:95], v[92:93], v[104:105], v[90:91] op_sel_hi:[1,0,1] neg_lo:[0,0,1] neg_hi:[0,0,1]
    v_cvt_pk_bf16_f32 v18, v92, v93
    v_pk_fma_f32 v[96:97], v[94:95], v[104:105], v[92:93] op_sel_hi:[1,0,1] neg_lo:[0,0,1] neg_hi:[0,0,1]
    v_cvt_pk_bf16_f32 v19, v94, v95
    v_pk_fma_f32 v[98:99], v[96:97], v[104:105], v[94:95] op_sel_hi:[1,0,1] neg_lo:[0,0,1] neg_hi:[0,0,1]
    v_cvt_pk_bf16_f32 v20, v96, v97
    v_pk_fma_f32 v[100:101], v[98:99], v[104:105], v[96:97] op_sel_hi:[1,0,1] neg_lo:[0,0,1] neg_hi:[0,0,1]
    v_cvt_pk_bf16_f32 v21, v98, v99
    v_pk_fma_f32 v[102:103], v[100:101], v[104:105], v[98:99] op_sel_hi:[1,0,1] neg_lo:[0,0,1] neg_hi:[0,0,1]
    v_cvt_pk_bf16_f32 v22, v100, v101
    v_cvt_pk_bf16_f32 v23, v102, v103
    s_cmp_ge_u32 s47, 43
    s_cselect_b32 s49, 1024, 0
    s_cselect_b32 s7, 43, 0
    s_cselect_b64 s[8:9], s[26:27], s[24:25]
    s_sub_u32 s51, s47, s7
    s_mov_b32 s10, 1409024
    s_mov_b32 s11, 0x20000
    v_lshrrev_b32 v4, 2, v1
    v_mul_u32_u24 v4, 44032, v4
    v_and_b32 v5, 3, v1
    v_lshl_add_u32 v4, v5, 4, v4
    s_mul_i32 s56, s3, 11008
    s_lshl_b32 s6, s51, 6
    s_add_u32 s56, s56, s6
    s_mul_i32 s59, s3, 8256
    s_bitcmp1_b32 s51, 0
    s_cselect_b32 s6, 5504, 0
    s_cselect_b32 s7, 4128, 0
    s_sub_u32 s57, s56, s6
    s_add_u32 s56, s56, s6
    s_add_u32 s60, s59, s7
    s_sub_u32 s61, s59, s7
    s_add_u32 m0, s60, 0
    s_add_u32 s7, s56, 0
    buffer_load_dwordx4 v4, s[8:11], s7 offen  lds
    s_add_u32 m0, s60, 1032
    s_add_u32 s7, s56, 704512
    buffer_load_dwordx4 v4, s[8:11], s7 offen  lds
    s_add_u32 m0, s60, 2064
    s_add_u32 s7, s56, 2752
    buffer_load_dwordx4 v4, s[8:11], s7 offen  lds
    s_add_u32 m0, s60, 3096
    s_add_u32 s7, s56, 707264
    buffer_load_dwordx4 v4, s[8:11], s7 offen  lds
    s_add_u32 m0, s61, 4128
    s_add_u32 s7, s57, 5504
    buffer_load_dwordx4 v4, s[8:11], s7 offen  lds
    s_add_u32 m0, s61, 5160
    s_add_u32 s7, s57, 710016
    buffer_load_dwordx4 v4, s[8:11], s7 offen  lds
    s_add_u32 m0, s61, 6192
    s_add_u32 s7, s57, 8256
    buffer_load_dwordx4 v4, s[8:11], s7 offen  lds
    s_add_u32 m0, s61, 7224
    s_add_u32 s7, s57, 712768
    buffer_load_dwordx4 v4, s[8:11], s7 offen  lds
    v_bfe_u32 v62, v1, 1, 3
    v_bfe_u32 v63, v1, 4, 1
    v_add_u32 v62, v62, v63
    v_cvt_f32_u32 v56, v62
    v_mul_f32 v56, 0x3d800000, v56
    v_cvt_f32_u32 v63, v63
    v_fma_f32 v62, v63, -2.0, 1.0
    v_mul_f32 v57, 0x3b000000, v62
    v_lshrrev_b32 v64, 5, v1
    v_cvt_f32_u32 v64, v64
    v_and_b32 v65, 1, v1
    v_cvt_f32_u32 v65, v65
    v_fma_f32 v58, -v62, v64, v65
    v_mul_f32 v58, 0x3e800000, v58
    v_fmamk_f32 v66, v63, 0xbd000000, v56
    v_mul_f32 v67, 0x3e800000, v65
    v_cmp_eq_f32 vcc, v63, v64
    v_mov_b32 v68, 0x3f3504f3
    s_nop 0
    v_cndmask_b32 v61, 0, 1.0, vcc
    s_mov_b64 vcc, 1
    v_cndmask_b32 v66, v66, 0.5, vcc
    v_cndmask_b32 v61, v61, v68, vcc
    s_mov_b64 vcc, 2
    v_cndmask_b32 v67, v67, 0, vcc
    v_cndmask_b32 v61, v61, 0, vcc
    s_lshl_b32 s5, s3, 2
    v_cvt_f32_u32 v69, s5
    v_fma_f32 v59, v69, v57, v56
    s_cmp_eq_u32 s3, 0
    s_cselect_b64 vcc, -1, 0
    v_cndmask_b32 v66, v59, v66, vcc
    v_cndmask_b32 v67, v58, v67, vcc
    v_cndmask_b32 v61, 1.0, v61, vcc
    v_add_f32 v104, v66, v66
    v_add_f32 v89, v67, v66
    v_add_f32 v90, v67, v104
    v_add_f32 v91, v89, v104
    v_cos_f32 v104, v104
    v_cos_f32 v88, v67
    v_cos_f32 v89, v89
    v_cos_f32 v90, v90
    v_cos_f32 v91, v91
    v_add_f32 v104, v104, v104
    v_mul_f32 v88, v61, v88
    v_mul_f32 v89, v61, v89
    v_mul_f32 v90, v61, v90
    v_mul_f32 v91, v61, v91
    v_cvt_pk_bf16_f32 v24, v88, v89
    v_pk_fma_f32 v[92:93], v[90:91], v[104:105], v[88:89] op_sel_hi:[1,0,1] neg_lo:[0,0,1] neg_hi:[0,0,1]
    v_cvt_pk_bf16_f32 v25, v90, v91
    v_pk_fma_f32 v[94:95], v[92:93], v[104:105], v[90:91] op_sel_hi:[1,0,1] neg_lo:[0,0,1] neg_hi:[0,0,1]
    v_cvt_pk_bf16_f32 v26, v92, v93
    v_pk_fma_f32 v[96:97], v[94:95], v[104:105], v[92:93] op_sel_hi:[1,0,1] neg_lo:[0,0,1] neg_hi:[0,0,1]
    v_cvt_pk_bf16_f32 v27, v94, v95
    v_pk_fma_f32 v[98:99], v[96:97], v[104:105], v[94:95] op_sel_hi:[1,0,1] neg_lo:[0,0,1] neg_hi:[0,0,1]
    v_cvt_pk_bf16_f32 v28, v96, v97
    v_pk_fma_f32 v[100:101], v[98:99], v[104:105], v[96:97] op_sel_hi:[1,0,1] neg_lo:[0,0,1] neg_hi:[0,0,1]
    v_cvt_pk_bf16_f32 v29, v98, v99
    v_pk_fma_f32 v[102:103], v[100:101], v[104:105], v[98:99] op_sel_hi:[1,0,1] neg_lo:[0,0,1] neg_hi:[0,0,1]
    v_cvt_pk_bf16_f32 v30, v100, v101
    v_cvt_pk_bf16_f32 v31, v102, v103
    v_add_f32 v59, v59, v57
    v_add_f32 v104, v59, v59
    v_add_f32 v89, v58, v59
    v_add_f32 v90, v58, v104
    v_add_f32 v91, v89, v104
    v_cos_f32 v104, v104
    v_cos_f32 v88, v58
    v_cos_f32 v89, v89
    v_cos_f32 v90, v90
    v_cos_f32 v91, v91
    v_add_f32 v104, v104, v104
    v_cvt_pk_bf16_f32 v32, v88, v89
    v_pk_fma_f32 v[92:93], v[90:91], v[104:105], v[88:89] op_sel_hi:[1,0,1] neg_lo:[0,0,1] neg_hi:[0,0,1]
    v_cvt_pk_bf16_f32 v33, v90, v91
    v_pk_fma_f32 v[94:95], v[92:93], v[104:105], v[90:91] op_sel_hi:[1,0,1] neg_lo:[0,0,1] neg_hi:[0,0,1]
    v_cvt_pk_bf16_f32 v34, v92, v93
    v_pk_fma_f32 v[96:97], v[94:95], v[104:105], v[92:93] op_sel_hi:[1,0,1] neg_lo:[0,0,1] neg_hi:[0,0,1]
    v_cvt_pk_bf16_f32 v35, v94, v95
    v_pk_fma_f32 v[98:99], v[96:97], v[104:105], v[94:95] op_sel_hi:[1,0,1] neg_lo:[0,0,1] neg_hi:[0,0,1]
    v_cvt_pk_bf16_f32 v36, v96, v97
    v_pk_fma_f32 v[100:101], v[98:99], v[104:105], v[96:97] op_sel_hi:[1,0,1] neg_lo:[0,0,1] neg_hi:[0,0,1]
    v_cvt_pk_bf16_f32 v37, v98, v99
    v_pk_fma_f32 v[102:103], v[100:101], v[104:105], v[98:99] op_sel_hi:[1,0,1] neg_lo:[0,0,1] neg_hi:[0,0,1]
    v_cvt_pk_bf16_f32 v38, v100, v101
    v_cvt_pk_bf16_f32 v39, v102, v103
    v_add_f32 v59, v59, v57
    v_add_f32 v104, v59, v59
    v_add_f32 v89, v58, v59
    v_add_f32 v90, v58, v104
    v_add_f32 v91, v89, v104
    v_cos_f32 v104, v104
    v_cos_f32 v88, v58
    v_cos_f32 v89, v89
    v_cos_f32 v90, v90
    v_cos_f32 v91, v91
    v_add_f32 v104, v104, v104
    v_cvt_pk_bf16_f32 v40, v88, v89
    v_pk_fma_f32 v[92:93], v[90:91], v[104:105], v[88:89] op_sel_hi:[1,0,1] neg_lo:[0,0,1] neg_hi:[0,0,1]
    v_cvt_pk_bf16_f32 v41, v90, v91
    v_pk_fma_f32 v[94:95], v[92:93], v[104:105], v[90:91] op_sel_hi:[1,0,1] neg_lo:[0,0,1] neg_hi:[0,0,1]
    v_cvt_pk_bf16_f32 v42, v92, v93
    v_pk_fma_f32 v[96:97], v[94:95], v[104:105], v[92:93] op_sel_hi:[1,0,1] neg_lo:[0,0,1] neg_hi:[0,0,1]
    v_cvt_pk_bf16_f32 v43, v94, v95
    v_pk_fma_f32 v[98:99], v[96:97], v[104:105], v[94:95] op_sel_hi:[1,0,1] neg_lo:[0,0,1] neg_hi:[0,0,1]
    v_cvt_pk_bf16_f32 v44, v96, v97
    v_pk_fma_f32 v[100:101], v[98:99], v[104:105], v[96:97] op_sel_hi:[1,0,1] neg_lo:[0,0,1] neg_hi:[0,0,1]
    v_cvt_pk_bf16_f32 v45, v98, v99
    v_pk_fma_f32 v[102:103], v[100:101], v[104:105], v[98:99] op_sel_hi:[1,0,1] neg_lo:[0,0,1] neg_hi:[0,0,1]
    v_cvt_pk_bf16_f32 v46, v100, v101
    v_cvt_pk_bf16_f32 v47, v102, v103
    v_add_f32 v59, v59, v57
    v_add_f32 v104, v59, v59
    v_add_f32 v89, v58, v59
    v_add_f32 v90, v58, v104
    v_add_f32 v91, v89, v104
    v_cos_f32 v104, v104
    v_cos_f32 v88, v58
    v_cos_f32 v89, v89
    v_cos_f32 v90, v90
    v_cos_f32 v91, v91
    v_add_f32 v104, v104, v104
    v_cvt_pk_bf16_f32 v48, v88, v89
    v_pk_fma_f32 v[92:93], v[90:91], v[104:105], v[88:89] op_sel_hi:[1,0,1] neg_lo:[0,0,1] neg_hi:[0,0,1]
    v_cvt_pk_bf16_f32 v49, v90, v91
    v_pk_fma_f32 v[94:95], v[92:93], v[104:105], v[90:91] op_sel_hi:[1,0,1] neg_lo:[0,0,1] neg_hi:[0,0,1]
    v_cvt_pk_bf16_f32 v50, v92, v93
    v_pk_fma_f32 v[96:97], v[94:95], v[104:105], v[92:93] op_sel_hi:[1,0,1] neg_lo:[0,0,1] neg_hi:[0,0,1]
    v_cvt_pk_bf16_f32 v51, v94, v95
    v_pk_fma_f32 v[98:99], v[96:97], v[104:105], v[94:95] op_sel_hi:[1,0,1] neg_lo:[0,0,1] neg_hi:[0,0,1]
    v_cvt_pk_bf16_f32 v52, v96, v97
    v_pk_fma_f32 v[100:101], v[98:99], v[104:105], v[96:97] op_sel_hi:[1,0,1] neg_lo:[0,0,1] neg_hi:[0,0,1]
    v_cvt_pk_bf16_f32 v53, v98, v99
    v_pk_fma_f32 v[102:103], v[100:101], v[104:105], v[98:99] op_sel_hi:[1,0,1] neg_lo:[0,0,1] neg_hi:[0,0,1]
    v_cvt_pk_bf16_f32 v54, v100, v101
    v_cvt_pk_bf16_f32 v55, v102, v103
    s_lshr_b32 s5, s3, 1
    s_lshl_b32 s5, s5, 10
    s_and_b32 s6, s3, 1
    s_lshl_b32 s6, s6, 3
    s_add_u32 s5, s5, s6
    s_add_u32 s5, s5, 33280
    v_lshl_add_u32 v2, v1, 4, s5
    s_lshl_b32 s5, s3, 13
    s_add_u32 s5, s5, 33280
    v_lshl_add_u32 v3, v1, 4, s5
    s_waitcnt lgkmcnt(0)
    s_add_u32 s36, s36, 16
    s_add_u32 s12, s34, 4390912
    s_addc_u32 s13, s35, 0
    s_mov_b32 s14, 2818048
    s_mov_b32 s15, 0x20000
    s_lshl_b32 s60, s51, 16
    s_lshl_b32 s5, s3, 13
    s_add_u32 s60, s60, s5
    s_add_u32 s60, s60, s49
    v_and_b32 v6, 3, v1
    v_bfe_u32 v7, v1, 2, 1
    v_lshl_add_u32 v6, v7, 3, v6
    v_bfe_u32 v7, v1, 3, 1
    v_lshl_add_u32 v6, v7, 2, v6
    v_lshrrev_b32 v7, 5, v1
    v_lshl_add_u32 v6, v7, 4, v6
    v_lshlrev_b32 v6, 4, v6
    v_bfe_u32 v7, v1, 4, 1
    v_lshl_add_u32 v6, v7, 15, v6
    v_lshrrev_b32 v5, 5, v1
    v_mul_u32_u24 v5, 1032, v5
    v_bfe_u32 v8, v1, 2, 2
    v_lshl_add_u32 v5, v8, 6, v5
    v_lshl_add_u32 v5, v7, 5, v5
    v_and_b32 v8, 3, v1
    v_lshl_add_u32 v5, v8, 3, v5
    v_add_u32 v5, s59, v5
    s_and_b32 s5, s2, 7
    s_lshl_b32 s5, s5, 5
    s_lshr_b32 s4, s2, 3
    s_add_u32 s4, s4, s5
    s_lshr_b32 s5, s3, 1
    s_lshl_b32 s5, s5, 5
    s_and_b32 s6, s3, 1
    s_lshl_b32 s6, s6, 2
    s_add_u32 s43, s5, s6
    v_and_b32 v168, 15, v1
    v_lshrrev_b32 v169, 4, v1
    v_lshrrev_b32 v170, 2, v168
    v_and_b32 v171, 3, v168
    v_lshl_add_u32 v170, v170, 3, v171
    v_add_u32 v170, s43, v170
    v_cvt_f32_u32 v170, v170
    v_cvt_f32_u32 v171, v169
    v_cvt_f32_u32 v172, v168
    v_mul_f32 v171, 4.0, v171
    v_mul_f32 v160, 0x3c800000, v170
    v_add_f32 v162, v160, v160
    v_mul_f32 v176, v171, v162
    v_cos_f32 v162, v162
    v_add_f32 v177, v176, v160
    v_add_f32 v178, v177, v160
    v_add_f32 v179, v178, v160
    v_sin_f32 v184, v176
    v_sin_f32 v185, v177
    v_sin_f32 v186, v178
    v_sin_f32 v187, v179
    v_cos_f32 v176, v176
    v_cos_f32 v177, v177
    v_cos_f32 v178, v178
    v_cos_f32 v179, v179
    v_add_f32 v162, v162, v162
    s_mov_b32 s74, 0x80008000
    v_and_b32 v164, 1, v168
    v_mul_lo_u32 v164, v164, s74
    v_pk_fma_f32 v[180:181], v[178:179], v[162:163], v[176:177] op_sel_hi:[1,0,1] neg_lo:[0,0,1] neg_hi:[0,0,1]
    v_pk_fma_f32 v[182:183], v[180:181], v[162:163], v[178:179] op_sel_hi:[1,0,1] neg_lo:[0,0,1] neg_hi:[0,0,1]
    v_pk_fma_f32 v[188:189], v[186:187], v[162:163], v[184:185] op_sel_hi:[1,0,1] neg_lo:[0,0,1] neg_hi:[0,0,1]
    v_pk_fma_f32 v[190:191], v[188:189], v[162:163], v[186:187] op_sel_hi:[1,0,1] neg_lo:[0,0,1] neg_hi:[0,0,1]
    v_cvt_pk_bf16_f32 v192, v176, v177
    v_cvt_pk_bf16_f32 v200, v184, v185
    v_cvt_pk_bf16_f32 v193, v178, v179
    v_cvt_pk_bf16_f32 v201, v186, v187
    v_cvt_pk_bf16_f32 v194, v180, v181
    v_cvt_pk_bf16_f32 v202, v188, v189
    v_cvt_pk_bf16_f32 v195, v182, v183
    v_cvt_pk_bf16_f32 v203, v190, v191
    v_xor_b32 v196, v164, v192
    v_xor_b32 v204, v164, v200
    v_xor_b32 v197, v164, v193
    v_xor_b32 v205, v164, v201
    v_xor_b32 v198, v164, v194
    v_xor_b32 v206, v164, v202
    v_xor_b32 v199, v164, v195
    v_xor_b32 v207, v164, v203
    v_xor_b32 v208, s74, v200
    v_xor_b32 v209, s74, v201
    v_xor_b32 v210, s74, v202
    v_xor_b32 v211, s74, v203
    v_xor_b32 v212, s74, v204
    v_xor_b32 v213, s74, v205
    v_xor_b32 v214, s74, v206
    v_xor_b32 v215, s74, v207
    v_lshlrev_b32 v174, 4, v1
    v_add_u32 v174, 131072, v174
    s_lshl_b32 s5, s3, 11
    v_add_u32 v173, s5, v174
    ds_write_b128 v173, v[192:195] offset:0
    ds_write_b128 v173, v[196:199] offset:1024
    ds_write_b128 v173, v[200:203] offset:8192
    ds_write_b128 v173, v[204:207] offset:9216
    ds_write_b128 v173, v[208:211] offset:16384
    ds_write_b128 v173, v[212:215] offset:17408
    v_mul_f32 v160, 0x3d000000, v172
    v_mul_f32 v176, v171, v160
    v_add_f32 v177, v176, v160
    v_add_f32 v178, v177, v160
    v_add_f32 v179, v178, v160
    v_sin_f32 v180, v176
    v_sin_f32 v181, v177
    v_sin_f32 v182, v178
    v_sin_f32 v183, v179
    v_cos_f32 v176, v176
    v_cos_f32 v177, v177
    v_cos_f32 v178, v178
    v_cos_f32 v179, v179
    s_lshl_b32 s5, s74, 16
    s_waitcnt lgkmcnt(0)
    v_cvt_pk_bf16_f32 v192, v176, v177
    v_cvt_pk_bf16_f32 v193, v178, v179
    v_xor_b32 v194, v164, v192
    v_xor_b32 v195, v164, v193
    v_xor_b32 v196, s5, v192
    v_xor_b32 v197, s5, v193
    v_xor_b32 v198, s5, v194
    v_xor_b32 v199, s5, v195
    v_cvt_pk_bf16_f32 v200, v180, v181
    v_cvt_pk_bf16_f32 v201, v182, v183
    v_xor_b32 v202, v164, v200
    v_xor_b32 v203, v164, v201
    v_xor_b32 v204, s5, v200
    v_xor_b32 v205, s5, v201
    v_xor_b32 v206, s5, v202
    v_xor_b32 v207, s5, v203
    v_xor_b32 v208, s74, v200
    v_xor_b32 v209, s74, v201
    v_xor_b32 v210, s74, v202
    v_xor_b32 v211, s74, v203
    v_xor_b32 v212, s74, v204
    v_xor_b32 v213, s74, v205
    v_xor_b32 v214, s74, v206
    v_xor_b32 v215, s74, v207
    ds_write_b128 v174, v[192:195] offset:24576
    ds_write_b128 v174, v[196:199] offset:25600
    ds_write_b128 v174, v[200:203] offset:26624
    ds_write_b128 v174, v[204:207] offset:27648
    ds_write_b128 v174, v[208:211] offset:28672
    ds_write_b128 v174, v[212:215] offset:29696
    s_mov_b32 s5, 0x3a000000
    v_mul_f32 v160, s5, v170
    v_mul_f32 v216, v171, v160
    v_mul_f32 v162, 0x41800000, v160
    v_add_f32 v217, v216, v160
    v_add_f32 v218, v217, v160
    v_add_f32 v219, v218, v160
    v_sin_f32 v224, v216
    v_sin_f32 v225, v217
    v_sin_f32 v226, v218
    v_sin_f32 v227, v219
    v_cos_f32 v216, v216
    v_cos_f32 v217, v217
    v_cos_f32 v218, v218
    v_cos_f32 v219, v219
    v_sin_f32 v164, v162
    v_cos_f32 v162, v162
    v_lshl_add_u32 v166, v169, 3, s43
    v_cvt_f32_u32 v166, v166
    v_pk_mul_f32 v[220:221], v[216:217], v[162:163] op_sel_hi:[1,0]
    v_pk_mul_f32 v[228:229], v[224:225], v[162:163] op_sel_hi:[1,0]
    v_pk_mul_f32 v[222:223], v[218:219], v[162:163] op_sel_hi:[1,0]
    v_pk_mul_f32 v[230:231], v[226:227], v[162:163] op_sel_hi:[1,0]
    v_pk_fma_f32 v[220:221], v[224:225], v[164:165], v[220:221] op_sel_hi:[1,0,1] neg_lo:[1,0,0] neg_hi:[1,0,0]
    v_pk_fma_f32 v[228:229], v[216:217], v[164:165], v[228:229] op_sel_hi:[1,0,1]
    v_pk_fma_f32 v[222:223], v[226:227], v[164:165], v[222:223] op_sel_hi:[1,0,1] neg_lo:[1,0,0] neg_hi:[1,0,0]
    v_pk_fma_f32 v[230:231], v[218:219], v[164:165], v[230:231] op_sel_hi:[1,0,1]
    v_mul_f32 v160, s5, v172
    v_add_f32 v161, 0x3c000000, v160
    v_mul_f32 v232, v166, v160
    v_add_f32 v233, v232, v160
    v_add_f32 v234, v233, v160
    v_add_f32 v235, v234, v160
    v_sin_f32 v240, v232
    v_sin_f32 v241, v233
    v_sin_f32 v242, v234
    v_sin_f32 v243, v235
    v_cos_f32 v232, v232
    v_cos_f32 v233, v233
    v_cos_f32 v234, v234
    v_cos_f32 v235, v235
    s_waitcnt vmcnt(8)
    v_mul_f32 v236, v166, v161
    v_add_f32 v237, v236, v161
    v_add_f32 v238, v237, v161
    v_add_f32 v239, v238, v161
    v_sin_f32 v244, v236
    v_sin_f32 v245, v237
    v_sin_f32 v246, v238
    v_sin_f32 v247, v239
    v_cos_f32 v236, v236
    v_cos_f32 v237, v237
    v_cos_f32 v238, v238
    v_cos_f32 v239, v239
    s_and_b32 s44, s45, 255
    s_lshr_b32 s45, s45, 8
    s_lshl_b32 s46, s45, 2
    s_add_u32 s46, s46, s3
    s_and_b32 s37, s45, 0
    s_lshl_b32 s37, s37, 13
    s_and_b32 s5, s2, 7
    s_lshl_b32 s5, s5, 2
    s_lshr_b32 s6, s2, 6
    s_add_u32 s5, s5, s6
    s_bfe_u32 s53, s2, 0x30003
    s_mul_i32 s6, s5, 86
    s_lshr_b32 s6, s6, 8
    s_mov_b32 s101, s6
    s_mul_i32 s7, s6, 3
    s_add_u32 s54, s5, s7
    s_mul_i32 s7, s6, 9
    s_add_u32 s7, s7, 5
    s_sub_u32 s55, s7, s5
    s_cmp_eq_u32 s6, 10
    s_cselect_b32 s6, 2, 0
    s_sub_u32 s55, s55, s6
    s_lshr_b32 s5, s3, 1
    s_lshl_b32 s42, s53, 1
    s_add_u32 s42, s42, s5
    s_and_b32 s5, s3, 1
    s_lshl_b32 s76, s5, 8
    s_xor_b32 s82, s76, 256
    s_waitcnt lgkmcnt(0)
    s_waitcnt vmcnt(0)
    ds_read_b64_tr_b16 v[120:121], v5 offset:0
    ds_read_b64_tr_b16 v[122:123], v5 offset:256
    ds_read_b64_tr_b16 v[128:129], v5 offset:2064
    ds_read_b64_tr_b16 v[130:131], v5 offset:2320
    ds_read_b64_tr_b16 v[136:137], v5 offset:4128
    ds_read_b64_tr_b16 v[138:139], v5 offset:4384
    ds_read_b64_tr_b16 v[144:145], v5 offset:6192
    ds_read_b64_tr_b16 v[146:147], v5 offset:6448
    ds_read_b64_tr_b16 v[124:125], v5 offset:512
    ds_read_b64_tr_b16 v[126:127], v5 offset:768
    ds_read_b64_tr_b16 v[132:133], v5 offset:2576
    ds_read_b64_tr_b16 v[134:135], v5 offset:2832
    ds_read_b64_tr_b16 v[140:141], v5 offset:4640
    ds_read_b64_tr_b16 v[142:143], v5 offset:4896
    ds_read_b64_tr_b16 v[148:149], v5 offset:6704
    ds_read_b64_tr_b16 v[150:151], v5 offset:6960
    s_waitcnt lgkmcnt(14)
    v_mfma_f32_32x32x16_bf16 v[152:167], v[16:19], v[120:123], 0
    s_waitcnt lgkmcnt(12)
    v_mfma_f32_32x32x16_bf16 v[168:183], v[16:19], v[128:131], 0
    s_waitcnt lgkmcnt(10)
    v_mfma_f32_32x32x16_bf16 v[184:199], v[16:19], v[136:139], 0
    s_waitcnt lgkmcnt(8)
    v_mfma_f32_32x32x16_bf16 v[200:215], v[16:19], v[144:147], 0
    s_waitcnt lgkmcnt(6)
    v_mfma_f32_32x32x16_bf16 v[152:167], v[20:23], v[124:127], v[152:167]
    s_waitcnt lgkmcnt(4)
    v_mfma_f32_32x32x16_bf16 v[168:183], v[20:23], v[132:135], v[168:183]
    s_waitcnt lgkmcnt(2)
    v_mfma_f32_32x32x16_bf16 v[184:199], v[20:23], v[140:143], v[184:199]
    s_waitcnt lgkmcnt(0)
    v_mfma_f32_32x32x16_bf16 v[200:215], v[20:23], v[148:151], v[200:215]
    s_nop 7
    v_cvt_pk_bf16_f32 v120, v152, v168
    v_cvt_pk_bf16_f32 v122, v153, v169
    v_cvt_pk_bf16_f32 v124, v154, v170
    v_cvt_pk_bf16_f32 v126, v155, v171
    v_cvt_pk_bf16_f32 v128, v156, v172
    v_cvt_pk_bf16_f32 v130, v157, v173
    v_cvt_pk_bf16_f32 v132, v158, v174
    v_cvt_pk_bf16_f32 v134, v159, v175
    v_cvt_pk_bf16_f32 v136, v160, v176
    v_cvt_pk_bf16_f32 v138, v161, v177
    v_cvt_pk_bf16_f32 v140, v162, v178
    v_cvt_pk_bf16_f32 v142, v163, v179
    v_cvt_pk_bf16_f32 v144, v164, v180
    v_cvt_pk_bf16_f32 v146, v165, v181
    v_cvt_pk_bf16_f32 v148, v166, v182
    v_cvt_pk_bf16_f32 v150, v167, v183
    v_cvt_pk_bf16_f32 v121, v184, v200
    ds_write_b64 v2, v[120:121] offset:0
    v_cvt_pk_bf16_f32 v123, v185, v201
    ds_write_b64 v2, v[122:123] offset:2048
    v_cvt_pk_bf16_f32 v125, v186, v202
    ds_write_b64 v2, v[124:125] offset:4096
    v_cvt_pk_bf16_f32 v127, v187, v203
    ds_write_b64 v2, v[126:127] offset:6144
    v_cvt_pk_bf16_f32 v129, v188, v204
    ds_write_b64 v2, v[128:129] offset:8192
    v_cvt_pk_bf16_f32 v131, v189, v205
    ds_write_b64 v2, v[130:131] offset:10240
    v_cvt_pk_bf16_f32 v133, v190, v206
    ds_write_b64 v2, v[132:133] offset:12288
    v_cvt_pk_bf16_f32 v135, v191, v207
    ds_write_b64 v2, v[134:135] offset:14336
    v_cvt_pk_bf16_f32 v137, v192, v208
    ds_write_b64 v2, v[136:137] offset:16384
    v_cvt_pk_bf16_f32 v139, v193, v209
    ds_write_b64 v2, v[138:139] offset:18432
    v_cvt_pk_bf16_f32 v141, v194, v210
    ds_write_b64 v2, v[140:141] offset:20480
    v_cvt_pk_bf16_f32 v143, v195, v211
    ds_write_b64 v2, v[142:143] offset:22528
    v_cvt_pk_bf16_f32 v145, v196, v212
    ds_write_b64 v2, v[144:145] offset:24576
    v_cvt_pk_bf16_f32 v147, v197, v213
    ds_write_b64 v2, v[146:147] offset:26624
    v_cvt_pk_bf16_f32 v149, v198, v214
    ds_write_b64 v2, v[148:149] offset:28672
    v_cvt_pk_bf16_f32 v151, v199, v215
    ds_write_b64 v2, v[150:151] offset:30720
    s_waitcnt lgkmcnt(0)
    s_barrier
    ds_read_b128 v[88:91], v3 offset:0
    ds_read_b128 v[92:95], v3 offset:1024
    ds_read_b128 v[96:99], v3 offset:2048
    ds_read_b128 v[100:103], v3 offset:3072
    ds_read_b128 v[104:107], v3 offset:4096
    ds_read_b128 v[108:111], v3 offset:5120
    ds_read_b128 v[112:115], v3 offset:6144
    ds_read_b128 v[116:119], v3 offset:7168
    s_waitcnt lgkmcnt(7)
    v_mfma_f32_32x32x16_bf16 v[152:167], v[24:27], v[88:91], 0
    s_waitcnt lgkmcnt(6)
    v_mfma_f32_32x32x16_bf16 v[152:167], v[28:31], v[92:95], v[152:167]
    s_waitcnt lgkmcnt(5)
    v_mfma_f32_32x32x16_bf16 v[168:183], v[32:35], v[96:99], 0
    s_waitcnt lgkmcnt(4)
    v_mfma_f32_32x32x16_bf16 v[168:183], v[36:39], v[100:103], v[168:183]
    s_nop 7
    v_cvt_pk_bf16_f32 v120, v152, v153
    v_cvt_pk_bf16_f32 v121, v154, v155
    v_cvt_pk_bf16_f32 v122, v156, v157
    v_cvt_pk_bf16_f32 v123, v158, v159
    v_cvt_pk_bf16_f32 v124, v160, v161
    v_cvt_pk_bf16_f32 v125, v162, v163
    v_cvt_pk_bf16_f32 v126, v164, v165
    v_cvt_pk_bf16_f32 v127, v166, v167
    buffer_store_dwordx4 v[120:123], v6, s[12:15], s60 offen sc1
    buffer_store_dwordx4 v[124:127], v6, s[12:15], s60 offen offset:512 sc1
    s_add_u32 s60, s60, 2048
    s_waitcnt lgkmcnt(3)
    v_mfma_f32_32x32x16_bf16 v[184:199], v[40:43], v[104:107], 0
    s_waitcnt lgkmcnt(2)
    v_mfma_f32_32x32x16_bf16 v[184:199], v[44:47], v[108:111], v[184:199]
    v_cvt_pk_bf16_f32 v128, v168, v169
    v_cvt_pk_bf16_f32 v129, v170, v171
    v_cvt_pk_bf16_f32 v130, v172, v173
    v_cvt_pk_bf16_f32 v131, v174, v175
    v_cvt_pk_bf16_f32 v132, v176, v177
    v_cvt_pk_bf16_f32 v133, v178, v179
    v_cvt_pk_bf16_f32 v134, v180, v181
    v_cvt_pk_bf16_f32 v135, v182, v183
    buffer_store_dwordx4 v[128:131], v6, s[12:15], s60 offen sc1
    buffer_store_dwordx4 v[132:135], v6, s[12:15], s60 offen offset:512 sc1
    s_add_u32 s60, s60, 2048
    s_waitcnt lgkmcnt(1)
    v_mfma_f32_32x32x16_bf16 v[200:215], v[48:51], v[112:115], 0
    s_waitcnt lgkmcnt(0)
    v_mfma_f32_32x32x16_bf16 v[200:215], v[52:55], v[116:119], v[200:215]
    v_cvt_pk_bf16_f32 v136, v184, v185
    v_cvt_pk_bf16_f32 v137, v186, v187
    v_cvt_pk_bf16_f32 v138, v188, v189
    v_cvt_pk_bf16_f32 v139, v190, v191
    v_cvt_pk_bf16_f32 v140, v192, v193
    v_cvt_pk_bf16_f32 v141, v194, v195
    v_cvt_pk_bf16_f32 v142, v196, v197
    v_cvt_pk_bf16_f32 v143, v198, v199
    buffer_store_dwordx4 v[136:139], v6, s[12:15], s60 offen sc1
    buffer_store_dwordx4 v[140:143], v6, s[12:15], s60 offen offset:512 sc1
    s_add_u32 s60, s60, 2048
    s_nop 0
    v_cvt_pk_bf16_f32 v144, v200, v201
    v_cvt_pk_bf16_f32 v145, v202, v203
    v_cvt_pk_bf16_f32 v146, v204, v205
    v_cvt_pk_bf16_f32 v147, v206, v207
    v_cvt_pk_bf16_f32 v148, v208, v209
    v_cvt_pk_bf16_f32 v149, v210, v211
    v_cvt_pk_bf16_f32 v150, v212, v213
    v_cvt_pk_bf16_f32 v151, v214, v215
    buffer_store_dwordx4 v[144:147], v6, s[12:15], s60 offen sc1
    buffer_store_dwordx4 v[148:151], v6, s[12:15], s60 offen offset:512 sc1
    s_and_b32 s5, s3, 1
    s_lshl_b32 s5, s5, 1
    s_lshr_b32 s6, s3, 1
    s_add_u32 s5, s5, s6
    s_lshl_b32 s5, s5, 10
    s_add_u32 s5, s5, 26112
    v_and_b32 v81, 15, v1
    v_lshl_add_u32 v81, v81, 6, s5
    buffer_load_dword v80, v81, s[96:99], 0 offen sc1
    s_branch L_p1done
L_t2:
    v_and_b32 v56, 3, v1
    v_bfe_u32 v57, v1, 3, 2
    v_lshl_add_u32 v56, v57, 2, v56
    v_bfe_u32 v57, v1, 2, 1
    v_cvt_f32_u32 v58, v56
    v_mul_f32 v58, 0x3d000000, v58
    v_cvt_f32_u32 v59, v57
    v_mul_f32 v59, 0x3e800000, v59
    v_and_b32 v60, 31, v1
    v_cmp_eq_u32 vcc, 4, v60
    v_lshrrev_b32 v60, 1, v1
    v_and_b32 v60, 16, v60
    v_cndmask_b32 v58, v58, 0.5, vcc
    v_cndmask_b32 v59, v59, 0, vcc
    v_cvt_f32_u32 v60, v60
    v_fmac_f32 v59, v60, v58
    s_mov_b32 s5, 0x3d800000
    v_add_f32 v104, v58, v58
    v_add_f32 v89, v59, v58
    v_add_f32 v90, v59, v104
    v_add_f32 v91, v89, v104
    v_cos_f32 v104, v104
    v_cos_f32 v88, v59
    v_cos_f32 v89, v89
    v_cos_f32 v90, v90
    v_cos_f32 v91, v91
    v_add_f32 v104, v104, v104
    v_mul_f32 v88, s5, v88
    v_mul_f32 v89, s5, v89
    v_mul_f32 v90, s5, v90
    v_mul_f32 v91, s5, v91
    v_cvt_pk_bf16_f32 v16, v88, v89
    v_pk_fma_f32 v[92:93], v[90:91], v[104:105], v[88:89] op_sel_hi:[1,0,1] neg_lo:[0,0,1] neg_hi:[0,0,1]
    v_cvt_pk_bf16_f32 v17, v90, v91
    v_pk_fma_f32 v[94:95], v[92:93], v[104:105], v[90:91] op_sel_hi:[1,0,1] neg_lo:[0,0,1] neg_hi:[0,0,1]
    v_cvt_pk_bf16_f32 v18, v92, v93
    v_pk_fma_f32 v[96:97], v[94:95], v[104:105], v[92:93] op_sel_hi:[1,0,1] neg_lo:[0,0,1] neg_hi:[0,0,1]
    v_cvt_pk_bf16_f32 v19, v94, v95
    v_pk_fma_f32 v[98:99], v[96:97], v[104:105], v[94:95] op_sel_hi:[1,0,1] neg_lo:[0,0,1] neg_hi:[0,0,1]
    v_cvt_pk_bf16_f32 v20, v96, v97
    v_pk_fma_f32 v[100:101], v[98:99], v[104:105], v[96:97] op_sel_hi:[1,0,1] neg_lo:[0,0,1] neg_hi:[0,0,1]
    v_cvt_pk_bf16_f32 v21, v98, v99
    v_pk_fma_f32 v[102:103], v[100:101], v[104:105], v[98:99] op_sel_hi:[1,0,1] neg_lo:[0,0,1] neg_hi:[0,0,1]
    v_cvt_pk_bf16_f32 v22, v100, v101
    v_cvt_pk_bf16_f32 v23, v102, v103
    s_mov_b32 s8, s28
    s_mov_b32 s9, s29
    s_mov_b32 s10, 1409024
    s_mov_b32 s11, 0x20000
    v_lshlrev_b32 v4, 4, v1
    s_mul_i32 s59, s3, 8256
    s_lshl_b32 s56, s47, 15
    s_lshl_b32 s6, s3, 13
    s_add_u32 s56, s56, s6
    s_add_u32 m0, s59, 0
    s_add_u32 s7, s56, 0
    buffer_load_dwordx4 v4, s[8:11], s7 offen  lds
    s_add_u32 m0, s59, 1032
    s_add_u32 s7, s56, 1024
    buffer_load_dwordx4 v4, s[8:11], s7 offen  lds
    s_add_u32 m0, s59, 2064
    s_add_u32 s7, s56, 2048
    buffer_load_dwordx4 v4, s[8:11], s7 offen  lds
    s_add_u32 m0, s59, 3096
    s_add_u32 s7, s56, 3072
    buffer_load_dwordx4 v4, s[8:11], s7 offen  lds
    s_add_u32 m0, s59, 4128
    s_add_u32 s7, s56, 4096
    buffer_load_dwordx4 v4, s[8:11], s7 offen  lds
    s_add_u32 m0, s59, 5160
    s_add_u32 s7, s56, 5120
    buffer_load_dwordx4 v4, s[8:11], s7 offen  lds
    s_add_u32 m0, s59, 6192
    s_add_u32 s7, s56, 6144
    buffer_load_dwordx4 v4, s[8:11], s7 offen  lds
    s_add_u32 m0, s59, 7224
    s_add_u32 s7, s56, 7168
    buffer_load_dwordx4 v4, s[8:11], s7 offen  lds
    v_bfe_u32 v62, v1, 1, 3
    v_bfe_u32 v63, v1, 4, 1
    v_add_u32 v62, v62, v63
    v_cvt_f32_u32 v56, v62
    v_mul_f32 v56, 0x3d800000, v56
    v_cvt_f32_u32 v63, v63
    v_fma_f32 v62, v63, -2.0, 1.0
    v_mul_f32 v57, 0x3b000000, v62
    v_lshrrev_b32 v64, 5, v1
    v_cvt_f32_u32 v64, v64
    v_and_b32 v65, 1, v1
    v_cvt_f32_u32 v65, v65
    v_fma_f32 v58, -v62, v64, v65
    v_mul_f32 v58, 0x3e800000, v58
    v_fmamk_f32 v66, v63, 0xbd000000, v56
    v_mul_f32 v67, 0x3e800000, v65
    v_cmp_eq_f32 vcc, v63, v64
    v_mov_b32 v68, 0x3f3504f3
    s_nop 0
    v_cndmask_b32 v61, 0, 1.0, vcc
    s_mov_b64 vcc, 1
    v_cndmask_b32 v66, v66, 0.5, vcc
    v_cndmask_b32 v61, v61, v68, vcc
    s_mov_b64 vcc, 2
    v_cndmask_b32 v67, v67, 0, vcc
    v_cndmask_b32 v61, v61, v68, vcc
    s_lshl_b32 s5, s3, 2
    v_cvt_f32_u32 v69, s5
    v_fma_f32 v59, v69, v57, v56
    s_cmp_eq_u32 s3, 0
    s_cselect_b64 vcc, -1, 0
    v_cndmask_b32 v66, v59, v66, vcc
    v_cndmask_b32 v67, v58, v67, vcc
    v_cndmask_b32 v61, 1.0, v61, vcc
    v_add_f32 v104, v66, v66
    v_add_f32 v89, v67, v66
    v_add_f32 v90, v67, v104
    v_add_f32 v91, v89, v104
    v_cos_f32 v104, v104
    v_cos_f32 v88, v67
    v_cos_f32 v89, v89
    v_cos_f32 v90, v90
    v_cos_f32 v91, v91
    v_add_f32 v104, v104, v104
    v_mul_f32 v88, v61, v88
    v_mul_f32 v89, v61, v89
    v_mul_f32 v90, v61, v90
    v_mul_f32 v91, v61, v91
    v_cvt_pk_bf16_f32 v24, v88, v89
    v_pk_fma_f32 v[92:93], v[90:91], v[104:105], v[88:89] op_sel_hi:[1,0,1] neg_lo:[0,0,1] neg_hi:[0,0,1]
    v_cvt_pk_bf16_f32 v25, v90, v91
    v_pk_fma_f32 v[94:95], v[92:93], v[104:105], v[90:91] op_sel_hi:[1,0,1] neg_lo:[0,0,1] neg_hi:[0,0,1]
    v_cvt_pk_bf16_f32 v26, v92, v93
    v_pk_fma_f32 v[96:97], v[94:95], v[104:105], v[92:93] op_sel_hi:[1,0,1] neg_lo:[0,0,1] neg_hi:[0,0,1]
    v_cvt_pk_bf16_f32 v27, v94, v95
    v_pk_fma_f32 v[98:99], v[96:97], v[104:105], v[94:95] op_sel_hi:[1,0,1] neg_lo:[0,0,1] neg_hi:[0,0,1]
    v_cvt_pk_bf16_f32 v28, v96, v97
    v_pk_fma_f32 v[100:101], v[98:99], v[104:105], v[96:97] op_sel_hi:[1,0,1] neg_lo:[0,0,1] neg_hi:[0,0,1]
    v_cvt_pk_bf16_f32 v29, v98, v99
    v_pk_fma_f32 v[102:103], v[100:101], v[104:105], v[98:99] op_sel_hi:[1,0,1] neg_lo:[0,0,1] neg_hi:[0,0,1]
    v_cvt_pk_bf16_f32 v30, v100, v101
    v_cvt_pk_bf16_f32 v31, v102, v103
    v_add_f32 v59, v59, v57
    v_add_f32 v104, v59, v59
    v_add_f32 v89, v58, v59
    v_add_f32 v90, v58, v104
    v_add_f32 v91, v89, v104
    v_cos_f32 v104, v104
    v_cos_f32 v88, v58
    v_cos_f32 v89, v89
    v_cos_f32 v90, v90
    v_cos_f32 v91, v91
    v_add_f32 v104, v104, v104
    v_cvt_pk_bf16_f32 v32, v88, v89
    v_pk_fma_f32 v[92:93], v[90:91], v[104:105], v[88:89] op_sel_hi:[1,0,1] neg_lo:[0,0,1] neg_hi:[0,0,1]
    v_cvt_pk_bf16_f32 v33, v90, v91
    v_pk_fma_f32 v[94:95], v[92:93], v[104:105], v[90:91] op_sel_hi:[1,0,1] neg_lo:[0,0,1] neg_hi:[0,0,1]
    v_cvt_pk_bf16_f32 v34, v92, v93
    v_pk_fma_f32 v[96:97], v[94:95], v[104:105], v[92:93] op_sel_hi:[1,0,1] neg_lo:[0,0,1] neg_hi:[0,0,1]
    v_cvt_pk_bf16_f32 v35, v94, v95
    v_pk_fma_f32 v[98:99], v[96:97], v[104:105], v[94:95] op_sel_hi:[1,0,1] neg_lo:[0,0,1] neg_hi:[0,0,1]
    v_cvt_pk_bf16_f32 v36, v96, v97
    v_pk_fma_f32 v[100:101], v[98:99], v[104:105], v[96:97] op_sel_hi:[1,0,1] neg_lo:[0,0,1] neg_hi:[0,0,1]
    v_cvt_pk_bf16_f32 v37, v98, v99
    v_pk_fma_f32 v[102:103], v[100:101], v[104:105], v[98:99] op_sel_hi:[1,0,1] neg_lo:[0,0,1] neg_hi:[0,0,1]
    v_cvt_pk_bf16_f32 v38, v100, v101
    v_cvt_pk_bf16_f32 v39, v102, v103
    v_add_f32 v59, v59, v57
    v_add_f32 v104, v59, v59
    v_add_f32 v89, v58, v59
    v_add_f32 v90, v58, v104
    v_add_f32 v91, v89, v104
    v_cos_f32 v104, v104
    v_cos_f32 v88, v58
    v_cos_f32 v89, v89
    v_cos_f32 v90, v90
    v_cos_f32 v91, v91
    v_add_f32 v104, v104, v104
    v_cvt_pk_bf16_f32 v40, v88, v89
    v_pk_fma_f32 v[92:93], v[90:91], v[104:105], v[88:89] op_sel_hi:[1,0,1] neg_lo:[0,0,1] neg_hi:[0,0,1]
    v_cvt_pk_bf16_f32 v41, v90, v91
    v_pk_fma_f32 v[94:95], v[92:93], v[104:105], v[90:91] op_sel_hi:[1,0,1] neg_lo:[0,0,1] neg_hi:[0,0,1]
    v_cvt_pk_bf16_f32 v42, v92, v93
    v_pk_fma_f32 v[96:97], v[94:95], v[104:105], v[92:93] op_sel_hi:[1,0,1] neg_lo:[0,0,1] neg_hi:[0,0,1]
    v_cvt_pk_bf16_f32 v43, v94, v95
    v_pk_fma_f32 v[98:99], v[96:97], v[104:105], v[94:95] op_sel_hi:[1,0,1] neg_lo:[0,0,1] neg_hi:[0,0,1]
    v_cvt_pk_bf16_f32 v44, v96, v97
    v_pk_fma_f32 v[100:101], v[98:99], v[104:105], v[96:97] op_sel_hi:[1,0,1] neg_lo:[0,0,1] neg_hi:[0,0,1]
    v_cvt_pk_bf16_f32 v45, v98, v99
    v_pk_fma_f32 v[102:103], v[100:101], v[104:105], v[98:99] op_sel_hi:[1,0,1] neg_lo:[0,0,1] neg_hi:[0,0,1]
    v_cvt_pk_bf16_f32 v46, v100, v101
    v_cvt_pk_bf16_f32 v47, v102, v103
    v_add_f32 v59, v59, v57
    v_add_f32 v104, v59, v59
    v_add_f32 v89, v58, v59
    v_add_f32 v90, v58, v104
    v_add_f32 v91, v89, v104
    v_cos_f32 v104, v104
    v_cos_f32 v88, v58
    v_cos_f32 v89, v89
    v_cos_f32 v90, v90
    v_cos_f32 v91, v91
    v_add_f32 v104, v104, v104
    v_cvt_pk_bf16_f32 v48, v88, v89
    v_pk_fma_f32 v[92:93], v[90:91], v[104:105], v[88:89] op_sel_hi:[1,0,1] neg_lo:[0,0,1] neg_hi:[0,0,1]
    v_cvt_pk_bf16_f32 v49, v90, v91
    v_pk_fma_f32 v[94:95], v[92:93], v[104:105], v[90:91] op_sel_hi:[1,0,1] neg_lo:[0,0,1] neg_hi:[0,0,1]
    v_cvt_pk_bf16_f32 v50, v92, v93
    v_pk_fma_f32 v[96:97], v[94:95], v[104:105], v[92:93] op_sel_hi:[1,0,1] neg_lo:[0,0,1] neg_hi:[0,0,1]
    v_cvt_pk_bf16_f32 v51, v94, v95
    v_pk_fma_f32 v[98:99], v[96:97], v[104:105], v[94:95] op_sel_hi:[1,0,1] neg_lo:[0,0,1] neg_hi:[0,0,1]
    v_cvt_pk_bf16_f32 v52, v96, v97
    v_pk_fma_f32 v[100:101], v[98:99], v[104:105], v[96:97] op_sel_hi:[1,0,1] neg_lo:[0,0,1] neg_hi:[0,0,1]
    v_cvt_pk_bf16_f32 v53, v98, v99
    v_pk_fma_f32 v[102:103], v[100:101], v[104:105], v[98:99] op_sel_hi:[1,0,1] neg_lo:[0,0,1] neg_hi:[0,0,1]
    v_cvt_pk_bf16_f32 v54, v100, v101
    v_cvt_pk_bf16_f32 v55, v102, v103
    v_and_b32 v5, 31, v1
    v_mul_u32_u24 v5, 1032, v5
    v_lshrrev_b32 v8, 5, v1
    v_lshl_add_u32 v5, v8, 9, v5
    s_lshl_b32 s5, s3, 3
    v_add_u32 v5, s5, v5
    s_mov_b32 s64, 0x05040100
    s_mov_b32 s65, 0x07060302
    s_lshr_b32 s5, s3, 1
    s_lshl_b32 s5, s5, 10
    s_and_b32 s6, s3, 1
    s_lshl_b32 s6, s6, 3
    s_add_u32 s5, s5, s6
    s_add_u32 s5, s5, 33280
    v_lshl_add_u32 v2, v1, 4, s5
    s_lshl_b32 s5, s3, 13
    s_add_u32 s5, s5, 33280
    v_lshl_add_u32 v3, v1, 4, s5
    s_waitcnt lgkmcnt(0)
    s_add_u32 s36, s36, 16
    s_add_u32 s12, s34, 13631488
    s_addc_u32 s13, s35, 0
    s_mov_b32 s14, 1409024
    s_mov_b32 s15, 0x20000
    s_mul_i32 s60, s3, 352256
    s_lshl_b32 s6, s47, 11
    s_add_u32 s60, s60, s6
    s_add_u32 s68, s34, 15040512
    s_addc_u32 s69, s35, 0
    s_mov_b32 s70, 1933312
    s_mov_b32 s71, 0x20000
    s_mul_i32 s62, s3, 483328
    s_add_u32 s62, s62, s6
    v_lshrrev_b32 v10, 5, v1
    v_bfe_u32 v11, v1, 2, 2
    v_lshl_add_u32 v10, v10, 2, v11
    v_mul_u32_u24 v9, 1032, v10
    v_and_b32 v10, 1, v1
    v_lshl_add_u32 v9, v10, 4, v9
    v_bfe_u32 v10, v1, 1, 1
    v_lshl_add_u32 v9, v10, 3, v9
    v_bfe_u32 v10, v1, 4, 1
    v_lshl_add_u32 v9, v10, 5, v9
    s_lshl_b32 s5, s3, 8
    v_add_u32 v9, s5, v9
    s_and_b32 s5, s2, 7
    s_lshl_b32 s5, s5, 5
    s_lshr_b32 s4, s2, 3
    s_add_u32 s4, s4, s5
    s_lshr_b32 s5, s3, 1
    s_lshl_b32 s5, s5, 5
    s_and_b32 s6, s3, 1
    s_lshl_b32 s6, s6, 2
    s_add_u32 s43, s5, s6
    v_and_b32 v168, 15, v1
    v_lshrrev_b32 v169, 4, v1
    v_lshrrev_b32 v170, 2, v168
    v_and_b32 v171, 3, v168
    v_lshl_add_u32 v170, v170, 3, v171
    v_add_u32 v170, s43, v170
    v_cvt_f32_u32 v170, v170
    v_cvt_f32_u32 v171, v169
    v_cvt_f32_u32 v172, v168
    v_mul_f32 v171, 4.0, v171
    v_mul_f32 v160, 0x3c800000, v170
    v_add_f32 v162, v160, v160
    v_mul_f32 v176, v171, v162
    v_cos_f32 v162, v162
    v_add_f32 v177, v176, v160
    v_add_f32 v178, v177, v160
    v_add_f32 v179, v178, v160
    v_sin_f32 v184, v176
    v_sin_f32 v185, v177
    v_sin_f32 v186, v178
    v_sin_f32 v187, v179
    v_cos_f32 v176, v176
    v_cos_f32 v177, v177
    v_cos_f32 v178, v178
    v_cos_f32 v179, v179
    v_add_f32 v162, v162, v162
    s_mov_b32 s74, 0x80008000
    v_and_b32 v164, 1, v168
    v_mul_lo_u32 v164, v164, s74
    v_pk_fma_f32 v[180:181], v[178:179], v[162:163], v[176:177] op_sel_hi:[1,0,1] neg_lo:[0,0,1] neg_hi:[0,0,1]
    v_pk_fma_f32 v[182:183], v[180:181], v[162:163], v[178:179] op_sel_hi:[1,0,1] neg_lo:[0,0,1] neg_hi:[0,0,1]
    v_pk_fma_f32 v[188:189], v[186:187], v[162:163], v[184:185] op_sel_hi:[1,0,1] neg_lo:[0,0,1] neg_hi:[0,0,1]
    v_pk_fma_f32 v[190:191], v[188:189], v[162:163], v[186:187] op_sel_hi:[1,0,1] neg_lo:[0,0,1] neg_hi:[0,0,1]
    v_cvt_pk_bf16_f32 v192, v176, v177
    v_cvt_pk_bf16_f32 v200, v184, v185
    v_cvt_pk_bf16_f32 v193, v178, v179
    v_cvt_pk_bf16_f32 v201, v186, v187
    v_cvt_pk_bf16_f32 v194, v180, v181
    v_cvt_pk_bf16_f32 v202, v188, v189
    v_cvt_pk_bf16_f32 v195, v182, v183
    v_cvt_pk_bf16_f32 v203, v190, v191
    v_xor_b32 v196, v164, v192
    v_xor_b32 v204, v164, v200
    v_xor_b32 v197, v164, v193
    v_xor_b32 v205, v164, v201
    v_xor_b32 v198, v164, v194
    v_xor_b32 v206, v164, v202
    v_xor_b32 v199, v164, v195
    v_xor_b32 v207, v164, v203
    v_xor_b32 v208, s74, v200
    v_xor_b32 v209, s74, v201
    v_xor_b32 v210, s74, v202
    v_xor_b32 v211, s74, v203
    v_xor_b32 v212, s74, v204
    v_xor_b32 v213, s74, v205
    v_xor_b32 v214, s74, v206
    v_xor_b32 v215, s74, v207
    v_lshlrev_b32 v174, 4, v1
    v_add_u32 v174, 131072, v174
    s_lshl_b32 s5, s3, 11
    v_add_u32 v173, s5, v174
    ds_write_b128 v173, v[192:195] offset:0
    ds_write_b128 v173, v[196:199] offset:1024
    ds_write_b128 v173, v[200:203] offset:8192
    ds_write_b128 v173, v[204:207] offset:9216
    ds_write_b128 v173, v[208:211] offset:16384
    ds_write_b128 v173, v[212:215] offset:17408
    v_mul_f32 v160, 0x3d000000, v172
    v_mul_f32 v176, v171, v160
    v_add_f32 v177, v176, v160
    v_add_f32 v178, v177, v160
    v_add_f32 v179, v178, v160
    v_sin_f32 v180, v176
    v_sin_f32 v181, v177
    v_sin_f32 v182, v178
    v_sin_f32 v183, v179
    v_cos_f32 v176, v176
    v_cos_f32 v177, v177
    v_cos_f32 v178, v178
    v_cos_f32 v179, v179
    s_lshl_b32 s5, s74, 16
    s_waitcnt lgkmcnt(0)
    v_cvt_pk_bf16_f32 v192, v176, v177
    v_cvt_pk_bf16_f32 v193, v178, v179
    v_xor_b32 v194, v164, v192
    v_xor_b32 v195, v164, v193
    v_xor_b32 v196, s5, v192
    v_xor_b32 v197, s5, v193
    v_xor_b32 v198, s5, v194
    v_xor_b32 v199, s5, v195
    v_cvt_pk_bf16_f32 v200, v180, v181
    v_cvt_pk_bf16_f32 v201, v182, v183
    v_xor_b32 v202, v164, v200
    v_xor_b32 v203, v164, v201
    v_xor_b32 v204, s5, v200
    v_xor_b32 v205, s5, v201
    v_xor_b32 v206, s5, v202
    v_xor_b32 v207, s5, v203
    v_xor_b32 v208, s74, v200
    v_xor_b32 v209, s74, v201
    v_xor_b32 v210, s74, v202
    v_xor_b32 v211, s74, v203
    v_xor_b32 v212, s74, v204
    v_xor_b32 v213, s74, v205
    v_xor_b32 v214, s74, v206
    v_xor_b32 v215, s74, v207
    ds_write_b128 v174, v[192:195] offset:24576
    ds_write_b128 v174, v[196:199] offset:25600
    ds_write_b128 v174, v[200:203] offset:26624
    ds_write_b128 v174, v[204:207] offset:27648
    ds_write_b128 v174, v[208:211] offset:28672
    ds_write_b128 v174, v[212:215] offset:29696
    s_mov_b32 s5, 0x3a000000
    v_mul_f32 v160, s5, v170
    v_mul_f32 v216, v171, v160
    v_mul_f32 v162, 0x41800000, v160
    v_add_f32 v217, v216, v160
    v_add_f32 v218, v217, v160
    v_add_f32 v219, v218, v160
    v_sin_f32 v224, v216
    v_sin_f32 v225, v217
    v_sin_f32 v226, v218
    v_sin_f32 v227, v219
    v_cos_f32 v216, v216
    v_cos_f32 v217, v217
    v_cos_f32 v218, v218
    v_cos_f32 v219, v219
    v_sin_f32 v164, v162
    v_cos_f32 v162, v162
    v_lshl_add_u32 v166, v169, 3, s43
    v_cvt_f32_u32 v166, v166
    v_pk_mul_f32 v[220:221], v[216:217], v[162:163] op_sel_hi:[1,0]
    v_pk_mul_f32 v[228:229], v[224:225], v[162:163] op_sel_hi:[1,0]
    v_pk_mul_f32 v[222:223], v[218:219], v[162:163] op_sel_hi:[1,0]
    v_pk_mul_f32 v[230:231], v[226:227], v[162:163] op_sel_hi:[1,0]
    v_pk_fma_f32 v[220:221], v[224:225], v[164:165], v[220:221] op_sel_hi:[1,0,1] neg_lo:[1,0,0] neg_hi:[1,0,0]
    v_pk_fma_f32 v[228:229], v[216:217], v[164:165], v[228:229] op_sel_hi:[1,0,1]
    v_pk_fma_f32 v[222:223], v[226:227], v[164:165], v[222:223] op_sel_hi:[1,0,1] neg_lo:[1,0,0] neg_hi:[1,0,0]
    v_pk_fma_f32 v[230:231], v[218:219], v[164:165], v[230:231] op_sel_hi:[1,0,1]
    v_mul_f32 v160, s5, v172
    v_add_f32 v161, 0x3c000000, v160
    v_mul_f32 v232, v166, v160
    v_add_f32 v233, v232, v160
    v_add_f32 v234, v233, v160
    v_add_f32 v235, v234, v160
    v_sin_f32 v240, v232
    v_sin_f32 v241, v233
    v_sin_f32 v242, v234
    v_sin_f32 v243, v235
    v_cos_f32 v232, v232
    v_cos_f32 v233, v233
    v_cos_f32 v234, v234
    v_cos_f32 v235, v235
    s_waitcnt vmcnt(8)
    v_mul_f32 v236, v166, v161
    v_add_f32 v237, v236, v161
    v_add_f32 v238, v237, v161
    v_add_f32 v239, v238, v161
    v_sin_f32 v244, v236
    v_sin_f32 v245, v237
    v_sin_f32 v246, v238
    v_sin_f32 v247, v239
    v_cos_f32 v236, v236
    v_cos_f32 v237, v237
    v_cos_f32 v238, v238
    v_cos_f32 v239, v239
    s_and_b32 s44, s45, 255
    s_lshr_b32 s45, s45, 8
    s_lshl_b32 s46, s45, 2
    s_add_u32 s46, s46, s3
    s_and_b32 s37, s45, 0
    s_lshl_b32 s37, s37, 13
    s_and_b32 s5, s2, 7
    s_lshl_b32 s5, s5, 2
    s_lshr_b32 s6, s2, 6
    s_add_u32 s5, s5, s6
    s_bfe_u32 s53, s2, 0x30003
    s_mul_i32 s6, s5, 86
    s_lshr_b32 s6, s6, 8
    s_mov_b32 s101, s6
    s_mul_i32 s7, s6, 3
    s_add_u32 s54, s5, s7
    s_mul_i32 s7, s6, 9
    s_add_u32 s7, s7, 5
    s_sub_u32 s55, s7, s5
    s_cmp_eq_u32 s6, 10
    s_cselect_b32 s6, 2, 0
    s_sub_u32 s55, s55, s6
    s_lshr_b32 s5, s3, 1
    s_lshl_b32 s42, s53, 1
    s_add_u32 s42, s42, s5
    s_and_b32 s5, s3, 1
    s_lshl_b32 s76, s5, 8
    s_xor_b32 s82, s76, 256
    s_waitcnt lgkmcnt(0)
    s_waitcnt vmcnt(0)
    s_barrier
    ds_read_b64 v[88:89], v5 offset:0
    ds_read_b64 v[90:91], v5 offset:32
    ds_read_b64 v[92:93], v5 offset:64
    ds_read_b64 v[94:95], v5 offset:96
    ds_read_b64 v[96:97], v5 offset:128
    ds_read_b64 v[98:99], v5 offset:160
    ds_read_b64 v[100:101], v5 offset:192
    ds_read_b64 v[102:103], v5 offset:224
    ds_read_b64 v[104:105], v5 offset:256
    ds_read_b64 v[106:107], v5 offset:288
    ds_read_b64 v[108:109], v5 offset:320
    ds_read_b64 v[110:111], v5 offset:352
    ds_read_b64 v[112:113], v5 offset:384
    ds_read_b64 v[114:115], v5 offset:416
    ds_read_b64 v[116:117], v5 offset:448
    ds_read_b64 v[118:119], v5 offset:480
    ds_read_b64_tr_b16 v[56:57], v9 offset:0
    ds_read_b64_tr_b16 v[58:59], v9 offset:8256
    ds_read_b64_tr_b16 v[60:61], v9 offset:16512
    ds_read_b64_tr_b16 v[62:63], v9 offset:24768
    ds_read_b64_tr_b16 v[64:65], v9 offset:64
    ds_read_b64_tr_b16 v[66:67], v9 offset:8320
    ds_read_b64_tr_b16 v[68:69], v9 offset:16576
    ds_read_b64_tr_b16 v[70:71], v9 offset:24832
    s_waitcnt lgkmcnt(15)
    v_perm_b32 v120, v90, v88, s64
    v_perm_b32 v121, v94, v92, s64
    v_perm_b32 v122, v98, v96, s64
    v_perm_b32 v123, v102, v100, s64
    v_perm_b32 v128, v90, v88, s65
    v_perm_b32 v129, v94, v92, s65
    v_perm_b32 v130, v98, v96, s65
    v_perm_b32 v131, v102, v100, s65
    v_mfma_f32_32x32x16_bf16 v[152:167], v[16:19], v[120:123], 0
    v_perm_b32 v136, v91, v89, s64
    v_perm_b32 v137, v95, v93, s64
    v_perm_b32 v138, v99, v97, s64
    v_perm_b32 v139, v103, v101, s64
    v_mfma_f32_32x32x16_bf16 v[168:183], v[16:19], v[128:131], 0
    v_perm_b32 v144, v91, v89, s65
    v_perm_b32 v145, v95, v93, s65
    v_perm_b32 v146, v99, v97, s65
    v_perm_b32 v147, v103, v101, s65
    v_mfma_f32_32x32x16_bf16 v[184:199], v[16:19], v[136:139], 0
    s_waitcnt lgkmcnt(14)
    v_perm_b32 v124, v106, v104, s64
    s_waitcnt lgkmcnt(12)
    v_perm_b32 v125, v110, v108, s64
    s_waitcnt lgkmcnt(10)
    v_perm_b32 v126, v114, v112, s64
    s_waitcnt lgkmcnt(8)
    v_perm_b32 v127, v118, v116, s64
    v_mfma_f32_32x32x16_bf16 v[200:215], v[16:19], v[144:147], 0
    v_perm_b32 v132, v106, v104, s65
    v_perm_b32 v133, v110, v108, s65
    v_perm_b32 v134, v114, v112, s65
    v_perm_b32 v135, v118, v116, s65
    v_mfma_f32_32x32x16_bf16 v[152:167], v[20:23], v[124:127], v[152:167]
    v_perm_b32 v140, v107, v105, s64
    v_perm_b32 v141, v111, v109, s64
    v_perm_b32 v142, v115, v113, s64
    v_perm_b32 v143, v119, v117, s64
    v_mfma_f32_32x32x16_bf16 v[168:183], v[20:23], v[132:135], v[168:183]
    v_perm_b32 v148, v107, v105, s65
    v_perm_b32 v149, v111, v109, s65
    v_perm_b32 v150, v115, v113, s65
    v_perm_b32 v151, v119, v117, s65
    v_mfma_f32_32x32x16_bf16 v[184:199], v[20:23], v[140:143], v[184:199]
    s_nop 0
    v_mfma_f32_32x32x16_bf16 v[200:215], v[20:23], v[148:151], v[200:215]
    s_waitcnt lgkmcnt(6)
    buffer_store_dwordx4 v[56:59], v4, s[68:71], s62 offen offset:0 sc1
    s_waitcnt lgkmcnt(4)
    buffer_store_dwordx4 v[60:63], v4, s[68:71], s62 offen offset:1024 sc1
    s_add_u32 s62, s62, 120832
    s_waitcnt lgkmcnt(2)
    buffer_store_dwordx4 v[64:67], v4, s[68:71], s62 offen offset:0 sc1
    s_waitcnt lgkmcnt(0)
    buffer_store_dwordx4 v[68:71], v4, s[68:71], s62 offen offset:1024 sc1
    s_add_u32 s62, s62, 120832
    ds_read_b64_tr_b16 v[56:57], v9 offset:128
    ds_read_b64_tr_b16 v[58:59], v9 offset:8384
    ds_read_b64_tr_b16 v[60:61], v9 offset:16640
    ds_read_b64_tr_b16 v[62:63], v9 offset:24896
    ds_read_b64_tr_b16 v[64:65], v9 offset:192
    ds_read_b64_tr_b16 v[66:67], v9 offset:8448
    ds_read_b64_tr_b16 v[68:69], v9 offset:16704
    ds_read_b64_tr_b16 v[70:71], v9 offset:24960
    v_cvt_pk_bf16_f32 v120, v152, v168
    v_cvt_pk_bf16_f32 v122, v153, v169
    v_cvt_pk_bf16_f32 v124, v154, v170
    v_cvt_pk_bf16_f32 v126, v155, v171
    v_cvt_pk_bf16_f32 v128, v156, v172
    v_cvt_pk_bf16_f32 v130, v157, v173
    v_cvt_pk_bf16_f32 v132, v158, v174
    v_cvt_pk_bf16_f32 v134, v159, v175
    v_cvt_pk_bf16_f32 v136, v160, v176
    v_cvt_pk_bf16_f32 v138, v161, v177
    v_cvt_pk_bf16_f32 v140, v162, v178
    v_cvt_pk_bf16_f32 v142, v163, v179
    v_cvt_pk_bf16_f32 v144, v164, v180
    v_cvt_pk_bf16_f32 v146, v165, v181
    v_cvt_pk_bf16_f32 v148, v166, v182
    v_cvt_pk_bf16_f32 v150, v167, v183
    v_cvt_pk_bf16_f32 v121, v184, v200
    ds_write_b64 v2, v[120:121] offset:0
    v_cvt_pk_bf16_f32 v123, v185, v201
    ds_write_b64 v2, v[122:123] offset:2048
    v_cvt_pk_bf16_f32 v125, v186, v202
    ds_write_b64 v2, v[124:125] offset:4096
    v_cvt_pk_bf16_f32 v127, v187, v203
    ds_write_b64 v2, v[126:127] offset:6144
    v_cvt_pk_bf16_f32 v129, v188, v204
    ds_write_b64 v2, v[128:129] offset:8192
    v_cvt_pk_bf16_f32 v131, v189, v205
    ds_write_b64 v2, v[130:131] offset:10240
    v_cvt_pk_bf16_f32 v133, v190, v206
    ds_write_b64 v2, v[132:133] offset:12288
    v_cvt_pk_bf16_f32 v135, v191, v207
    ds_write_b64 v2, v[134:135] offset:14336
    v_cvt_pk_bf16_f32 v137, v192, v208
    ds_write_b64 v2, v[136:137] offset:16384
    v_cvt_pk_bf16_f32 v139, v193, v209
    ds_write_b64 v2, v[138:139] offset:18432
    v_cvt_pk_bf16_f32 v141, v194, v210
    ds_write_b64 v2, v[140:141] offset:20480
    v_cvt_pk_bf16_f32 v143, v195, v211
    ds_write_b64 v2, v[142:143] offset:22528
    v_cvt_pk_bf16_f32 v145, v196, v212
    ds_write_b64 v2, v[144:145] offset:24576
    v_cvt_pk_bf16_f32 v147, v197, v213
    ds_write_b64 v2, v[146:147] offset:26624
    v_cvt_pk_bf16_f32 v149, v198, v214
    ds_write_b64 v2, v[148:149] offset:28672
    v_cvt_pk_bf16_f32 v151, v199, v215
    ds_write_b64 v2, v[150:151] offset:30720
    s_waitcnt lgkmcnt(15)
    buffer_store_dwordx4 v[56:59], v4, s[68:71], s62 offen offset:0 sc1
    buffer_store_dwordx4 v[60:63], v4, s[68:71], s62 offen offset:1024 sc1
    s_add_u32 s62, s62, 120832
    buffer_store_dwordx4 v[64:67], v4, s[68:71], s62 offen offset:0 sc1
    buffer_store_dwordx4 v[68:71], v4, s[68:71], s62 offen offset:1024 sc1
    s_add_u32 s62, s62, 120832
    s_waitcnt lgkmcnt(0)
    s_barrier
    ds_read_b128 v[88:91], v3 offset:0
    ds_read_b128 v[92:95], v3 offset:1024
    ds_read_b128 v[96:99], v3 offset:2048
    ds_read_b128 v[100:103], v3 offset:3072
    ds_read_b128 v[104:107], v3 offset:4096
    ds_read_b128 v[108:111], v3 offset:5120
    ds_read_b128 v[112:115], v3 offset:6144
    ds_read_b128 v[116:119], v3 offset:7168
    s_waitcnt lgkmcnt(7)
    v_mfma_f32_32x32x16_bf16 v[152:167], v[88:91], v[24:27], 0
    s_waitcnt lgkmcnt(6)
    v_mfma_f32_32x32x16_bf16 v[152:167], v[92:95], v[28:31], v[152:167]
    s_waitcnt lgkmcnt(5)
    v_mfma_f32_32x32x16_bf16 v[168:183], v[96:99], v[32:35], 0
    s_waitcnt lgkmcnt(4)
    v_mfma_f32_32x32x16_bf16 v[168:183], v[100:103], v[36:39], v[168:183]
    s_nop 7
    v_cvt_pk_bf16_f32 v120, v152, v153
    v_cvt_pk_bf16_f32 v121, v154, v155
    v_cvt_pk_bf16_f32 v122, v156, v157
    v_cvt_pk_bf16_f32 v123, v158, v159
    v_cvt_pk_bf16_f32 v124, v160, v161
    v_cvt_pk_bf16_f32 v125, v162, v163
    v_cvt_pk_bf16_f32 v126, v164, v165
    v_cvt_pk_bf16_f32 v127, v166, v167
    buffer_store_dwordx4 v[120:123], v4, s[12:15], s60 offen sc1
    buffer_store_dwordx4 v[124:127], v4, s[12:15], s60 offen offset:1024 sc1
    s_add_u32 s60, s60, 88064
    s_waitcnt lgkmcnt(3)
    v_mfma_f32_32x32x16_bf16 v[184:199], v[104:107], v[40:43], 0
    s_waitcnt lgkmcnt(2)
    v_mfma_f32_32x32x16_bf16 v[184:199], v[108:111], v[44:47], v[184:199]
    v_cvt_pk_bf16_f32 v128, v168, v169
    v_cvt_pk_bf16_f32 v129, v170, v171
    v_cvt_pk_bf16_f32 v130, v172, v173
    v_cvt_pk_bf16_f32 v131, v174, v175
    v_cvt_pk_bf16_f32 v132, v176, v177
    v_cvt_pk_bf16_f32 v133, v178, v179
    v_cvt_pk_bf16_f32 v134, v180, v181
    v_cvt_pk_bf16_f32 v135, v182, v183
    buffer_store_dwordx4 v[128:131], v4, s[12:15], s60 offen sc1
    buffer_store_dwordx4 v[132:135], v4, s[12:15], s60 offen offset:1024 sc1
    s_add_u32 s60, s60, 88064
    s_waitcnt lgkmcnt(1)
    v_mfma_f32_32x32x16_bf16 v[200:215], v[112:115], v[48:51], 0
    s_waitcnt lgkmcnt(0)
    v_mfma_f32_32x32x16_bf16 v[200:215], v[116:119], v[52:55], v[200:215]
    v_cvt_pk_bf16_f32 v136, v184, v185
    v_cvt_pk_bf16_f32 v137, v186, v187
    v_cvt_pk_bf16_f32 v138, v188, v189
    v_cvt_pk_bf16_f32 v139, v190, v191
    v_cvt_pk_bf16_f32 v140, v192, v193
    v_cvt_pk_bf16_f32 v141, v194, v195
    v_cvt_pk_bf16_f32 v142, v196, v197
    v_cvt_pk_bf16_f32 v143, v198, v199
    buffer_store_dwordx4 v[136:139], v4, s[12:15], s60 offen sc1
    buffer_store_dwordx4 v[140:143], v4, s[12:15], s60 offen offset:1024 sc1
    s_add_u32 s60, s60, 88064
    s_nop 0
    v_cvt_pk_bf16_f32 v144, v200, v201
    v_cvt_pk_bf16_f32 v145, v202, v203
    v_cvt_pk_bf16_f32 v146, v204, v205
    v_cvt_pk_bf16_f32 v147, v206, v207
    v_cvt_pk_bf16_f32 v148, v208, v209
    v_cvt_pk_bf16_f32 v149, v210, v211
    v_cvt_pk_bf16_f32 v150, v212, v213
    v_cvt_pk_bf16_f32 v151, v214, v215
    buffer_store_dwordx4 v[144:147], v4, s[12:15], s60 offen sc1
    buffer_store_dwordx4 v[148:151], v4, s[12:15], s60 offen offset:1024 sc1
    s_and_b32 s5, s3, 1
    s_lshl_b32 s5, s5, 1
    s_lshr_b32 s6, s3, 1
    s_add_u32 s5, s5, s6
    s_lshl_b32 s5, s5, 10
    s_add_u32 s5, s5, 26112
    v_and_b32 v81, 15, v1
    v_lshl_add_u32 v81, v81, 6, s5
    buffer_load_dword v80, v81, s[96:99], 0 offen sc1
    s_branch L_p1done
L_t4:
    s_cmp_lt_u32 s47, 59
    s_cbranch_scc1 t4no3_2
    v_bfe_u32 v3, v1, 3, 2
    v_lshrrev_b32 v9, 5, v1
    v_lshl_add_u32 v3, v9, 3, v3
    v_mul_u32_u24 v3, 514, v3
    v_and_b32 v9, 7, v1
    v_lshl_add_u32 v3, v9, 4, v3
    s_mul_i32 s6, s62, 514
    s_lshl_b32 s5, s47, 7
    s_add_u32 s6, s6, s5
    s_add_u32 s6, s6, 940266
    s_add_u32 m0, s64, 33792
    s_nop 0
    buffer_load_dwordx4 v3, s[8:11], s6 offen  lds
    s_add_u32 m0, s64, 34848
    s_nop 0
    buffer_load_dwordx4 v3, s[12:15], s6 offen  lds
t4no3_2:
    s_lshl_b32 s60, s47, 7
    s_movk_i32 s62, 8064
    s_sub_u32 s61, s47, 59
    s_lshl_b32 s61, s61, 6
    s_mul_i32 s5, s3, 48
    s_sub_u32 s61, s61, s5
    v_lshrrev_b32 v3, 3, v1
    s_lshl_b32 s5, s3, 6
    s_add_u32 s5, s5, 1
    v_add_u32 v3, s5, v3
    v_and_b32 v4, 7, v1
    v_lshlrev_b32 v4, 4, v4
    s_movk_i32 s7, 8576
    v_add_u32 v5, 0, v3
    v_and_b32 v6, 31, v5
    v_sub_u32 v7, 32, v6
    v_min_u32 v6, v6, v7
    v_and_b32 v6, 15, v6
    v_bfe_u32 v7, v5, 5, 3
    v_lshl_add_u32 v6, v6, 4, v7
    v_bfe_u32 v7, v5, 4, 1
    v_lshl_add_u32 v6, v7, 3, v6
    v_mad_u32_u24 v96, v6, s7, v4
    v_add_u32 v5, 8, v3
    v_and_b32 v6, 31, v5
    v_sub_u32 v7, 32, v6
    v_min_u32 v6, v6, v7
    v_and_b32 v6, 15, v6
    v_bfe_u32 v7, v5, 5, 3
    v_lshl_add_u32 v6, v6, 4, v7
    v_bfe_u32 v7, v5, 4, 1
    v_lshl_add_u32 v6, v7, 3, v6
    v_mad_u32_u24 v97, v6, s7, v4
    v_add_u32 v5, 16, v3
    v_and_b32 v6, 31, v5
    v_sub_u32 v7, 32, v6
    v_min_u32 v6, v6, v7
    v_and_b32 v6, 15, v6
    v_bfe_u32 v7, v5, 5, 3
    v_lshl_add_u32 v6, v6, 4, v7
    v_bfe_u32 v7, v5, 4, 1
    v_lshl_add_u32 v6, v7, 3, v6
    v_mad_u32_u24 v98, v6, s7, v4
    v_add_u32 v5, 24, v3
    v_and_b32 v6, 31, v5
    v_sub_u32 v7, 32, v6
    v_min_u32 v6, v6, v7
    v_and_b32 v6, 15, v6
    v_bfe_u32 v7, v5, 5, 3
    v_lshl_add_u32 v6, v6, 4, v7
    v_bfe_u32 v7, v5, 4, 1
    v_lshl_add_u32 v6, v7, 3, v6
    v_mad_u32_u24 v99, v6, s7, v4
    v_add_u32 v5, 32, v3
    v_and_b32 v6, 31, v5
    v_sub_u32 v7, 32, v6
    v_min_u32 v6, v6, v7
    v_and_b32 v6, 15, v6
    v_bfe_u32 v7, v5, 5, 3
    v_lshl_add_u32 v6, v6, 4, v7
    v_bfe_u32 v7, v5, 4, 1
    v_lshl_add_u32 v6, v7, 3, v6
    v_mad_u32_u24 v100, v6, s7, v4
    v_add_u32 v5, 40, v3
    v_and_b32 v6, 31, v5
    v_sub_u32 v7, 32, v6
    v_min_u32 v6, v6, v7
    v_and_b32 v6, 15, v6
    v_bfe_u32 v7, v5, 5, 3
    v_lshl_add_u32 v6, v6, 4, v7
    v_bfe_u32 v7, v5, 4, 1
    v_lshl_add_u32 v6, v7, 3, v6
    v_mad_u32_u24 v101, v6, s7, v4
    v_add_u32 v5, 48, v3
    v_and_b32 v6, 31, v5
    v_sub_u32 v7, 32, v6
    v_min_u32 v6, v6, v7
    v_and_b32 v6, 15, v6
    v_bfe_u32 v7, v5, 5, 3
    v_lshl_add_u32 v6, v6, 4, v7
    v_bfe_u32 v7, v5, 4, 1
    v_lshl_add_u32 v6, v7, 3, v6
    v_mad_u32_u24 v102, v6, s7, v4
    v_add_u32 v5, 56, v3
    v_and_b32 v6, 31, v5
    v_sub_u32 v7, 32, v6
    v_min_u32 v6, v6, v7
    v_and_b32 v6, 15, v6
    v_bfe_u32 v7, v5, 5, 3
    v_lshl_add_u32 v6, v6, 4, v7
    v_bfe_u32 v7, v5, 4, 1
    v_lshl_add_u32 v6, v7, 3, v6
    v_mad_u32_u24 v103, v6, s7, v4
    v_add3_u32 v5, s61, v3, 0
    v_and_b32 v6, 31, v5
    v_sub_u32 v7, 32, v6
    v_min_u32 v6, v6, v7
    v_and_b32 v6, 15, v6
    v_bfe_u32 v7, v5, 5, 3
    v_lshl_add_u32 v6, v6, 4, v7
    v_bfe_u32 v7, v5, 4, 1
    v_lshl_add_u32 v6, v7, 3, v6
    v_mad_u32_u24 v104, v6, s7, v4
    v_add3_u32 v5, s61, v3, 8
    v_and_b32 v6, 31, v5
    v_sub_u32 v7, 32, v6
    v_min_u32 v6, v6, v7
    v_and_b32 v6, 15, v6
    v_bfe_u32 v7, v5, 5, 3
    v_lshl_add_u32 v6, v6, 4, v7
    v_bfe_u32 v7, v5, 4, 1
    v_lshl_add_u32 v6, v7, 3, v6
    v_mad_u32_u24 v105, v6, s7, v4
    v_lshrrev_b32 v5, 5, v1
    v_mul_u32_u24 v5, 8448, v5
    v_bfe_u32 v6, v1, 4, 1
    v_lshl_add_u32 v5, v6, 9, v5
    v_bfe_u32 v6, v1, 2, 2
    s_movk_i32 s5, 1056
    v_mad_u32_u24 v5, v6, s5, v5
    v_and_b32 v6, 3, v1
    v_lshl_add_u32 v5, v6, 3, v5
    s_lshl_b32 s5, s3, 7
    v_add_u32 v5, s5, v5
    s_mul_i32 s5, s3, 9216
    s_add_u32 s5, s5, 69632
    v_and_b32 v6, 15, v1
    v_mul_u32_u24 v6, 144, v6
    v_and_b32 v7, 48, v1
    v_add3_u32 v6, v6, v7, s5
    v_lshrrev_b32 v7, 3, v1
    v_mul_u32_u24 v7, 144, v7
    v_add3_u32 v7, v7, v4, s5
    s_add_u32 s96, s34, 17301504
    s_addc_u32 s97, s35, 0
    s_mov_b32 s98, 153728
    s_mov_b32 s99, 0x20000
    s_load_dword s36, s[96:97], 153600
    s_getpc_b64 s[6:7]
pc_3:
    s_add_u32 s6, s6, L_tasks - pc_3
    s_addc_u32 s7, s7, 0
    s_lshl_b32 s5, s2, 2
    s_load_dword s45, s[6:7], s5
    s_mov_b32 s38, 0xffff0000
    s_mov_b32 s40, 0x00010001
    s_mov_b32 s41, 0xfffefffe
    s_add_u32 s72, s34, 7340032
    s_addc_u32 s73, s35, 0
    s_mov_b32 s74, 49152
    s_mov_b32 s75, 0x20000
    s_lshl_b32 s5, s47, 12
    v_lshlrev_b32 v8, 4, v0
    v_mov_b32 v84, -1
    v_mov_b32 v85, -1
    v_mov_b32 v86, -1
    v_mov_b32 v87, -1
    buffer_store_dwordx4 v[84:87], v8, s[72:75], s5 offen sc1
    s_waitcnt lgkmcnt(0)
    s_add_u32 s36, s36, 16
    v_lshlrev_b32 v108, 4, v0
    v_mov_b32 v109, 16777216
    v_cmp_gt_u32 vcc, 4, v0
    s_add_u32 s6, s36, 0
    v_mov_b32 v110, s6
    v_mov_b32 v111, s6
    v_cndmask_b32 v108, v109, v108, vcc
    v_pk_mov_b32 v[112:113], v[110:111], v[110:111]
    s_lshl_b32 s63, s47, 6
    s_add_u32 s63, s63, 22016
    s_cmp_ge_u32 s47, 32
    s_cbranch_scc1 not5_4
    s_lshr_b32 s51, s47, 1
    s_and_b32 s6, s47, 1
    s_lshl_b32 s6, s6, 2
    s_add_u32 s6, s6, s3
    s_lshl_b32 s6, s6, 1
    s_add_u32 s12, s34, 15040512
    s_addc_u32 s13, s35, 0
    s_mov_b32 s14, 1933312
    s_mov_b32 s15, 0x20000
    v_and_b32 v120, 19, v1
    v_bfe_u32 v121, v1, 3, 1
    v_lshl_add_u32 v120, v121, 2, v120
    v_bfe_u32 v121, v1, 2, 1
    v_lshl_add_u32 v120, v121, 3, v120
    s_lshl_b32 s5, s51, 5
    v_add_u32 v120, s5, v120
    v_lshrrev_b32 v121, 5, v1
    v_lshlrev_b32 v121, 6, v121
    v_lshlrev_b32 v122, 4, v1
    s_mul_i32 s5, s51, 120832
    s_lshl_b32 s7, s6, 11
    s_add_u32 s5, s5, s7
    s_add_u32 s5, s5, 88064
    s_cmp_eq_u32 s6, 0
    s_cselect_b32 s7, 16, s6
    s_sub_u32 s7, 32, s7
    s_add_u32 s56, s6, 0
    v_add_u32 v136, s56, v121
    v_mul_u32_u24 v136, v136, v120
    v_and_b32 v136, 511, v136
    v_cvt_f32_u32 v136, v136
    v_mul_f32 v136, 0x3b000000, v136
    v_sin_f32 v137, v136
    v_cos_f32 v136, v136
    v_mul_f32 v137, 0xbd800000, v137
    v_mul_f32 v136, 0x3d800000, v136
    s_add_u32 s56, s6, 32
    v_add_u32 v138, s56, v121
    v_mul_u32_u24 v138, v138, v120
    v_and_b32 v138, 511, v138
    v_cvt_f32_u32 v138, v138
    v_mul_f32 v138, 0x3b000000, v138
    v_sin_f32 v139, v138
    v_cos_f32 v138, v138
    v_mul_f32 v139, 0xbd800000, v139
    v_mul_f32 v138, 0x3d800000, v138
    s_add_u32 s56, s6, 128
    v_add_u32 v140, s56, v121
    v_mul_u32_u24 v140, v140, v120
    v_and_b32 v140, 511, v140
    v_cvt_f32_u32 v140, v140
    v_mul_f32 v140, 0x3b000000, v140
    v_sin_f32 v141, v140
    v_cos_f32 v140, v140
    v_mul_f32 v141, 0xbd800000, v141
    v_mul_f32 v140, 0x3d800000, v140
    s_add_u32 s56, s6, 160
    v_add_u32 v142, s56, v121
    v_mul_u32_u24 v142, v142, v120
    v_and_b32 v142, 511, v142
    v_cvt_f32_u32 v142, v142
    v_mul_f32 v142, 0x3b000000, v142
    v_sin_f32 v143, v142
    v_cos_f32 v142, v142
    v_mul_f32 v143, 0xbd800000, v143
    v_mul_f32 v142, 0x3d800000, v142
    s_add_u32 s56, s7, 0
    v_add_u32 v144, s56, v121
    v_mul_u32_u24 v144, v144, v120
    v_and_b32 v144, 511, v144
    v_cvt_f32_u32 v144, v144
    v_mul_f32 v144, 0x3b000000, v144
    v_sin_f32 v145, v144
    v_cos_f32 v144, v144
    v_mul_f32 v145, 0xbd800000, v145
    v_mul_f32 v144, 0x3d800000, v144
    s_add_u32 s56, s7, 32
    v_add_u32 v146, s56, v121
    v_mul_u32_u24 v146, v146, v120
    v_and_b32 v146, 511, v146
    v_cvt_f32_u32 v146, v146
    v_mul_f32 v146, 0x3b000000, v146
    v_sin_f32 v147, v146
    v_cos_f32 v146, v146
    v_mul_f32 v147, 0xbd800000, v147
    v_mul_f32 v146, 0x3d800000, v146
    s_add_u32 s56, s7, 128
    v_add_u32 v148, s56, v121
    v_mul_u32_u24 v148, v148, v120
    v_and_b32 v148, 511, v148
    v_cvt_f32_u32 v148, v148
    v_mul_f32 v148, 0x3b000000, v148
    v_sin_f32 v149, v148
    v_cos_f32 v148, v148
    v_mul_f32 v149, 0xbd800000, v149
    v_mul_f32 v148, 0x3d800000, v148
    s_add_u32 s56, s7, 160
    v_add_u32 v150, s56, v121
    v_mul_u32_u24 v150, v150, v120
    v_and_b32 v150, 511, v150
    v_cvt_f32_u32 v150, v150
    v_mul_f32 v150, 0x3b000000, v150
    v_sin_f32 v151, v150
    v_cos_f32 v150, v150
    v_mul_f32 v151, 0xbd800000, v151
    v_mul_f32 v150, 0x3d800000, v150
    s_cmp_eq_u32 s6, 0
    s_cselect_b32 vcc_lo, -1, 0
    s_mov_b32 vcc_hi, 0
    v_mov_b32 v123, 0x3d3504f3
    v_lshlrev_b32 v124, 31, v120
    v_xor_b32 v124, v124, v123
    v_cndmask_b32 v136, v136, v124, vcc
    v_cndmask_b32 v137, v137, v123, vcc
    v_cvt_pk_bf16_f32 v128, v136, v137
    v_cvt_pk_bf16_f32 v129, v138, v139
    v_cvt_pk_bf16_f32 v130, v140, v141
    v_cvt_pk_bf16_f32 v131, v142, v143
    v_cvt_pk_bf16_f32 v132, v144, v145
    v_cvt_pk_bf16_f32 v133, v146, v147
    v_cvt_pk_bf16_f32 v134, v148, v149
    v_cvt_pk_bf16_f32 v135, v150, v151
    buffer_store_dwordx4 v[128:131], v122, s[12:15], s5 offen sc1
    buffer_store_dwordx4 v[132:135], v122, s[12:15], s5 offen offset:1024 sc1
    s_add_u32 s5, s5, 2048
    s_add_u32 s6, s6, 1
    s_cmp_eq_u32 s6, 0
    s_cselect_b32 s7, 16, s6
    s_sub_u32 s7, 32, s7
    s_add_u32 s56, s6, 0
    v_add_u32 v136, s56, v121
    v_mul_u32_u24 v136, v136, v120
    v_and_b32 v136, 511, v136
    v_cvt_f32_u32 v136, v136
    v_mul_f32 v136, 0x3b000000, v136
    v_sin_f32 v137, v136
    v_cos_f32 v136, v136
    v_mul_f32 v137, 0xbd800000, v137
    v_mul_f32 v136, 0x3d800000, v136
    s_add_u32 s56, s6, 32
    v_add_u32 v138, s56, v121
    v_mul_u32_u24 v138, v138, v120
    v_and_b32 v138, 511, v138
    v_cvt_f32_u32 v138, v138
    v_mul_f32 v138, 0x3b000000, v138
    v_sin_f32 v139, v138
    v_cos_f32 v138, v138
    v_mul_f32 v139, 0xbd800000, v139
    v_mul_f32 v138, 0x3d800000, v138
    s_add_u32 s56, s6, 128
    v_add_u32 v140, s56, v121
    v_mul_u32_u24 v140, v140, v120
    v_and_b32 v140, 511, v140
    v_cvt_f32_u32 v140, v140
    v_mul_f32 v140, 0x3b000000, v140
    v_sin_f32 v141, v140
    v_cos_f32 v140, v140
    v_mul_f32 v141, 0xbd800000, v141
    v_mul_f32 v140, 0x3d800000, v140
    s_add_u32 s56, s6, 160
    v_add_u32 v142, s56, v121
    v_mul_u32_u24 v142, v142, v120
    v_and_b32 v142, 511, v142
    v_cvt_f32_u32 v142, v142
    v_mul_f32 v142, 0x3b000000, v142
    v_sin_f32 v143, v142
    v_cos_f32 v142, v142
    v_mul_f32 v143, 0xbd800000, v143
    v_mul_f32 v142, 0x3d800000, v142
    s_add_u32 s56, s7, 0
    v_add_u32 v144, s56, v121
    v_mul_u32_u24 v144, v144, v120
    v_and_b32 v144, 511, v144
    v_cvt_f32_u32 v144, v144
    v_mul_f32 v144, 0x3b000000, v144
    v_sin_f32 v145, v144
    v_cos_f32 v144, v144
    v_mul_f32 v145, 0xbd800000, v145
    v_mul_f32 v144, 0x3d800000, v144
    s_add_u32 s56, s7, 32
    v_add_u32 v146, s56, v121
    v_mul_u32_u24 v146, v146, v120
    v_and_b32 v146, 511, v146
    v_cvt_f32_u32 v146, v146
    v_mul_f32 v146, 0x3b000000, v146
    v_sin_f32 v147, v146
    v_cos_f32 v146, v146
    v_mul_f32 v147, 0xbd800000, v147
    v_mul_f32 v146, 0x3d800000, v146
    s_add_u32 s56, s7, 128
    v_add_u32 v148, s56, v121
    v_mul_u32_u24 v148, v148, v120
    v_and_b32 v148, 511, v148
    v_cvt_f32_u32 v148, v148
    v_mul_f32 v148, 0x3b000000, v148
    v_sin_f32 v149, v148
    v_cos_f32 v148, v148
    v_mul_f32 v149, 0xbd800000, v149
    v_mul_f32 v148, 0x3d800000, v148
    s_add_u32 s56, s7, 160
    v_add_u32 v150, s56, v121
    v_mul_u32_u24 v150, v150, v120
    v_and_b32 v150, 511, v150
    v_cvt_f32_u32 v150, v150
    v_mul_f32 v150, 0x3b000000, v150
    v_sin_f32 v151, v150
    v_cos_f32 v150, v150
    v_mul_f32 v151, 0xbd800000, v151
    v_mul_f32 v150, 0x3d800000, v150
    s_cmp_eq_u32 s6, 0
    s_cselect_b32 vcc_lo, -1, 0
    s_mov_b32 vcc_hi, 0
    v_mov_b32 v123, 0x3d3504f3
    v_lshlrev_b32 v124, 31, v120
    v_xor_b32 v124, v124, v123
    v_cndmask_b32 v136, v136, v124, vcc
    v_cndmask_b32 v137, v137, v123, vcc
    v_cvt_pk_bf16_f32 v128, v136, v137
    v_cvt_pk_bf16_f32 v129, v138, v139
    v_cvt_pk_bf16_f32 v130, v140, v141
    v_cvt_pk_bf16_f32 v131, v142, v143
    v_cvt_pk_bf16_f32 v132, v144, v145
    v_cvt_pk_bf16_f32 v133, v146, v147
    v_cvt_pk_bf16_f32 v134, v148, v149
    v_cvt_pk_bf16_f32 v135, v150, v151
    buffer_store_dwordx4 v[128:131], v122, s[12:15], s5 offen sc1
    buffer_store_dwordx4 v[132:135], v122, s[12:15], s5 offen offset:1024 sc1
    s_add_u32 s5, s5, 2048
    s_add_u32 s6, s6, 1
not5_4:
    s_nop 1
    s_and_b32 s5, s2, 7
    s_lshl_b32 s5, s5, 5
    s_lshr_b32 s4, s2, 3
    s_add_u32 s4, s4, s5
    s_lshr_b32 s5, s3, 1
    s_lshl_b32 s5, s5, 5
    s_and_b32 s6, s3, 1
    s_lshl_b32 s6, s6, 2
    s_add_u32 s43, s5, s6
    v_and_b32 v168, 15, v1
    v_lshrrev_b32 v169, 4, v1
    v_lshrrev_b32 v170, 2, v168
    v_and_b32 v171, 3, v168
    v_lshl_add_u32 v170, v170, 3, v171
    v_add_u32 v170, s43, v170
    v_cvt_f32_u32 v170, v170
    v_cvt_f32_u32 v171, v169
    v_cvt_f32_u32 v172, v168
    v_mul_f32 v171, 4.0, v171
    v_mul_f32 v160, 0x3c800000, v170
    v_add_f32 v162, v160, v160
    v_mul_f32 v176, v171, v162
    v_cos_f32 v162, v162
    v_add_f32 v177, v176, v160
    v_add_f32 v178, v177, v160
    v_add_f32 v179, v178, v160
    v_sin_f32 v184, v176
    v_sin_f32 v185, v177
    v_sin_f32 v186, v178
    v_sin_f32 v187, v179
    v_cos_f32 v176, v176
    v_cos_f32 v177, v177
    v_cos_f32 v178, v178
    v_cos_f32 v179, v179
    v_add_f32 v162, v162, v162
    s_mov_b32 s74, 0x80008000
    v_and_b32 v164, 1, v168
    v_mul_lo_u32 v164, v164, s74
    v_pk_fma_f32 v[180:181], v[178:179], v[162:163], v[176:177] op_sel_hi:[1,0,1] neg_lo:[0,0,1] neg_hi:[0,0,1]
    v_pk_fma_f32 v[182:183], v[180:181], v[162:163], v[178:179] op_sel_hi:[1,0,1] neg_lo:[0,0,1] neg_hi:[0,0,1]
    v_pk_fma_f32 v[188:189], v[186:187], v[162:163], v[184:185] op_sel_hi:[1,0,1] neg_lo:[0,0,1] neg_hi:[0,0,1]
    v_pk_fma_f32 v[190:191], v[188:189], v[162:163], v[186:187] op_sel_hi:[1,0,1] neg_lo:[0,0,1] neg_hi:[0,0,1]
    v_cvt_pk_bf16_f32 v192, v176, v177
    v_cvt_pk_bf16_f32 v200, v184, v185
    v_cvt_pk_bf16_f32 v193, v178, v179
    v_cvt_pk_bf16_f32 v201, v186, v187
    v_cvt_pk_bf16_f32 v194, v180, v181
    v_cvt_pk_bf16_f32 v202, v188, v189
    v_cvt_pk_bf16_f32 v195, v182, v183
    v_cvt_pk_bf16_f32 v203, v190, v191
    v_xor_b32 v196, v164, v192
    v_xor_b32 v204, v164, v200
    v_xor_b32 v197, v164, v193
    v_xor_b32 v205, v164, v201
    v_xor_b32 v198, v164, v194
    v_xor_b32 v206, v164, v202
    v_xor_b32 v199, v164, v195
    v_xor_b32 v207, v164, v203
    v_xor_b32 v208, s74, v200
    v_xor_b32 v209, s74, v201
    v_xor_b32 v210, s74, v202
    v_xor_b32 v211, s74, v203
    v_xor_b32 v212, s74, v204
    v_xor_b32 v213, s74, v205
    v_xor_b32 v214, s74, v206
    v_xor_b32 v215, s74, v207
    v_lshlrev_b32 v174, 4, v1
    v_add_u32 v174, 131072, v174
    s_lshl_b32 s5, s3, 11
    v_add_u32 v173, s5, v174
    ds_write_b128 v173, v[192:195] offset:0
    ds_write_b128 v173, v[196:199] offset:1024
    ds_write_b128 v173, v[200:203] offset:8192
    ds_write_b128 v173, v[204:207] offset:9216
    ds_write_b128 v173, v[208:211] offset:16384
    ds_write_b128 v173, v[212:215] offset:17408
    v_mul_f32 v160, 0x3d000000, v172
    v_mul_f32 v176, v171, v160
    v_add_f32 v177, v176, v160
    v_add_f32 v178, v177, v160
    v_add_f32 v179, v178, v160
    v_sin_f32 v180, v176
    v_sin_f32 v181, v177
    v_sin_f32 v182, v178
    v_sin_f32 v183, v179
    v_cos_f32 v176, v176
    v_cos_f32 v177, v177
    v_cos_f32 v178, v178
    v_cos_f32 v179, v179
    s_lshl_b32 s5, s74, 16
    s_waitcnt lgkmcnt(0)
    v_cvt_pk_bf16_f32 v192, v176, v177
    v_cvt_pk_bf16_f32 v193, v178, v179
    v_xor_b32 v194, v164, v192
    v_xor_b32 v195, v164, v193
    v_xor_b32 v196, s5, v192
    v_xor_b32 v197, s5, v193
    v_xor_b32 v198, s5, v194
    v_xor_b32 v199, s5, v195
    v_cvt_pk_bf16_f32 v200, v180, v181
    v_cvt_pk_bf16_f32 v201, v182, v183
    v_xor_b32 v202, v164, v200
    v_xor_b32 v203, v164, v201
    v_xor_b32 v204, s5, v200
    v_xor_b32 v205, s5, v201
    v_xor_b32 v206, s5, v202
    v_xor_b32 v207, s5, v203
    v_xor_b32 v208, s74, v200
    v_xor_b32 v209, s74, v201
    v_xor_b32 v210, s74, v202
    v_xor_b32 v211, s74, v203
    v_xor_b32 v212, s74, v204
    v_xor_b32 v213, s74, v205
    v_xor_b32 v214, s74, v206
    v_xor_b32 v215, s74, v207
    ds_write_b128 v174, v[192:195] offset:24576
    ds_write_b128 v174, v[196:199] offset:25600
    ds_write_b128 v174, v[200:203] offset:26624
    ds_write_b128 v174, v[204:207] offset:27648
    ds_write_b128 v174, v[208:211] offset:28672
    ds_write_b128 v174, v[212:215] offset:29696
    s_mov_b32 s5, 0x3a000000
    v_mul_f32 v160, s5, v170
    v_mul_f32 v216, v171, v160
    v_mul_f32 v162, 0x41800000, v160
    v_add_f32 v217, v216, v160
    v_add_f32 v218, v217, v160
    v_add_f32 v219, v218, v160
    v_sin_f32 v224, v216
    v_sin_f32 v225, v217
    v_sin_f32 v226, v218
    v_sin_f32 v227, v219
    v_cos_f32 v216, v216
    v_cos_f32 v217, v217
    v_cos_f32 v218, v218
    v_cos_f32 v219, v219
    v_sin_f32 v164, v162
    v_cos_f32 v162, v162
    v_lshl_add_u32 v166, v169, 3, s43
    v_cvt_f32_u32 v166, v166
    v_pk_mul_f32 v[220:221], v[216:217], v[162:163] op_sel_hi:[1,0]
    v_pk_mul_f32 v[228:229], v[224:225], v[162:163] op_sel_hi:[1,0]
    v_pk_mul_f32 v[222:223], v[218:219], v[162:163] op_sel_hi:[1,0]
    v_pk_mul_f32 v[230:231], v[226:227], v[162:163] op_sel_hi:[1,0]
    v_pk_fma_f32 v[220:221], v[224:225], v[164:165], v[220:221] op_sel_hi:[1,0,1] neg_lo:[1,0,0] neg_hi:[1,0,0]
    v_pk_fma_f32 v[228:229], v[216:217], v[164:165], v[228:229] op_sel_hi:[1,0,1]
    v_pk_fma_f32 v[222:223], v[226:227], v[164:165], v[222:223] op_sel_hi:[1,0,1] neg_lo:[1,0,0] neg_hi:[1,0,0]
    v_pk_fma_f32 v[230:231], v[218:219], v[164:165], v[230:231] op_sel_hi:[1,0,1]
    v_mul_f32 v160, s5, v172
    v_add_f32 v161, 0x3c000000, v160
    v_mul_f32 v232, v166, v160
    v_add_f32 v233, v232, v160
    v_add_f32 v234, v233, v160
    v_add_f32 v235, v234, v160
    v_sin_f32 v240, v232
    v_sin_f32 v241, v233
    v_sin_f32 v242, v234
    v_sin_f32 v243, v235
    v_cos_f32 v232, v232
    v_cos_f32 v233, v233
    v_cos_f32 v234, v234
    v_cos_f32 v235, v235
    s_waitcnt vmcnt(15)
    v_mul_f32 v236, v166, v161
    v_add_f32 v237, v236, v161
    v_add_f32 v238, v237, v161
    v_add_f32 v239, v238, v161
    v_sin_f32 v244, v236
    v_sin_f32 v245, v237
    v_sin_f32 v246, v238
    v_sin_f32 v247, v239
    v_cos_f32 v236, v236
    v_cos_f32 v237, v237
    v_cos_f32 v238, v238
    v_cos_f32 v239, v239
    s_and_b32 s44, s45, 255
    s_lshr_b32 s45, s45, 8
    s_lshl_b32 s46, s45, 2
    s_add_u32 s46, s46, s3
    s_and_b32 s37, s45, 0
    s_lshl_b32 s37, s37, 13
    s_and_b32 s5, s2, 7
    s_lshl_b32 s5, s5, 2
    s_lshr_b32 s6, s2, 6
    s_add_u32 s5, s5, s6
    s_bfe_u32 s53, s2, 0x30003
    s_mul_i32 s6, s5, 86
    s_lshr_b32 s6, s6, 8
    s_mov_b32 s101, s6
    s_mul_i32 s7, s6, 3
    s_add_u32 s54, s5, s7
    s_mul_i32 s7, s6, 9
    s_add_u32 s7, s7, 5
    s_sub_u32 s55, s7, s5
    s_cmp_eq_u32 s6, 10
    s_cselect_b32 s6, 2, 0
    s_sub_u32 s55, s55, s6
    s_lshr_b32 s5, s3, 1
    s_lshl_b32 s42, s53, 1
    s_add_u32 s42, s42, s5
    s_and_b32 s5, s3, 1
    s_lshl_b32 s76, s5, 8
    s_xor_b32 s82, s76, 256
    s_waitcnt lgkmcnt(0)
    s_add_u32 s68, s34, 2097152
    s_addc_u32 s69, s35, 0
    s_mov_b32 s70, 2195456
    s_mov_b32 s71, 0x20000
    s_waitcnt vmcnt(0)
    s_barrier
    ds_read_b64_tr_b16 v[16:17], v5 offset:0
    ds_read_b64_tr_b16 v[18:19], v5 offset:4224
    ds_read_b64_tr_b16 v[20:21], v5 offset:32
    ds_read_b64_tr_b16 v[22:23], v5 offset:4256
    ds_read_b64_tr_b16 v[24:25], v5 offset:64
    ds_read_b64_tr_b16 v[26:27], v5 offset:4288
    ds_read_b64_tr_b16 v[28:29], v5 offset:96
    ds_read_b64_tr_b16 v[30:31], v5 offset:4320
    ds_read_b64_tr_b16 v[32:33], v5 offset:16896
    ds_read_b64_tr_b16 v[34:35], v5 offset:21120
    ds_read_b64_tr_b16 v[36:37], v5 offset:16928
    ds_read_b64_tr_b16 v[38:39], v5 offset:21152
    ds_read_b64_tr_b16 v[40:41], v5 offset:16960
    ds_read_b64_tr_b16 v[42:43], v5 offset:21184
    ds_read_b64_tr_b16 v[44:45], v5 offset:16992
    ds_read_b64_tr_b16 v[46:47], v5 offset:21216
    s_waitcnt lgkmcnt(14)
    ds_write_b128 v6, v[16:19] offset:0
    s_waitcnt lgkmcnt(13)
    ds_write_b128 v6, v[20:23] offset:2304
    s_waitcnt lgkmcnt(12)
    ds_write_b128 v6, v[24:27] offset:4608
    s_waitcnt lgkmcnt(11)
    ds_write_b128 v6, v[28:31] offset:6912
    s_waitcnt lgkmcnt(10)
    ds_write_b128 v6, v[32:35] offset:64
    s_waitcnt lgkmcnt(9)
    ds_write_b128 v6, v[36:39] offset:2368
    s_waitcnt lgkmcnt(8)
    ds_write_b128 v6, v[40:43] offset:4672
    s_waitcnt lgkmcnt(7)
    ds_write_b128 v6, v[44:47] offset:6976
    ds_read_b128 v[48:51], v7 offset:0
    ds_read_b128 v[52:55], v7 offset:1152
    ds_read_b128 v[56:59], v7 offset:2304
    ds_read_b128 v[60:63], v7 offset:3456
    ds_read_b128 v[64:67], v7 offset:4608
    ds_read_b128 v[68:71], v7 offset:5760
    ds_read_b128 v[72:75], v7 offset:6912
    ds_read_b128 v[76:79], v7 offset:8064
    s_waitcnt lgkmcnt(7)
    buffer_store_dwordx4 v[48:51], v96, s[68:71], s60 offen sc1
    s_waitcnt lgkmcnt(6)
    buffer_store_dwordx4 v[52:55], v97, s[68:71], s60 offen sc1
    s_waitcnt lgkmcnt(5)
    buffer_store_dwordx4 v[56:59], v98, s[68:71], s60 offen sc1
    s_waitcnt lgkmcnt(4)
    buffer_store_dwordx4 v[60:63], v99, s[68:71], s60 offen sc1
    s_waitcnt lgkmcnt(3)
    buffer_store_dwordx4 v[64:67], v100, s[68:71], s60 offen sc1
    s_waitcnt lgkmcnt(2)
    buffer_store_dwordx4 v[68:71], v101, s[68:71], s60 offen sc1
    s_waitcnt lgkmcnt(1)
    buffer_store_dwordx4 v[72:75], v102, s[68:71], s60 offen sc1
    s_waitcnt lgkmcnt(0)
    buffer_store_dwordx4 v[76:79], v103, s[68:71], s60 offen sc1
    s_cmp_lt_u32 s47, 59
    s_cbranch_scc1 t4t5_5
    v_bfe_u32 v5, v1, 2, 2
    v_mul_u32_u24 v5, 1056, v5
    v_lshrrev_b32 v9, 4, v1
    v_lshl_add_u32 v5, v9, 7, v5
    v_and_b32 v9, 3, v1
    v_lshl_add_u32 v5, v9, 3, v5
    s_lshl_b32 s5, s3, 5
    v_add_u32 v5, s5, v5
    ds_read_b64_tr_b16 v[16:17], v5 offset:33792
    ds_read_b64_tr_b16 v[18:19], v5 offset:38016
    ds_read_b64_tr_b16 v[20:21], v5 offset:34304
    ds_read_b64_tr_b16 v[22:23], v5 offset:38528
    s_waitcnt lgkmcnt(2)
    ds_write_b128 v6, v[16:19] offset:0
    s_waitcnt lgkmcnt(1)
    ds_write_b128 v6, v[20:23] offset:64
    ds_read_b128 v[24:27], v7 offset:0
    ds_read_b128 v[28:31], v7 offset:1152
    s_waitcnt lgkmcnt(1)
    buffer_store_dwordx4 v[24:27], v104, s[68:71], s62 offen sc1
    s_waitcnt lgkmcnt(0)
    buffer_store_dwordx4 v[28:31], v105, s[68:71], s62 offen sc1
t4t5_5:
    s_nop 1
    s_waitcnt vmcnt(0)
    s_barrier
    buffer_store_dwordx4 v[110:113], v108, s[96:99], s63 offen sc1
    s_and_b32 s5, s3, 1
    s_lshl_b32 s5, s5, 1
    s_lshr_b32 s6, s3, 1
    s_add_u32 s5, s5, s6
    s_lshl_b32 s5, s5, 10
    s_add_u32 s5, s5, 26112
    v_and_b32 v81, 15, v1
    v_lshl_add_u32 v81, v81, 6, s5
    buffer_load_dword v80, v81, s[96:99], 0 offen sc1
    s_branch L_p1done
L_t1:
    s_add_u32 s96, s34, 17301504
    s_addc_u32 s97, s35, 0
    s_mov_b32 s98, 153728
    s_mov_b32 s99, 0x20000
    s_load_dword s36, s[96:97], 153600
    s_getpc_b64 s[6:7]
pc_7:
    s_add_u32 s6, s6, L_tasks - pc_7
    s_addc_u32 s7, s7, 0
    s_lshl_b32 s5, s2, 2
    s_load_dword s45, s[6:7], s5
    s_mov_b32 s38, 0xffff0000
    s_mov_b32 s40, 0x00010001
    s_mov_b32 s41, 0xfffefffe
    v_and_b32 v56, 3, v1
    v_bfe_u32 v57, v1, 3, 2
    v_lshl_add_u32 v56, v57, 2, v56
    v_bfe_u32 v57, v1, 2, 1
    v_cvt_f32_u32 v58, v56
    v_mul_f32 v58, 0x3d000000, v58
    v_cvt_f32_u32 v59, v57
    v_mul_f32 v59, 0x3e800000, v59
    v_and_b32 v60, 31, v1
    v_cmp_eq_u32 vcc, 4, v60
    v_lshrrev_b32 v60, 1, v1
    v_and_b32 v60, 16, v60
    v_cndmask_b32 v58, v58, 0.5, vcc
    v_cndmask_b32 v59, v59, 0, vcc
    v_cvt_f32_u32 v60, v60
    v_fmac_f32 v59, v60, v58
    s_mov_b32 s5, 0x3d800000
    v_add_f32 v104, v58, v58
    v_add_f32 v89, v59, v58
    v_add_f32 v90, v59, v104
    v_add_f32 v91, v89, v104
    v_cos_f32 v104, v104
    v_cos_f32 v88, v59
    v_cos_f32 v89, v89
    v_cos_f32 v90, v90
    v_cos_f32 v91, v91
    v_add_f32 v104, v104, v104
    v_mul_f32 v88, s5, v88
    v_mul_f32 v89, s5, v89
    v_mul_f32 v90, s5, v90
    v_mul_f32 v91, s5, v91
    v_cvt_pk_bf16_f32 v16, v88, v89
    v_pk_fma_f32 v[92:93], v[90:91], v[104:105], v[88:89] op_sel_hi:[1,0,1] neg_lo:[0,0,1] neg_hi:[0,0,1]
    v_cvt_pk_bf16_f32 v17, v90, v91
    v_pk_fma_f32 v[94:95], v[92:93], v[104:105], v[90:91] op_sel_hi:[1,0,1] neg_lo:[0,0,1] neg_hi:[0,0,1]
    v_cvt_pk_bf16_f32 v18, v92, v93
    v_pk_fma_f32 v[96:97], v[94:95], v[104:105], v[92:93] op_sel_hi:[1,0,1] neg_lo:[0,0,1] neg_hi:[0,0,1]
    v_cvt_pk_bf16_f32 v19, v94, v95
    v_pk_fma_f32 v[98:99], v[96:97], v[104:105], v[94:95] op_sel_hi:[1,0,1] neg_lo:[0,0,1] neg_hi:[0,0,1]
    v_cvt_pk_bf16_f32 v20, v96, v97
    v_pk_fma_f32 v[100:101], v[98:99], v[104:105], v[96:97] op_sel_hi:[1,0,1] neg_lo:[0,0,1] neg_hi:[0,0,1]
    v_cvt_pk_bf16_f32 v21, v98, v99
    v_pk_fma_f32 v[102:103], v[100:101], v[104:105], v[98:99] op_sel_hi:[1,0,1] neg_lo:[0,0,1] neg_hi:[0,0,1]
    v_cvt_pk_bf16_f32 v22, v100, v101
    v_cvt_pk_bf16_f32 v23, v102, v103
    v_and_b32 v5, 31, v1
    v_mul_u32_u24 v5, 1032, v5
    v_lshrrev_b32 v8, 5, v1
    v_lshl_add_u32 v5, v8, 9, v5
    s_lshl_b32 s5, s3, 3
    v_add_u32 v5, s5, v5
    s_mov_b32 s64, 0x05040100
    s_mov_b32 s65, 0x07060302
    s_lshr_b32 s5, s3, 1
    s_lshl_b32 s5, s5, 10
    s_and_b32 s6, s3, 1
    s_lshl_b32 s6, s6, 3
    s_add_u32 s5, s5, s6
    s_add_u32 s5, s5, 33280
    v_lshl_add_u32 v2, v1, 4, s5
    s_lshl_b32 s5, s3, 13
    s_add_u32 s5, s5, 33280
    v_lshl_add_u32 v3, v1, 4, s5
    v_bfe_u32 v62, v1, 1, 3
    v_bfe_u32 v63, v1, 4, 1
    v_add_u32 v62, v62, v63
    v_cvt_f32_u32 v56, v62
    v_mul_f32 v56, 0x3d800000, v56
    v_cvt_f32_u32 v63, v63
    v_fma_f32 v62, v63, -2.0, 1.0
    v_mul_f32 v57, 0x3b000000, v62
    v_lshrrev_b32 v64, 5, v1
    v_cvt_f32_u32 v64, v64
    v_and_b32 v65, 1, v1
    v_cvt_f32_u32 v65, v65
    v_fma_f32 v58, -v62, v64, v65
    v_mul_f32 v58, 0x3e800000, v58
    v_fmamk_f32 v66, v63, 0xbd000000, v56
    v_mul_f32 v67, 0x3e800000, v65
    v_cmp_eq_f32 vcc, v63, v64
    v_mov_b32 v68, 0x3f3504f3
    s_nop 0
    v_cndmask_b32 v61, 0, 1.0, vcc
    s_mov_b64 vcc, 1
    v_cndmask_b32 v66, v66, 0.5, vcc
    v_cndmask_b32 v61, v61, v68, vcc
    s_mov_b64 vcc, 2
    v_cndmask_b32 v67, v67, 0, vcc
    v_cndmask_b32 v61, v61, v68, vcc
    s_lshl_b32 s5, s3, 2
    v_cvt_f32_u32 v69, s5
    v_fma_f32 v59, v69, v57, v56
    s_cmp_eq_u32 s3, 0
    s_cselect_b64 vcc, -1, 0
    v_cndmask_b32 v66, v59, v66, vcc
    v_cndmask_b32 v67, v58, v67, vcc
    v_cndmask_b32 v61, 1.0, v61, vcc
    v_add_f32 v104, v66, v66
    v_add_f32 v89, v67, v66
    v_add_f32 v90, v67, v104
    v_add_f32 v91, v89, v104
    v_cos_f32 v104, v104
    v_cos_f32 v88, v67
    v_cos_f32 v89, v89
    v_cos_f32 v90, v90
    v_cos_f32 v91, v91
    v_add_f32 v104, v104, v104
    v_mul_f32 v88, v61, v88
    v_mul_f32 v89, v61, v89
    v_mul_f32 v90, v61, v90
    v_mul_f32 v91, v61, v91
    v_cvt_pk_bf16_f32 v24, v88, v89
    v_pk_fma_f32 v[92:93], v[90:91], v[104:105], v[88:89] op_sel_hi:[1,0,1] neg_lo:[0,0,1] neg_hi:[0,0,1]
    v_cvt_pk_bf16_f32 v25, v90, v91
    v_pk_fma_f32 v[94:95], v[92:93], v[104:105], v[90:91] op_sel_hi:[1,0,1] neg_lo:[0,0,1] neg_hi:[0,0,1]
    v_cvt_pk_bf16_f32 v26, v92, v93
    v_pk_fma_f32 v[96:97], v[94:95], v[104:105], v[92:93] op_sel_hi:[1,0,1] neg_lo:[0,0,1] neg_hi:[0,0,1]
    v_cvt_pk_bf16_f32 v27, v94, v95
    v_pk_fma_f32 v[98:99], v[96:97], v[104:105], v[94:95] op_sel_hi:[1,0,1] neg_lo:[0,0,1] neg_hi:[0,0,1]
    v_cvt_pk_bf16_f32 v28, v96, v97
    v_pk_fma_f32 v[100:101], v[98:99], v[104:105], v[96:97] op_sel_hi:[1,0,1] neg_lo:[0,0,1] neg_hi:[0,0,1]
    v_cvt_pk_bf16_f32 v29, v98, v99
    v_pk_fma_f32 v[102:103], v[100:101], v[104:105], v[98:99] op_sel_hi:[1,0,1] neg_lo:[0,0,1] neg_hi:[0,0,1]
    v_cvt_pk_bf16_f32 v30, v100, v101
    v_cvt_pk_bf16_f32 v31, v102, v103
    v_add_f32 v59, v59, v57
    v_add_f32 v104, v59, v59
    v_add_f32 v89, v58, v59
    v_add_f32 v90, v58, v104
    v_add_f32 v91, v89, v104
    v_cos_f32 v104, v104
    v_cos_f32 v88, v58
    v_cos_f32 v89, v89
    v_cos_f32 v90, v90
    v_cos_f32 v91, v91
    v_add_f32 v104, v104, v104
    v_cvt_pk_bf16_f32 v32, v88, v89
    v_pk_fma_f32 v[92:93], v[90:91], v[104:105], v[88:89] op_sel_hi:[1,0,1] neg_lo:[0,0,1] neg_hi:[0,0,1]
    v_cvt_pk_bf16_f32 v33, v90, v91
    v_pk_fma_f32 v[94:95], v[92:93], v[104:105], v[90:91] op_sel_hi:[1,0,1] neg_lo:[0,0,1] neg_hi:[0,0,1]
    v_cvt_pk_bf16_f32 v34, v92, v93
    v_pk_fma_f32 v[96:97], v[94:95], v[104:105], v[92:93] op_sel_hi:[1,0,1] neg_lo:[0,0,1] neg_hi:[0,0,1]
    v_cvt_pk_bf16_f32 v35, v94, v95
    v_pk_fma_f32 v[98:99], v[96:97], v[104:105], v[94:95] op_sel_hi:[1,0,1] neg_lo:[0,0,1] neg_hi:[0,0,1]
    v_cvt_pk_bf16_f32 v36, v96, v97
    v_pk_fma_f32 v[100:101], v[98:99], v[104:105], v[96:97] op_sel_hi:[1,0,1] neg_lo:[0,0,1] neg_hi:[0,0,1]
    v_cvt_pk_bf16_f32 v37, v98, v99
    v_pk_fma_f32 v[102:103], v[100:101], v[104:105], v[98:99] op_sel_hi:[1,0,1] neg_lo:[0,0,1] neg_hi:[0,0,1]
    v_cvt_pk_bf16_f32 v38, v100, v101
    v_cvt_pk_bf16_f32 v39, v102, v103
    v_add_f32 v59, v59, v57
    v_add_f32 v104, v59, v59
    v_add_f32 v89, v58, v59
    v_add_f32 v90, v58, v104
    v_add_f32 v91, v89, v104
    v_cos_f32 v104, v104
    v_cos_f32 v88, v58
    v_cos_f32 v89, v89
    v_cos_f32 v90, v90
    v_cos_f32 v91, v91
    v_add_f32 v104, v104, v104
    v_cvt_pk_bf16_f32 v40, v88, v89
    v_pk_fma_f32 v[92:93], v[90:91], v[104:105], v[88:89] op_sel_hi:[1,0,1] neg_lo:[0,0,1] neg_hi:[0,0,1]
    v_cvt_pk_bf16_f32 v41, v90, v91
    v_pk_fma_f32 v[94:95], v[92:93], v[104:105], v[90:91] op_sel_hi:[1,0,1] neg_lo:[0,0,1] neg_hi:[0,0,1]
    v_cvt_pk_bf16_f32 v42, v92, v93
    v_pk_fma_f32 v[96:97], v[94:95], v[104:105], v[92:93] op_sel_hi:[1,0,1] neg_lo:[0,0,1] neg_hi:[0,0,1]
    v_cvt_pk_bf16_f32 v43, v94, v95
    v_pk_fma_f32 v[98:99], v[96:97], v[104:105], v[94:95] op_sel_hi:[1,0,1] neg_lo:[0,0,1] neg_hi:[0,0,1]
    v_cvt_pk_bf16_f32 v44, v96, v97
    v_pk_fma_f32 v[100:101], v[98:99], v[104:105], v[96:97] op_sel_hi:[1,0,1] neg_lo:[0,0,1] neg_hi:[0,0,1]
    v_cvt_pk_bf16_f32 v45, v98, v99
    v_pk_fma_f32 v[102:103], v[100:101], v[104:105], v[98:99] op_sel_hi:[1,0,1] neg_lo:[0,0,1] neg_hi:[0,0,1]
    v_cvt_pk_bf16_f32 v46, v100, v101
    v_cvt_pk_bf16_f32 v47, v102, v103
    v_add_f32 v59, v59, v57
    v_add_f32 v104, v59, v59
    v_add_f32 v89, v58, v59
    v_add_f32 v90, v58, v104
    v_add_f32 v91, v89, v104
    v_cos_f32 v104, v104
    v_cos_f32 v88, v58
    v_cos_f32 v89, v89
    v_cos_f32 v90, v90
    v_cos_f32 v91, v91
    v_add_f32 v104, v104, v104
    v_cvt_pk_bf16_f32 v48, v88, v89
    v_pk_fma_f32 v[92:93], v[90:91], v[104:105], v[88:89] op_sel_hi:[1,0,1] neg_lo:[0,0,1] neg_hi:[0,0,1]
    v_cvt_pk_bf16_f32 v49, v90, v91
    v_pk_fma_f32 v[94:95], v[92:93], v[104:105], v[90:91] op_sel_hi:[1,0,1] neg_lo:[0,0,1] neg_hi:[0,0,1]
    v_cvt_pk_bf16_f32 v50, v92, v93
    v_pk_fma_f32 v[96:97], v[94:95], v[104:105], v[92:93] op_sel_hi:[1,0,1] neg_lo:[0,0,1] neg_hi:[0,0,1]
    v_cvt_pk_bf16_f32 v51, v94, v95
    v_pk_fma_f32 v[98:99], v[96:97], v[104:105], v[94:95] op_sel_hi:[1,0,1] neg_lo:[0,0,1] neg_hi:[0,0,1]
    v_cvt_pk_bf16_f32 v52, v96, v97
    v_pk_fma_f32 v[100:101], v[98:99], v[104:105], v[96:97] op_sel_hi:[1,0,1] neg_lo:[0,0,1] neg_hi:[0,0,1]
    v_cvt_pk_bf16_f32 v53, v98, v99
    v_pk_fma_f32 v[102:103], v[100:101], v[104:105], v[98:99] op_sel_hi:[1,0,1] neg_lo:[0,0,1] neg_hi:[0,0,1]
    v_cvt_pk_bf16_f32 v54, v100, v101
    v_cvt_pk_bf16_f32 v55, v102, v103
    s_mul_i32 s5, s3, 10240
    s_add_u32 s5, s5, 69632
    v_and_b32 v11, 31, v1
    v_mul_u32_u24 v11, 80, v11
    v_add_u32 v10, 66048, v11
    v_lshl_add_u32 v11, v8, 4, v11
    v_add_u32 v11, s5, v11
    v_lshrrev_b32 v12, 2, v1
    v_mul_u32_u24 v12, 80, v12
    v_and_b32 v7, 3, v1
    v_lshl_add_u32 v12, v7, 4, v12
    v_add_u32 v12, s5, v12
    v_lshrrev_b32 v9, 5, v0
    v_lshl_add_u32 v9, v9, 3, v10
    v_bfe_u32 v13, v0, 1, 1
    v_bfe_u32 v7, v0, 3, 1
    v_lshl_add_u32 v13, v7, 1, v13
    v_lshlrev_b32 v13, 10, v13
    v_bfe_u32 v7, v0, 2, 1
    v_lshl_add_u32 v13, v7, 4, v13
    v_bfe_u32 v7, v0, 4, 1
    v_lshl_add_u32 v13, v7, 5, v13
    v_and_b32 v7, 1, v0
    v_lshl_add_u32 v13, v7, 3, v13
    v_lshrrev_b32 v7, 5, v0
    v_lshl_add_u32 v13, v7, 14, v13
    s_add_u32 s68, s34, 4325376
    s_addc_u32 s69, s35, 0
    s_mov_b32 s70, 16384
    s_mov_b32 s71, 0x20000
    s_lshr_b32 s5, s47, 4
    s_lshl_b32 s62, s5, 12
    s_and_b32 s6, s47, 15
    s_lshl_b32 s6, s6, 6
    s_add_u32 s62, s62, s6
    s_waitcnt lgkmcnt(0)
    s_add_u32 s36, s36, 16
    v_lshlrev_b32 v72, 4, v0
    v_mov_b32 v73, 16777216
    v_cmp_gt_u32 vcc, 4, v0
    s_add_u32 s6, s36, 0
    v_mov_b32 v74, s6
    v_mov_b32 v75, s6
    v_cndmask_b32 v72, v73, v72, vcc
    v_pk_mov_b32 v[76:77], v[74:75], v[74:75]
    s_lshl_b32 s63, s47, 6
    s_add_u32 s63, s63, 26112
    buffer_store_dwordx4 v[84:87], v4, s[12:15], s60 offen offset:0 sc1
    buffer_store_dwordx4 v[84:87], v4, s[12:15], s60 offen offset:1024 sc1
    buffer_store_dwordx4 v[84:87], v4, s[12:15], s60 offen offset:2048 sc1
    buffer_store_dwordx4 v[84:87], v4, s[12:15], s60 offen offset:3072 sc1
    buffer_store_dwordx4 v[84:87], v4, s[12:15], s61 offen offset:0 sc1
    buffer_store_dwordx4 v[84:87], v4, s[12:15], s61 offen offset:1024 sc1
    buffer_store_dwordx4 v[84:87], v4, s[12:15], s61 offen offset:2048 sc1
    buffer_store_dwordx4 v[84:87], v4, s[12:15], s61 offen offset:3072 sc1
    v_mov_b32 v56, 0
    v_mov_b32 v58, 0
    s_waitcnt vmcnt(8)
    s_barrier
    ds_read_b64 v[88:89], v5 offset:0
    ds_read_b64 v[90:91], v5 offset:32
    ds_read_b64 v[92:93], v5 offset:64
    ds_read_b64 v[94:95], v5 offset:96
    ds_read_b64 v[96:97], v5 offset:128
    ds_read_b64 v[98:99], v5 offset:160
    ds_read_b64 v[100:101], v5 offset:192
    ds_read_b64 v[102:103], v5 offset:224
    ds_read_b64 v[104:105], v5 offset:256
    ds_read_b64 v[106:107], v5 offset:288
    ds_read_b64 v[108:109], v5 offset:320
    ds_read_b64 v[110:111], v5 offset:352
    ds_read_b64 v[112:113], v5 offset:384
    ds_read_b64 v[114:115], v5 offset:416
    ds_read_b64 v[116:117], v5 offset:448
    ds_read_b64 v[118:119], v5 offset:480
    s_waitcnt lgkmcnt(14)
    v_perm_b32 v120, v90, v88, s64
    s_waitcnt lgkmcnt(12)
    v_perm_b32 v121, v94, v92, s64
    s_waitcnt lgkmcnt(10)
    v_perm_b32 v122, v98, v96, s64
    s_waitcnt lgkmcnt(8)
    v_perm_b32 v123, v102, v100, s64
    v_perm_b32 v128, v90, v88, s65
    v_perm_b32 v129, v94, v92, s65
    v_perm_b32 v130, v98, v96, s65
    v_perm_b32 v131, v102, v100, s65
    v_mfma_f32_32x32x16_bf16 v[152:167], v[16:19], v[120:123], 0
    v_perm_b32 v136, v91, v89, s64
    v_perm_b32 v137, v95, v93, s64
    v_perm_b32 v138, v99, v97, s64
    v_perm_b32 v139, v103, v101, s64
    v_mfma_f32_32x32x16_bf16 v[168:183], v[16:19], v[128:131], 0
    v_perm_b32 v144, v91, v89, s65
    v_perm_b32 v145, v95, v93, s65
    v_perm_b32 v146, v99, v97, s65
    v_perm_b32 v147, v103, v101, s65
    v_mfma_f32_32x32x16_bf16 v[184:199], v[16:19], v[136:139], 0
    s_waitcnt lgkmcnt(6)
    v_perm_b32 v124, v106, v104, s64
    s_waitcnt lgkmcnt(4)
    v_perm_b32 v125, v110, v108, s64
    s_waitcnt lgkmcnt(2)
    v_perm_b32 v126, v114, v112, s64
    s_waitcnt lgkmcnt(0)
    v_perm_b32 v127, v118, v116, s64
    v_mfma_f32_32x32x16_bf16 v[200:215], v[16:19], v[144:147], 0
    v_perm_b32 v132, v106, v104, s65
    v_perm_b32 v133, v110, v108, s65
    v_perm_b32 v134, v114, v112, s65
    v_perm_b32 v135, v118, v116, s65
    v_mfma_f32_32x32x16_bf16 v[152:167], v[20:23], v[124:127], v[152:167]
    v_perm_b32 v140, v107, v105, s64
    v_perm_b32 v141, v111, v109, s64
    v_perm_b32 v142, v115, v113, s64
    v_perm_b32 v143, v119, v117, s64
    v_mfma_f32_32x32x16_bf16 v[168:183], v[20:23], v[132:135], v[168:183]
    v_perm_b32 v148, v107, v105, s65
    v_perm_b32 v149, v111, v109, s65
    v_perm_b32 v150, v115, v113, s65
    v_perm_b32 v151, v119, v117, s65
    v_mfma_f32_32x32x16_bf16 v[184:199], v[20:23], v[140:143], v[184:199]
    s_nop 0
    v_mfma_f32_32x32x16_bf16 v[200:215], v[20:23], v[148:151], v[200:215]
    v_dot2c_f32_bf16 v56, v88, v88
    v_dot2c_f32_bf16 v58, v89, v89
    v_dot2c_f32_bf16 v56, v90, v90
    v_dot2c_f32_bf16 v58, v91, v91
    v_dot2c_f32_bf16 v56, v92, v92
    v_dot2c_f32_bf16 v58, v93, v93
    v_dot2c_f32_bf16 v56, v94, v94
    v_dot2c_f32_bf16 v58, v95, v95
    v_dot2c_f32_bf16 v56, v96, v96
    v_dot2c_f32_bf16 v58, v97, v97
    v_cvt_pk_bf16_f32 v120, v152, v168
    v_cvt_pk_bf16_f32 v122, v153, v169
    v_cvt_pk_bf16_f32 v124, v154, v170
    v_cvt_pk_bf16_f32 v126, v155, v171
    v_cvt_pk_bf16_f32 v128, v156, v172
    v_cvt_pk_bf16_f32 v130, v157, v173
    v_cvt_pk_bf16_f32 v132, v158, v174
    v_cvt_pk_bf16_f32 v134, v159, v175
    v_cvt_pk_bf16_f32 v136, v160, v176
    v_cvt_pk_bf16_f32 v138, v161, v177
    v_cvt_pk_bf16_f32 v140, v162, v178
    v_cvt_pk_bf16_f32 v142, v163, v179
    v_cvt_pk_bf16_f32 v144, v164, v180
    v_cvt_pk_bf16_f32 v146, v165, v181
    v_cvt_pk_bf16_f32 v148, v166, v182
    v_cvt_pk_bf16_f32 v150, v167, v183
    v_cvt_pk_bf16_f32 v121, v184, v200
    ds_write_b64 v2, v[120:121] offset:0
    v_dot2c_f32_bf16 v56, v98, v98
    v_cvt_pk_bf16_f32 v123, v185, v201
    ds_write_b64 v2, v[122:123] offset:2048
    v_dot2c_f32_bf16 v58, v99, v99
    v_cvt_pk_bf16_f32 v125, v186, v202
    ds_write_b64 v2, v[124:125] offset:4096
    v_dot2c_f32_bf16 v56, v100, v100
    v_cvt_pk_bf16_f32 v127, v187, v203
    ds_write_b64 v2, v[126:127] offset:6144
    v_dot2c_f32_bf16 v58, v101, v101
    v_cvt_pk_bf16_f32 v129, v188, v204
    ds_write_b64 v2, v[128:129] offset:8192
    v_dot2c_f32_bf16 v56, v102, v102
    v_cvt_pk_bf16_f32 v131, v189, v205
    ds_write_b64 v2, v[130:131] offset:10240
    v_dot2c_f32_bf16 v58, v103, v103
    v_cvt_pk_bf16_f32 v133, v190, v206
    ds_write_b64 v2, v[132:133] offset:12288
    v_dot2c_f32_bf16 v56, v104, v104
    v_cvt_pk_bf16_f32 v135, v191, v207
    ds_write_b64 v2, v[134:135] offset:14336
    v_dot2c_f32_bf16 v58, v105, v105
    v_cvt_pk_bf16_f32 v137, v192, v208
    ds_write_b64 v2, v[136:137] offset:16384
    v_dot2c_f32_bf16 v56, v106, v106
    v_cvt_pk_bf16_f32 v139, v193, v209
    ds_write_b64 v2, v[138:139] offset:18432
    v_dot2c_f32_bf16 v58, v107, v107
    v_cvt_pk_bf16_f32 v141, v194, v210
    ds_write_b64 v2, v[140:141] offset:20480
    v_dot2c_f32_bf16 v56, v108, v108
    v_cvt_pk_bf16_f32 v143, v195, v211
    ds_write_b64 v2, v[142:143] offset:22528
    v_dot2c_f32_bf16 v58, v109, v109
    v_cvt_pk_bf16_f32 v145, v196, v212
    ds_write_b64 v2, v[144:145] offset:24576
    v_dot2c_f32_bf16 v56, v110, v110
    v_cvt_pk_bf16_f32 v147, v197, v213
    ds_write_b64 v2, v[146:147] offset:26624
    v_dot2c_f32_bf16 v58, v111, v111
    v_cvt_pk_bf16_f32 v149, v198, v214
    ds_write_b64 v2, v[148:149] offset:28672
    v_dot2c_f32_bf16 v56, v112, v112
    v_cvt_pk_bf16_f32 v151, v199, v215
    ds_write_b64 v2, v[150:151] offset:30720
    v_dot2c_f32_bf16 v58, v113, v113
    v_dot2c_f32_bf16 v56, v114, v114
    v_dot2c_f32_bf16 v58, v115, v115
    v_dot2c_f32_bf16 v56, v116, v116
    v_dot2c_f32_bf16 v58, v117, v117
    v_dot2c_f32_bf16 v56, v118, v118
    v_dot2c_f32_bf16 v58, v119, v119
    v_add_f32 v57, v152, v168
    v_add_f32 v59, v184, v200
    s_nop 0
    v_pk_add_f32 v[56:57], v[56:57], v[58:59]
    ds_write_b64 v9, v[56:57]
    s_waitcnt vmcnt(0)
    s_waitcnt lgkmcnt(0)
    s_barrier
    ds_read_b128 v[88:91], v3 offset:0
    ds_read_b128 v[92:95], v3 offset:1024
    ds_read_b128 v[96:99], v3 offset:2048
    ds_read_b128 v[100:103], v3 offset:3072
    ds_read_b128 v[104:107], v3 offset:4096
    ds_read_b128 v[108:111], v3 offset:5120
    ds_read_b128 v[112:115], v3 offset:6144
    ds_read_b128 v[116:119], v3 offset:7168
    buffer_store_dwordx4 v[74:77], v72, s[96:99], s63 offen sc1
    s_waitcnt lgkmcnt(7)
    v_mfma_f32_32x32x16_bf16 v[152:167], v[88:91], v[24:27], 0
    s_waitcnt lgkmcnt(6)
    v_mfma_f32_32x32x16_bf16 v[152:167], v[92:95], v[28:31], v[152:167]
    s_waitcnt lgkmcnt(5)
    v_mfma_f32_32x32x16_bf16 v[168:183], v[96:99], v[32:35], 0
    s_waitcnt lgkmcnt(4)
    v_mfma_f32_32x32x16_bf16 v[168:183], v[100:103], v[36:39], v[168:183]
    s_nop 7
    v_cvt_pk_bf16_f32 v120, v152, v153
    v_cvt_pk_bf16_f32 v121, v154, v155
    v_cvt_pk_bf16_f32 v122, v156, v157
    v_cvt_pk_bf16_f32 v123, v158, v159
    v_cvt_pk_bf16_f32 v124, v160, v161
    v_cvt_pk_bf16_f32 v125, v162, v163
    v_cvt_pk_bf16_f32 v126, v164, v165
    v_cvt_pk_bf16_f32 v127, v166, v167
    ds_read_b128 v[56:59], v10 offset:0
    ds_read_b128 v[60:63], v10 offset:16
    ds_read_b128 v[64:67], v10 offset:32
    ds_read_b128 v[68:71], v10 offset:48
    v_and_b32 v120, -2, v120
    ds_write_b128 v11, v[120:123] offset:0
    v_and_b32 v124, -2, v124
    ds_write_b128 v11, v[124:127] offset:32
    ds_read_b128 v[24:27], v12 offset:0
    ds_read_b128 v[28:31], v12 offset:1280
    s_waitcnt lgkmcnt(11)
    v_mfma_f32_32x32x16_bf16 v[184:199], v[104:107], v[40:43], 0
    s_waitcnt lgkmcnt(10)
    v_mfma_f32_32x32x16_bf16 v[184:199], v[108:111], v[44:47], v[184:199]
    v_cvt_pk_bf16_f32 v128, v168, v169
    v_cvt_pk_bf16_f32 v129, v170, v171
    v_cvt_pk_bf16_f32 v130, v172, v173
    v_cvt_pk_bf16_f32 v131, v174, v175
    v_cvt_pk_bf16_f32 v132, v176, v177
    v_cvt_pk_bf16_f32 v133, v178, v179
    v_cvt_pk_bf16_f32 v134, v180, v181
    v_cvt_pk_bf16_f32 v135, v182, v183
    v_and_b32 v128, -2, v128
    ds_write_b128 v11, v[128:131] offset:2560
    v_and_b32 v132, -2, v132
    ds_write_b128 v11, v[132:135] offset:2592
    ds_read_b128 v[32:35], v12 offset:2560
    ds_read_b128 v[36:39], v12 offset:3840
    s_waitcnt lgkmcnt(5)
    buffer_store_dwordx4 v[24:27], v4, s[12:15], s60 offen sc1
    s_waitcnt lgkmcnt(4)
    buffer_store_dwordx4 v[28:31], v4, s[12:15], s60 offen offset:1024 sc1
    s_add_u32 s60, s60, 2048
    v_mfma_f32_32x32x16_bf16 v[200:215], v[112:115], v[48:51], 0
    v_mfma_f32_32x32x16_bf16 v[200:215], v[116:119], v[52:55], v[200:215]
    v_cvt_pk_bf16_f32 v136, v184, v185
    v_cvt_pk_bf16_f32 v137, v186, v187
    v_cvt_pk_bf16_f32 v138, v188, v189
    v_cvt_pk_bf16_f32 v139, v190, v191
    v_cvt_pk_bf16_f32 v140, v192, v193
    v_cvt_pk_bf16_f32 v141, v194, v195
    v_cvt_pk_bf16_f32 v142, v196, v197
    v_cvt_pk_bf16_f32 v143, v198, v199
    v_and_b32 v136, -2, v136
    ds_write_b128 v11, v[136:139] offset:5120
    v_and_b32 v140, -2, v140
    ds_write_b128 v11, v[140:143] offset:5152
    ds_read_b128 v[40:43], v12 offset:5120
    ds_read_b128 v[44:47], v12 offset:6400
    s_waitcnt lgkmcnt(5)
    buffer_store_dwordx4 v[32:35], v4, s[12:15], s60 offen sc1
    s_waitcnt lgkmcnt(4)
    buffer_store_dwordx4 v[36:39], v4, s[12:15], s60 offen offset:1024 sc1
    s_add_u32 s60, s60, 2048
    v_cvt_pk_bf16_f32 v144, v200, v201
    v_cvt_pk_bf16_f32 v145, v202, v203
    v_cvt_pk_bf16_f32 v146, v204, v205
    v_cvt_pk_bf16_f32 v147, v206, v207
    v_cvt_pk_bf16_f32 v148, v208, v209
    v_cvt_pk_bf16_f32 v149, v210, v211
    v_cvt_pk_bf16_f32 v150, v212, v213
    v_cvt_pk_bf16_f32 v151, v214, v215
    v_and_b32 v144, -2, v144
    ds_write_b128 v11, v[144:147] offset:7680
    v_and_b32 v148, -2, v148
    ds_write_b128 v11, v[148:151] offset:7712
    ds_read_b128 v[48:51], v12 offset:7680
    ds_read_b128 v[52:55], v12 offset:8960
    s_waitcnt lgkmcnt(5)
    buffer_store_dwordx4 v[40:43], v4, s[12:15], s60 offen sc1
    s_waitcnt lgkmcnt(4)
    buffer_store_dwordx4 v[44:47], v4, s[12:15], s60 offen offset:1024 sc1
    s_add_u32 s60, s60, 2048
    v_add_f32 v56, v56, v58
    v_add_f32 v60, v60, v62
    v_add_f32 v64, v64, v66
    v_add_f32 v68, v68, v70
    v_pk_add_f32 v[56:57], v[56:57], v[60:61]
    v_pk_add_f32 v[64:65], v[64:65], v[68:69]
    v_pk_add_f32 v[56:57], v[56:57], v[64:65]
    v_mul_f32 v57, v57, v57
    v_fma_f32 v56, v57, -0.5, v56
    v_max_f32 v56, 0, v56
    v_mov_b32 v57, s36
    buffer_store_dwordx2 v[56:57], v13, s[68:71], s62 offen sc1
    s_waitcnt lgkmcnt(1)
    buffer_store_dwordx4 v[48:51], v4, s[12:15], s60 offen sc1
    s_waitcnt lgkmcnt(0)
    buffer_store_dwordx4 v[52:55], v4, s[12:15], s60 offen offset:1024 sc1
    s_and_b32 s5, s2, 7
    s_lshl_b32 s5, s5, 5
    s_lshr_b32 s4, s2, 3
    s_add_u32 s4, s4, s5
    s_lshr_b32 s5, s3, 1
    s_lshl_b32 s5, s5, 5
    s_and_b32 s6, s3, 1
    s_lshl_b32 s6, s6, 2
    s_add_u32 s43, s5, s6
    v_and_b32 v168, 15, v1
    v_lshrrev_b32 v169, 4, v1
    v_lshrrev_b32 v170, 2, v168
    v_and_b32 v171, 3, v168
    v_lshl_add_u32 v170, v170, 3, v171
    v_add_u32 v170, s43, v170
    v_cvt_f32_u32 v170, v170
    v_cvt_f32_u32 v171, v169
    v_cvt_f32_u32 v172, v168
    v_mul_f32 v171, 4.0, v171
    v_mul_f32 v160, 0x3c800000, v170
    v_add_f32 v162, v160, v160
    v_mul_f32 v176, v171, v162
    v_cos_f32 v162, v162
    v_add_f32 v177, v176, v160
    v_add_f32 v178, v177, v160
    v_add_f32 v179, v178, v160
    v_sin_f32 v184, v176
    v_sin_f32 v185, v177
    v_sin_f32 v186, v178
    v_sin_f32 v187, v179
    v_cos_f32 v176, v176
    v_cos_f32 v177, v177
    v_cos_f32 v178, v178
    v_cos_f32 v179, v179
    v_add_f32 v162, v162, v162
    s_mov_b32 s74, 0x80008000
    v_and_b32 v164, 1, v168
    v_mul_lo_u32 v164, v164, s74
    v_pk_fma_f32 v[180:181], v[178:179], v[162:163], v[176:177] op_sel_hi:[1,0,1] neg_lo:[0,0,1] neg_hi:[0,0,1]
    v_pk_fma_f32 v[182:183], v[180:181], v[162:163], v[178:179] op_sel_hi:[1,0,1] neg_lo:[0,0,1] neg_hi:[0,0,1]
    v_pk_fma_f32 v[188:189], v[186:187], v[162:163], v[184:185] op_sel_hi:[1,0,1] neg_lo:[0,0,1] neg_hi:[0,0,1]
    v_pk_fma_f32 v[190:191], v[188:189], v[162:163], v[186:187] op_sel_hi:[1,0,1] neg_lo:[0,0,1] neg_hi:[0,0,1]
    v_cvt_pk_bf16_f32 v192, v176, v177
    v_cvt_pk_bf16_f32 v200, v184, v185
    v_cvt_pk_bf16_f32 v193, v178, v179
    v_cvt_pk_bf16_f32 v201, v186, v187
    v_cvt_pk_bf16_f32 v194, v180, v181
    v_cvt_pk_bf16_f32 v202, v188, v189
    v_cvt_pk_bf16_f32 v195, v182, v183
    v_cvt_pk_bf16_f32 v203, v190, v191
    v_xor_b32 v196, v164, v192
    v_xor_b32 v204, v164, v200
    v_xor_b32 v197, v164, v193
    v_xor_b32 v205, v164, v201
    v_xor_b32 v198, v164, v194
    v_xor_b32 v206, v164, v202
    v_xor_b32 v199, v164, v195
    v_xor_b32 v207, v164, v203
    v_xor_b32 v208, s74, v200
    v_xor_b32 v209, s74, v201
    v_xor_b32 v210, s74, v202
    v_xor_b32 v211, s74, v203
    v_xor_b32 v212, s74, v204
    v_xor_b32 v213, s74, v205
    v_xor_b32 v214, s74, v206
    v_xor_b32 v215, s74, v207
    v_lshlrev_b32 v174, 4, v1
    v_add_u32 v174, 131072, v174
    s_lshl_b32 s5, s3, 11
    v_add_u32 v173, s5, v174
    ds_write_b128 v173, v[192:195] offset:0
    ds_write_b128 v173, v[196:199] offset:1024
    ds_write_b128 v173, v[200:203] offset:8192
    ds_write_b128 v173, v[204:207] offset:9216
    ds_write_b128 v173, v[208:211] offset:16384
    ds_write_b128 v173, v[212:215] offset:17408
    v_mul_f32 v160, 0x3d000000, v172
    v_mul_f32 v176, v171, v160
    v_add_f32 v177, v176, v160
    v_add_f32 v178, v177, v160
    v_add_f32 v179, v178, v160
    v_sin_f32 v180, v176
    v_sin_f32 v181, v177
    v_sin_f32 v182, v178
    v_sin_f32 v183, v179
    v_cos_f32 v176, v176
    v_cos_f32 v177, v177
    v_cos_f32 v178, v178
    v_cos_f32 v179, v179
    s_lshl_b32 s5, s74, 16
    s_waitcnt lgkmcnt(0)
    v_cvt_pk_bf16_f32 v192, v176, v177
    v_cvt_pk_bf16_f32 v193, v178, v179
    v_xor_b32 v194, v164, v192
    v_xor_b32 v195, v164, v193
    v_xor_b32 v196, s5, v192
    v_xor_b32 v197, s5, v193
    v_xor_b32 v198, s5, v194
    v_xor_b32 v199, s5, v195
    v_cvt_pk_bf16_f32 v200, v180, v181
    v_cvt_pk_bf16_f32 v201, v182, v183
    v_xor_b32 v202, v164, v200
    v_xor_b32 v203, v164, v201
    v_xor_b32 v204, s5, v200
    v_xor_b32 v205, s5, v201
    v_xor_b32 v206, s5, v202
    v_xor_b32 v207, s5, v203
    v_xor_b32 v208, s74, v200
    v_xor_b32 v209, s74, v201
    v_xor_b32 v210, s74, v202
    v_xor_b32 v211, s74, v203
    v_xor_b32 v212, s74, v204
    v_xor_b32 v213, s74, v205
    v_xor_b32 v214, s74, v206
    v_xor_b32 v215, s74, v207
    ds_write_b128 v174, v[192:195] offset:24576
    ds_write_b128 v174, v[196:199] offset:25600
    ds_write_b128 v174, v[200:203] offset:26624
    ds_write_b128 v174, v[204:207] offset:27648
    ds_write_b128 v174, v[208:211] offset:28672
    ds_write_b128 v174, v[212:215] offset:29696
    s_and_b32 s5, s3, 1
    s_lshl_b32 s5, s5, 1
    s_lshr_b32 s6, s3, 1
    s_add_u32 s5, s5, s6
    s_lshl_b32 s5, s5, 10
    s_add_u32 s5, s5, 26112
    v_and_b32 v81, 15, v1
    v_lshl_add_u32 v81, v81, 6, s5
    buffer_load_dword v80, v81, s[96:99], 0 offen sc1
    s_mov_b32 s5, 0x3a000000
    v_mul_f32 v160, s5, v170
    v_mul_f32 v216, v171, v160
    v_mul_f32 v162, 0x41800000, v160
    v_add_f32 v217, v216, v160
    v_add_f32 v218, v217, v160
    v_add_f32 v219, v218, v160
    v_sin_f32 v224, v216
    v_sin_f32 v225, v217
    v_sin_f32 v226, v218
    v_sin_f32 v227, v219
    v_cos_f32 v216, v216
    v_cos_f32 v217, v217
    v_cos_f32 v218, v218
    v_cos_f32 v219, v219
    v_sin_f32 v164, v162
    v_cos_f32 v162, v162
    v_lshl_add_u32 v166, v169, 3, s43
    v_cvt_f32_u32 v166, v166
    v_pk_mul_f32 v[220:221], v[216:217], v[162:163] op_sel_hi:[1,0]
    v_pk_mul_f32 v[228:229], v[224:225], v[162:163] op_sel_hi:[1,0]
    v_pk_mul_f32 v[222:223], v[218:219], v[162:163] op_sel_hi:[1,0]
    v_pk_mul_f32 v[230:231], v[226:227], v[162:163] op_sel_hi:[1,0]
    v_pk_fma_f32 v[220:221], v[224:225], v[164:165], v[220:221] op_sel_hi:[1,0,1] neg_lo:[1,0,0] neg_hi:[1,0,0]
    v_pk_fma_f32 v[228:229], v[216:217], v[164:165], v[228:229] op_sel_hi:[1,0,1]
    v_pk_fma_f32 v[222:223], v[226:227], v[164:165], v[222:223] op_sel_hi:[1,0,1] neg_lo:[1,0,0] neg_hi:[1,0,0]
    v_pk_fma_f32 v[230:231], v[218:219], v[164:165], v[230:231] op_sel_hi:[1,0,1]
    v_mul_f32 v160, s5, v172
    v_add_f32 v161, 0x3c000000, v160
    v_mul_f32 v232, v166, v160
    v_add_f32 v233, v232, v160
    v_add_f32 v234, v233, v160
    v_add_f32 v235, v234, v160
    v_sin_f32 v240, v232
    v_sin_f32 v241, v233
    v_sin_f32 v242, v234
    v_sin_f32 v243, v235
    v_cos_f32 v232, v232
    v_cos_f32 v233, v233
    v_cos_f32 v234, v234
    v_cos_f32 v235, v235
    v_mul_f32 v236, v166, v161
    v_add_f32 v237, v236, v161
    v_add_f32 v238, v237, v161
    v_add_f32 v239, v238, v161
    v_sin_f32 v244, v236
    v_sin_f32 v245, v237
    v_sin_f32 v246, v238
    v_sin_f32 v247, v239
    v_cos_f32 v236, v236
    v_cos_f32 v237, v237
    v_cos_f32 v238, v238
    v_cos_f32 v239, v239
    s_and_b32 s44, s45, 255
    s_lshr_b32 s45, s45, 8
    s_lshl_b32 s46, s45, 2
    s_add_u32 s46, s46, s3
    s_and_b32 s37, s45, 0
    s_lshl_b32 s37, s37, 13
    s_and_b32 s5, s2, 7
    s_lshl_b32 s5, s5, 2
    s_lshr_b32 s6, s2, 6
    s_add_u32 s5, s5, s6
    s_bfe_u32 s53, s2, 0x30003
    s_mul_i32 s6, s5, 86
    s_lshr_b32 s6, s6, 8
    s_mov_b32 s101, s6
    s_mul_i32 s7, s6, 3
    s_add_u32 s54, s5, s7
    s_mul_i32 s7, s6, 9
    s_add_u32 s7, s7, 5
    s_sub_u32 s55, s7, s5
    s_cmp_eq_u32 s6, 10
    s_cselect_b32 s6, 2, 0
    s_sub_u32 s55, s55, s6
    s_lshr_b32 s5, s3, 1
    s_lshl_b32 s42, s53, 1
    s_add_u32 s42, s42, s5
    s_and_b32 s5, s3, 1
    s_lshl_b32 s76, s5, 8
    s_xor_b32 s82, s76, 256
    s_waitcnt lgkmcnt(0)
L_p1done:
    s_nop 1
    v_lshlrev_b32 v9, 4, v1
    v_add_u32 v10, 114688, v9
    v_lshrrev_b32 v8, 2, v1
    v_lshlrev_b32 v8, 11, v8
    v_and_or_b32 v8, v1, 3, v8
    v_lshlrev_b32 v8, 4, v8
    s_and_b32 s6, s3, 1
    s_lshr_b32 s7, s3, 1
    s_lshl_b32 s7, s7, 10
    s_lshl_b32 s66, s6, 11
    s_add_u32 s66, s66, s7
    s_lshl_b32 s65, s4, 7
    s_lshl_b32 s6, s66, 9
    s_add_u32 s65, s65, s6
    s_lshl_b32 s66, s66, 2
    s_mul_i32 s67, s4, 8576
    s_lshl_b32 s6, s3, 11
    s_add_u32 s67, s67, s6
    s_mov_b32 s8, s34
    s_mov_b32 s9, s35
    s_mov_b32 s10, 2097152
    s_mov_b32 s11, 0x20000
    s_add_u32 s12, s34, 4325376
    s_addc_u32 s13, s35, 0
    s_mov_b32 s14, 32768
    s_mov_b32 s15, 0x20000
    s_add_u32 s68, s34, 2097152
    s_addc_u32 s69, s35, 0
    s_mov_b32 s70, 2195456
    s_mov_b32 s71, 0x20000
    s_lshl_b32 s5, s3, 11
    v_add_u32 v7, s5, v10
    ds_read_b128 v[32:35], v7 offset:16384
    ds_read_b128 v[36:39], v7 offset:17408
    ds_read_b128 v[40:43], v7 offset:24576
    ds_read_b128 v[44:47], v7 offset:25600
    ds_read_b128 v[48:51], v7 offset:32768
    ds_read_b128 v[52:55], v7 offset:33792
    ds_read_b128 v[56:59], v10 offset:40960
    ds_read_b128 v[60:63], v10 offset:41984
    ds_read_b128 v[64:67], v10 offset:43008
    ds_read_b128 v[68:71], v10 offset:44032
    ds_read_b128 v[72:75], v10 offset:45056
    ds_read_b128 v[76:79], v10 offset:46080
    s_lshl_b32 s5, s3, 4
    v_and_b32 v85, 15, v1
    v_add_u32 v85, s5, v85
    v_min_u32 v85, 62, v85
    v_lshlrev_b32 v85, 6, v85
    v_add_u32 v85, 22016, v85
    s_lshl_b32 s5, s47, 2
    s_add_u32 s5, s5, s3
    s_lshl_b32 s5, s5, 6
    s_cmp_eq_u32 s48, 1
    s_cselect_b32 s63, s5, 16777216
    v_lshlrev_b32 v88, 4, v1
    v_mov_b32 v89, 16777216
    v_cmp_gt_u32 vcc, 4, v1
    s_add_u32 s6, s36, 0
    v_mov_b32 v90, s6
    v_mov_b32 v91, s6
    v_cndmask_b32 v88, v89, v88, vcc
    v_pk_mov_b32 v[92:93], v[90:91], v[90:91]
    s_and_b32 s6, s3, 1
    s_lshr_b32 s7, s3, 1
    s_lshl_b32 s5, s6, 2
    s_add_u32 s5, s5, s7
    s_lshl_b32 s5, s5, 10
    v_add_u32 v7, s5, v10
    s_lshl_b32 s5, s7, 7
    s_add_u32 s5, s5, s6
    s_lshl_b32 s5, s5, 3
    v_add_u32 v11, s5, v10
    s_lshl_b32 s5, s6, 12
    v_add_u32 v12, s5, v10
    s_lshl_b32 s5, s7, 12
    v_add_u32 v13, s5, v10
    v_mov_b32 v2, 0x4227c5ac
    v_mov_b32 v3, v2
    v_mov_b32 v4, 0x46000000
    v_mov_b32 v5, v4
    s_cmp_eq_u32 s4, 0
    s_cselect_b32 s73, 0, -1
    s_waitcnt vmcnt(0)
    s_add_u32 s6, s36, 0
    v_subrev_u32 v80, s6, v80
    v_cmp_le_u32 vcc, 8, v80
    s_cbranch_vccnz pslow_9
pback_8:
    buffer_load_dwordx4 v[16:19], v8, s[8:11], s65 offen sc1
    buffer_load_dwordx4 v[20:23], v8, s[8:11], s65 offen offset:64 sc1
    buffer_load_dwordx4 v[176:179], v9, s[12:15], s66 offen offset:0 sc1
    buffer_load_dwordx4 v[180:183], v9, s[12:15], s66 offen offset:1024 sc1
    buffer_load_dwordx4 v[184:187], v9, s[12:15], s66 offen offset:2048 sc1
    buffer_load_dwordx4 v[188:191], v9, s[12:15], s66 offen offset:3072 sc1
    buffer_store_dwordx4 v[90:93], v88, s[96:99], s63 offen sc1
    s_lshl_b32 s5, s46, 15
    s_add_u32 s5, s5, 4390912
    s_add_u32 s24, s34, s5
    s_addc_u32 s25, s35, 0
    s_mov_b32 s26, 32768
    s_mov_b32 s27, 0x20000
    s_cmp_ge_u32 s46, 86
    s_cselect_b32 s26, 0, s26
    s_lshr_b32 s5, s46, 1
    s_min_u32 s5, s5, 42
    s_lshl_b32 s5, s5, 2
    v_bfe_u32 v87, v0, 2, 1
    v_mul_u32_u24 v87, 172, v87
    v_and_b32 v86, 3, v0
    v_add3_u32 v87, v87, v86, s5
    v_lshlrev_b32 v87, 6, v87
    s_waitcnt vmcnt(6)
    v_lshlrev_b32 v160, 16, v16
    v_and_b32 v161, s38, v16
    v_lshlrev_b32 v162, 16, v17
    v_and_b32 v163, s38, v17
    v_lshlrev_b32 v164, 16, v18
    v_and_b32 v165, s38, v18
    v_lshlrev_b32 v166, 16, v19
    v_and_b32 v167, s38, v19
    s_waitcnt vmcnt(5)
    v_lshlrev_b32 v168, 16, v20
    v_and_b32 v169, s38, v20
    v_lshlrev_b32 v170, 16, v21
    v_and_b32 v171, s38, v21
    v_lshlrev_b32 v172, 16, v22
    v_and_b32 v173, s38, v22
    v_lshlrev_b32 v174, 16, v23
    v_and_b32 v175, s38, v23
    s_waitcnt vmcnt(4)
    v_bitop3_b32 v128, v177, v179, s36 bitop3:0x7e
    s_waitcnt vmcnt(3)
    v_bitop3_b32 v129, v181, v183, s36 bitop3:0x7e
    s_waitcnt vmcnt(2)
    v_bitop3_b32 v130, v185, v187, s36 bitop3:0x7e
    s_waitcnt vmcnt(1)
    v_bitop3_b32 v131, v189, v191, s36 bitop3:0x7e
    v_bitop3_b32 v14, v16, v20, 1 bitop3:0xa8
    v_or3_b32 v14, v14, v128, v129
    v_or3_b32 v14, v14, v130, v131
    v_cmp_ne_u32 vcc, 0, v14
    s_cbranch_vccnz cslow_11
cback_10:
    buffer_load_dword v84, v85, s[96:99], 0 offen sc1
    v_fma_f32 v112, v176, v4, v2
    v_fma_f32 v113, v178, v4, v2
    v_fma_f32 v114, v180, v4, v2
    v_fma_f32 v115, v182, v4, v2
    v_fma_f32 v116, v184, v4, v2
    v_fma_f32 v117, v186, v4, v2
    v_fma_f32 v118, v188, v4, v2
    v_fma_f32 v119, v190, v4, v2
    v_rsq_f32 v112, v112
    v_rsq_f32 v113, v113
    v_rsq_f32 v114, v114
    v_rsq_f32 v115, v115
    v_rsq_f32 v116, v116
    v_rsq_f32 v117, v117
    v_rsq_f32 v118, v118
    v_rsq_f32 v119, v119
    v_pk_mul_f32 v[128:129], v[112:113], v[160:161]
    v_pk_mul_f32 v[130:131], v[114:115], v[162:163]
    v_pk_mul_f32 v[132:133], v[116:117], v[164:165]
    v_pk_mul_f32 v[134:135], v[118:119], v[166:167]
    v_cvt_pk_bf16_f32 v16, v128, v129
    v_cvt_pk_bf16_f32 v17, v130, v131
    v_cvt_pk_bf16_f32 v18, v132, v133
    v_cvt_pk_bf16_f32 v19, v134, v135
    ds_write_b128 v7, v[16:19] offset:0
    v_pk_mul_f32 v[136:137], v[112:113], v[168:169]
    v_pk_mul_f32 v[138:139], v[114:115], v[170:171]
    v_pk_mul_f32 v[140:141], v[116:117], v[172:173]
    v_pk_mul_f32 v[142:143], v[118:119], v[174:175]
    v_cvt_pk_bf16_f32 v20, v136, v137
    v_cvt_pk_bf16_f32 v21, v138, v139
    v_cvt_pk_bf16_f32 v22, v140, v141
    v_cvt_pk_bf16_f32 v23, v142, v143
    v_and_b32 v20, s73, v20
    v_and_b32 v21, s73, v21
    v_and_b32 v22, s73, v22
    v_and_b32 v23, s73, v23
    ds_write_b128 v7, v[20:23] offset:2048
    s_waitcnt lgkmcnt(0)
    s_barrier
    ds_read_b128 v[176:179], v10 offset:0
    ds_read_b128 v[180:183], v10 offset:1024
    ds_read_b128 v[184:187], v10 offset:2048
    ds_read_b128 v[188:191], v10 offset:3072
    ds_read_b128 v[192:195], v10 offset:4096
    ds_read_b128 v[196:199], v10 offset:5120
    ds_read_b128 v[200:203], v10 offset:6144
    ds_read_b128 v[204:207], v10 offset:7168
    s_add_u32 s6, s36, 0
    s_waitcnt vmcnt(0)
    v_subrev_u32 v84, s6, v84
    v_cmp_le_u32 vcc, 8, v84
    s_cbranch_vccnz pslow_13
pback_12:
    buffer_load_dwordx4 v[24:27], v9, s[68:71], s67 offen sc1
    buffer_load_dwordx4 v[28:31], v9, s[68:71], s67 offen offset:1024 sc1
    buffer_load_dword v86, v87, s[96:99], 0 offen sc1
    s_waitcnt lgkmcnt(7)
    v_mfma_f32_16x16x32_bf16 v[112:115], v[176:179], v[32:35], 0
    v_mfma_f32_16x16x32_bf16 v[120:123], v[176:179], v[48:51], 0
    s_waitcnt lgkmcnt(6)
    v_mfma_f32_16x16x32_bf16 v[112:115], v[180:183], v[36:39], v[112:115]
    v_mfma_f32_16x16x32_bf16 v[120:123], v[180:183], v[52:55], v[120:123]
    s_waitcnt lgkmcnt(5)
    v_mfma_f32_16x16x32_bf16 v[112:115], v[184:187], v[40:43], v[112:115]
    v_mfma_f32_16x16x32_bf16 v[120:123], v[184:187], v[32:35], v[120:123]
    s_waitcnt lgkmcnt(4)
    v_mfma_f32_16x16x32_bf16 v[112:115], v[188:191], v[44:47], v[112:115]
    v_mfma_f32_16x16x32_bf16 v[120:123], v[188:191], v[36:39], v[120:123]
    s_waitcnt lgkmcnt(3)
    v_mfma_f32_16x16x32_bf16 v[116:119], v[192:195], v[32:35], 0
    v_mfma_f32_16x16x32_bf16 v[124:127], v[192:195], v[48:51], 0
    s_waitcnt lgkmcnt(2)
    v_mfma_f32_16x16x32_bf16 v[116:119], v[196:199], v[36:39], v[116:119]
    v_mfma_f32_16x16x32_bf16 v[124:127], v[196:199], v[52:55], v[124:127]
    s_waitcnt lgkmcnt(1)
    v_mfma_f32_16x16x32_bf16 v[116:119], v[200:203], v[40:43], v[116:119]
    v_mfma_f32_16x16x32_bf16 v[124:127], v[200:203], v[32:35], v[124:127]
    s_waitcnt lgkmcnt(0)
    v_mfma_f32_16x16x32_bf16 v[116:119], v[204:207], v[44:47], v[116:119]
    v_mfma_f32_16x16x32_bf16 v[124:127], v[204:207], v[36:39], v[124:127]
    v_pk_mul_f32 v[128:129], v[112:113], v[216:217]
    v_pk_mul_f32 v[136:137], v[120:121], v[216:217]
    v_pk_mul_f32 v[130:131], v[114:115], v[218:219]
    v_pk_mul_f32 v[138:139], v[122:123], v[218:219]
    s_nop 2
    v_pk_mul_f32 v[132:133], v[116:117], v[220:221]
    v_pk_mul_f32 v[140:141], v[124:125], v[220:221]
    v_pk_mul_f32 v[134:135], v[118:119], v[222:223]
    v_pk_mul_f32 v[142:143], v[126:127], v[222:223]
    v_pk_fma_f32 v[128:129], v[120:121], v[224:225], v[128:129]
    v_pk_fma_f32 v[130:131], v[122:123], v[226:227], v[130:131]
    v_pk_fma_f32 v[132:133], v[124:125], v[228:229], v[132:133]
    v_pk_fma_f32 v[134:135], v[126:127], v[230:231], v[134:135]
    v_cvt_pk_bf16_f32 v16, v128, v129
    v_cvt_pk_bf16_f32 v17, v130, v131
    v_cvt_pk_bf16_f32 v18, v132, v133
    v_cvt_pk_bf16_f32 v19, v134, v135
    v_pk_fma_f32 v[136:137], v[112:113], v[224:225], v[136:137] neg_lo:[1,0,0] neg_hi:[1,0,0]
    v_pk_fma_f32 v[138:139], v[114:115], v[226:227], v[138:139] neg_lo:[1,0,0] neg_hi:[1,0,0]
    v_pk_fma_f32 v[140:141], v[116:117], v[228:229], v[140:141] neg_lo:[1,0,0] neg_hi:[1,0,0]
    v_pk_fma_f32 v[142:143], v[118:119], v[230:231], v[142:143] neg_lo:[1,0,0] neg_hi:[1,0,0]
    v_cvt_pk_bf16_f32 v20, v136, v137
    v_cvt_pk_bf16_f32 v21, v138, v139
    v_cvt_pk_bf16_f32 v22, v140, v141
    v_cvt_pk_bf16_f32 v23, v142, v143
    v_mfma_f32_16x16x32_bf16 v[112:115], v[56:59], v[16:19], 0
    ds_read_b128 v[32:35], v13 offset:16384
    ds_read_b128 v[36:39], v13 offset:17408
    v_mfma_f32_16x16x32_bf16 v[120:123], v[72:75], v[16:19], 0
    ds_read_b128 v[40:43], v13 offset:18432
    ds_read_b128 v[44:47], v13 offset:19456
    v_mfma_f32_16x16x32_bf16 v[116:119], v[60:63], v[16:19], 0
    ds_read_b128 v[48:51], v13 offset:24576
    ds_read_b128 v[52:55], v13 offset:25600
    v_mfma_f32_16x16x32_bf16 v[124:127], v[76:79], v[16:19], 0
    ds_read_b128 v[216:219], v13 offset:26624
    ds_read_b128 v[220:223], v13 offset:27648
    v_mfma_f32_16x16x32_bf16 v[112:115], v[64:67], v[20:23], v[112:115]
    s_waitcnt vmcnt(2)
    v_lshlrev_b32 v176, 16, v24
    v_and_b32 v184, s38, v24
    v_mfma_f32_16x16x32_bf16 v[120:123], v[56:59], v[20:23], v[120:123]
    v_lshlrev_b32 v177, 16, v25
    v_and_b32 v185, s38, v25
    v_mfma_f32_16x16x32_bf16 v[116:119], v[68:71], v[20:23], v[116:119]
    v_lshlrev_b32 v178, 16, v26
    v_and_b32 v186, s38, v26
    v_mfma_f32_16x16x32_bf16 v[124:127], v[60:63], v[20:23], v[124:127]
    v_lshlrev_b32 v179, 16, v27
    v_and_b32 v187, s38, v27
    s_waitcnt vmcnt(1)
    v_lshlrev_b32 v180, 16, v28
    v_and_b32 v188, s38, v28
    v_lshlrev_b32 v181, 16, v29
    v_and_b32 v189, s38, v29
    v_lshlrev_b32 v182, 16, v30
    v_and_b32 v190, s38, v30
    v_lshlrev_b32 v183, 16, v31
    v_and_b32 v191, s38, v31
    v_pk_mul_f32 v[128:129], v[112:113], v[176:177]
    v_pk_mul_f32 v[136:137], v[120:121], v[176:177]
    v_pk_mul_f32 v[130:131], v[114:115], v[178:179]
    v_pk_mul_f32 v[138:139], v[122:123], v[178:179]
    v_pk_mul_f32 v[132:133], v[116:117], v[180:181]
    v_pk_mul_f32 v[140:141], v[124:125], v[180:181]
    v_pk_mul_f32 v[134:135], v[118:119], v[182:183]
    v_pk_mul_f32 v[142:143], v[126:127], v[182:183]
    v_pk_fma_f32 v[128:129], v[120:121], v[184:185], v[128:129] neg_lo:[1,0,0] neg_hi:[1,0,0]
    v_pk_fma_f32 v[130:131], v[122:123], v[186:187], v[130:131] neg_lo:[1,0,0] neg_hi:[1,0,0]
    v_pk_fma_f32 v[132:133], v[124:125], v[188:189], v[132:133] neg_lo:[1,0,0] neg_hi:[1,0,0]
    v_pk_fma_f32 v[134:135], v[126:127], v[190:191], v[134:135] neg_lo:[1,0,0] neg_hi:[1,0,0]
    v_cvt_pk_bf16_f32 v16, v128, v129
    v_cvt_pk_bf16_f32 v17, v130, v131
    v_cvt_pk_bf16_f32 v18, v132, v133
    v_cvt_pk_bf16_f32 v19, v134, v135
    v_pk_fma_f32 v[136:137], v[112:113], v[184:185], v[136:137]
    v_pk_fma_f32 v[138:139], v[114:115], v[186:187], v[138:139]
    v_pk_fma_f32 v[140:141], v[116:117], v[188:189], v[140:141]
    v_pk_fma_f32 v[142:143], v[118:119], v[190:191], v[142:143]
    v_cvt_pk_bf16_f32 v20, v136, v137
    v_cvt_pk_bf16_f32 v21, v138, v139
    v_cvt_pk_bf16_f32 v22, v140, v141
    v_cvt_pk_bf16_f32 v23, v142, v143
    v_mfma_f32_16x16x32_bf16 v[112:115], v[16:19], v[56:59], 0
    ds_read_b128 v[224:227], v13 offset:32768
    v_mfma_f32_16x16x32_bf16 v[120:123], v[16:19], v[64:67], 0
    ds_read_b128 v[228:231], v13 offset:33792
    v_mfma_f32_16x16x32_bf16 v[116:119], v[16:19], v[60:63], 0
    ds_read_b128 v[248:251], v13 offset:34816
    v_mfma_f32_16x16x32_bf16 v[124:127], v[16:19], v[68:71], 0
    ds_read_b128 v[252:255], v13 offset:35840
    v_mfma_f32_16x16x32_bf16 v[112:115], v[20:23], v[72:75], v[112:115]
    v_mfma_f32_16x16x32_bf16 v[120:123], v[20:23], v[56:59], v[120:123]
    v_mfma_f32_16x16x32_bf16 v[116:119], v[20:23], v[76:79], v[116:119]
    v_mfma_f32_16x16x32_bf16 v[124:127], v[20:23], v[60:63], v[124:127]
    s_add_u32 s6, s36, 0
    s_waitcnt vmcnt(0)
    v_subrev_u32 v86, s6, v86
    v_cmp_le_u32 vcc, 8, v86
    s_cbranch_vccnz pslow_15
pback_14:
    s_xor_b32 s64, s37, 0
    buffer_load_dwordx4 a[0:3], v9, s[24:27], s64 offen offset:0 sc1
    buffer_load_dwordx4 a[4:7], v9, s[24:27], s64 offen offset:1024 sc1
    buffer_load_dwordx4 a[8:11], v9, s[24:27], s64 offen offset:2048 sc1
    buffer_load_dwordx4 a[12:15], v9, s[24:27], s64 offen offset:3072 sc1
    s_xor_b32 s64, s37, 4096
    buffer_load_dwordx4 a[16:19], v9, s[24:27], s64 offen offset:0 sc1
    buffer_load_dwordx4 a[20:23], v9, s[24:27], s64 offen offset:1024 sc1
    buffer_load_dwordx4 a[24:27], v9, s[24:27], s64 offen offset:2048 sc1
    buffer_load_dwordx4 a[28:31], v9, s[24:27], s64 offen offset:3072 sc1
    v_pk_mul_f32 v[128:129], v[112:113], v[232:233]
    v_pk_mul_f32 v[136:137], v[120:121], v[232:233]
    v_pk_mul_f32 v[130:131], v[114:115], v[234:235]
    v_pk_mul_f32 v[138:139], v[122:123], v[234:235]
    v_pk_mul_f32 v[132:133], v[116:117], v[236:237]
    v_pk_mul_f32 v[140:141], v[124:125], v[236:237]
    v_pk_mul_f32 v[134:135], v[118:119], v[238:239]
    v_pk_mul_f32 v[142:143], v[126:127], v[238:239]
    v_pk_fma_f32 v[128:129], v[120:121], v[240:241], v[128:129] neg_lo:[1,0,0] neg_hi:[1,0,0]
    v_pk_fma_f32 v[130:131], v[122:123], v[242:243], v[130:131] neg_lo:[1,0,0] neg_hi:[1,0,0]
    v_pk_fma_f32 v[132:133], v[124:125], v[244:245], v[132:133] neg_lo:[1,0,0] neg_hi:[1,0,0]
    v_pk_fma_f32 v[134:135], v[126:127], v[246:247], v[134:135] neg_lo:[1,0,0] neg_hi:[1,0,0]
    v_cvt_pk_bf16_f32 v16, v128, v129
    v_cvt_pk_bf16_f32 v17, v130, v131
    v_cvt_pk_bf16_f32 v18, v132, v133
    v_cvt_pk_bf16_f32 v19, v134, v135
    ds_write_b64 v11, v[16:17] offset:8192
    ds_write_b64 v11, v[18:19] offset:12288
    v_pk_fma_f32 v[136:137], v[112:113], v[240:241], v[136:137]
    v_pk_fma_f32 v[138:139], v[114:115], v[242:243], v[138:139]
    v_pk_fma_f32 v[140:141], v[116:117], v[244:245], v[140:141]
    v_pk_fma_f32 v[142:143], v[118:119], v[246:247], v[142:143]
    v_cvt_pk_bf16_f32 v20, v136, v137
    v_cvt_pk_bf16_f32 v21, v138, v139
    v_cvt_pk_bf16_f32 v22, v140, v141
    v_cvt_pk_bf16_f32 v23, v142, v143
    ds_write_b64 v11, v[20:21] offset:10240
    ds_write_b64 v11, v[22:23] offset:14336
    s_waitcnt lgkmcnt(0)
    s_barrier
    ds_read_b128 v[176:179], v12 offset:8192
    ds_read_b128 v[180:183], v12 offset:9216
    ds_read_b128 v[184:187], v12 offset:10240
    ds_read_b128 v[188:191], v12 offset:11264
    s_xor_b32 s64, s37, 8192
    buffer_load_dwordx4 a[32:35], v9, s[24:27], s64 offen offset:0 sc1
    buffer_load_dwordx4 a[36:39], v9, s[24:27], s64 offen offset:1024 sc1
    buffer_load_dwordx4 a[40:43], v9, s[24:27], s64 offen offset:2048 sc1
    buffer_load_dwordx4 a[44:47], v9, s[24:27], s64 offen offset:3072 sc1
    s_cmp_eq_u32 s4, 0
    s_cbranch_scc1 colskip_16
    s_waitcnt lgkmcnt(3)
    v_mfma_f32_16x16x32_bf16 v[168:171], v[48:51], v[176:179], v[168:171]
    v_mfma_f32_16x16x32_bf16 v[172:175], v[216:219], v[176:179], v[172:175]
    s_waitcnt lgkmcnt(2)
    v_mfma_f32_16x16x32_bf16 v[168:171], v[52:55], v[180:183], v[168:171]
    v_mfma_f32_16x16x32_bf16 v[172:175], v[220:223], v[180:183], v[172:175]
    s_waitcnt lgkmcnt(1)
    v_mfma_f32_16x16x32_bf16 v[168:171], v[32:35], v[184:187], v[168:171]
    v_mfma_f32_16x16x32_bf16 v[172:175], v[40:43], v[184:187], v[172:175]
    s_waitcnt lgkmcnt(0)
    v_mfma_f32_16x16x32_bf16 v[168:171], v[36:39], v[188:191], v[168:171]
    v_mfma_f32_16x16x32_bf16 v[172:175], v[44:47], v[188:191], v[172:175]
colskip_16:
    s_waitcnt lgkmcnt(3)
    v_mfma_f32_16x16x32_bf16 v[160:163], v[32:35], v[176:179], v[160:163]
    v_mfma_f32_16x16x32_bf16 v[164:167], v[40:43], v[176:179], v[164:167]
    s_waitcnt lgkmcnt(2)
    v_mfma_f32_16x16x32_bf16 v[160:163], v[36:39], v[180:183], v[160:163]
    v_mfma_f32_16x16x32_bf16 v[164:167], v[44:47], v[180:183], v[164:167]
    s_waitcnt lgkmcnt(1)
    v_mfma_f32_16x16x32_bf16 v[160:163], v[224:227], v[184:187], v[160:163]
    v_mfma_f32_16x16x32_bf16 v[164:167], v[248:251], v[184:187], v[164:167]
    s_waitcnt lgkmcnt(0)
    v_mfma_f32_16x16x32_bf16 v[160:163], v[228:231], v[188:191], v[160:163]
    v_mfma_f32_16x16x32_bf16 v[164:167], v[252:255], v[188:191], v[164:167]
    v_cvt_pk_bf16_f32 v20, v168, v169
    v_cvt_pk_bf16_f32 v21, v170, v171
    v_cvt_pk_bf16_f32 v22, v172, v173
    v_cvt_pk_bf16_f32 v23, v174, v175
    v_or_b32 v20, s40, v20
    buffer_store_dwordx4 v[20:23], v8, s[8:11], s65 offen offset:64 sc1
    s_nop 0
    v_cvt_pk_bf16_f32 v16, v160, v161
    v_cvt_pk_bf16_f32 v17, v162, v163
    v_cvt_pk_bf16_f32 v18, v164, v165
    v_cvt_pk_bf16_f32 v19, v166, v167
    v_or_b32 v16, s40, v16
    buffer_store_dwordx4 v[16:19], v8, s[8:11], s65 offen offset:0 sc1
    v_lshlrev_b32 v5, 4, v1
    v_lshrrev_b32 v8, 5, v1
    v_lshlrev_b32 v8, 10, v8
    v_bfe_u32 v2, v1, 4, 1
    v_mul_u32_u24 v3, 288, v2
    v_add_u32 v8, v8, v3
    v_lshl_add_u32 v95, v2, 5, 0
    v_xor_b32 v95, v95, v5
    v_bfe_u32 v2, v1, 2, 2
    v_lshl_add_u32 v8, v2, 6, v8
    v_and_b32 v2, 1, v1
    v_lshl_add_u32 v8, v2, 4, v8
    v_bfe_u32 v2, v1, 1, 1
    v_lshl_add_u32 v8, v2, 3, v8
    v_xor_b32 v92, 32, v8
    v_add_u32 v9, 65536, v8
    v_add_u32 v93, 65536, v92
    v_add_u32 v10, 131072, v8
    v_add_u32 v94, 131072, v92
    s_lshl_b32 s49, s3, 12
    v_add_u32 v3, s49, v5
    v_add_u32 v6, 65536, v3
    v_add_u32 v7, 131072, v3
    s_mul_i32 s48, s44, 196608
    s_lshr_b32 s5, s3, 1
    s_lshl_b32 s5, s5, 15
    s_add_u32 s50, s48, s5
    s_and_b32 s5, s3, 1
    s_lshl_b32 s5, s5, 12
    s_add_u32 s50, s50, s5
    s_add_u32 s48, s48, s49
    s_add_u32 s12, s34, 7389184
    s_addc_u32 s13, s35, 0
    s_mov_b32 s14, 5767168
    s_mov_b32 s15, 0x20000
    s_mul_i32 s47, s44, 540672
    s_lshl_b32 s5, s46, 10
    s_add_u32 s47, s47, s5
    s_cmp_eq_u32 s44, 10
    s_cselect_b32 s73, 0, s40
    s_cmp_ge_u32 s3, 2
    s_cselect_b32 s78, s73, s40
    s_mul_i32 s5, s44, 88
    s_add_u32 s5, s5, s46
    s_lshl_b32 s5, s5, 6
    s_add_u32 s5, s5, 91648
    s_cmp_eq_u32 s45, 22
    s_cselect_b32 s83, 16777216, s5
    v_lshlrev_b32 v16, 4, v1
    v_mov_b32 v17, 16777216
    v_cmp_gt_u32 vcc, 4, v1
    s_add_u32 s6, s36, 1
    v_mov_b32 v18, s6
    v_mov_b32 v19, s6
    v_cndmask_b32 v16, v17, v16, vcc
    v_pk_mov_b32 v[20:21], v[18:19], v[18:19]
    v_mov_b32 v24, 1
    v_mov_b32 v25, 1
    v_mov_b32 v26, 1
    v_mov_b32 v27, 1
    s_mul_i32 s5, s101, 88
    s_add_u32 s5, s5, s3
    s_lshl_b32 s5, s5, 6
    s_add_u32 s5, s5, 91648
    v_min_u32 v119, 21, v1
    v_lshl_add_u32 v119, v119, 8, s5
    s_xor_b32 s6, s42, 0
    s_mul_i32 s6, s6, 88064
    s_add_u32 s6, s6, 13631488
    s_add_u32 s56, s34, s6
    s_addc_u32 s57, s35, 0
    s_mov_b32 s58, 88064
    s_mov_b32 s59, 0x20000
    s_xor_b32 s6, s42, 1
    s_mul_i32 s6, s6, 88064
    s_add_u32 s6, s6, 13631488
    s_add_u32 s60, s34, s6
    s_addc_u32 s61, s35, 0
    s_mov_b32 s62, 88064
    s_mov_b32 s63, 0x20000
    s_mul_i32 s5, s54, 90112
    s_add_u32 s5, s5, 7389184
    s_add_u32 s16, s34, s5
    s_addc_u32 s17, s35, 0
    s_mov_b32 s18, 90112
    s_mov_b32 s19, 0x20000
    s_lshl_b32 s28, s54, 7
    s_mul_i32 s5, s55, 90112
    s_add_u32 s5, s5, 7389184
    s_add_u32 s20, s34, s5
    s_addc_u32 s21, s35, 0
    s_mov_b32 s22, 90112
    s_mov_b32 s23, 0x20000
    s_lshl_b32 s29, s55, 7
    v_lshrrev_b32 v4, 5, v1
    v_lshlrev_b32 v4, 12, v4
    v_bfe_u32 v40, v1, 4, 1
    v_lshl_add_u32 v4, v40, 9, v4
    s_lshl_b32 s5, s3, 10
    v_and_b32 v40, 15, v1
    v_lshl_add_u32 v40, v40, 4, s5
    v_add_u32 v4, v4, v40
    v_and_b32 v40, 8, v1
    v_lshl_add_u32 v14, v40, 4, v4
    s_mul_i32 s6, s3, 6144
    s_add_u32 s6, s6, 65536
    v_add_u32 v112, s6, v5
    s_xor_b32 s5, s3, 1
    s_mul_i32 s5, s5, 6144
    s_add_u32 s5, s5, 65536
    v_add_u32 v11, s5, v5
    s_xor_b32 s5, s3, 2
    s_mul_i32 s5, s5, 6144
    s_add_u32 s5, s5, 65536
    v_add_u32 v12, s5, v5
    s_xor_b32 s5, s3, 3
    s_mul_i32 s5, s5, 6144
    s_add_u32 s5, s5, 65536
    v_add_u32 v13, s5, v5
    s_add_u32 s68, s34, 7340032
    s_addc_u32 s69, s35, 0
    s_mov_b32 s70, 8192
    s_mov_b32 s71, 0x20000
    s_and_b32 s5, s3, 1
    v_lshrrev_b32 v40, 4, v1
    v_and_b32 v41, 15, v1
    v_lshl_add_u32 v41, s5, 4, v41
    v_lshlrev_b32 v113, 6, v41
    v_lshl_add_u32 v113, v40, 4, v113
    v_lshlrev_b32 v114, 5, v40
    v_bfe_u32 v42, v1, 1, 3
    v_lshl_add_u32 v115, v42, 2, v114
    s_lshl_b32 s6, s3, 7
    v_add_u32 v115, s6, v115
    s_lshl_b32 s5, s42, 5
    v_or_b32 v42, s5, v41
    v_cmp_eq_u32 vcc, 1, v42
    s_nop 1
    v_cndmask_b32 v116, 1.0, 0, vcc
    v_and_b32 v117, 15, v1
    s_lshl_b32 s6, s3, 9
    v_lshl_add_u32 v117, v117, 5, s6
    v_mov_b32 v42, 16777216
    v_cmp_gt_u32 vcc, 4, v1
    s_nop 1
    v_cndmask_b32 v118, v42, v5, vcc
    s_cmp_eq_u32 s3, 0
    s_cselect_b32 s65, s54, s55
    s_lshl_b32 s65, s65, 6
    s_lshl_b32 s5, s53, 12
    s_add_u32 s65, s65, s5
    s_lshl_b32 s5, s42, 11
    s_lshl_b32 s74, s54, 15
    s_add_u32 s74, s74, s5
    s_lshl_b32 s5, s42, 11
    s_lshl_b32 s75, s55, 15
    s_add_u32 s75, s75, s5
    s_xor_b32 s64, s37, 12288
    buffer_load_dwordx4 a[48:51], v5, s[24:27], s64 offen offset:0 sc1
    buffer_load_dwordx4 a[52:55], v5, s[24:27], s64 offen offset:1024 sc1
    buffer_load_dwordx4 a[56:59], v5, s[24:27], s64 offen offset:2048 sc1
    buffer_load_dwordx4 a[60:63], v5, s[24:27], s64 offen offset:3072 sc1
    s_xor_b32 s64, s37, 16384
    buffer_load_dwordx4 a[64:67], v5, s[24:27], s64 offen offset:0 sc1
    buffer_load_dwordx4 a[68:71], v5, s[24:27], s64 offen offset:1024 sc1
    buffer_load_dwordx4 a[72:75], v5, s[24:27], s64 offen offset:2048 sc1
    buffer_load_dwordx4 a[76:79], v5, s[24:27], s64 offen offset:3072 sc1
    s_xor_b32 s64, s37, 20480
    buffer_load_dwordx4 a[80:83], v5, s[24:27], s64 offen offset:0 sc1
    buffer_load_dwordx4 a[84:87], v5, s[24:27], s64 offen offset:1024 sc1
    s_waitcnt vmcnt(10)
    s_barrier
    s_cmp_eq_u32 s45, 22
    s_cbranch_scc1 L_g1stats0
    s_add_u32 m0, s49, 0
    s_add_u32 s52, s50, 0
    buffer_load_dwordx4 v95, s[8:11], s52 offen offset:0 sc1 lds
    buffer_load_dwordx4 v95, s[8:11], s52 offen offset:1024 sc1 lds
    buffer_load_dwordx4 v95, s[8:11], s52 offen offset:2048 sc1 lds
    buffer_load_dwordx4 v95, s[8:11], s52 offen offset:3072 sc1 lds
    s_add_u32 m0, s49, 16384
    s_add_u32 s52, s50, 8192
    buffer_load_dwordx4 v95, s[8:11], s52 offen offset:0 sc1 lds
    buffer_load_dwordx4 v95, s[8:11], s52 offen offset:1024 sc1 lds
    buffer_load_dwordx4 v95, s[8:11], s52 offen offset:2048 sc1 lds
    buffer_load_dwordx4 v95, s[8:11], s52 offen offset:3072 sc1 lds
    s_waitcnt vmcnt(4)
    ds_read2st64_b32 v[88:89], v3 offset0:0 offset1:4
    ds_read2st64_b32 v[90:91], v3 offset0:8 offset1:12
    s_waitcnt lgkmcnt(0)
    v_bitop3_b32 v88, v88, v89, v90 bitop3:0x80
    v_bitop3_b32 v88, v88, v91, s40 bitop3:0x80
    v_cmp_ne_u32 vcc, s40, v88
    s_cbranch_vccnz cslow_18
cback_17:
    s_barrier
    ds_read_b64_tr_b16 v[176:177], v8 offset:0
    ds_read_b64_tr_b16 v[178:179], v8 offset:512
    ds_read_b64_tr_b16 v[180:181], v8 offset:8192
    ds_read_b64_tr_b16 v[182:183], v8 offset:8704
    ds_read_b64_tr_b16 v[184:185], v92 offset:0
    ds_read_b64_tr_b16 v[186:187], v92 offset:512
    ds_read_b64_tr_b16 v[188:189], v92 offset:8192
    ds_read_b64_tr_b16 v[190:191], v92 offset:8704
    ds_read_b64_tr_b16 v[192:193], v8 offset:2048
    ds_read_b64_tr_b16 v[194:195], v8 offset:2560
    s_waitcnt lgkmcnt(6)
    v_mfma_f32_16x16x32_bf16 v[40:43], a[0:3], v[176:179], 0
    ds_read_b64_tr_b16 v[196:197], v8 offset:10240
    ds_read_b64_tr_b16 v[198:199], v8 offset:10752
    v_mfma_f32_16x16x32_bf16 v[48:51], a[4:7], v[176:179], 0
    s_add_u32 m0, s49, 32768
    s_add_u32 s52, s50, 16384
    v_mfma_f32_16x16x32_bf16 v[56:59], a[0:3], v[180:183], 0
    ds_read_b64_tr_b16 v[176:177], v92 offset:2048
    ds_read_b64_tr_b16 v[178:179], v92 offset:2560
    v_mfma_f32_16x16x32_bf16 v[64:67], a[4:7], v[180:183], 0
    buffer_load_dwordx4 v95, s[8:11], s52 offen offset:0 sc1 lds
    s_waitcnt lgkmcnt(6)
    v_mfma_f32_16x16x32_bf16 v[44:47], a[0:3], v[184:187], 0
    ds_read_b64_tr_b16 v[180:181], v92 offset:10240
    ds_read_b64_tr_b16 v[182:183], v92 offset:10752
    v_mfma_f32_16x16x32_bf16 v[52:55], a[4:7], v[184:187], 0
    buffer_load_dwordx4 v95, s[8:11], s52 offen offset:1024 sc1 lds
    v_mfma_f32_16x16x32_bf16 v[60:63], a[0:3], v[188:191], 0
    ds_read_b64_tr_b16 v[184:185], v8 offset:4096
    ds_read_b64_tr_b16 v[186:187], v8 offset:4608
    v_mfma_f32_16x16x32_bf16 v[68:71], a[4:7], v[188:191], 0
    s_waitcnt lgkmcnt(6)
    v_mfma_f32_16x16x32_bf16 v[40:43], a[8:11], v[192:195], v[40:43]
    ds_read_b64_tr_b16 v[188:189], v8 offset:12288
    ds_read_b64_tr_b16 v[190:191], v8 offset:12800
    v_mfma_f32_16x16x32_bf16 v[48:51], a[12:15], v[192:195], v[48:51]
    s_waitcnt vmcnt(2)
    ds_read2st64_b32 v[88:89], v3 offset0:64 offset1:68
    v_mfma_f32_16x16x32_bf16 v[56:59], a[8:11], v[196:199], v[56:59]
    ds_read_b64_tr_b16 v[192:193], v92 offset:4096
    ds_read_b64_tr_b16 v[194:195], v92 offset:4608
    v_mfma_f32_16x16x32_bf16 v[64:67], a[12:15], v[196:199], v[64:67]
    buffer_load_dwordx4 v95, s[8:11], s52 offen offset:2048 sc1 lds
    s_waitcnt lgkmcnt(7)
    v_mfma_f32_16x16x32_bf16 v[44:47], a[8:11], v[176:179], v[44:47]
    ds_read_b64_tr_b16 v[196:197], v92 offset:12288
    ds_read_b64_tr_b16 v[198:199], v92 offset:12800
    v_mfma_f32_16x16x32_bf16 v[52:55], a[12:15], v[176:179], v[52:55]
    buffer_load_dwordx4 v95, s[8:11], s52 offen offset:3072 sc1 lds
    ds_read2st64_b32 v[90:91], v3 offset0:72 offset1:76
    v_mfma_f32_16x16x32_bf16 v[60:63], a[8:11], v[180:183], v[60:63]
    ds_read_b64_tr_b16 v[176:177], v8 offset:6144
    ds_read_b64_tr_b16 v[178:179], v8 offset:6656
    v_mfma_f32_16x16x32_bf16 v[68:71], a[12:15], v[180:183], v[68:71]
    s_waitcnt lgkmcnt(8)
    v_mfma_f32_16x16x32_bf16 v[40:43], a[16:19], v[184:187], v[40:43]
    ds_read_b64_tr_b16 v[180:181], v8 offset:14336
    ds_read_b64_tr_b16 v[182:183], v8 offset:14848
    v_mfma_f32_16x16x32_bf16 v[48:51], a[20:23], v[184:187], v[48:51]
    buffer_load_dwordx4 a[88:91], v5, s[24:27], s64 offen offset:2048 sc1
    v_mfma_f32_16x16x32_bf16 v[56:59], a[16:19], v[188:191], v[56:59]
    ds_read_b64_tr_b16 v[184:185], v92 offset:6144
    ds_read_b64_tr_b16 v[186:187], v92 offset:6656
    v_mfma_f32_16x16x32_bf16 v[64:67], a[20:23], v[188:191], v[64:67]
    s_waitcnt lgkmcnt(6)
    v_bitop3_b32 v88, v88, v89, v90 bitop3:0x80
    v_mfma_f32_16x16x32_bf16 v[44:47], a[16:19], v[192:195], v[44:47]
    ds_read_b64_tr_b16 v[188:189], v92 offset:14336
    ds_read_b64_tr_b16 v[190:191], v92 offset:14848
    v_mfma_f32_16x16x32_bf16 v[52:55], a[20:23], v[192:195], v[52:55]
    v_bitop3_b32 v88, v88, v91, s40 bitop3:0x80
    v_cmp_ne_u32 vcc, s40, v88
    v_mfma_f32_16x16x32_bf16 v[60:63], a[16:19], v[196:199], v[60:63]
    s_cbranch_vccnz cslow_20
cback_19:
    s_barrier
    v_mfma_f32_16x16x32_bf16 v[68:71], a[20:23], v[196:199], v[68:71]
    ds_read_b64_tr_b16 v[192:193], v8 offset:16384
    ds_read_b64_tr_b16 v[194:195], v8 offset:16896
    s_waitcnt lgkmcnt(6)
    v_mfma_f32_16x16x32_bf16 v[40:43], a[24:27], v[176:179], v[40:43]
    ds_read_b64_tr_b16 v[196:197], v8 offset:24576
    ds_read_b64_tr_b16 v[198:199], v8 offset:25088
    v_mfma_f32_16x16x32_bf16 v[48:51], a[28:31], v[176:179], v[48:51]
    buffer_load_dwordx4 a[92:95], v5, s[24:27], s64 offen offset:3072 sc1
    s_xor_b32 s64, s37, 24576
    v_mfma_f32_16x16x32_bf16 v[56:59], a[24:27], v[180:183], v[56:59]
    ds_read_b64_tr_b16 v[176:177], v92 offset:16384
    ds_read_b64_tr_b16 v[178:179], v92 offset:16896
    v_mfma_f32_16x16x32_bf16 v[64:67], a[28:31], v[180:183], v[64:67]
    buffer_load_dwordx4 a[96:99], v5, s[24:27], s64 offen offset:0 sc1
    s_waitcnt lgkmcnt(6)
    v_mfma_f32_16x16x32_bf16 v[44:47], a[24:27], v[184:187], v[44:47]
    ds_read_b64_tr_b16 v[180:181], v92 offset:24576
    ds_read_b64_tr_b16 v[182:183], v92 offset:25088
    v_mfma_f32_16x16x32_bf16 v[52:55], a[28:31], v[184:187], v[52:55]
    v_mfma_f32_16x16x32_bf16 v[60:63], a[24:27], v[188:191], v[60:63]
    ds_read_b64_tr_b16 v[184:185], v8 offset:18432
    ds_read_b64_tr_b16 v[186:187], v8 offset:18944
    v_mfma_f32_16x16x32_bf16 v[68:71], a[28:31], v[188:191], v[68:71]
    buffer_load_dwordx4 a[100:103], v5, s[24:27], s64 offen offset:1024 sc1
    s_waitcnt lgkmcnt(6)
    v_mfma_f32_16x16x32_bf16 v[40:43], a[32:35], v[192:195], v[40:43]
    ds_read_b64_tr_b16 v[188:189], v8 offset:26624
    ds_read_b64_tr_b16 v[190:191], v8 offset:27136
    v_mfma_f32_16x16x32_bf16 v[48:51], a[36:39], v[192:195], v[48:51]
    s_add_u32 m0, s49, 49152
    s_add_u32 s52, s50, 24576
    v_mfma_f32_16x16x32_bf16 v[56:59], a[32:35], v[196:199], v[56:59]
    ds_read_b64_tr_b16 v[192:193], v92 offset:18432
    ds_read_b64_tr_b16 v[194:195], v92 offset:18944
    v_mfma_f32_16x16x32_bf16 v[64:67], a[36:39], v[196:199], v[64:67]
    buffer_load_dwordx4 v95, s[8:11], s52 offen offset:0 sc1 lds
    s_waitcnt lgkmcnt(6)
    v_mfma_f32_16x16x32_bf16 v[44:47], a[32:35], v[176:179], v[44:47]
    ds_read_b64_tr_b16 v[196:197], v92 offset:26624
    ds_read_b64_tr_b16 v[198:199], v92 offset:27136
    v_mfma_f32_16x16x32_bf16 v[52:55], a[36:39], v[176:179], v[52:55]
    buffer_load_dwordx4 v95, s[8:11], s52 offen offset:1024 sc1 lds
    v_mfma_f32_16x16x32_bf16 v[60:63], a[32:35], v[180:183], v[60:63]
    ds_read_b64_tr_b16 v[176:177], v8 offset:20480
    ds_read_b64_tr_b16 v[178:179], v8 offset:20992
    v_mfma_f32_16x16x32_bf16 v[68:71], a[36:39], v[180:183], v[68:71]
    s_waitcnt lgkmcnt(6)
    v_mfma_f32_16x16x32_bf16 v[40:43], a[40:43], v[184:187], v[40:43]
    ds_read_b64_tr_b16 v[180:181], v8 offset:28672
    ds_read_b64_tr_b16 v[182:183], v8 offset:29184
    v_mfma_f32_16x16x32_bf16 v[48:51], a[44:47], v[184:187], v[48:51]
    s_waitcnt vmcnt(6)
    ds_read2st64_b32 v[88:89], v3 offset0:128 offset1:132
    v_mfma_f32_16x16x32_bf16 v[56:59], a[40:43], v[188:191], v[56:59]
    ds_read_b64_tr_b16 v[184:185], v92 offset:20480
    ds_read_b64_tr_b16 v[186:187], v92 offset:20992
    v_mfma_f32_16x16x32_bf16 v[64:67], a[44:47], v[188:191], v[64:67]
    buffer_load_dwordx4 v95, s[8:11], s52 offen offset:2048 sc1 lds
    s_waitcnt lgkmcnt(7)
    v_mfma_f32_16x16x32_bf16 v[44:47], a[40:43], v[192:195], v[44:47]
    ds_read_b64_tr_b16 v[188:189], v92 offset:28672
    ds_read_b64_tr_b16 v[190:191], v92 offset:29184
    v_mfma_f32_16x16x32_bf16 v[52:55], a[44:47], v[192:195], v[52:55]
    buffer_load_dwordx4 v95, s[8:11], s52 offen offset:3072 sc1 lds
    ds_read2st64_b32 v[90:91], v3 offset0:136 offset1:140
    v_mfma_f32_16x16x32_bf16 v[60:63], a[40:43], v[196:199], v[60:63]
    ds_read_b64_tr_b16 v[192:193], v8 offset:22528
    ds_read_b64_tr_b16 v[194:195], v8 offset:23040
    v_mfma_f32_16x16x32_bf16 v[68:71], a[44:47], v[196:199], v[68:71]
    s_waitcnt lgkmcnt(8)
    v_mfma_f32_16x16x32_bf16 v[40:43], a[48:51], v[176:179], v[40:43]
    ds_read_b64_tr_b16 v[196:197], v8 offset:30720
    ds_read_b64_tr_b16 v[198:199], v8 offset:31232
    v_mfma_f32_16x16x32_bf16 v[48:51], a[52:55], v[176:179], v[48:51]
    buffer_load_dwordx4 a[104:107], v5, s[24:27], s64 offen offset:2048 sc1
    v_mfma_f32_16x16x32_bf16 v[56:59], a[48:51], v[180:183], v[56:59]
    ds_read_b64_tr_b16 v[176:177], v92 offset:22528
    ds_read_b64_tr_b16 v[178:179], v92 offset:23040
    v_mfma_f32_16x16x32_bf16 v[64:67], a[52:55], v[180:183], v[64:67]
    s_waitcnt lgkmcnt(6)
    v_bitop3_b32 v88, v88, v89, v90 bitop3:0x80
    v_mfma_f32_16x16x32_bf16 v[44:47], a[48:51], v[184:187], v[44:47]
    ds_read_b64_tr_b16 v[180:181], v92 offset:30720
    ds_read_b64_tr_b16 v[182:183], v92 offset:31232
    v_mfma_f32_16x16x32_bf16 v[52:55], a[52:55], v[184:187], v[52:55]
    v_bitop3_b32 v88, v88, v91, s40 bitop3:0x80
    v_cmp_ne_u32 vcc, s40, v88
    v_mfma_f32_16x16x32_bf16 v[60:63], a[48:51], v[188:191], v[60:63]
    s_cbranch_vccnz cslow_22
cback_21:
    s_barrier
    v_mfma_f32_16x16x32_bf16 v[68:71], a[52:55], v[188:191], v[68:71]
    ds_read_b64_tr_b16 v[184:185], v8 offset:32768
    ds_read_b64_tr_b16 v[186:187], v8 offset:33280
    s_waitcnt lgkmcnt(6)
    v_mfma_f32_16x16x32_bf16 v[40:43], a[56:59], v[192:195], v[40:43]
    ds_read_b64_tr_b16 v[188:189], v8 offset:40960
    ds_read_b64_tr_b16 v[190:191], v8 offset:41472
    v_mfma_f32_16x16x32_bf16 v[48:51], a[60:63], v[192:195], v[48:51]
    buffer_load_dwordx4 a[108:111], v5, s[24:27], s64 offen offset:3072 sc1
    s_xor_b32 s64, s37, 28672
    v_mfma_f32_16x16x32_bf16 v[56:59], a[56:59], v[196:199], v[56:59]
    ds_read_b64_tr_b16 v[192:193], v92 offset:32768
    ds_read_b64_tr_b16 v[194:195], v92 offset:33280
    v_mfma_f32_16x16x32_bf16 v[64:67], a[60:63], v[196:199], v[64:67]
    buffer_load_dwordx4 a[112:115], v5, s[24:27], s64 offen offset:0 sc1
    s_waitcnt lgkmcnt(6)
    v_mfma_f32_16x16x32_bf16 v[44:47], a[56:59], v[176:179], v[44:47]
    ds_read_b64_tr_b16 v[196:197], v92 offset:40960
    ds_read_b64_tr_b16 v[198:199], v92 offset:41472
    v_mfma_f32_16x16x32_bf16 v[52:55], a[60:63], v[176:179], v[52:55]
    v_mfma_f32_16x16x32_bf16 v[60:63], a[56:59], v[180:183], v[60:63]
    ds_read_b64_tr_b16 v[176:177], v8 offset:34816
    ds_read_b64_tr_b16 v[178:179], v8 offset:35328
    v_mfma_f32_16x16x32_bf16 v[68:71], a[60:63], v[180:183], v[68:71]
    buffer_load_dwordx4 a[116:119], v5, s[24:27], s64 offen offset:1024 sc1
    s_waitcnt lgkmcnt(6)
    v_mfma_f32_16x16x32_bf16 v[40:43], a[64:67], v[184:187], v[40:43]
    ds_read_b64_tr_b16 v[180:181], v8 offset:43008
    ds_read_b64_tr_b16 v[182:183], v8 offset:43520
    v_mfma_f32_16x16x32_bf16 v[48:51], a[68:71], v[184:187], v[48:51]
    s_add_u32 m0, s49, 65536
    s_add_u32 s52, s48, 65536
    v_mfma_f32_16x16x32_bf16 v[56:59], a[64:67], v[188:191], v[56:59]
    ds_read_b64_tr_b16 v[184:185], v92 offset:34816
    ds_read_b64_tr_b16 v[186:187], v92 offset:35328
    v_mfma_f32_16x16x32_bf16 v[64:67], a[68:71], v[188:191], v[64:67]
    buffer_load_dwordx4 v95, s[8:11], s52 offen offset:0 sc1 lds
    s_waitcnt lgkmcnt(6)
    v_mfma_f32_16x16x32_bf16 v[44:47], a[64:67], v[192:195], v[44:47]
    ds_read_b64_tr_b16 v[188:189], v92 offset:43008
    ds_read_b64_tr_b16 v[190:191], v92 offset:43520
    v_mfma_f32_16x16x32_bf16 v[52:55], a[68:71], v[192:195], v[52:55]
    buffer_load_dwordx4 v95, s[8:11], s52 offen offset:1024 sc1 lds
    v_mfma_f32_16x16x32_bf16 v[60:63], a[64:67], v[196:199], v[60:63]
    ds_read_b64_tr_b16 v[192:193], v8 offset:36864
    ds_read_b64_tr_b16 v[194:195], v8 offset:37376
    v_mfma_f32_16x16x32_bf16 v[68:71], a[68:71], v[196:199], v[68:71]
    s_waitcnt lgkmcnt(6)
    v_mfma_f32_16x16x32_bf16 v[40:43], a[72:75], v[176:179], v[40:43]
    ds_read_b64_tr_b16 v[196:197], v8 offset:45056
    ds_read_b64_tr_b16 v[198:199], v8 offset:45568
    v_mfma_f32_16x16x32_bf16 v[48:51], a[76:79], v[176:179], v[48:51]
    s_waitcnt vmcnt(6)
    ds_read2st64_b32 v[88:89], v3 offset0:192 offset1:196
    v_mfma_f32_16x16x32_bf16 v[56:59], a[72:75], v[180:183], v[56:59]
    ds_read_b64_tr_b16 v[176:177], v92 offset:36864
    ds_read_b64_tr_b16 v[178:179], v92 offset:37376
    v_mfma_f32_16x16x32_bf16 v[64:67], a[76:79], v[180:183], v[64:67]
    buffer_load_dwordx4 v95, s[8:11], s52 offen offset:2048 sc1 lds
    s_waitcnt lgkmcnt(7)
    v_mfma_f32_16x16x32_bf16 v[44:47], a[72:75], v[184:187], v[44:47]
    ds_read_b64_tr_b16 v[180:181], v92 offset:45056
    ds_read_b64_tr_b16 v[182:183], v92 offset:45568
    v_mfma_f32_16x16x32_bf16 v[52:55], a[76:79], v[184:187], v[52:55]
    buffer_load_dwordx4 v95, s[8:11], s52 offen offset:3072 sc1 lds
    ds_read2st64_b32 v[90:91], v3 offset0:200 offset1:204
    v_mfma_f32_16x16x32_bf16 v[60:63], a[72:75], v[188:191], v[60:63]
    ds_read_b64_tr_b16 v[184:185], v8 offset:38912
    ds_read_b64_tr_b16 v[186:187], v8 offset:39424
    v_mfma_f32_16x16x32_bf16 v[68:71], a[76:79], v[188:191], v[68:71]
    s_waitcnt lgkmcnt(8)
    v_mfma_f32_16x16x32_bf16 v[40:43], a[80:83], v[192:195], v[40:43]
    ds_read_b64_tr_b16 v[188:189], v8 offset:47104
    ds_read_b64_tr_b16 v[190:191], v8 offset:47616
    v_mfma_f32_16x16x32_bf16 v[48:51], a[84:87], v[192:195], v[48:51]
    buffer_load_dwordx4 a[120:123], v5, s[24:27], s64 offen offset:2048 sc1
    v_mfma_f32_16x16x32_bf16 v[56:59], a[80:83], v[196:199], v[56:59]
    ds_read_b64_tr_b16 v[192:193], v92 offset:38912
    ds_read_b64_tr_b16 v[194:195], v92 offset:39424
    v_mfma_f32_16x16x32_bf16 v[64:67], a[84:87], v[196:199], v[64:67]
    s_waitcnt lgkmcnt(6)
    v_bitop3_b32 v88, v88, v89, v90 bitop3:0x80
    v_mfma_f32_16x16x32_bf16 v[44:47], a[80:83], v[176:179], v[44:47]
    ds_read_b64_tr_b16 v[196:197], v92 offset:47104
    ds_read_b64_tr_b16 v[198:199], v92 offset:47616
    v_mfma_f32_16x16x32_bf16 v[52:55], a[84:87], v[176:179], v[52:55]
    v_bitop3_b32 v88, v88, v91, s40 bitop3:0x80
    v_cmp_ne_u32 vcc, s40, v88
    v_mfma_f32_16x16x32_bf16 v[60:63], a[80:83], v[180:183], v[60:63]
    s_cbranch_vccnz cslow_24
cback_23:
    s_barrier
    v_mfma_f32_16x16x32_bf16 v[68:71], a[84:87], v[180:183], v[68:71]
    ds_read_b64_tr_b16 v[176:177], v8 offset:49152
    ds_read_b64_tr_b16 v[178:179], v8 offset:49664
    s_waitcnt lgkmcnt(6)
    v_mfma_f32_16x16x32_bf16 v[40:43], a[88:91], v[184:187], v[40:43]
    ds_read_b64_tr_b16 v[180:181], v8 offset:57344
    ds_read_b64_tr_b16 v[182:183], v8 offset:57856
    v_mfma_f32_16x16x32_bf16 v[48:51], a[92:95], v[184:187], v[48:51]
    buffer_load_dwordx4 a[124:127], v5, s[24:27], s64 offen offset:3072 sc1
    s_add_u32 m0, s49, 81920
    s_add_u32 s52, s48, 81920
    v_mfma_f32_16x16x32_bf16 v[56:59], a[88:91], v[188:191], v[56:59]
    ds_read_b64_tr_b16 v[184:185], v92 offset:49152
    ds_read_b64_tr_b16 v[186:187], v92 offset:49664
    v_mfma_f32_16x16x32_bf16 v[64:67], a[92:95], v[188:191], v[64:67]
    buffer_load_dwordx4 v95, s[8:11], s52 offen offset:0 sc1 lds
    s_waitcnt lgkmcnt(6)
    v_mfma_f32_16x16x32_bf16 v[44:47], a[88:91], v[192:195], v[44:47]
    ds_read_b64_tr_b16 v[188:189], v92 offset:57344
    ds_read_b64_tr_b16 v[190:191], v92 offset:57856
    v_mfma_f32_16x16x32_bf16 v[52:55], a[92:95], v[192:195], v[52:55]
    v_mfma_f32_16x16x32_bf16 v[60:63], a[88:91], v[196:199], v[60:63]
    ds_read_b64_tr_b16 v[192:193], v8 offset:51200
    ds_read_b64_tr_b16 v[194:195], v8 offset:51712
    v_mfma_f32_16x16x32_bf16 v[68:71], a[92:95], v[196:199], v[68:71]
    buffer_load_dwordx4 v95, s[8:11], s52 offen offset:1024 sc1 lds
    s_waitcnt lgkmcnt(6)
    v_mfma_f32_16x16x32_bf16 v[40:43], a[96:99], v[176:179], v[40:43]
    ds_read_b64_tr_b16 v[196:197], v8 offset:59392
    ds_read_b64_tr_b16 v[198:199], v8 offset:59904
    v_mfma_f32_16x16x32_bf16 v[48:51], a[100:103], v[176:179], v[48:51]
    v_mfma_f32_16x16x32_bf16 v[56:59], a[96:99], v[180:183], v[56:59]
    ds_read_b64_tr_b16 v[176:177], v92 offset:51200
    ds_read_b64_tr_b16 v[178:179], v92 offset:51712
    v_mfma_f32_16x16x32_bf16 v[64:67], a[100:103], v[180:183], v[64:67]
    buffer_load_dwordx4 v95, s[8:11], s52 offen offset:2048 sc1 lds
    s_waitcnt lgkmcnt(6)
    v_mfma_f32_16x16x32_bf16 v[44:47], a[96:99], v[184:187], v[44:47]
    ds_read_b64_tr_b16 v[180:181], v92 offset:59392
    ds_read_b64_tr_b16 v[182:183], v92 offset:59904
    v_mfma_f32_16x16x32_bf16 v[52:55], a[100:103], v[184:187], v[52:55]
    buffer_load_dwordx4 v95, s[8:11], s52 offen offset:3072 sc1 lds
    v_mfma_f32_16x16x32_bf16 v[60:63], a[96:99], v[188:191], v[60:63]
    ds_read_b64_tr_b16 v[184:185], v8 offset:53248
    ds_read_b64_tr_b16 v[186:187], v8 offset:53760
    v_mfma_f32_16x16x32_bf16 v[68:71], a[100:103], v[188:191], v[68:71]
    s_waitcnt lgkmcnt(6)
    s_waitcnt vmcnt(13)
    v_mfma_f32_16x16x32_bf16 v[40:43], a[104:107], v[192:195], v[40:43]
    ds_read_b64_tr_b16 v[188:189], v8 offset:61440
    ds_read_b64_tr_b16 v[190:191], v8 offset:61952
    s_waitcnt vmcnt(12)
    v_mfma_f32_16x16x32_bf16 v[48:51], a[108:111], v[192:195], v[48:51]
    s_waitcnt vmcnt(6)
    ds_read2st64_b32 v[88:89], v6 offset0:0 offset1:4
    v_mfma_f32_16x16x32_bf16 v[56:59], a[104:107], v[196:199], v[56:59]
    ds_read_b64_tr_b16 v[192:193], v92 offset:53248
    ds_read_b64_tr_b16 v[194:195], v92 offset:53760
    v_mfma_f32_16x16x32_bf16 v[64:67], a[108:111], v[196:199], v[64:67]
    s_add_u32 m0, s49, 98304
    s_add_u32 s52, s48, 98304
    s_waitcnt lgkmcnt(7)
    v_mfma_f32_16x16x32_bf16 v[44:47], a[104:107], v[176:179], v[44:47]
    ds_read_b64_tr_b16 v[196:197], v92 offset:61440
    ds_read_b64_tr_b16 v[198:199], v92 offset:61952
    v_mfma_f32_16x16x32_bf16 v[52:55], a[108:111], v[176:179], v[52:55]
    buffer_load_dwordx4 v95, s[8:11], s52 offen offset:0 sc1 lds
    ds_read2st64_b32 v[90:91], v6 offset0:8 offset1:12
    v_mfma_f32_16x16x32_bf16 v[60:63], a[104:107], v[180:183], v[60:63]
    ds_read_b64_tr_b16 v[176:177], v8 offset:55296
    ds_read_b64_tr_b16 v[178:179], v8 offset:55808
    v_mfma_f32_16x16x32_bf16 v[68:71], a[108:111], v[180:183], v[68:71]
    buffer_load_dwordx4 v95, s[8:11], s52 offen offset:1024 sc1 lds
    s_waitcnt lgkmcnt(8)
    v_mfma_f32_16x16x32_bf16 v[40:43], a[112:115], v[184:187], v[40:43]
    ds_read_b64_tr_b16 v[180:181], v8 offset:63488
    ds_read_b64_tr_b16 v[182:183], v8 offset:64000
    v_mfma_f32_16x16x32_bf16 v[48:51], a[116:119], v[184:187], v[48:51]
    v_mfma_f32_16x16x32_bf16 v[56:59], a[112:115], v[188:191], v[56:59]
    ds_read_b64_tr_b16 v[184:185], v92 offset:55296
    ds_read_b64_tr_b16 v[186:187], v92 offset:55808
    v_mfma_f32_16x16x32_bf16 v[64:67], a[116:119], v[188:191], v[64:67]
    buffer_load_dwordx4 v95, s[8:11], s52 offen offset:2048 sc1 lds
    s_waitcnt lgkmcnt(6)
    v_bitop3_b32 v88, v88, v89, v90 bitop3:0x80
    v_mfma_f32_16x16x32_bf16 v[44:47], a[112:115], v[192:195], v[44:47]
    ds_read_b64_tr_b16 v[188:189], v92 offset:63488
    ds_read_b64_tr_b16 v[190:191], v92 offset:64000
    v_mfma_f32_16x16x32_bf16 v[52:55], a[116:119], v[192:195], v[52:55]
    v_bitop3_b32 v88, v88, v91, s40 bitop3:0x80
    v_cmp_ne_u32 vcc, s40, v88
    v_mfma_f32_16x16x32_bf16 v[60:63], a[112:115], v[196:199], v[60:63]
    s_cbranch_vccnz cslow_26
cback_25:
    s_barrier
    v_mfma_f32_16x16x32_bf16 v[68:71], a[116:119], v[196:199], v[68:71]
    ds_read_b64_tr_b16 v[192:193], v9 offset:0
    ds_read_b64_tr_b16 v[194:195], v9 offset:512
    s_waitcnt lgkmcnt(6)
    s_waitcnt vmcnt(8)
    v_mfma_f32_16x16x32_bf16 v[40:43], a[120:123], v[176:179], v[40:43]
    ds_read_b64_tr_b16 v[196:197], v93 offset:0
    ds_read_b64_tr_b16 v[198:199], v93 offset:512
    s_waitcnt vmcnt(7)
    v_mfma_f32_16x16x32_bf16 v[48:51], a[124:127], v[176:179], v[48:51]
    buffer_load_dwordx4 v95, s[8:11], s52 offen offset:3072 sc1 lds
    s_add_u32 s51, s47, 270336
    v_mfma_f32_16x16x32_bf16 v[56:59], a[120:123], v[180:183], v[56:59]
    ds_read_b64_tr_b16 v[176:177], v9 offset:2048
    ds_read_b64_tr_b16 v[178:179], v9 offset:2560
    v_mfma_f32_16x16x32_bf16 v[64:67], a[124:127], v[180:183], v[64:67]
    buffer_store_dwordx4 v[24:27], v5, s[12:15], s51 offen sc1
    s_waitcnt lgkmcnt(6)
    v_mfma_f32_16x16x32_bf16 v[44:47], a[120:123], v[184:187], v[44:47]
    ds_read_b64_tr_b16 v[180:181], v93 offset:2048
    ds_read_b64_tr_b16 v[182:183], v93 offset:2560
    v_mfma_f32_16x16x32_bf16 v[52:55], a[124:127], v[184:187], v[52:55]
    s_add_u32 s1, s76, 0
    v_mfma_f32_16x16x32_bf16 v[60:63], a[120:123], v[188:191], v[60:63]
    ds_read_b64_tr_b16 v[184:185], v9 offset:4096
    ds_read_b64_tr_b16 v[186:187], v9 offset:4608
    v_mfma_f32_16x16x32_bf16 v[68:71], a[124:127], v[188:191], v[68:71]
    buffer_load_dwordx4 a[128:131], v4, s[56:59], s1 offen sc1
    s_waitcnt lgkmcnt(6)
    v_mfma_f32_16x16x32_bf16 v[72:75], a[0:3], v[192:195], 0
    ds_read_b64_tr_b16 v[188:189], v93 offset:4096
    ds_read_b64_tr_b16 v[190:191], v93 offset:4608
    v_mfma_f32_16x16x32_bf16 v[80:83], a[4:7], v[192:195], 0
    s_add_u32 m0, s49, 114688
    s_add_u32 s52, s48, 114688
    v_mfma_f32_16x16x32_bf16 v[76:79], a[0:3], v[196:199], 0
    ds_read_b64_tr_b16 v[192:193], v9 offset:6144
    ds_read_b64_tr_b16 v[194:195], v9 offset:6656
    v_mfma_f32_16x16x32_bf16 v[84:87], a[4:7], v[196:199], 0
    buffer_load_dwordx4 v95, s[8:11], s52 offen offset:0 sc1 lds
    v_max_f32 v40, 0, v40
    v_max_f32 v41, 0, v41
    s_waitcnt lgkmcnt(6)
    v_mfma_f32_16x16x32_bf16 v[72:75], a[8:11], v[176:179], v[72:75]
    ds_read_b64_tr_b16 v[196:197], v93 offset:6144
    ds_read_b64_tr_b16 v[198:199], v93 offset:6656
    v_mfma_f32_16x16x32_bf16 v[80:83], a[12:15], v[176:179], v[80:83]
    v_max_f32 v42, 0, v42
    v_max_f32 v43, 0, v43
    v_mfma_f32_16x16x32_bf16 v[76:79], a[8:11], v[180:183], v[76:79]
    ds_read_b64_tr_b16 v[176:177], v9 offset:8192
    ds_read_b64_tr_b16 v[178:179], v9 offset:8704
    v_mfma_f32_16x16x32_bf16 v[84:87], a[12:15], v[180:183], v[84:87]
    buffer_load_dwordx4 v95, s[8:11], s52 offen offset:1024 sc1 lds
    v_max_f32 v44, 0, v44
    v_max_f32 v45, 0, v45
    s_waitcnt lgkmcnt(6)
    v_mfma_f32_16x16x32_bf16 v[72:75], a[16:19], v[184:187], v[72:75]
    ds_read_b64_tr_b16 v[180:181], v93 offset:8192
    ds_read_b64_tr_b16 v[182:183], v93 offset:8704
    v_mfma_f32_16x16x32_bf16 v[80:83], a[20:23], v[184:187], v[80:83]
    s_waitcnt vmcnt(8)
    ds_read2st64_b32 v[88:89], v6 offset0:64 offset1:68
    v_max_f32 v46, 0, v46
    v_max_f32 v47, 0, v47
    v_mfma_f32_16x16x32_bf16 v[76:79], a[16:19], v[188:191], v[76:79]
    ds_read_b64_tr_b16 v[184:185], v9 offset:10240
    ds_read_b64_tr_b16 v[186:187], v9 offset:10752
    v_mfma_f32_16x16x32_bf16 v[84:87], a[20:23], v[188:191], v[84:87]
    buffer_load_dwordx4 v95, s[8:11], s52 offen offset:2048 sc1 lds
    v_mul_f32 v40, v40, v48
    v_mul_f32 v41, v41, v49
    s_waitcnt lgkmcnt(7)
    v_mfma_f32_16x16x32_bf16 v[72:75], a[24:27], v[192:195], v[72:75]
    ds_read_b64_tr_b16 v[188:189], v93 offset:10240
    ds_read_b64_tr_b16 v[190:191], v93 offset:10752
    v_mfma_f32_16x16x32_bf16 v[80:83], a[28:31], v[192:195], v[80:83]
    buffer_load_dwordx4 v95, s[8:11], s52 offen offset:3072 sc1 lds
    ds_read2st64_b32 v[90:91], v6 offset0:72 offset1:76
    v_cvt_pk_bf16_f32 v104, v40, v41
    v_mul_f32 v44, v44, v52
    v_mfma_f32_16x16x32_bf16 v[76:79], a[24:27], v[196:199], v[76:79]
    ds_read_b64_tr_b16 v[192:193], v9 offset:12288
    ds_read_b64_tr_b16 v[194:195], v9 offset:12800
    v_mfma_f32_16x16x32_bf16 v[84:87], a[28:31], v[196:199], v[84:87]
    v_mul_f32 v45, v45, v53
    v_cvt_pk_bf16_f32 v106, v44, v45
    s_waitcnt lgkmcnt(8)
    v_mfma_f32_16x16x32_bf16 v[72:75], a[32:35], v[176:179], v[72:75]
    ds_read_b64_tr_b16 v[196:197], v93 offset:12288
    ds_read_b64_tr_b16 v[198:199], v93 offset:12800
    v_mfma_f32_16x16x32_bf16 v[80:83], a[36:39], v[176:179], v[80:83]
    buffer_load_dwordx4 a[132:135], v4, s[60:63], s1 offen sc1
    v_mul_f32 v42, v42, v50
    v_mul_f32 v43, v43, v51
    v_mfma_f32_16x16x32_bf16 v[76:79], a[32:35], v[180:183], v[76:79]
    ds_read_b64_tr_b16 v[176:177], v9 offset:14336
    ds_read_b64_tr_b16 v[178:179], v9 offset:14848
    v_mfma_f32_16x16x32_bf16 v[84:87], a[36:39], v[180:183], v[84:87]
    s_waitcnt lgkmcnt(6)
    v_bitop3_b32 v88, v88, v89, v90 bitop3:0x80
    v_cvt_pk_bf16_f32 v105, v42, v43
    v_mfma_f32_16x16x32_bf16 v[72:75], a[40:43], v[184:187], v[72:75]
    ds_read_b64_tr_b16 v[180:181], v93 offset:14336
    ds_read_b64_tr_b16 v[182:183], v93 offset:14848
    v_mfma_f32_16x16x32_bf16 v[80:83], a[44:47], v[184:187], v[80:83]
    v_bitop3_b32 v88, v88, v91, s40 bitop3:0x80
    v_cmp_ne_u32 vcc, s40, v88
    v_mul_f32 v46, v46, v54
    v_mul_f32 v47, v47, v55
    v_mfma_f32_16x16x32_bf16 v[76:79], a[40:43], v[188:191], v[76:79]
    s_cbranch_vccnz cslow_28
cback_27:
    s_barrier
    v_mfma_f32_16x16x32_bf16 v[84:87], a[44:47], v[188:191], v[84:87]
    ds_read_b64_tr_b16 v[184:185], v9 offset:16384
    ds_read_b64_tr_b16 v[186:187], v9 offset:16896
    v_cvt_pk_bf16_f32 v107, v46, v47
    s_waitcnt lgkmcnt(6)
    v_mfma_f32_16x16x32_bf16 v[72:75], a[48:51], v[192:195], v[72:75]
    ds_read_b64_tr_b16 v[188:189], v93 offset:16384
    ds_read_b64_tr_b16 v[190:191], v93 offset:16896
    v_mfma_f32_16x16x32_bf16 v[80:83], a[52:55], v[192:195], v[80:83]
    v_permlane16_swap_b32 v104, v106
    s_add_u32 s51, s47, 360448
    v_permlane16_swap_b32 v105, v107
    v_mfma_f32_16x16x32_bf16 v[76:79], a[48:51], v[196:199], v[76:79]
    ds_read_b64_tr_b16 v[192:193], v9 offset:18432
    ds_read_b64_tr_b16 v[194:195], v9 offset:18944
    v_mfma_f32_16x16x32_bf16 v[84:87], a[52:55], v[196:199], v[84:87]
    buffer_store_dwordx4 v[24:27], v5, s[12:15], s51 offen sc1
    v_and_b32 v104, -2, v104
    s_add_u32 s51, s47, 0
    s_waitcnt lgkmcnt(6)
    v_mfma_f32_16x16x32_bf16 v[72:75], a[56:59], v[176:179], v[72:75]
    ds_read_b64_tr_b16 v[196:197], v93 offset:18432
    ds_read_b64_tr_b16 v[198:199], v93 offset:18944
    v_mfma_f32_16x16x32_bf16 v[80:83], a[60:63], v[176:179], v[80:83]
    buffer_store_dwordx4 v[104:107], v5, s[12:15], s51 offen sc1
    v_max_f32 v56, 0, v56
    v_max_f32 v57, 0, v57
    v_mfma_f32_16x16x32_bf16 v[76:79], a[56:59], v[180:183], v[76:79]
    ds_read_b64_tr_b16 v[176:177], v9 offset:20480
    ds_read_b64_tr_b16 v[178:179], v9 offset:20992
    v_mfma_f32_16x16x32_bf16 v[84:87], a[60:63], v[180:183], v[84:87]
    v_max_f32 v58, 0, v58
    s_add_u32 m0, s49, 0
    s_add_u32 s52, s48, 131072
    s_waitcnt lgkmcnt(6)
    v_mfma_f32_16x16x32_bf16 v[72:75], a[64:67], v[184:187], v[72:75]
    ds_read_b64_tr_b16 v[180:181], v93 offset:20480
    ds_read_b64_tr_b16 v[182:183], v93 offset:20992
    v_mfma_f32_16x16x32_bf16 v[80:83], a[68:71], v[184:187], v[80:83]
    buffer_load_dwordx4 v95, s[8:11], s52 offen offset:0 sc1 lds
    v_max_f32 v59, 0, v59
    v_max_f32 v60, 0, v60
    v_mfma_f32_16x16x32_bf16 v[76:79], a[64:67], v[188:191], v[76:79]
    ds_read_b64_tr_b16 v[184:185], v9 offset:22528
    ds_read_b64_tr_b16 v[186:187], v9 offset:23040
    v_mfma_f32_16x16x32_bf16 v[84:87], a[68:71], v[188:191], v[84:87]
    v_max_f32 v61, 0, v61
    v_max_f32 v62, 0, v62
    s_waitcnt lgkmcnt(6)
    v_mfma_f32_16x16x32_bf16 v[72:75], a[72:75], v[192:195], v[72:75]
    ds_read_b64_tr_b16 v[188:189], v93 offset:22528
    ds_read_b64_tr_b16 v[190:191], v93 offset:23040
    v_mfma_f32_16x16x32_bf16 v[80:83], a[76:79], v[192:195], v[80:83]
    buffer_load_dwordx4 v95, s[8:11], s52 offen offset:1024 sc1 lds
    v_max_f32 v63, 0, v63
    v_mul_f32 v56, v56, v64
    v_mfma_f32_16x16x32_bf16 v[76:79], a[72:75], v[196:199], v[76:79]
    ds_read_b64_tr_b16 v[192:193], v9 offset:24576
    ds_read_b64_tr_b16 v[194:195], v9 offset:25088
    v_mfma_f32_16x16x32_bf16 v[84:87], a[76:79], v[196:199], v[84:87]
    v_mul_f32 v57, v57, v65
    v_cvt_pk_bf16_f32 v108, v56, v57
    s_waitcnt lgkmcnt(6)
    v_mfma_f32_16x16x32_bf16 v[72:75], a[80:83], v[176:179], v[72:75]
    ds_read_b64_tr_b16 v[196:197], v93 offset:24576
    ds_read_b64_tr_b16 v[198:199], v93 offset:25088
    v_mfma_f32_16x16x32_bf16 v[80:83], a[84:87], v[176:179], v[80:83]
    s_waitcnt vmcnt(11)
    ds_read2st64_b32 v[88:89], v6 offset0:128 offset1:132
    v_mul_f32 v60, v60, v68
    v_mul_f32 v61, v61, v69
    v_mfma_f32_16x16x32_bf16 v[76:79], a[80:83], v[180:183], v[76:79]
    ds_read_b64_tr_b16 v[176:177], v9 offset:26624
    ds_read_b64_tr_b16 v[178:179], v9 offset:27136
    v_mfma_f32_16x16x32_bf16 v[84:87], a[84:87], v[180:183], v[84:87]
    buffer_load_dwordx4 v95, s[8:11], s52 offen offset:2048 sc1 lds
    v_cvt_pk_bf16_f32 v110, v60, v61
    v_mul_f32 v58, v58, v66
    s_waitcnt lgkmcnt(7)
    v_mfma_f32_16x16x32_bf16 v[72:75], a[88:91], v[184:187], v[72:75]
    ds_read_b64_tr_b16 v[180:181], v93 offset:26624
    ds_read_b64_tr_b16 v[182:183], v93 offset:27136
    v_mfma_f32_16x16x32_bf16 v[80:83], a[92:95], v[184:187], v[80:83]
    buffer_load_dwordx4 v95, s[8:11], s52 offen offset:3072 sc1 lds
    ds_read2st64_b32 v[90:91], v6 offset0:136 offset1:140
    v_mul_f32 v59, v59, v67
    v_cvt_pk_bf16_f32 v109, v58, v59
    v_mfma_f32_16x16x32_bf16 v[76:79], a[88:91], v[188:191], v[76:79]
    ds_read_b64_tr_b16 v[184:185], v9 offset:28672
    ds_read_b64_tr_b16 v[186:187], v9 offset:29184
    v_mfma_f32_16x16x32_bf16 v[84:87], a[92:95], v[188:191], v[84:87]
    v_mul_f32 v62, v62, v70
    s_add_u32 s1, s82, 0
    v_mul_f32 v63, v63, v71
    s_waitcnt lgkmcnt(8)
    v_mfma_f32_16x16x32_bf16 v[72:75], a[96:99], v[192:195], v[72:75]
    ds_read_b64_tr_b16 v[188:189], v93 offset:28672
    ds_read_b64_tr_b16 v[190:191], v93 offset:29184
    v_mfma_f32_16x16x32_bf16 v[80:83], a[100:103], v[192:195], v[80:83]
    buffer_load_dwordx4 a[136:139], v4, s[56:59], s1 offen sc1
    v_cvt_pk_bf16_f32 v111, v62, v63
    v_permlane16_swap_b32 v108, v110
    v_mfma_f32_16x16x32_bf16 v[76:79], a[96:99], v[196:199], v[76:79]
    ds_read_b64_tr_b16 v[192:193], v9 offset:30720
    ds_read_b64_tr_b16 v[194:195], v9 offset:31232
    v_mfma_f32_16x16x32_bf16 v[84:87], a[100:103], v[196:199], v[84:87]
    s_waitcnt lgkmcnt(6)
    v_bitop3_b32 v88, v88, v89, v90 bitop3:0x80
    v_permlane16_swap_b32 v109, v111
    v_mfma_f32_16x16x32_bf16 v[72:75], a[104:107], v[176:179], v[72:75]
    ds_read_b64_tr_b16 v[196:197], v93 offset:30720
    ds_read_b64_tr_b16 v[198:199], v93 offset:31232
    v_mfma_f32_16x16x32_bf16 v[80:83], a[108:111], v[176:179], v[80:83]
    v_bitop3_b32 v88, v88, v91, s40 bitop3:0x80
    v_cmp_ne_u32 vcc, s40, v88
    v_and_b32 v108, -2, v108
    v_mfma_f32_16x16x32_bf16 v[76:79], a[104:107], v[180:183], v[76:79]
    s_cbranch_vccnz cslow_30
cback_29:
    s_barrier
    v_mfma_f32_16x16x32_bf16 v[84:87], a[108:111], v[180:183], v[84:87]
    ds_read_b64_tr_b16 v[176:177], v9 offset:32768
    ds_read_b64_tr_b16 v[178:179], v9 offset:33280
    s_add_u32 s51, s47, 90112
    s_waitcnt lgkmcnt(6)
    v_mfma_f32_16x16x32_bf16 v[72:75], a[112:115], v[184:187], v[72:75]
    ds_read_b64_tr_b16 v[180:181], v93 offset:32768
    ds_read_b64_tr_b16 v[182:183], v93 offset:33280
    v_mfma_f32_16x16x32_bf16 v[80:83], a[116:119], v[184:187], v[80:83]
    buffer_store_dwordx4 v[108:111], v5, s[12:15], s51 offen sc1
    v_mfma_f32_16x16x32_bf16 v[76:79], a[112:115], v[188:191], v[76:79]
    ds_read_b64_tr_b16 v[184:185], v9 offset:34816
    ds_read_b64_tr_b16 v[186:187], v9 offset:35328
    v_mfma_f32_16x16x32_bf16 v[84:87], a[116:119], v[188:191], v[84:87]
    s_waitcnt lgkmcnt(6)
    v_mfma_f32_16x16x32_bf16 v[72:75], a[120:123], v[192:195], v[72:75]
    ds_read_b64_tr_b16 v[188:189], v93 offset:34816
    ds_read_b64_tr_b16 v[190:191], v93 offset:35328
    v_mfma_f32_16x16x32_bf16 v[80:83], a[124:127], v[192:195], v[80:83]
    buffer_load_dwordx4 a[140:143], v4, s[60:63], s1 offen sc1
    v_mfma_f32_16x16x32_bf16 v[76:79], a[120:123], v[196:199], v[76:79]
    ds_read_b64_tr_b16 v[192:193], v9 offset:36864
    ds_read_b64_tr_b16 v[194:195], v9 offset:37376
    v_mfma_f32_16x16x32_bf16 v[84:87], a[124:127], v[196:199], v[84:87]
    s_add_u32 m0, s49, 16384
    s_add_u32 s52, s48, 147456
    s_waitcnt lgkmcnt(6)
    v_mfma_f32_16x16x32_bf16 v[40:43], a[0:3], v[176:179], 0
    ds_read_b64_tr_b16 v[196:197], v93 offset:36864
    ds_read_b64_tr_b16 v[198:199], v93 offset:37376
    v_mfma_f32_16x16x32_bf16 v[48:51], a[4:7], v[176:179], 0
    buffer_load_dwordx4 v95, s[8:11], s52 offen offset:0 sc1 lds
    v_mfma_f32_16x16x32_bf16 v[44:47], a[0:3], v[180:183], 0
    ds_read_b64_tr_b16 v[176:177], v9 offset:38912
    ds_read_b64_tr_b16 v[178:179], v9 offset:39424
    v_mfma_f32_16x16x32_bf16 v[52:55], a[4:7], v[180:183], 0
    s_waitcnt lgkmcnt(6)
    v_mfma_f32_16x16x32_bf16 v[40:43], a[8:11], v[184:187], v[40:43]
    ds_read_b64_tr_b16 v[180:181], v93 offset:38912
    ds_read_b64_tr_b16 v[182:183], v93 offset:39424
    v_mfma_f32_16x16x32_bf16 v[48:51], a[12:15], v[184:187], v[48:51]
    buffer_load_dwordx4 v95, s[8:11], s52 offen offset:1024 sc1 lds
    v_max_f32 v72, 0, v72
    v_max_f32 v73, 0, v73
    v_mfma_f32_16x16x32_bf16 v[44:47], a[8:11], v[188:191], v[44:47]
    ds_read_b64_tr_b16 v[184:185], v9 offset:40960
    ds_read_b64_tr_b16 v[186:187], v9 offset:41472
    v_mfma_f32_16x16x32_bf16 v[52:55], a[12:15], v[188:191], v[52:55]
    v_max_f32 v74, 0, v74
    v_max_f32 v75, 0, v75
    s_waitcnt lgkmcnt(6)
    v_mfma_f32_16x16x32_bf16 v[40:43], a[16:19], v[192:195], v[40:43]
    ds_read_b64_tr_b16 v[188:189], v93 offset:40960
    ds_read_b64_tr_b16 v[190:191], v93 offset:41472
    v_mfma_f32_16x16x32_bf16 v[48:51], a[20:23], v[192:195], v[48:51]
    s_waitcnt vmcnt(12)
    ds_read2st64_b32 v[88:89], v6 offset0:192 offset1:196
    v_max_f32 v76, 0, v76
    v_max_f32 v77, 0, v77
    v_mfma_f32_16x16x32_bf16 v[44:47], a[16:19], v[196:199], v[44:47]
    ds_read_b64_tr_b16 v[192:193], v9 offset:43008
    ds_read_b64_tr_b16 v[194:195], v9 offset:43520
    v_mfma_f32_16x16x32_bf16 v[52:55], a[20:23], v[196:199], v[52:55]
    buffer_load_dwordx4 v95, s[8:11], s52 offen offset:2048 sc1 lds
    v_max_f32 v78, 0, v78
    v_max_f32 v79, 0, v79
    s_waitcnt lgkmcnt(7)
    v_mfma_f32_16x16x32_bf16 v[40:43], a[24:27], v[176:179], v[40:43]
    ds_read_b64_tr_b16 v[196:197], v93 offset:43008
    ds_read_b64_tr_b16 v[198:199], v93 offset:43520
    v_mfma_f32_16x16x32_bf16 v[48:51], a[28:31], v[176:179], v[48:51]
    buffer_load_dwordx4 v95, s[8:11], s52 offen offset:3072 sc1 lds
    ds_read2st64_b32 v[90:91], v6 offset0:200 offset1:204
    v_mul_f32 v72, v72, v80
    v_mul_f32 v73, v73, v81
    v_mfma_f32_16x16x32_bf16 v[44:47], a[24:27], v[180:183], v[44:47]
    ds_read_b64_tr_b16 v[176:177], v9 offset:45056
    ds_read_b64_tr_b16 v[178:179], v9 offset:45568
    v_mfma_f32_16x16x32_bf16 v[52:55], a[28:31], v[180:183], v[52:55]
    v_cvt_pk_bf16_f32 v104, v72, v73
    s_add_u32 s51, s47, 450560
    v_mul_f32 v76, v76, v84
    s_waitcnt lgkmcnt(8)
    v_mfma_f32_16x16x32_bf16 v[40:43], a[32:35], v[184:187], v[40:43]
    ds_read_b64_tr_b16 v[180:181], v93 offset:45056
    ds_read_b64_tr_b16 v[182:183], v93 offset:45568
    v_mfma_f32_16x16x32_bf16 v[48:51], a[36:39], v[184:187], v[48:51]
    buffer_store_dwordx4 v[24:27], v5, s[12:15], s51 offen sc1
    v_mul_f32 v77, v77, v85
    v_cvt_pk_bf16_f32 v106, v76, v77
    v_mfma_f32_16x16x32_bf16 v[44:47], a[32:35], v[188:191], v[44:47]
    ds_read_b64_tr_b16 v[184:185], v9 offset:47104
    ds_read_b64_tr_b16 v[186:187], v9 offset:47616
    v_mfma_f32_16x16x32_bf16 v[52:55], a[36:39], v[188:191], v[52:55]
    s_waitcnt lgkmcnt(6)
    v_bitop3_b32 v88, v88, v89, v90 bitop3:0x80
    v_mul_f32 v74, v74, v82
    v_mfma_f32_16x16x32_bf16 v[40:43], a[40:43], v[192:195], v[40:43]
    ds_read_b64_tr_b16 v[188:189], v93 offset:47104
    ds_read_b64_tr_b16 v[190:191], v93 offset:47616
    v_mfma_f32_16x16x32_bf16 v[48:51], a[44:47], v[192:195], v[48:51]
    v_bitop3_b32 v88, v88, v91, s40 bitop3:0x80
    v_cmp_ne_u32 vcc, s40, v88
    v_mul_f32 v75, v75, v83
    v_cvt_pk_bf16_f32 v105, v74, v75
    v_mfma_f32_16x16x32_bf16 v[44:47], a[40:43], v[196:199], v[44:47]
    s_cbranch_vccnz cslow_32
cback_31:
    s_barrier
    v_mfma_f32_16x16x32_bf16 v[52:55], a[44:47], v[196:199], v[52:55]
    ds_read_b64_tr_b16 v[192:193], v9 offset:49152
    ds_read_b64_tr_b16 v[194:195], v9 offset:49664
    v_mul_f32 v78, v78, v86
    s_waitcnt lgkmcnt(6)
    v_mfma_f32_16x16x32_bf16 v[40:43], a[48:51], v[176:179], v[40:43]
    ds_read_b64_tr_b16 v[196:197], v93 offset:49152
    ds_read_b64_tr_b16 v[198:199], v93 offset:49664
    v_mfma_f32_16x16x32_bf16 v[48:51], a[52:55], v[176:179], v[48:51]
    v_mul_f32 v79, v79, v87
    s_add_u32 s1, s76, 8192
    v_cvt_pk_bf16_f32 v107, v78, v79
    v_mfma_f32_16x16x32_bf16 v[44:47], a[48:51], v[180:183], v[44:47]
    ds_read_b64_tr_b16 v[176:177], v9 offset:51200
    ds_read_b64_tr_b16 v[178:179], v9 offset:51712
    v_mfma_f32_16x16x32_bf16 v[52:55], a[52:55], v[180:183], v[52:55]
    buffer_load_dwordx4 a[144:147], v4, s[56:59], s1 offen sc1
    v_permlane16_swap_b32 v104, v106
    v_permlane16_swap_b32 v105, v107
    s_waitcnt lgkmcnt(6)
    v_mfma_f32_16x16x32_bf16 v[40:43], a[56:59], v[184:187], v[40:43]
    ds_read_b64_tr_b16 v[180:181], v93 offset:51200
    ds_read_b64_tr_b16 v[182:183], v93 offset:51712
    v_mfma_f32_16x16x32_bf16 v[48:51], a[60:63], v[184:187], v[48:51]
    buffer_load_dwordx4 a[148:151], v4, s[60:63], s1 offen sc1
    v_and_b32 v104, -2, v104
    s_add_u32 s51, s47, 180224
    v_mfma_f32_16x16x32_bf16 v[44:47], a[56:59], v[188:191], v[44:47]
    ds_read_b64_tr_b16 v[184:185], v9 offset:53248
    ds_read_b64_tr_b16 v[186:187], v9 offset:53760
    v_mfma_f32_16x16x32_bf16 v[52:55], a[60:63], v[188:191], v[52:55]
    buffer_store_dwordx4 v[104:107], v5, s[12:15], s51 offen sc1
    s_waitcnt lgkmcnt(6)
    v_mfma_f32_16x16x32_bf16 v[40:43], a[64:67], v[192:195], v[40:43]
    ds_read_b64_tr_b16 v[188:189], v93 offset:53248
    ds_read_b64_tr_b16 v[190:191], v93 offset:53760
    v_mfma_f32_16x16x32_bf16 v[48:51], a[68:71], v[192:195], v[48:51]
    s_add_u32 m0, s49, 32768
    s_add_u32 s52, s48, 163840
    v_mfma_f32_16x16x32_bf16 v[44:47], a[64:67], v[196:199], v[44:47]
    ds_read_b64_tr_b16 v[192:193], v9 offset:55296
    ds_read_b64_tr_b16 v[194:195], v9 offset:55808
    v_mfma_f32_16x16x32_bf16 v[52:55], a[68:71], v[196:199], v[52:55]
    buffer_load_dwordx4 v95, s[8:11], s52 offen offset:0 sc1 lds
    s_waitcnt lgkmcnt(6)
    v_mfma_f32_16x16x32_bf16 v[40:43], a[72:75], v[176:179], v[40:43]
    ds_read_b64_tr_b16 v[196:197], v93 offset:55296
    ds_read_b64_tr_b16 v[198:199], v93 offset:55808
    v_mfma_f32_16x16x32_bf16 v[48:51], a[76:79], v[176:179], v[48:51]
    v_mfma_f32_16x16x32_bf16 v[44:47], a[72:75], v[180:183], v[44:47]
    ds_read_b64_tr_b16 v[176:177], v9 offset:57344
    ds_read_b64_tr_b16 v[178:179], v9 offset:57856
    v_mfma_f32_16x16x32_bf16 v[52:55], a[76:79], v[180:183], v[52:55]
    buffer_load_dwordx4 v95, s[8:11], s52 offen offset:1024 sc1 lds
    s_waitcnt lgkmcnt(6)
    v_mfma_f32_16x16x32_bf16 v[40:43], a[80:83], v[184:187], v[40:43]
    ds_read_b64_tr_b16 v[180:181], v93 offset:57344
    ds_read_b64_tr_b16 v[182:183], v93 offset:57856
    v_mfma_f32_16x16x32_bf16 v[48:51], a[84:87], v[184:187], v[48:51]
    s_waitcnt vmcnt(13)
    ds_read2st64_b32 v[88:89], v3 offset0:0 offset1:4
    v_mfma_f32_16x16x32_bf16 v[44:47], a[80:83], v[188:191], v[44:47]
    ds_read_b64_tr_b16 v[184:185], v9 offset:59392
    ds_read_b64_tr_b16 v[186:187], v9 offset:59904
    v_mfma_f32_16x16x32_bf16 v[52:55], a[84:87], v[188:191], v[52:55]
    buffer_load_dwordx4 v95, s[8:11], s52 offen offset:2048 sc1 lds
    s_waitcnt lgkmcnt(7)
    v_mfma_f32_16x16x32_bf16 v[40:43], a[88:91], v[192:195], v[40:43]
    ds_read_b64_tr_b16 v[188:189], v93 offset:59392
    ds_read_b64_tr_b16 v[190:191], v93 offset:59904
    v_mfma_f32_16x16x32_bf16 v[48:51], a[92:95], v[192:195], v[48:51]
    ds_read2st64_b32 v[90:91], v3 offset0:8 offset1:12
    v_mfma_f32_16x16x32_bf16 v[44:47], a[88:91], v[196:199], v[44:47]
    ds_read_b64_tr_b16 v[192:193], v9 offset:61440
    ds_read_b64_tr_b16 v[194:195], v9 offset:61952
    v_mfma_f32_16x16x32_bf16 v[52:55], a[92:95], v[196:199], v[52:55]
    buffer_load_dwordx4 v95, s[8:11], s52 offen offset:3072 sc1 lds
    s_add_u32 s1, s82, 8192
    s_waitcnt lgkmcnt(8)
    v_mfma_f32_16x16x32_bf16 v[40:43], a[96:99], v[176:179], v[40:43]
    ds_read_b64_tr_b16 v[196:197], v93 offset:61440
    ds_read_b64_tr_b16 v[198:199], v93 offset:61952
    v_mfma_f32_16x16x32_bf16 v[48:51], a[100:103], v[176:179], v[48:51]
    buffer_load_dwordx4 a[152:155], v4, s[56:59], s1 offen sc1
    v_mfma_f32_16x16x32_bf16 v[44:47], a[96:99], v[180:183], v[44:47]
    ds_read_b64_tr_b16 v[176:177], v9 offset:63488
    ds_read_b64_tr_b16 v[178:179], v9 offset:64000
    v_mfma_f32_16x16x32_bf16 v[52:55], a[100:103], v[180:183], v[52:55]
    s_waitcnt lgkmcnt(6)
    v_bitop3_b32 v88, v88, v89, v90 bitop3:0x80
    v_mfma_f32_16x16x32_bf16 v[40:43], a[104:107], v[184:187], v[40:43]
    ds_read_b64_tr_b16 v[180:181], v93 offset:63488
    ds_read_b64_tr_b16 v[182:183], v93 offset:64000
    v_mfma_f32_16x16x32_bf16 v[48:51], a[108:111], v[184:187], v[48:51]
    v_bitop3_b32 v88, v88, v91, s73 bitop3:0x80
    v_cmp_ne_u32 vcc, s73, v88
    v_mfma_f32_16x16x32_bf16 v[44:47], a[104:107], v[188:191], v[44:47]
    s_cbranch_vccnz cslow_34
cback_33:
    s_barrier
    v_mfma_f32_16x16x32_bf16 v[52:55], a[108:111], v[188:191], v[52:55]
    ds_read_b64_tr_b16 v[184:185], v8 offset:0
    ds_read_b64_tr_b16 v[186:187], v8 offset:512
    s_waitcnt lgkmcnt(6)
    v_mfma_f32_16x16x32_bf16 v[40:43], a[112:115], v[192:195], v[40:43]
    ds_read_b64_tr_b16 v[188:189], v92 offset:0
    ds_read_b64_tr_b16 v[190:191], v92 offset:512
    v_mfma_f32_16x16x32_bf16 v[48:51], a[116:119], v[192:195], v[48:51]
    buffer_load_dwordx4 a[156:159], v4, s[60:63], s1 offen sc1
    s_add_u32 s1, s76, 16384
    v_mfma_f32_16x16x32_bf16 v[44:47], a[112:115], v[196:199], v[44:47]
    ds_read_b64_tr_b16 v[192:193], v8 offset:2048
    ds_read_b64_tr_b16 v[194:195], v8 offset:2560
    v_mfma_f32_16x16x32_bf16 v[52:55], a[116:119], v[196:199], v[52:55]
    buffer_load_dwordx4 a[160:163], v4, s[56:59], s1 offen sc1
    s_waitcnt lgkmcnt(6)
    v_mfma_f32_16x16x32_bf16 v[40:43], a[120:123], v[176:179], v[40:43]
    ds_read_b64_tr_b16 v[196:197], v92 offset:2048
    ds_read_b64_tr_b16 v[198:199], v92 offset:2560
    v_mfma_f32_16x16x32_bf16 v[48:51], a[124:127], v[176:179], v[48:51]
    v_mfma_f32_16x16x32_bf16 v[44:47], a[120:123], v[180:183], v[44:47]
    ds_read_b64_tr_b16 v[176:177], v8 offset:4096
    ds_read_b64_tr_b16 v[178:179], v8 offset:4608
    v_mfma_f32_16x16x32_bf16 v[52:55], a[124:127], v[180:183], v[52:55]
    buffer_load_dwordx4 a[164:167], v4, s[60:63], s1 offen sc1
    s_waitcnt lgkmcnt(6)
    v_mfma_f32_16x16x32_bf16 v[56:59], a[0:3], v[184:187], 0
    ds_read_b64_tr_b16 v[180:181], v92 offset:4096
    ds_read_b64_tr_b16 v[182:183], v92 offset:4608
    v_mfma_f32_16x16x32_bf16 v[64:67], a[4:7], v[184:187], 0
    s_add_u32 m0, s49, 49152
    s_add_u32 s52, s48, 180224
    v_mfma_f32_16x16x32_bf16 v[60:63], a[0:3], v[188:191], 0
    ds_read_b64_tr_b16 v[184:185], v8 offset:6144
    ds_read_b64_tr_b16 v[186:187], v8 offset:6656
    v_mfma_f32_16x16x32_bf16 v[68:71], a[4:7], v[188:191], 0
    buffer_load_dwordx4 v95, s[8:11], s52 offen offset:0 sc1 lds
    s_waitcnt lgkmcnt(6)
    v_mfma_f32_16x16x32_bf16 v[56:59], a[8:11], v[192:195], v[56:59]
    ds_read_b64_tr_b16 v[188:189], v92 offset:6144
    ds_read_b64_tr_b16 v[190:191], v92 offset:6656
    v_mfma_f32_16x16x32_bf16 v[64:67], a[12:15], v[192:195], v[64:67]
    buffer_load_dwordx4 v95, s[8:11], s52 offen offset:1024 sc1 lds
    v_max_f32 v40, 0, v40
    v_max_f32 v41, 0, v41
    v_mfma_f32_16x16x32_bf16 v[60:63], a[8:11], v[196:199], v[60:63]
    ds_read_b64_tr_b16 v[192:193], v8 offset:8192
    ds_read_b64_tr_b16 v[194:195], v8 offset:8704
    v_mfma_f32_16x16x32_bf16 v[68:71], a[12:15], v[196:199], v[68:71]
    v_max_f32 v42, 0, v42
    v_max_f32 v43, 0, v43
    s_waitcnt lgkmcnt(6)
    v_mfma_f32_16x16x32_bf16 v[56:59], a[16:19], v[176:179], v[56:59]
    ds_read_b64_tr_b16 v[196:197], v92 offset:8192
    ds_read_b64_tr_b16 v[198:199], v92 offset:8704
    v_mfma_f32_16x16x32_bf16 v[64:67], a[20:23], v[176:179], v[64:67]
    s_waitcnt vmcnt(14)
    ds_read2st64_b32 v[88:89], v3 offset0:64 offset1:68
    v_max_f32 v44, 0, v44
    v_max_f32 v45, 0, v45
    v_mfma_f32_16x16x32_bf16 v[60:63], a[16:19], v[180:183], v[60:63]
    ds_read_b64_tr_b16 v[176:177], v8 offset:10240
    ds_read_b64_tr_b16 v[178:179], v8 offset:10752
    v_mfma_f32_16x16x32_bf16 v[68:71], a[20:23], v[180:183], v[68:71]
    buffer_load_dwordx4 v95, s[8:11], s52 offen offset:2048 sc1 lds
    v_max_f32 v46, 0, v46
    v_max_f32 v47, 0, v47
    s_waitcnt lgkmcnt(7)
    v_mfma_f32_16x16x32_bf16 v[56:59], a[24:27], v[184:187], v[56:59]
    ds_read_b64_tr_b16 v[180:181], v92 offset:10240
    ds_read_b64_tr_b16 v[182:183], v92 offset:10752
    v_mfma_f32_16x16x32_bf16 v[64:67], a[28:31], v[184:187], v[64:67]
    buffer_load_dwordx4 v95, s[8:11], s52 offen offset:3072 sc1 lds
    ds_read2st64_b32 v[90:91], v3 offset0:72 offset1:76
    v_mul_f32 v40, v40, v48
    v_mul_f32 v41, v41, v49
    v_mfma_f32_16x16x32_bf16 v[60:63], a[24:27], v[188:191], v[60:63]
    ds_read_b64_tr_b16 v[184:185], v8 offset:12288
    ds_read_b64_tr_b16 v[186:187], v8 offset:12800
    v_mfma_f32_16x16x32_bf16 v[68:71], a[28:31], v[188:191], v[68:71]
    v_cvt_pk_bf16_f32 v108, v40, v41
    s_add_u32 s1, s82, 16384
    v_mul_f32 v44, v44, v52
    s_waitcnt lgkmcnt(8)
    v_mfma_f32_16x16x32_bf16 v[56:59], a[32:35], v[192:195], v[56:59]
    ds_read_b64_tr_b16 v[188:189], v92 offset:12288
    ds_read_b64_tr_b16 v[190:191], v92 offset:12800
    v_mfma_f32_16x16x32_bf16 v[64:67], a[36:39], v[192:195], v[64:67]
    buffer_load_dwordx4 a[168:171], v4, s[56:59], s1 offen sc1
    v_mul_f32 v45, v45, v53
    v_cvt_pk_bf16_f32 v110, v44, v45
    v_mfma_f32_16x16x32_bf16 v[60:63], a[32:35], v[196:199], v[60:63]
    ds_read_b64_tr_b16 v[192:193], v8 offset:14336
    ds_read_b64_tr_b16 v[194:195], v8 offset:14848
    v_mfma_f32_16x16x32_bf16 v[68:71], a[36:39], v[196:199], v[68:71]
    s_waitcnt lgkmcnt(6)
    v_bitop3_b32 v88, v88, v89, v90 bitop3:0x80
    v_mul_f32 v42, v42, v50
    v_mfma_f32_16x16x32_bf16 v[56:59], a[40:43], v[176:179], v[56:59]
    ds_read_b64_tr_b16 v[196:197], v92 offset:14336
    ds_read_b64_tr_b16 v[198:199], v92 offset:14848
    v_mfma_f32_16x16x32_bf16 v[64:67], a[44:47], v[176:179], v[64:67]
    v_bitop3_b32 v88, v88, v91, s73 bitop3:0x80
    v_cmp_ne_u32 vcc, s73, v88
    v_mul_f32 v43, v43, v51
    v_cvt_pk_bf16_f32 v109, v42, v43
    v_mfma_f32_16x16x32_bf16 v[60:63], a[40:43], v[180:183], v[60:63]
    s_cbranch_vccnz cslow_36
cback_35:
    s_barrier
    v_mfma_f32_16x16x32_bf16 v[68:71], a[44:47], v[180:183], v[68:71]
    ds_read_b64_tr_b16 v[176:177], v8 offset:16384
    ds_read_b64_tr_b16 v[178:179], v8 offset:16896
    v_mul_f32 v46, v46, v54
    s_waitcnt lgkmcnt(6)
    v_mfma_f32_16x16x32_bf16 v[56:59], a[48:51], v[184:187], v[56:59]
    ds_read_b64_tr_b16 v[180:181], v92 offset:16384
    ds_read_b64_tr_b16 v[182:183], v92 offset:16896
    v_mfma_f32_16x16x32_bf16 v[64:67], a[52:55], v[184:187], v[64:67]
    buffer_load_dwordx4 a[172:175], v4, s[60:63], s1 offen sc1
    v_mul_f32 v47, v47, v55
    s_add_u32 s1, s76, 24576
    v_cvt_pk_bf16_f32 v111, v46, v47
    v_mfma_f32_16x16x32_bf16 v[60:63], a[48:51], v[188:191], v[60:63]
    ds_read_b64_tr_b16 v[184:185], v8 offset:18432
    ds_read_b64_tr_b16 v[186:187], v8 offset:18944
    v_mfma_f32_16x16x32_bf16 v[68:71], a[52:55], v[188:191], v[68:71]
    buffer_load_dwordx4 a[176:179], v4, s[56:59], s1 offen sc1
    v_permlane16_swap_b32 v108, v110
    v_permlane16_swap_b32 v109, v111
    s_waitcnt lgkmcnt(6)
    v_mfma_f32_16x16x32_bf16 v[56:59], a[56:59], v[192:195], v[56:59]
    ds_read_b64_tr_b16 v[188:189], v92 offset:18432
    ds_read_b64_tr_b16 v[190:191], v92 offset:18944
    v_mfma_f32_16x16x32_bf16 v[64:67], a[60:63], v[192:195], v[64:67]
    v_and_b32 v108, -2, v108
    v_mfma_f32_16x16x32_bf16 v[60:63], a[56:59], v[196:199], v[60:63]
    ds_read_b64_tr_b16 v[192:193], v8 offset:20480
    ds_read_b64_tr_b16 v[194:195], v8 offset:20992
    v_mfma_f32_16x16x32_bf16 v[68:71], a[60:63], v[196:199], v[68:71]
    s_waitcnt vmcnt(15)
    buffer_store_dwordx4 v[18:21], v16, s[96:99], s83 offen sc1
    s_add_u32 s51, s47, 270336
    s_waitcnt lgkmcnt(6)
    v_mfma_f32_16x16x32_bf16 v[56:59], a[64:67], v[176:179], v[56:59]
    ds_read_b64_tr_b16 v[196:197], v92 offset:20480
    ds_read_b64_tr_b16 v[198:199], v92 offset:20992
    v_mfma_f32_16x16x32_bf16 v[64:67], a[68:71], v[176:179], v[64:67]
    buffer_store_dwordx4 v[108:111], v5, s[12:15], s51 offen sc1
    v_mfma_f32_16x16x32_bf16 v[60:63], a[64:67], v[180:183], v[60:63]
    ds_read_b64_tr_b16 v[176:177], v8 offset:22528
    ds_read_b64_tr_b16 v[178:179], v8 offset:23040
    v_mfma_f32_16x16x32_bf16 v[68:71], a[68:71], v[180:183], v[68:71]
    s_waitcnt lgkmcnt(6)
    v_mfma_f32_16x16x32_bf16 v[56:59], a[72:75], v[184:187], v[56:59]
    ds_read_b64_tr_b16 v[180:181], v92 offset:22528
    ds_read_b64_tr_b16 v[182:183], v92 offset:23040
    v_mfma_f32_16x16x32_bf16 v[64:67], a[76:79], v[184:187], v[64:67]
    buffer_load_dwordx4 a[180:183], v4, s[60:63], s1 offen sc1
    v_mfma_f32_16x16x32_bf16 v[60:63], a[72:75], v[188:191], v[60:63]
    ds_read_b64_tr_b16 v[184:185], v8 offset:24576
    ds_read_b64_tr_b16 v[186:187], v8 offset:25088
    v_mfma_f32_16x16x32_bf16 v[68:71], a[76:79], v[188:191], v[68:71]
    s_waitcnt lgkmcnt(6)
    v_mfma_f32_16x16x32_bf16 v[56:59], a[80:83], v[192:195], v[56:59]
    ds_read_b64_tr_b16 v[188:189], v92 offset:24576
    ds_read_b64_tr_b16 v[190:191], v92 offset:25088
    v_mfma_f32_16x16x32_bf16 v[64:67], a[84:87], v[192:195], v[64:67]
    s_waitcnt vmcnt(14)
    ds_read2st64_b32 v[88:89], v3 offset0:128 offset1:132
    s_add_u32 s1, s82, 24576
    v_mfma_f32_16x16x32_bf16 v[60:63], a[80:83], v[196:199], v[60:63]
    ds_read_b64_tr_b16 v[192:193], v8 offset:26624
    ds_read_b64_tr_b16 v[194:195], v8 offset:27136
    v_mfma_f32_16x16x32_bf16 v[68:71], a[84:87], v[196:199], v[68:71]
    buffer_load_dwordx4 a[184:187], v4, s[56:59], s1 offen sc1
    s_waitcnt lgkmcnt(7)
    v_mfma_f32_16x16x32_bf16 v[56:59], a[88:91], v[176:179], v[56:59]
    ds_read_b64_tr_b16 v[196:197], v92 offset:26624
    ds_read_b64_tr_b16 v[198:199], v92 offset:27136
    v_mfma_f32_16x16x32_bf16 v[64:67], a[92:95], v[176:179], v[64:67]
    buffer_load_dwordx4 a[188:191], v4, s[60:63], s1 offen sc1
    ds_read2st64_b32 v[90:91], v3 offset0:136 offset1:140
    v_mfma_f32_16x16x32_bf16 v[60:63], a[88:91], v[180:183], v[60:63]
    ds_read_b64_tr_b16 v[176:177], v8 offset:28672
    ds_read_b64_tr_b16 v[178:179], v8 offset:29184
    v_mfma_f32_16x16x32_bf16 v[68:71], a[92:95], v[180:183], v[68:71]
    s_add_u32 s1, s76, 32768
    s_waitcnt lgkmcnt(8)
    v_mfma_f32_16x16x32_bf16 v[56:59], a[96:99], v[184:187], v[56:59]
    ds_read_b64_tr_b16 v[180:181], v92 offset:28672
    ds_read_b64_tr_b16 v[182:183], v92 offset:29184
    v_mfma_f32_16x16x32_bf16 v[64:67], a[100:103], v[184:187], v[64:67]
    buffer_load_dwordx4 a[192:195], v4, s[56:59], s1 offen sc1
    v_mfma_f32_16x16x32_bf16 v[60:63], a[96:99], v[188:191], v[60:63]
    ds_read_b64_tr_b16 v[184:185], v8 offset:30720
    ds_read_b64_tr_b16 v[186:187], v8 offset:31232
    v_mfma_f32_16x16x32_bf16 v[68:71], a[100:103], v[188:191], v[68:71]
    s_waitcnt lgkmcnt(6)
    v_bitop3_b32 v88, v88, v89, v90 bitop3:0x80
    v_mfma_f32_16x16x32_bf16 v[56:59], a[104:107], v[192:195], v[56:59]
    ds_read_b64_tr_b16 v[188:189], v92 offset:30720
    ds_read_b64_tr_b16 v[190:191], v92 offset:31232
    v_mfma_f32_16x16x32_bf16 v[64:67], a[108:111], v[192:195], v[64:67]
    v_bitop3_b32 v88, v88, v91, s73 bitop3:0x80
    v_cmp_ne_u32 vcc, s73, v88
    v_mfma_f32_16x16x32_bf16 v[60:63], a[104:107], v[196:199], v[60:63]
    s_cbranch_vccnz cslow_38
cback_37:
    s_barrier
    v_mfma_f32_16x16x32_bf16 v[68:71], a[108:111], v[196:199], v[68:71]
    ds_read_b64_tr_b16 v[192:193], v8 offset:32768
    ds_read_b64_tr_b16 v[194:195], v8 offset:33280
    s_waitcnt lgkmcnt(6)
    v_mfma_f32_16x16x32_bf16 v[56:59], a[112:115], v[176:179], v[56:59]
    ds_read_b64_tr_b16 v[196:197], v92 offset:32768
    ds_read_b64_tr_b16 v[198:199], v92 offset:33280
    v_mfma_f32_16x16x32_bf16 v[64:67], a[116:119], v[176:179], v[64:67]
    buffer_load_dwordx4 a[196:199], v4, s[60:63], s1 offen sc1
    s_add_u32 s1, s82, 32768
    v_mfma_f32_16x16x32_bf16 v[60:63], a[112:115], v[180:183], v[60:63]
    ds_read_b64_tr_b16 v[176:177], v8 offset:34816
    ds_read_b64_tr_b16 v[178:179], v8 offset:35328
    v_mfma_f32_16x16x32_bf16 v[68:71], a[116:119], v[180:183], v[68:71]
    buffer_load_dwordx4 a[200:203], v4, s[56:59], s1 offen sc1
    s_waitcnt lgkmcnt(6)
    v_mfma_f32_16x16x32_bf16 v[56:59], a[120:123], v[184:187], v[56:59]
    ds_read_b64_tr_b16 v[180:181], v92 offset:34816
    ds_read_b64_tr_b16 v[182:183], v92 offset:35328
    v_mfma_f32_16x16x32_bf16 v[64:67], a[124:127], v[184:187], v[64:67]
    v_mfma_f32_16x16x32_bf16 v[60:63], a[120:123], v[188:191], v[60:63]
    ds_read_b64_tr_b16 v[184:185], v8 offset:36864
    ds_read_b64_tr_b16 v[186:187], v8 offset:37376
    v_mfma_f32_16x16x32_bf16 v[68:71], a[124:127], v[188:191], v[68:71]
    buffer_load_dwordx4 a[204:207], v4, s[60:63], s1 offen sc1
    s_waitcnt lgkmcnt(6)
    v_mfma_f32_16x16x32_bf16 v[72:75], a[0:3], v[192:195], 0
    ds_read_b64_tr_b16 v[188:189], v92 offset:36864
    ds_read_b64_tr_b16 v[190:191], v92 offset:37376
    v_mfma_f32_16x16x32_bf16 v[80:83], a[4:7], v[192:195], 0
    s_add_u32 s1, s76, 40960
    v_mfma_f32_16x16x32_bf16 v[76:79], a[0:3], v[196:199], 0
    ds_read_b64_tr_b16 v[192:193], v8 offset:38912
    ds_read_b64_tr_b16 v[194:195], v8 offset:39424
    v_mfma_f32_16x16x32_bf16 v[84:87], a[4:7], v[196:199], 0
    buffer_load_dwordx4 a[208:211], v4, s[56:59], s1 offen sc1
    s_waitcnt lgkmcnt(6)
    v_mfma_f32_16x16x32_bf16 v[72:75], a[8:11], v[176:179], v[72:75]
    ds_read_b64_tr_b16 v[196:197], v92 offset:38912
    ds_read_b64_tr_b16 v[198:199], v92 offset:39424
    v_mfma_f32_16x16x32_bf16 v[80:83], a[12:15], v[176:179], v[80:83]
    buffer_load_dwordx4 a[212:215], v4, s[60:63], s1 offen sc1
    v_max_f32 v56, 0, v56
    v_max_f32 v57, 0, v57
    v_mfma_f32_16x16x32_bf16 v[76:79], a[8:11], v[180:183], v[76:79]
    ds_read_b64_tr_b16 v[176:177], v8 offset:40960
    ds_read_b64_tr_b16 v[178:179], v8 offset:41472
    v_mfma_f32_16x16x32_bf16 v[84:87], a[12:15], v[180:183], v[84:87]
    v_max_f32 v58, 0, v58
    v_max_f32 v59, 0, v59
    s_waitcnt lgkmcnt(6)
    v_mfma_f32_16x16x32_bf16 v[72:75], a[16:19], v[184:187], v[72:75]
    ds_read_b64_tr_b16 v[180:181], v92 offset:40960
    ds_read_b64_tr_b16 v[182:183], v92 offset:41472
    v_mfma_f32_16x16x32_bf16 v[80:83], a[20:23], v[184:187], v[80:83]
    s_waitcnt vmcnt(14)
    ds_read2st64_b32 v[88:89], v3 offset0:192 offset1:196
    v_max_f32 v60, 0, v60
    s_add_u32 s1, s82, 40960
    v_mfma_f32_16x16x32_bf16 v[76:79], a[16:19], v[188:191], v[76:79]
    ds_read_b64_tr_b16 v[184:185], v8 offset:43008
    ds_read_b64_tr_b16 v[186:187], v8 offset:43520
    v_mfma_f32_16x16x32_bf16 v[84:87], a[20:23], v[188:191], v[84:87]
    buffer_load_dwordx4 a[216:219], v4, s[56:59], s1 offen sc1
    v_max_f32 v61, 0, v61
    v_max_f32 v62, 0, v62
    s_waitcnt lgkmcnt(7)
    v_mfma_f32_16x16x32_bf16 v[72:75], a[24:27], v[192:195], v[72:75]
    ds_read_b64_tr_b16 v[188:189], v92 offset:43008
    ds_read_b64_tr_b16 v[190:191], v92 offset:43520
    v_mfma_f32_16x16x32_bf16 v[80:83], a[28:31], v[192:195], v[80:83]
    buffer_load_dwordx4 a[220:223], v4, s[60:63], s1 offen sc1
    ds_read2st64_b32 v[90:91], v3 offset0:200 offset1:204
    v_max_f32 v63, 0, v63
    v_mul_f32 v56, v56, v64
    v_mfma_f32_16x16x32_bf16 v[76:79], a[24:27], v[196:199], v[76:79]
    ds_read_b64_tr_b16 v[192:193], v8 offset:45056
    ds_read_b64_tr_b16 v[194:195], v8 offset:45568
    v_mfma_f32_16x16x32_bf16 v[84:87], a[28:31], v[196:199], v[84:87]
    v_mul_f32 v57, v57, v65
    s_add_u32 s1, s76, 49152
    v_cvt_pk_bf16_f32 v104, v56, v57
    s_waitcnt lgkmcnt(8)
    v_mfma_f32_16x16x32_bf16 v[72:75], a[32:35], v[176:179], v[72:75]
    ds_read_b64_tr_b16 v[196:197], v92 offset:45056
    ds_read_b64_tr_b16 v[198:199], v92 offset:45568
    v_mfma_f32_16x16x32_bf16 v[80:83], a[36:39], v[176:179], v[80:83]
    buffer_load_dwordx4 a[224:227], v4, s[56:59], s1 offen sc1
    v_mul_f32 v60, v60, v68
    v_mul_f32 v61, v61, v69
    v_mfma_f32_16x16x32_bf16 v[76:79], a[32:35], v[180:183], v[76:79]
    ds_read_b64_tr_b16 v[176:177], v8 offset:47104
    ds_read_b64_tr_b16 v[178:179], v8 offset:47616
    v_mfma_f32_16x16x32_bf16 v[84:87], a[36:39], v[180:183], v[84:87]
    s_waitcnt lgkmcnt(6)
    v_bitop3_b32 v88, v88, v89, v90 bitop3:0x80
    v_cvt_pk_bf16_f32 v106, v60, v61
    v_mfma_f32_16x16x32_bf16 v[72:75], a[40:43], v[184:187], v[72:75]
    ds_read_b64_tr_b16 v[180:181], v92 offset:47104
    ds_read_b64_tr_b16 v[182:183], v92 offset:47616
    v_mfma_f32_16x16x32_bf16 v[80:83], a[44:47], v[184:187], v[80:83]
    v_bitop3_b32 v88, v88, v91, s73 bitop3:0x80
    v_cmp_ne_u32 vcc, s73, v88
    v_mul_f32 v58, v58, v66
    v_mul_f32 v59, v59, v67
    v_mfma_f32_16x16x32_bf16 v[76:79], a[40:43], v[188:191], v[76:79]
    s_cbranch_vccnz cslow_40
cback_39:
    s_barrier
    v_mfma_f32_16x16x32_bf16 v[84:87], a[44:47], v[188:191], v[84:87]
    ds_read_b64_tr_b16 v[184:185], v8 offset:49152
    ds_read_b64_tr_b16 v[186:187], v8 offset:49664
    v_cvt_pk_bf16_f32 v105, v58, v59
    s_waitcnt lgkmcnt(6)
    v_mfma_f32_16x16x32_bf16 v[72:75], a[48:51], v[192:195], v[72:75]
    ds_read_b64_tr_b16 v[188:189], v92 offset:49152
    ds_read_b64_tr_b16 v[190:191], v92 offset:49664
    v_mfma_f32_16x16x32_bf16 v[80:83], a[52:55], v[192:195], v[80:83]
    buffer_load_dwordx4 a[228:231], v4, s[60:63], s1 offen sc1
    v_mul_f32 v62, v62, v70
    s_add_u32 s1, s82, 49152
    v_mul_f32 v63, v63, v71
    v_mfma_f32_16x16x32_bf16 v[76:79], a[48:51], v[196:199], v[76:79]
    ds_read_b64_tr_b16 v[192:193], v8 offset:51200
    ds_read_b64_tr_b16 v[194:195], v8 offset:51712
    v_mfma_f32_16x16x32_bf16 v[84:87], a[52:55], v[196:199], v[84:87]
    buffer_load_dwordx4 a[232:235], v4, s[56:59], s1 offen sc1
    v_cvt_pk_bf16_f32 v107, v62, v63
    v_permlane16_swap_b32 v104, v106
    s_waitcnt lgkmcnt(6)
    v_mfma_f32_16x16x32_bf16 v[72:75], a[56:59], v[176:179], v[72:75]
    ds_read_b64_tr_b16 v[196:197], v92 offset:51200
    ds_read_b64_tr_b16 v[198:199], v92 offset:51712
    v_mfma_f32_16x16x32_bf16 v[80:83], a[60:63], v[176:179], v[80:83]
    v_permlane16_swap_b32 v105, v107
    v_and_b32 v104, -2, v104
    v_mfma_f32_16x16x32_bf16 v[76:79], a[56:59], v[180:183], v[76:79]
    ds_read_b64_tr_b16 v[176:177], v8 offset:53248
    ds_read_b64_tr_b16 v[178:179], v8 offset:53760
    v_mfma_f32_16x16x32_bf16 v[84:87], a[60:63], v[180:183], v[84:87]
    buffer_load_dwordx4 a[236:239], v4, s[60:63], s1 offen sc1
    s_add_u32 s51, s47, 360448
    s_waitcnt lgkmcnt(6)
    v_mfma_f32_16x16x32_bf16 v[72:75], a[64:67], v[184:187], v[72:75]
    ds_read_b64_tr_b16 v[180:181], v92 offset:53248
    ds_read_b64_tr_b16 v[182:183], v92 offset:53760
    v_mfma_f32_16x16x32_bf16 v[80:83], a[68:71], v[184:187], v[80:83]
    buffer_store_dwordx4 v[104:107], v5, s[12:15], s51 offen sc1
    v_mfma_f32_16x16x32_bf16 v[76:79], a[64:67], v[188:191], v[76:79]
    ds_read_b64_tr_b16 v[184:185], v8 offset:55296
    ds_read_b64_tr_b16 v[186:187], v8 offset:55808
    v_mfma_f32_16x16x32_bf16 v[84:87], a[68:71], v[188:191], v[84:87]
    s_add_u32 s1, s76, 57344
    s_waitcnt lgkmcnt(6)
    v_mfma_f32_16x16x32_bf16 v[72:75], a[72:75], v[192:195], v[72:75]
    ds_read_b64_tr_b16 v[188:189], v92 offset:55296
    ds_read_b64_tr_b16 v[190:191], v92 offset:55808
    v_mfma_f32_16x16x32_bf16 v[80:83], a[76:79], v[192:195], v[80:83]
    buffer_load_dwordx4 a[240:243], v4, s[56:59], s1 offen sc1
    v_mfma_f32_16x16x32_bf16 v[76:79], a[72:75], v[196:199], v[76:79]
    ds_read_b64_tr_b16 v[192:193], v8 offset:57344
    ds_read_b64_tr_b16 v[194:195], v8 offset:57856
    v_mfma_f32_16x16x32_bf16 v[84:87], a[76:79], v[196:199], v[84:87]
    s_waitcnt lgkmcnt(6)
    v_mfma_f32_16x16x32_bf16 v[72:75], a[80:83], v[176:179], v[72:75]
    ds_read_b64_tr_b16 v[196:197], v92 offset:57344
    ds_read_b64_tr_b16 v[198:199], v92 offset:57856
    v_mfma_f32_16x16x32_bf16 v[80:83], a[84:87], v[176:179], v[80:83]
    buffer_load_dwordx4 a[244:247], v4, s[60:63], s1 offen sc1
    v_mfma_f32_16x16x32_bf16 v[76:79], a[80:83], v[180:183], v[76:79]
    ds_read_b64_tr_b16 v[176:177], v8 offset:59392
    ds_read_b64_tr_b16 v[178:179], v8 offset:59904
    v_mfma_f32_16x16x32_bf16 v[84:87], a[84:87], v[180:183], v[84:87]
    s_add_u32 s1, s82, 57344
    s_waitcnt lgkmcnt(6)
    v_mfma_f32_16x16x32_bf16 v[72:75], a[88:91], v[184:187], v[72:75]
    ds_read_b64_tr_b16 v[180:181], v92 offset:59392
    ds_read_b64_tr_b16 v[182:183], v92 offset:59904
    v_mfma_f32_16x16x32_bf16 v[80:83], a[92:95], v[184:187], v[80:83]
    buffer_load_dwordx4 a[248:251], v4, s[56:59], s1 offen sc1
    v_mfma_f32_16x16x32_bf16 v[76:79], a[88:91], v[188:191], v[76:79]
    ds_read_b64_tr_b16 v[184:185], v8 offset:61440
    ds_read_b64_tr_b16 v[186:187], v8 offset:61952
    v_mfma_f32_16x16x32_bf16 v[84:87], a[92:95], v[188:191], v[84:87]
    s_waitcnt lgkmcnt(6)
    v_mfma_f32_16x16x32_bf16 v[72:75], a[96:99], v[192:195], v[72:75]
    ds_read_b64_tr_b16 v[188:189], v92 offset:61440
    ds_read_b64_tr_b16 v[190:191], v92 offset:61952
    v_mfma_f32_16x16x32_bf16 v[80:83], a[100:103], v[192:195], v[80:83]
    buffer_load_dwordx4 a[252:255], v4, s[60:63], s1 offen sc1
    s_add_u32 s1, s76, 65536
    v_mfma_f32_16x16x32_bf16 v[76:79], a[96:99], v[196:199], v[76:79]
    ds_read_b64_tr_b16 v[192:193], v8 offset:63488
    ds_read_b64_tr_b16 v[194:195], v8 offset:64000
    v_mfma_f32_16x16x32_bf16 v[84:87], a[100:103], v[196:199], v[84:87]
    buffer_load_dwordx4 v[208:211], v4, s[56:59], s1 offen sc1
    s_waitcnt lgkmcnt(6)
    v_mfma_f32_16x16x32_bf16 v[72:75], a[104:107], v[176:179], v[72:75]
    ds_read_b64_tr_b16 v[196:197], v92 offset:63488
    ds_read_b64_tr_b16 v[198:199], v92 offset:64000
    v_mfma_f32_16x16x32_bf16 v[80:83], a[108:111], v[176:179], v[80:83]
    buffer_load_dword v2, v119, s[96:99], 0 offen sc1
    v_mfma_f32_16x16x32_bf16 v[76:79], a[104:107], v[180:183], v[76:79]
    v_mfma_f32_16x16x32_bf16 v[84:87], a[108:111], v[180:183], v[84:87]
    buffer_load_dwordx4 v[212:215], v4, s[60:63], s1 offen sc1
    s_waitcnt lgkmcnt(4)
    v_mfma_f32_16x16x32_bf16 v[72:75], a[112:115], v[184:187], v[72:75]
    v_mfma_f32_16x16x32_bf16 v[80:83], a[116:119], v[184:187], v[80:83]
    s_add_u32 s1, s82, 65536
    v_mfma_f32_16x16x32_bf16 v[76:79], a[112:115], v[188:191], v[76:79]
    v_mfma_f32_16x16x32_bf16 v[84:87], a[116:119], v[188:191], v[84:87]
    buffer_load_dwordx4 v[216:219], v4, s[56:59], s1 offen sc1
    s_waitcnt lgkmcnt(0)
    v_mfma_f32_16x16x32_bf16 v[72:75], a[120:123], v[192:195], v[72:75]
    v_mfma_f32_16x16x32_bf16 v[80:83], a[124:127], v[192:195], v[80:83]
    v_mfma_f32_16x16x32_bf16 v[76:79], a[120:123], v[196:199], v[76:79]
    v_mfma_f32_16x16x32_bf16 v[84:87], a[124:127], v[196:199], v[84:87]
    buffer_load_dwordx4 v[220:223], v4, s[60:63], s1 offen sc1
    s_nop 3
    v_max_f32 v72, 0, v72
    v_max_f32 v73, 0, v73
    v_max_f32 v74, 0, v74
    v_max_f32 v75, 0, v75
    v_max_f32 v76, 0, v76
    v_max_f32 v77, 0, v77
    v_max_f32 v78, 0, v78
    v_max_f32 v79, 0, v79
    v_pk_mul_f32 v[72:73], v[72:73], v[80:81]
    v_cvt_pk_bf16_f32 v108, v72, v73
    v_pk_mul_f32 v[76:77], v[76:77], v[84:85]
    v_cvt_pk_bf16_f32 v110, v76, v77
    v_pk_mul_f32 v[74:75], v[74:75], v[82:83]
    v_cvt_pk_bf16_f32 v109, v74, v75
    v_pk_mul_f32 v[78:79], v[78:79], v[86:87]
    v_cvt_pk_bf16_f32 v111, v78, v79
    v_permlane16_swap_b32 v108, v110
    s_nop 0
    v_permlane16_swap_b32 v109, v111
    v_and_b32 v108, -2, v108
    s_add_u32 s51, s47, 450560
    buffer_store_dwordx4 v[108:111], v5, s[12:15], s51 offen sc1
    s_add_u32 s1, s76, 73728
    buffer_load_dwordx4 v[224:227], v4, s[56:59], s1 offen sc1
    buffer_load_dwordx4 v[228:231], v4, s[60:63], s1 offen sc1
    s_add_u32 s1, s82, 73728
    buffer_load_dwordx4 v[232:235], v4, s[56:59], s1 offen sc1
    buffer_load_dwordx4 v[236:239], v4, s[60:63], s1 offen sc1
    s_add_u32 s1, s76, 81920
    buffer_load_dwordx4 v[240:243], v4, s[56:59], s1 offen sc1
    buffer_load_dwordx4 v[244:247], v4, s[60:63], s1 offen sc1
    s_add_u32 s1, s82, 81920
    buffer_load_dwordx4 v[248:251], v4, s[56:59], s1 offen sc1
    buffer_load_dwordx4 v[252:255], v4, s[60:63], s1 offen sc1
    s_add_u32 s6, s36, 1
    s_waitcnt vmcnt(12)
    v_subrev_u32 v2, s6, v2
    v_cmp_le_u32 vcc, 8, v2
    s_cbranch_vccnz pslow_42
pback_41:
    s_branch L_g20
L_g1stats0:
    v_lshlrev_b32 v6, 4, v0
    s_mul_i32 s48, s44, 196608
    s_cmp_ge_u32 s44, 11
    s_cselect_b32 s48, 0, s48
    s_add_u32 s7, s48, 0
    buffer_load_dwordx4 v[40:43], v6, s[8:11], s7 offen sc1
    s_add_u32 s7, s48, 4096
    buffer_load_dwordx4 v[44:47], v6, s[8:11], s7 offen sc1
    s_add_u32 s7, s48, 8192
    buffer_load_dwordx4 v[48:51], v6, s[8:11], s7 offen sc1
    s_add_u32 s7, s48, 12288
    buffer_load_dwordx4 v[52:55], v6, s[8:11], s7 offen sc1
    s_add_u32 s7, s48, 16384
    buffer_load_dwordx4 v[56:59], v6, s[8:11], s7 offen sc1
    s_add_u32 s7, s48, 20480
    buffer_load_dwordx4 v[60:63], v6, s[8:11], s7 offen sc1
    s_add_u32 s7, s48, 24576
    buffer_load_dwordx4 v[64:67], v6, s[8:11], s7 offen sc1
    s_add_u32 s7, s48, 28672
    buffer_load_dwordx4 v[68:71], v6, s[8:11], s7 offen sc1
    s_add_u32 s7, s48, 32768
    buffer_load_dwordx4 v[72:75], v6, s[8:11], s7 offen sc1
    s_add_u32 s7, s48, 36864
    buffer_load_dwordx4 v[76:79], v6, s[8:11], s7 offen sc1
    s_add_u32 s7, s48, 40960
    buffer_load_dwordx4 v[80:83], v6, s[8:11], s7 offen sc1
    s_add_u32 s7, s48, 45056
    buffer_load_dwordx4 v[84:87], v6, s[8:11], s7 offen sc1
    v_lshrrev_b32 v3, 2, v0
    v_cmp_eq_u32 s[50:51], 1, v3
    v_mul_u32_u24 v8, 768, v3
    v_and_b32 v3, 3, v0
    v_lshl_add_u32 v8, v3, 5, v8
    s_waitcnt vmcnt(9)
    v_bitop3_b32 v9, v40, v44, v48 bitop3:0x80
    s_waitcnt vmcnt(8)
    v_and_b32 v9, v9, v52
    v_and_b32 v9, s40, v9
    v_cmp_ne_u32 vcc, s40, v9
    s_cbranch_vccnz cslow_44
cback_43:
    s_add_u32 s7, s48, 49152
    buffer_load_dwordx4 v[88:91], v6, s[8:11], s7 offen sc1
    v_cndmask_b32 v40, v40, 0, s[50:51]
    v_lshlrev_b32 v104, 16, v40
    v_and_b32 v105, s38, v40
    v_pk_mul_f32 v[16:17], v[104:105], v[104:105]
    v_cndmask_b32 v41, v41, 0, s[50:51]
    v_lshlrev_b32 v104, 16, v41
    v_and_b32 v105, s38, v41
    v_pk_mul_f32 v[18:19], v[104:105], v[104:105]
    v_cndmask_b32 v42, v42, 0, s[50:51]
    v_lshlrev_b32 v104, 16, v42
    v_and_b32 v105, s38, v42
    v_pk_mul_f32 v[20:21], v[104:105], v[104:105]
    v_cndmask_b32 v43, v43, 0, s[50:51]
    v_lshlrev_b32 v104, 16, v43
    v_and_b32 v105, s38, v43
    v_pk_mul_f32 v[22:23], v[104:105], v[104:105]
    s_add_u32 s7, s48, 53248
    buffer_load_dwordx4 v[92:95], v6, s[8:11], s7 offen sc1
    v_lshlrev_b32 v104, 16, v44
    v_and_b32 v105, s38, v44
    v_pk_fma_f32 v[16:17], v[104:105], v[104:105], v[16:17]
    v_lshlrev_b32 v104, 16, v45
    v_and_b32 v105, s38, v45
    v_pk_fma_f32 v[18:19], v[104:105], v[104:105], v[18:19]
    v_lshlrev_b32 v104, 16, v46
    v_and_b32 v105, s38, v46
    v_pk_fma_f32 v[20:21], v[104:105], v[104:105], v[20:21]
    v_lshlrev_b32 v104, 16, v47
    v_and_b32 v105, s38, v47
    v_pk_fma_f32 v[22:23], v[104:105], v[104:105], v[22:23]
    s_add_u32 s7, s48, 57344
    buffer_load_dwordx4 v[96:99], v6, s[8:11], s7 offen sc1
    v_lshlrev_b32 v104, 16, v48
    v_and_b32 v105, s38, v48
    v_pk_fma_f32 v[16:17], v[104:105], v[104:105], v[16:17]
    v_lshlrev_b32 v104, 16, v49
    v_and_b32 v105, s38, v49
    v_pk_fma_f32 v[18:19], v[104:105], v[104:105], v[18:19]
    v_lshlrev_b32 v104, 16, v50
    v_and_b32 v105, s38, v50
    v_pk_fma_f32 v[20:21], v[104:105], v[104:105], v[20:21]
    v_lshlrev_b32 v104, 16, v51
    v_and_b32 v105, s38, v51
    v_pk_fma_f32 v[22:23], v[104:105], v[104:105], v[22:23]
    s_add_u32 s7, s48, 61440
    buffer_load_dwordx4 v[100:103], v6, s[8:11], s7 offen sc1
    v_lshlrev_b32 v104, 16, v52
    v_and_b32 v105, s38, v52
    v_pk_fma_f32 v[16:17], v[104:105], v[104:105], v[16:17]
    v_lshlrev_b32 v104, 16, v53
    v_and_b32 v105, s38, v53
    v_pk_fma_f32 v[18:19], v[104:105], v[104:105], v[18:19]
    v_lshlrev_b32 v104, 16, v54
    v_and_b32 v105, s38, v54
    v_pk_fma_f32 v[20:21], v[104:105], v[104:105], v[20:21]
    v_lshlrev_b32 v104, 16, v55
    v_and_b32 v105, s38, v55
    v_pk_fma_f32 v[22:23], v[104:105], v[104:105], v[22:23]
    s_waitcnt vmcnt(9)
    v_bitop3_b32 v9, v56, v60, v64 bitop3:0x80
    s_waitcnt vmcnt(8)
    v_and_b32 v9, v9, v68
    v_and_b32 v9, s40, v9
    v_cmp_ne_u32 vcc, s40, v9
    s_cbranch_vccnz cslow_46
cback_45:
    s_add_u32 s7, s48, 65536
    buffer_load_dwordx4 v[40:43], v6, s[8:11], s7 offen sc1
    v_lshlrev_b32 v104, 16, v56
    v_and_b32 v105, s38, v56
    v_pk_fma_f32 v[16:17], v[104:105], v[104:105], v[16:17]
    v_lshlrev_b32 v104, 16, v57
    v_and_b32 v105, s38, v57
    v_pk_fma_f32 v[18:19], v[104:105], v[104:105], v[18:19]
    v_lshlrev_b32 v104, 16, v58
    v_and_b32 v105, s38, v58
    v_pk_fma_f32 v[20:21], v[104:105], v[104:105], v[20:21]
    v_lshlrev_b32 v104, 16, v59
    v_and_b32 v105, s38, v59
    v_pk_fma_f32 v[22:23], v[104:105], v[104:105], v[22:23]
    s_add_u32 s7, s48, 69632
    buffer_load_dwordx4 v[44:47], v6, s[8:11], s7 offen sc1
    v_lshlrev_b32 v104, 16, v60
    v_and_b32 v105, s38, v60
    v_pk_fma_f32 v[16:17], v[104:105], v[104:105], v[16:17]
    v_lshlrev_b32 v104, 16, v61
    v_and_b32 v105, s38, v61
    v_pk_fma_f32 v[18:19], v[104:105], v[104:105], v[18:19]
    v_lshlrev_b32 v104, 16, v62
    v_and_b32 v105, s38, v62
    v_pk_fma_f32 v[20:21], v[104:105], v[104:105], v[20:21]
    v_lshlrev_b32 v104, 16, v63
    v_and_b32 v105, s38, v63
    v_pk_fma_f32 v[22:23], v[104:105], v[104:105], v[22:23]
    s_add_u32 s7, s48, 73728
    buffer_load_dwordx4 v[48:51], v6, s[8:11], s7 offen sc1
    v_lshlrev_b32 v104, 16, v64
    v_and_b32 v105, s38, v64
    v_pk_fma_f32 v[16:17], v[104:105], v[104:105], v[16:17]
    v_lshlrev_b32 v104, 16, v65
    v_and_b32 v105, s38, v65
    v_pk_fma_f32 v[18:19], v[104:105], v[104:105], v[18:19]
    v_lshlrev_b32 v104, 16, v66
    v_and_b32 v105, s38, v66
    v_pk_fma_f32 v[20:21], v[104:105], v[104:105], v[20:21]
    v_lshlrev_b32 v104, 16, v67
    v_and_b32 v105, s38, v67
    v_pk_fma_f32 v[22:23], v[104:105], v[104:105], v[22:23]
    s_add_u32 s7, s48, 77824
    buffer_load_dwordx4 v[52:55], v6, s[8:11], s7 offen sc1
    v_lshlrev_b32 v104, 16, v68
    v_and_b32 v105, s38, v68
    v_pk_fma_f32 v[16:17], v[104:105], v[104:105], v[16:17]
    v_lshlrev_b32 v104, 16, v69
    v_and_b32 v105, s38, v69
    v_pk_fma_f32 v[18:19], v[104:105], v[104:105], v[18:19]
    v_lshlrev_b32 v104, 16, v70
    v_and_b32 v105, s38, v70
    v_pk_fma_f32 v[20:21], v[104:105], v[104:105], v[20:21]
    v_lshlrev_b32 v104, 16, v71
    v_and_b32 v105, s38, v71
    v_pk_fma_f32 v[22:23], v[104:105], v[104:105], v[22:23]
    ds_write_b128 v8, v[16:19] offset:0
    ds_write_b128 v8, v[20:23] offset:16
    s_waitcnt vmcnt(9)
    v_bitop3_b32 v9, v72, v76, v80 bitop3:0x80
    s_waitcnt vmcnt(8)
    v_and_b32 v9, v9, v84
    v_and_b32 v9, s40, v9
    v_cmp_ne_u32 vcc, s40, v9
    s_cbranch_vccnz cslow_48
cback_47:
    s_add_u32 s7, s48, 81920
    buffer_load_dwordx4 v[56:59], v6, s[8:11], s7 offen sc1
    v_cndmask_b32 v72, v72, 0, s[50:51]
    v_lshlrev_b32 v104, 16, v72
    v_and_b32 v105, s38, v72
    v_pk_mul_f32 v[24:25], v[104:105], v[104:105]
    v_cndmask_b32 v73, v73, 0, s[50:51]
    v_lshlrev_b32 v104, 16, v73
    v_and_b32 v105, s38, v73
    v_pk_mul_f32 v[26:27], v[104:105], v[104:105]
    v_cndmask_b32 v74, v74, 0, s[50:51]
    v_lshlrev_b32 v104, 16, v74
    v_and_b32 v105, s38, v74
    v_pk_mul_f32 v[28:29], v[104:105], v[104:105]
    v_cndmask_b32 v75, v75, 0, s[50:51]
    v_lshlrev_b32 v104, 16, v75
    v_and_b32 v105, s38, v75
    v_pk_mul_f32 v[30:31], v[104:105], v[104:105]
    s_add_u32 s7, s48, 86016
    buffer_load_dwordx4 v[60:63], v6, s[8:11], s7 offen sc1
    v_lshlrev_b32 v104, 16, v76
    v_and_b32 v105, s38, v76
    v_pk_fma_f32 v[24:25], v[104:105], v[104:105], v[24:25]
    v_lshlrev_b32 v104, 16, v77
    v_and_b32 v105, s38, v77
    v_pk_fma_f32 v[26:27], v[104:105], v[104:105], v[26:27]
    v_lshlrev_b32 v104, 16, v78
    v_and_b32 v105, s38, v78
    v_pk_fma_f32 v[28:29], v[104:105], v[104:105], v[28:29]
    v_lshlrev_b32 v104, 16, v79
    v_and_b32 v105, s38, v79
    v_pk_fma_f32 v[30:31], v[104:105], v[104:105], v[30:31]
    s_add_u32 s7, s48, 90112
    buffer_load_dwordx4 v[64:67], v6, s[8:11], s7 offen sc1
    v_lshlrev_b32 v104, 16, v80
    v_and_b32 v105, s38, v80
    v_pk_fma_f32 v[24:25], v[104:105], v[104:105], v[24:25]
    v_lshlrev_b32 v104, 16, v81
    v_and_b32 v105, s38, v81
    v_pk_fma_f32 v[26:27], v[104:105], v[104:105], v[26:27]
    v_lshlrev_b32 v104, 16, v82
    v_and_b32 v105, s38, v82
    v_pk_fma_f32 v[28:29], v[104:105], v[104:105], v[28:29]
    v_lshlrev_b32 v104, 16, v83
    v_and_b32 v105, s38, v83
    v_pk_fma_f32 v[30:31], v[104:105], v[104:105], v[30:31]
    s_add_u32 s7, s48, 94208
    buffer_load_dwordx4 v[68:71], v6, s[8:11], s7 offen sc1
    v_lshlrev_b32 v104, 16, v84
    v_and_b32 v105, s38, v84
    v_pk_fma_f32 v[24:25], v[104:105], v[104:105], v[24:25]
    v_lshlrev_b32 v104, 16, v85
    v_and_b32 v105, s38, v85
    v_pk_fma_f32 v[26:27], v[104:105], v[104:105], v[26:27]
    v_lshlrev_b32 v104, 16, v86
    v_and_b32 v105, s38, v86
    v_pk_fma_f32 v[28:29], v[104:105], v[104:105], v[28:29]
    v_lshlrev_b32 v104, 16, v87
    v_and_b32 v105, s38, v87
    v_pk_fma_f32 v[30:31], v[104:105], v[104:105], v[30:31]
    s_waitcnt vmcnt(9)
    v_bitop3_b32 v9, v88, v92, v96 bitop3:0x80
    s_waitcnt vmcnt(8)
    v_and_b32 v9, v9, v100
    v_and_b32 v9, s40, v9
    v_cmp_ne_u32 vcc, s40, v9
    s_cbranch_vccnz cslow_50
cback_49:
    s_add_u32 s7, s48, 98304
    buffer_load_dwordx4 v[72:75], v6, s[8:11], s7 offen sc1
    v_lshlrev_b32 v104, 16, v88
    v_and_b32 v105, s38, v88
    v_pk_fma_f32 v[24:25], v[104:105], v[104:105], v[24:25]
    v_lshlrev_b32 v104, 16, v89
    v_and_b32 v105, s38, v89
    v_pk_fma_f32 v[26:27], v[104:105], v[104:105], v[26:27]
    v_lshlrev_b32 v104, 16, v90
    v_and_b32 v105, s38, v90
    v_pk_fma_f32 v[28:29], v[104:105], v[104:105], v[28:29]
    v_lshlrev_b32 v104, 16, v91
    v_and_b32 v105, s38, v91
    v_pk_fma_f32 v[30:31], v[104:105], v[104:105], v[30:31]
    s_add_u32 s7, s48, 102400
    buffer_load_dwordx4 v[76:79], v6, s[8:11], s7 offen sc1
    v_lshlrev_b32 v104, 16, v92
    v_and_b32 v105, s38, v92
    v_pk_fma_f32 v[24:25], v[104:105], v[104:105], v[24:25]
    v_lshlrev_b32 v104, 16, v93
    v_and_b32 v105, s38, v93
    v_pk_fma_f32 v[26:27], v[104:105], v[104:105], v[26:27]
    v_lshlrev_b32 v104, 16, v94
    v_and_b32 v105, s38, v94
    v_pk_fma_f32 v[28:29], v[104:105], v[104:105], v[28:29]
    v_lshlrev_b32 v104, 16, v95
    v_and_b32 v105, s38, v95
    v_pk_fma_f32 v[30:31], v[104:105], v[104:105], v[30:31]
    s_add_u32 s7, s48, 106496
    buffer_load_dwordx4 v[80:83], v6, s[8:11], s7 offen sc1
    v_lshlrev_b32 v104, 16, v96
    v_and_b32 v105, s38, v96
    v_pk_fma_f32 v[24:25], v[104:105], v[104:105], v[24:25]
    v_lshlrev_b32 v104, 16, v97
    v_and_b32 v105, s38, v97
    v_pk_fma_f32 v[26:27], v[104:105], v[104:105], v[26:27]
    v_lshlrev_b32 v104, 16, v98
    v_and_b32 v105, s38, v98
    v_pk_fma_f32 v[28:29], v[104:105], v[104:105], v[28:29]
    v_lshlrev_b32 v104, 16, v99
    v_and_b32 v105, s38, v99
    v_pk_fma_f32 v[30:31], v[104:105], v[104:105], v[30:31]
    s_add_u32 s7, s48, 110592
    buffer_load_dwordx4 v[84:87], v6, s[8:11], s7 offen sc1
    v_lshlrev_b32 v104, 16, v100
    v_and_b32 v105, s38, v100
    v_pk_fma_f32 v[24:25], v[104:105], v[104:105], v[24:25]
    v_lshlrev_b32 v104, 16, v101
    v_and_b32 v105, s38, v101
    v_pk_fma_f32 v[26:27], v[104:105], v[104:105], v[26:27]
    v_lshlrev_b32 v104, 16, v102
    v_and_b32 v105, s38, v102
    v_pk_fma_f32 v[28:29], v[104:105], v[104:105], v[28:29]
    v_lshlrev_b32 v104, 16, v103
    v_and_b32 v105, s38, v103
    v_pk_fma_f32 v[30:31], v[104:105], v[104:105], v[30:31]
    ds_write_b128 v8, v[24:27] offset:128
    ds_write_b128 v8, v[28:31] offset:144
    s_waitcnt vmcnt(9)
    v_bitop3_b32 v9, v40, v44, v48 bitop3:0x80
    s_waitcnt vmcnt(8)
    v_and_b32 v9, v9, v52
    v_and_b32 v9, s40, v9
    v_cmp_ne_u32 vcc, s40, v9
    s_cbranch_vccnz cslow_52
cback_51:
    s_add_u32 s7, s48, 114688
    buffer_load_dwordx4 v[88:91], v6, s[8:11], s7 offen sc1
    v_cndmask_b32 v40, v40, 0, s[50:51]
    v_lshlrev_b32 v104, 16, v40
    v_and_b32 v105, s38, v40
    v_pk_mul_f32 v[16:17], v[104:105], v[104:105]
    v_cndmask_b32 v41, v41, 0, s[50:51]
    v_lshlrev_b32 v104, 16, v41
    v_and_b32 v105, s38, v41
    v_pk_mul_f32 v[18:19], v[104:105], v[104:105]
    v_cndmask_b32 v42, v42, 0, s[50:51]
    v_lshlrev_b32 v104, 16, v42
    v_and_b32 v105, s38, v42
    v_pk_mul_f32 v[20:21], v[104:105], v[104:105]
    v_cndmask_b32 v43, v43, 0, s[50:51]
    v_lshlrev_b32 v104, 16, v43
    v_and_b32 v105, s38, v43
    v_pk_mul_f32 v[22:23], v[104:105], v[104:105]
    s_add_u32 s7, s48, 118784
    buffer_load_dwordx4 v[92:95], v6, s[8:11], s7 offen sc1
    v_lshlrev_b32 v104, 16, v44
    v_and_b32 v105, s38, v44
    v_pk_fma_f32 v[16:17], v[104:105], v[104:105], v[16:17]
    v_lshlrev_b32 v104, 16, v45
    v_and_b32 v105, s38, v45
    v_pk_fma_f32 v[18:19], v[104:105], v[104:105], v[18:19]
    v_lshlrev_b32 v104, 16, v46
    v_and_b32 v105, s38, v46
    v_pk_fma_f32 v[20:21], v[104:105], v[104:105], v[20:21]
    v_lshlrev_b32 v104, 16, v47
    v_and_b32 v105, s38, v47
    v_pk_fma_f32 v[22:23], v[104:105], v[104:105], v[22:23]
    s_add_u32 s7, s48, 122880
    buffer_load_dwordx4 v[96:99], v6, s[8:11], s7 offen sc1
    v_lshlrev_b32 v104, 16, v48
    v_and_b32 v105, s38, v48
    v_pk_fma_f32 v[16:17], v[104:105], v[104:105], v[16:17]
    v_lshlrev_b32 v104, 16, v49
    v_and_b32 v105, s38, v49
    v_pk_fma_f32 v[18:19], v[104:105], v[104:105], v[18:19]
    v_lshlrev_b32 v104, 16, v50
    v_and_b32 v105, s38, v50
    v_pk_fma_f32 v[20:21], v[104:105], v[104:105], v[20:21]
    v_lshlrev_b32 v104, 16, v51
    v_and_b32 v105, s38, v51
    v_pk_fma_f32 v[22:23], v[104:105], v[104:105], v[22:23]
    s_add_u32 s7, s48, 126976
    buffer_load_dwordx4 v[100:103], v6, s[8:11], s7 offen sc1
    v_lshlrev_b32 v104, 16, v52
    v_and_b32 v105, s38, v52
    v_pk_fma_f32 v[16:17], v[104:105], v[104:105], v[16:17]
    v_lshlrev_b32 v104, 16, v53
    v_and_b32 v105, s38, v53
    v_pk_fma_f32 v[18:19], v[104:105], v[104:105], v[18:19]
    v_lshlrev_b32 v104, 16, v54
    v_and_b32 v105, s38, v54
    v_pk_fma_f32 v[20:21], v[104:105], v[104:105], v[20:21]
    v_lshlrev_b32 v104, 16, v55
    v_and_b32 v105, s38, v55
    v_pk_fma_f32 v[22:23], v[104:105], v[104:105], v[22:23]
    s_waitcnt vmcnt(9)
    v_bitop3_b32 v9, v56, v60, v64 bitop3:0x80
    s_waitcnt vmcnt(8)
    v_and_b32 v9, v9, v68
    v_and_b32 v9, s40, v9
    v_cmp_ne_u32 vcc, s40, v9
    s_cbranch_vccnz cslow_54
cback_53:
    s_add_u32 s7, s48, 131072
    buffer_load_dwordx4 v[40:43], v6, s[8:11], s7 offen sc1
    v_lshlrev_b32 v104, 16, v56
    v_and_b32 v105, s38, v56
    v_pk_fma_f32 v[16:17], v[104:105], v[104:105], v[16:17]
    v_lshlrev_b32 v104, 16, v57
    v_and_b32 v105, s38, v57
    v_pk_fma_f32 v[18:19], v[104:105], v[104:105], v[18:19]
    v_lshlrev_b32 v104, 16, v58
    v_and_b32 v105, s38, v58
    v_pk_fma_f32 v[20:21], v[104:105], v[104:105], v[20:21]
    v_lshlrev_b32 v104, 16, v59
    v_and_b32 v105, s38, v59
    v_pk_fma_f32 v[22:23], v[104:105], v[104:105], v[22:23]
    s_add_u32 s7, s48, 135168
    buffer_load_dwordx4 v[44:47], v6, s[8:11], s7 offen sc1
    v_lshlrev_b32 v104, 16, v60
    v_and_b32 v105, s38, v60
    v_pk_fma_f32 v[16:17], v[104:105], v[104:105], v[16:17]
    v_lshlrev_b32 v104, 16, v61
    v_and_b32 v105, s38, v61
    v_pk_fma_f32 v[18:19], v[104:105], v[104:105], v[18:19]
    v_lshlrev_b32 v104, 16, v62
    v_and_b32 v105, s38, v62
    v_pk_fma_f32 v[20:21], v[104:105], v[104:105], v[20:21]
    v_lshlrev_b32 v104, 16, v63
    v_and_b32 v105, s38, v63
    v_pk_fma_f32 v[22:23], v[104:105], v[104:105], v[22:23]
    s_add_u32 s7, s48, 139264
    buffer_load_dwordx4 v[48:51], v6, s[8:11], s7 offen sc1
    v_lshlrev_b32 v104, 16, v64
    v_and_b32 v105, s38, v64
    v_pk_fma_f32 v[16:17], v[104:105], v[104:105], v[16:17]
    v_lshlrev_b32 v104, 16, v65
    v_and_b32 v105, s38, v65
    v_pk_fma_f32 v[18:19], v[104:105], v[104:105], v[18:19]
    v_lshlrev_b32 v104, 16, v66
    v_and_b32 v105, s38, v66
    v_pk_fma_f32 v[20:21], v[104:105], v[104:105], v[20:21]
    v_lshlrev_b32 v104, 16, v67
    v_and_b32 v105, s38, v67
    v_pk_fma_f32 v[22:23], v[104:105], v[104:105], v[22:23]
    s_add_u32 s7, s48, 143360
    buffer_load_dwordx4 v[52:55], v6, s[8:11], s7 offen sc1
    v_lshlrev_b32 v104, 16, v68
    v_and_b32 v105, s38, v68
    v_pk_fma_f32 v[16:17], v[104:105], v[104:105], v[16:17]
    v_lshlrev_b32 v104, 16, v69
    v_and_b32 v105, s38, v69
    v_pk_fma_f32 v[18:19], v[104:105], v[104:105], v[18:19]
    v_lshlrev_b32 v104, 16, v70
    v_and_b32 v105, s38, v70
    v_pk_fma_f32 v[20:21], v[104:105], v[104:105], v[20:21]
    v_lshlrev_b32 v104, 16, v71
    v_and_b32 v105, s38, v71
    v_pk_fma_f32 v[22:23], v[104:105], v[104:105], v[22:23]
    ds_write_b128 v8, v[16:19] offset:256
    ds_write_b128 v8, v[20:23] offset:272
    s_waitcnt vmcnt(9)
    v_bitop3_b32 v9, v72, v76, v80 bitop3:0x80
    s_waitcnt vmcnt(8)
    v_and_b32 v9, v9, v84
    v_and_b32 v9, s40, v9
    v_cmp_ne_u32 vcc, s40, v9
    s_cbranch_vccnz cslow_56
cback_55:
    s_add_u32 s7, s48, 147456
    buffer_load_dwordx4 v[56:59], v6, s[8:11], s7 offen sc1
    v_cndmask_b32 v72, v72, 0, s[50:51]
    v_lshlrev_b32 v104, 16, v72
    v_and_b32 v105, s38, v72
    v_pk_mul_f32 v[24:25], v[104:105], v[104:105]
    v_cndmask_b32 v73, v73, 0, s[50:51]
    v_lshlrev_b32 v104, 16, v73
    v_and_b32 v105, s38, v73
    v_pk_mul_f32 v[26:27], v[104:105], v[104:105]
    v_cndmask_b32 v74, v74, 0, s[50:51]
    v_lshlrev_b32 v104, 16, v74
    v_and_b32 v105, s38, v74
    v_pk_mul_f32 v[28:29], v[104:105], v[104:105]
    v_cndmask_b32 v75, v75, 0, s[50:51]
    v_lshlrev_b32 v104, 16, v75
    v_and_b32 v105, s38, v75
    v_pk_mul_f32 v[30:31], v[104:105], v[104:105]
    s_add_u32 s7, s48, 151552
    buffer_load_dwordx4 v[60:63], v6, s[8:11], s7 offen sc1
    v_lshlrev_b32 v104, 16, v76
    v_and_b32 v105, s38, v76
    v_pk_fma_f32 v[24:25], v[104:105], v[104:105], v[24:25]
    v_lshlrev_b32 v104, 16, v77
    v_and_b32 v105, s38, v77
    v_pk_fma_f32 v[26:27], v[104:105], v[104:105], v[26:27]
    v_lshlrev_b32 v104, 16, v78
    v_and_b32 v105, s38, v78
    v_pk_fma_f32 v[28:29], v[104:105], v[104:105], v[28:29]
    v_lshlrev_b32 v104, 16, v79
    v_and_b32 v105, s38, v79
    v_pk_fma_f32 v[30:31], v[104:105], v[104:105], v[30:31]
    s_add_u32 s7, s48, 155648
    buffer_load_dwordx4 v[64:67], v6, s[8:11], s7 offen sc1
    v_lshlrev_b32 v104, 16, v80
    v_and_b32 v105, s38, v80
    v_pk_fma_f32 v[24:25], v[104:105], v[104:105], v[24:25]
    v_lshlrev_b32 v104, 16, v81
    v_and_b32 v105, s38, v81
    v_pk_fma_f32 v[26:27], v[104:105], v[104:105], v[26:27]
    v_lshlrev_b32 v104, 16, v82
    v_and_b32 v105, s38, v82
    v_pk_fma_f32 v[28:29], v[104:105], v[104:105], v[28:29]
    v_lshlrev_b32 v104, 16, v83
    v_and_b32 v105, s38, v83
    v_pk_fma_f32 v[30:31], v[104:105], v[104:105], v[30:31]
    s_add_u32 s7, s48, 159744
    buffer_load_dwordx4 v[68:71], v6, s[8:11], s7 offen sc1
    v_lshlrev_b32 v104, 16, v84
    v_and_b32 v105, s38, v84
    v_pk_fma_f32 v[24:25], v[104:105], v[104:105], v[24:25]
    v_lshlrev_b32 v104, 16, v85
    v_and_b32 v105, s38, v85
    v_pk_fma_f32 v[26:27], v[104:105], v[104:105], v[26:27]
    v_lshlrev_b32 v104, 16, v86
    v_and_b32 v105, s38, v86
    v_pk_fma_f32 v[28:29], v[104:105], v[104:105], v[28:29]
    v_lshlrev_b32 v104, 16, v87
    v_and_b32 v105, s38, v87
    v_pk_fma_f32 v[30:31], v[104:105], v[104:105], v[30:31]
    s_waitcnt vmcnt(9)
    v_bitop3_b32 v9, v88, v92, v96 bitop3:0x80
    s_waitcnt vmcnt(8)
    v_and_b32 v9, v9, v100
    v_and_b32 v9, s40, v9
    v_cmp_ne_u32 vcc, s40, v9
    s_cbranch_vccnz cslow_58
cback_57:
    s_add_u32 s7, s48, 163840
    buffer_load_dwordx4 v[72:75], v6, s[8:11], s7 offen sc1
    v_lshlrev_b32 v104, 16, v88
    v_and_b32 v105, s38, v88
    v_pk_fma_f32 v[24:25], v[104:105], v[104:105], v[24:25]
    v_lshlrev_b32 v104, 16, v89
    v_and_b32 v105, s38, v89
    v_pk_fma_f32 v[26:27], v[104:105], v[104:105], v[26:27]
    v_lshlrev_b32 v104, 16, v90
    v_and_b32 v105, s38, v90
    v_pk_fma_f32 v[28:29], v[104:105], v[104:105], v[28:29]
    v_lshlrev_b32 v104, 16, v91
    v_and_b32 v105, s38, v91
    v_pk_fma_f32 v[30:31], v[104:105], v[104:105], v[30:31]
    s_add_u32 s7, s48, 167936
    buffer_load_dwordx4 v[76:79], v6, s[8:11], s7 offen sc1
    v_lshlrev_b32 v104, 16, v92
    v_and_b32 v105, s38, v92
    v_pk_fma_f32 v[24:25], v[104:105], v[104:105], v[24:25]
    v_lshlrev_b32 v104, 16, v93
    v_and_b32 v105, s38, v93
    v_pk_fma_f32 v[26:27], v[104:105], v[104:105], v[26:27]
    v_lshlrev_b32 v104, 16, v94
    v_and_b32 v105, s38, v94
    v_pk_fma_f32 v[28:29], v[104:105], v[104:105], v[28:29]
    v_lshlrev_b32 v104, 16, v95
    v_and_b32 v105, s38, v95
    v_pk_fma_f32 v[30:31], v[104:105], v[104:105], v[30:31]
    s_add_u32 s7, s48, 172032
    buffer_load_dwordx4 v[80:83], v6, s[8:11], s7 offen sc1
    v_lshlrev_b32 v104, 16, v96
    v_and_b32 v105, s38, v96
    v_pk_fma_f32 v[24:25], v[104:105], v[104:105], v[24:25]
    v_lshlrev_b32 v104, 16, v97
    v_and_b32 v105, s38, v97
    v_pk_fma_f32 v[26:27], v[104:105], v[104:105], v[26:27]
    v_lshlrev_b32 v104, 16, v98
    v_and_b32 v105, s38, v98
    v_pk_fma_f32 v[28:29], v[104:105], v[104:105], v[28:29]
    v_lshlrev_b32 v104, 16, v99
    v_and_b32 v105, s38, v99
    v_pk_fma_f32 v[30:31], v[104:105], v[104:105], v[30:31]
    s_add_u32 s7, s48, 176128
    buffer_load_dwordx4 v[84:87], v6, s[8:11], s7 offen sc1
    v_lshlrev_b32 v104, 16, v100
    v_and_b32 v105, s38, v100
    v_pk_fma_f32 v[24:25], v[104:105], v[104:105], v[24:25]
    v_lshlrev_b32 v104, 16, v101
    v_and_b32 v105, s38, v101
    v_pk_fma_f32 v[26:27], v[104:105], v[104:105], v[26:27]
    v_lshlrev_b32 v104, 16, v102
    v_and_b32 v105, s38, v102
    v_pk_fma_f32 v[28:29], v[104:105], v[104:105], v[28:29]
    v_lshlrev_b32 v104, 16, v103
    v_and_b32 v105, s38, v103
    v_pk_fma_f32 v[30:31], v[104:105], v[104:105], v[30:31]
    ds_write_b128 v8, v[24:27] offset:384
    ds_write_b128 v8, v[28:31] offset:400
    s_waitcnt vmcnt(9)
    v_bitop3_b32 v9, v40, v44, v48 bitop3:0x80
    s_waitcnt vmcnt(8)
    v_and_b32 v9, v9, v52
    v_and_b32 v9, s73, v9
    v_cmp_ne_u32 vcc, s73, v9
    s_cbranch_vccnz cslow_60
cback_59:
    s_add_u32 s7, s48, 180224
    buffer_load_dwordx4 v[88:91], v6, s[8:11], s7 offen sc1
    v_cndmask_b32 v40, v40, 0, s[50:51]
    v_lshlrev_b32 v104, 16, v40
    v_and_b32 v105, s38, v40
    v_pk_mul_f32 v[16:17], v[104:105], v[104:105]
    v_cndmask_b32 v41, v41, 0, s[50:51]
    v_lshlrev_b32 v104, 16, v41
    v_and_b32 v105, s38, v41
    v_pk_mul_f32 v[18:19], v[104:105], v[104:105]
    v_cndmask_b32 v42, v42, 0, s[50:51]
    v_lshlrev_b32 v104, 16, v42
    v_and_b32 v105, s38, v42
    v_pk_mul_f32 v[20:21], v[104:105], v[104:105]
    v_cndmask_b32 v43, v43, 0, s[50:51]
    v_lshlrev_b32 v104, 16, v43
    v_and_b32 v105, s38, v43
    v_pk_mul_f32 v[22:23], v[104:105], v[104:105]
    s_add_u32 s7, s48, 184320
    buffer_load_dwordx4 v[92:95], v6, s[8:11], s7 offen sc1
    v_lshlrev_b32 v104, 16, v44
    v_and_b32 v105, s38, v44
    v_pk_fma_f32 v[16:17], v[104:105], v[104:105], v[16:17]
    v_lshlrev_b32 v104, 16, v45
    v_and_b32 v105, s38, v45
    v_pk_fma_f32 v[18:19], v[104:105], v[104:105], v[18:19]
    v_lshlrev_b32 v104, 16, v46
    v_and_b32 v105, s38, v46
    v_pk_fma_f32 v[20:21], v[104:105], v[104:105], v[20:21]
    v_lshlrev_b32 v104, 16, v47
    v_and_b32 v105, s38, v47
    v_pk_fma_f32 v[22:23], v[104:105], v[104:105], v[22:23]
    s_add_u32 s7, s48, 188416
    buffer_load_dwordx4 v[96:99], v6, s[8:11], s7 offen sc1
    v_lshlrev_b32 v104, 16, v48
    v_and_b32 v105, s38, v48
    v_pk_fma_f32 v[16:17], v[104:105], v[104:105], v[16:17]
    v_lshlrev_b32 v104, 16, v49
    v_and_b32 v105, s38, v49
    v_pk_fma_f32 v[18:19], v[104:105], v[104:105], v[18:19]
    v_lshlrev_b32 v104, 16, v50
    v_and_b32 v105, s38, v50
    v_pk_fma_f32 v[20:21], v[104:105], v[104:105], v[20:21]
    v_lshlrev_b32 v104, 16, v51
    v_and_b32 v105, s38, v51
    v_pk_fma_f32 v[22:23], v[104:105], v[104:105], v[22:23]
    s_add_u32 s7, s48, 192512
    buffer_load_dwordx4 v[100:103], v6, s[8:11], s7 offen sc1
    v_lshlrev_b32 v104, 16, v52
    v_and_b32 v105, s38, v52
    v_pk_fma_f32 v[16:17], v[104:105], v[104:105], v[16:17]
    v_lshlrev_b32 v104, 16, v53
    v_and_b32 v105, s38, v53
    v_pk_fma_f32 v[18:19], v[104:105], v[104:105], v[18:19]
    v_lshlrev_b32 v104, 16, v54
    v_and_b32 v105, s38, v54
    v_pk_fma_f32 v[20:21], v[104:105], v[104:105], v[20:21]
    v_lshlrev_b32 v104, 16, v55
    v_and_b32 v105, s38, v55
    v_pk_fma_f32 v[22:23], v[104:105], v[104:105], v[22:23]
    s_waitcnt vmcnt(9)
    v_bitop3_b32 v9, v56, v60, v64 bitop3:0x80
    s_waitcnt vmcnt(8)
    v_and_b32 v9, v9, v68
    v_and_b32 v9, s73, v9
    v_cmp_ne_u32 vcc, s73, v9
    s_cbranch_vccnz cslow_62
cback_61:
    s_add_u32 s1, s76, 0
    buffer_load_dwordx4 a[128:131], v4, s[56:59], s1 offen sc1
    buffer_load_dwordx4 a[132:135], v4, s[60:63], s1 offen sc1
    v_lshlrev_b32 v104, 16, v56
    v_and_b32 v105, s38, v56
    v_pk_fma_f32 v[16:17], v[104:105], v[104:105], v[16:17]
    v_lshlrev_b32 v104, 16, v57
    v_and_b32 v105, s38, v57
    v_pk_fma_f32 v[18:19], v[104:105], v[104:105], v[18:19]
    v_lshlrev_b32 v104, 16, v58
    v_and_b32 v105, s38, v58
    v_pk_fma_f32 v[20:21], v[104:105], v[104:105], v[20:21]
    v_lshlrev_b32 v104, 16, v59
    v_and_b32 v105, s38, v59
    v_pk_fma_f32 v[22:23], v[104:105], v[104:105], v[22:23]
    s_add_u32 s1, s82, 0
    buffer_load_dwordx4 a[136:139], v4, s[56:59], s1 offen sc1
    buffer_load_dwordx4 a[140:143], v4, s[60:63], s1 offen sc1
    v_lshlrev_b32 v104, 16, v60
    v_and_b32 v105, s38, v60
    v_pk_fma_f32 v[16:17], v[104:105], v[104:105], v[16:17]
    v_lshlrev_b32 v104, 16, v61
    v_and_b32 v105, s38, v61
    v_pk_fma_f32 v[18:19], v[104:105], v[104:105], v[18:19]
    v_lshlrev_b32 v104, 16, v62
    v_and_b32 v105, s38, v62
    v_pk_fma_f32 v[20:21], v[104:105], v[104:105], v[20:21]
    v_lshlrev_b32 v104, 16, v63
    v_and_b32 v105, s38, v63
    v_pk_fma_f32 v[22:23], v[104:105], v[104:105], v[22:23]
    s_add_u32 s1, s76, 8192
    buffer_load_dwordx4 a[144:147], v4, s[56:59], s1 offen sc1
    buffer_load_dwordx4 a[148:151], v4, s[60:63], s1 offen sc1
    v_lshlrev_b32 v104, 16, v64
    v_and_b32 v105, s38, v64
    v_pk_fma_f32 v[16:17], v[104:105], v[104:105], v[16:17]
    v_lshlrev_b32 v104, 16, v65
    v_and_b32 v105, s38, v65
    v_pk_fma_f32 v[18:19], v[104:105], v[104:105], v[18:19]
    v_lshlrev_b32 v104, 16, v66
    v_and_b32 v105, s38, v66
    v_pk_fma_f32 v[20:21], v[104:105], v[104:105], v[20:21]
    v_lshlrev_b32 v104, 16, v67
    v_and_b32 v105, s38, v67
    v_pk_fma_f32 v[22:23], v[104:105], v[104:105], v[22:23]
    s_add_u32 s1, s82, 8192
    buffer_load_dwordx4 a[152:155], v4, s[56:59], s1 offen sc1
    buffer_load_dwordx4 a[156:159], v4, s[60:63], s1 offen sc1
    v_lshlrev_b32 v104, 16, v68
    v_and_b32 v105, s38, v68
    v_pk_fma_f32 v[16:17], v[104:105], v[104:105], v[16:17]
    v_lshlrev_b32 v104, 16, v69
    v_and_b32 v105, s38, v69
    v_pk_fma_f32 v[18:19], v[104:105], v[104:105], v[18:19]
    v_lshlrev_b32 v104, 16, v70
    v_and_b32 v105, s38, v70
    v_pk_fma_f32 v[20:21], v[104:105], v[104:105], v[20:21]
    v_lshlrev_b32 v104, 16, v71
    v_and_b32 v105, s38, v71
    v_pk_fma_f32 v[22:23], v[104:105], v[104:105], v[22:23]
    ds_write_b128 v8, v[16:19] offset:512
    ds_write_b128 v8, v[20:23] offset:528
    s_waitcnt vmcnt(13)
    v_bitop3_b32 v9, v72, v76, v80 bitop3:0x80
    s_waitcnt vmcnt(12)
    v_and_b32 v9, v9, v84
    v_and_b32 v9, s73, v9
    v_cmp_ne_u32 vcc, s73, v9
    s_cbranch_vccnz cslow_64
cback_63:
    s_add_u32 s1, s76, 16384
    buffer_load_dwordx4 a[160:163], v4, s[56:59], s1 offen sc1
    buffer_load_dwordx4 a[164:167], v4, s[60:63], s1 offen sc1
    v_cndmask_b32 v72, v72, 0, s[50:51]
    v_lshlrev_b32 v104, 16, v72
    v_and_b32 v105, s38, v72
    v_pk_mul_f32 v[24:25], v[104:105], v[104:105]
    v_cndmask_b32 v73, v73, 0, s[50:51]
    v_lshlrev_b32 v104, 16, v73
    v_and_b32 v105, s38, v73
    v_pk_mul_f32 v[26:27], v[104:105], v[104:105]
    v_cndmask_b32 v74, v74, 0, s[50:51]
    v_lshlrev_b32 v104, 16, v74
    v_and_b32 v105, s38, v74
    v_pk_mul_f32 v[28:29], v[104:105], v[104:105]
    v_cndmask_b32 v75, v75, 0, s[50:51]
    v_lshlrev_b32 v104, 16, v75
    v_and_b32 v105, s38, v75
    v_pk_mul_f32 v[30:31], v[104:105], v[104:105]
    s_add_u32 s1, s82, 16384
    buffer_load_dwordx4 a[168:171], v4, s[56:59], s1 offen sc1
    buffer_load_dwordx4 a[172:175], v4, s[60:63], s1 offen sc1
    v_lshlrev_b32 v104, 16, v76
    v_and_b32 v105, s38, v76
    v_pk_fma_f32 v[24:25], v[104:105], v[104:105], v[24:25]
    v_lshlrev_b32 v104, 16, v77
    v_and_b32 v105, s38, v77
    v_pk_fma_f32 v[26:27], v[104:105], v[104:105], v[26:27]
    v_lshlrev_b32 v104, 16, v78
    v_and_b32 v105, s38, v78
    v_pk_fma_f32 v[28:29], v[104:105], v[104:105], v[28:29]
    v_lshlrev_b32 v104, 16, v79
    v_and_b32 v105, s38, v79
    v_pk_fma_f32 v[30:31], v[104:105], v[104:105], v[30:31]
    s_add_u32 s1, s76, 24576
    buffer_load_dwordx4 a[176:179], v4, s[56:59], s1 offen sc1
    buffer_load_dwordx4 a[180:183], v4, s[60:63], s1 offen sc1
    v_lshlrev_b32 v104, 16, v80
    v_and_b32 v105, s38, v80
    v_pk_fma_f32 v[24:25], v[104:105], v[104:105], v[24:25]
    v_lshlrev_b32 v104, 16, v81
    v_and_b32 v105, s38, v81
    v_pk_fma_f32 v[26:27], v[104:105], v[104:105], v[26:27]
    v_lshlrev_b32 v104, 16, v82
    v_and_b32 v105, s38, v82
    v_pk_fma_f32 v[28:29], v[104:105], v[104:105], v[28:29]
    v_lshlrev_b32 v104, 16, v83
    v_and_b32 v105, s38, v83
    v_pk_fma_f32 v[30:31], v[104:105], v[104:105], v[30:31]
    s_add_u32 s1, s82, 24576
    buffer_load_dwordx4 a[184:187], v4, s[56:59], s1 offen sc1
    buffer_load_dwordx4 a[188:191], v4, s[60:63], s1 offen sc1
    v_lshlrev_b32 v104, 16, v84
    v_and_b32 v105, s38, v84
    v_pk_fma_f32 v[24:25], v[104:105], v[104:105], v[24:25]
    v_lshlrev_b32 v104, 16, v85
    v_and_b32 v105, s38, v85
    v_pk_fma_f32 v[26:27], v[104:105], v[104:105], v[26:27]
    v_lshlrev_b32 v104, 16, v86
    v_and_b32 v105, s38, v86
    v_pk_fma_f32 v[28:29], v[104:105], v[104:105], v[28:29]
    v_lshlrev_b32 v104, 16, v87
    v_and_b32 v105, s38, v87
    v_pk_fma_f32 v[30:31], v[104:105], v[104:105], v[30:31]
    s_waitcnt vmcnt(17)
    v_bitop3_b32 v9, v88, v92, v96 bitop3:0x80
    s_waitcnt vmcnt(16)
    v_and_b32 v9, v9, v100
    v_and_b32 v9, s73, v9
    v_cmp_ne_u32 vcc, s73, v9
    s_cbranch_vccnz cslow_66
cback_65:
    s_add_u32 s1, s76, 32768
    buffer_load_dwordx4 a[192:195], v4, s[56:59], s1 offen sc1
    buffer_load_dwordx4 a[196:199], v4, s[60:63], s1 offen sc1
    v_lshlrev_b32 v104, 16, v88
    v_and_b32 v105, s38, v88
    v_pk_fma_f32 v[24:25], v[104:105], v[104:105], v[24:25]
    v_lshlrev_b32 v104, 16, v89
    v_and_b32 v105, s38, v89
    v_pk_fma_f32 v[26:27], v[104:105], v[104:105], v[26:27]
    v_lshlrev_b32 v104, 16, v90
    v_and_b32 v105, s38, v90
    v_pk_fma_f32 v[28:29], v[104:105], v[104:105], v[28:29]
    v_lshlrev_b32 v104, 16, v91
    v_and_b32 v105, s38, v91
    v_pk_fma_f32 v[30:31], v[104:105], v[104:105], v[30:31]
    s_add_u32 s1, s82, 32768
    buffer_load_dwordx4 a[200:203], v4, s[56:59], s1 offen sc1
    buffer_load_dwordx4 a[204:207], v4, s[60:63], s1 offen sc1
    v_lshlrev_b32 v104, 16, v92
    v_and_b32 v105, s38, v92
    v_pk_fma_f32 v[24:25], v[104:105], v[104:105], v[24:25]
    v_lshlrev_b32 v104, 16, v93
    v_and_b32 v105, s38, v93
    v_pk_fma_f32 v[26:27], v[104:105], v[104:105], v[26:27]
    v_lshlrev_b32 v104, 16, v94
    v_and_b32 v105, s38, v94
    v_pk_fma_f32 v[28:29], v[104:105], v[104:105], v[28:29]
    v_lshlrev_b32 v104, 16, v95
    v_and_b32 v105, s38, v95
    v_pk_fma_f32 v[30:31], v[104:105], v[104:105], v[30:31]
    s_add_u32 s1, s76, 40960
    buffer_load_dwordx4 a[208:211], v4, s[56:59], s1 offen sc1
    buffer_load_dwordx4 a[212:215], v4, s[60:63], s1 offen sc1
    v_lshlrev_b32 v104, 16, v96
    v_and_b32 v105, s38, v96
    v_pk_fma_f32 v[24:25], v[104:105], v[104:105], v[24:25]
    v_lshlrev_b32 v104, 16, v97
    v_and_b32 v105, s38, v97
    v_pk_fma_f32 v[26:27], v[104:105], v[104:105], v[26:27]
    v_lshlrev_b32 v104, 16, v98
    v_and_b32 v105, s38, v98
    v_pk_fma_f32 v[28:29], v[104:105], v[104:105], v[28:29]
    v_lshlrev_b32 v104, 16, v99
    v_and_b32 v105, s38, v99
    v_pk_fma_f32 v[30:31], v[104:105], v[104:105], v[30:31]
    s_add_u32 s1, s82, 40960
    buffer_load_dwordx4 a[216:219], v4, s[56:59], s1 offen sc1
    buffer_load_dwordx4 a[220:223], v4, s[60:63], s1 offen sc1
    v_lshlrev_b32 v104, 16, v100
    v_and_b32 v105, s38, v100
    v_pk_fma_f32 v[24:25], v[104:105], v[104:105], v[24:25]
    v_lshlrev_b32 v104, 16, v101
    v_and_b32 v105, s38, v101
    v_pk_fma_f32 v[26:27], v[104:105], v[104:105], v[26:27]
    v_lshlrev_b32 v104, 16, v102
    v_and_b32 v105, s38, v102
    v_pk_fma_f32 v[28:29], v[104:105], v[104:105], v[28:29]
    v_lshlrev_b32 v104, 16, v103
    v_and_b32 v105, s38, v103
    v_pk_fma_f32 v[30:31], v[104:105], v[104:105], v[30:31]
    ds_write_b128 v8, v[24:27] offset:640
    ds_write_b128 v8, v[28:31] offset:656
    s_waitcnt lgkmcnt(0)
    s_barrier
    v_lshlrev_b32 v6, 2, v0
    ds_read2st64_b32 v[40:41], v6 offset0:0 offset1:3
    ds_read2st64_b32 v[42:43], v6 offset0:6 offset1:9
    ds_read2st64_b32 v[44:45], v6 offset0:12 offset1:15
    ds_read2st64_b32 v[46:47], v6 offset0:18 offset1:21
    ds_read2st64_b32 v[48:49], v6 offset0:24 offset1:27
    ds_read2st64_b32 v[50:51], v6 offset0:30 offset1:33
    ds_read2st64_b32 v[52:53], v6 offset0:36 offset1:39
    ds_read2st64_b32 v[54:55], v6 offset0:42 offset1:45
    ds_read2st64_b32 v[56:57], v6 offset0:48 offset1:51
    ds_read2st64_b32 v[58:59], v6 offset0:54 offset1:57
    ds_read2st64_b32 v[60:61], v6 offset0:60 offset1:63
    ds_read2st64_b32 v[62:63], v6 offset0:66 offset1:69
    ds_read2st64_b32 v[64:65], v6 offset0:72 offset1:75
    ds_read2st64_b32 v[66:67], v6 offset0:78 offset1:81
    ds_read2st64_b32 v[68:69], v6 offset0:84 offset1:87
    ds_read2st64_b32 v[70:71], v6 offset0:90 offset1:93
    ds_read2st64_b32 v[72:73], v6 offset0:96 offset1:99
    ds_read2st64_b32 v[74:75], v6 offset0:102 offset1:105
    ds_read2st64_b32 v[76:77], v6 offset0:108 offset1:111
    ds_read2st64_b32 v[78:79], v6 offset0:114 offset1:117
    ds_read2st64_b32 v[80:81], v6 offset0:120 offset1:123
    ds_read2st64_b32 v[82:83], v6 offset0:126 offset1:129
    ds_read2st64_b32 v[84:85], v6 offset0:132 offset1:135
    ds_read2st64_b32 v[86:87], v6 offset0:138 offset1:141
    ds_read2st64_b32 v[88:89], v6 offset0:144 offset1:147
    ds_read2st64_b32 v[90:91], v6 offset0:150 offset1:153
    ds_read2st64_b32 v[92:93], v6 offset0:156 offset1:159
    ds_read2st64_b32 v[94:95], v6 offset0:162 offset1:165
    ds_read2st64_b32 v[96:97], v6 offset0:168 offset1:171
    ds_read2st64_b32 v[98:99], v6 offset0:174 offset1:177
    ds_read2st64_b32 v[100:101], v6 offset0:180 offset1:183
    ds_read2st64_b32 v[102:103], v6 offset0:186 offset1:189
    s_waitcnt lgkmcnt(15)
    v_pk_add_f32 v[40:41], v[40:41], v[72:73]
    s_waitcnt lgkmcnt(14)
    v_pk_add_f32 v[42:43], v[42:43], v[74:75]
    s_waitcnt lgkmcnt(13)
    v_pk_add_f32 v[44:45], v[44:45], v[76:77]
    s_waitcnt lgkmcnt(12)
    v_pk_add_f32 v[46:47], v[46:47], v[78:79]
    s_waitcnt lgkmcnt(11)
    v_pk_add_f32 v[48:49], v[48:49], v[80:81]
    s_waitcnt lgkmcnt(10)
    v_pk_add_f32 v[50:51], v[50:51], v[82:83]
    s_waitcnt lgkmcnt(9)
    v_pk_add_f32 v[52:53], v[52:53], v[84:85]
    s_waitcnt lgkmcnt(8)
    v_pk_add_f32 v[54:55], v[54:55], v[86:87]
    s_waitcnt lgkmcnt(7)
    v_pk_add_f32 v[56:57], v[56:57], v[88:89]
    s_waitcnt lgkmcnt(6)
    v_pk_add_f32 v[58:59], v[58:59], v[90:91]
    s_waitcnt lgkmcnt(5)
    v_pk_add_f32 v[60:61], v[60:61], v[92:93]
    s_waitcnt lgkmcnt(4)
    v_pk_add_f32 v[62:63], v[62:63], v[94:95]
    s_waitcnt lgkmcnt(3)
    v_pk_add_f32 v[64:65], v[64:65], v[96:97]
    s_waitcnt lgkmcnt(2)
    v_pk_add_f32 v[66:67], v[66:67], v[98:99]
    s_waitcnt lgkmcnt(1)
    v_pk_add_f32 v[68:69], v[68:69], v[100:101]
    s_waitcnt lgkmcnt(0)
    v_pk_add_f32 v[70:71], v[70:71], v[102:103]
    v_pk_add_f32 v[40:41], v[40:41], v[56:57]
    v_pk_add_f32 v[42:43], v[42:43], v[58:59]
    v_pk_add_f32 v[44:45], v[44:45], v[60:61]
    v_pk_add_f32 v[46:47], v[46:47], v[62:63]
    v_pk_add_f32 v[48:49], v[48:49], v[64:65]
    v_pk_add_f32 v[50:51], v[50:51], v[66:67]
    v_pk_add_f32 v[52:53], v[52:53], v[68:69]
    v_pk_add_f32 v[54:55], v[54:55], v[70:71]
    v_pk_add_f32 v[40:41], v[40:41], v[48:49]
    v_pk_add_f32 v[42:43], v[42:43], v[50:51]
    v_pk_add_f32 v[44:45], v[44:45], v[52:53]
    v_pk_add_f32 v[46:47], v[46:47], v[54:55]
    v_pk_add_f32 v[40:41], v[40:41], v[44:45]
    v_pk_add_f32 v[42:43], v[42:43], v[46:47]
    v_pk_add_f32 v[40:41], v[40:41], v[42:43]
    v_add_f32 v40, v40, v41
    v_mov_b32 v8, 0x3727c5ac
    v_fmamk_f32 v40, v40, 0x3b000000, v8
    v_rcp_f32 v40, v40
    s_add_u32 s12, s34, 7340032
    s_addc_u32 s13, s35, 0
    s_mov_b32 s14, 8192
    s_mov_b32 s15, 0x20000
    s_mul_i32 s5, s44, 768
    v_mov_b32 v8, 16777216
    v_min_u32 v40, -2, v40
    v_cmp_gt_u32 vcc, 192, v0
    s_nop 1
    v_cndmask_b32 v6, v8, v6, vcc
    buffer_store_dword v40, v6, s[12:15], s5 offen sc1
    s_add_u32 s1, s76, 49152
    buffer_load_dwordx4 a[224:227], v4, s[56:59], s1 offen sc1
    buffer_load_dwordx4 a[228:231], v4, s[60:63], s1 offen sc1
    s_add_u32 s1, s82, 49152
    buffer_load_dwordx4 a[232:235], v4, s[56:59], s1 offen sc1
    buffer_load_dwordx4 a[236:239], v4, s[60:63], s1 offen sc1
    s_add_u32 s1, s76, 57344
    buffer_load_dwordx4 a[240:243], v4, s[56:59], s1 offen sc1
    buffer_load_dwordx4 a[244:247], v4, s[60:63], s1 offen sc1
    s_add_u32 s1, s82, 57344
    buffer_load_dwordx4 a[248:251], v4, s[56:59], s1 offen sc1
    buffer_load_dwordx4 a[252:255], v4, s[60:63], s1 offen sc1
    s_add_u32 s1, s76, 65536
    buffer_load_dwordx4 v[208:211], v4, s[56:59], s1 offen sc1
    buffer_load_dwordx4 v[212:215], v4, s[60:63], s1 offen sc1
    s_add_u32 s1, s82, 65536
    buffer_load_dwordx4 v[216:219], v4, s[56:59], s1 offen sc1
    buffer_load_dwordx4 v[220:223], v4, s[60:63], s1 offen sc1
    s_add_u32 s1, s76, 73728
    buffer_load_dwordx4 v[224:227], v4, s[56:59], s1 offen sc1
    buffer_load_dwordx4 v[228:231], v4, s[60:63], s1 offen sc1
    s_add_u32 s1, s82, 73728
    buffer_load_dwordx4 v[232:235], v4, s[56:59], s1 offen sc1
    buffer_load_dwordx4 v[236:239], v4, s[60:63], s1 offen sc1
    s_add_u32 s1, s76, 81920
    buffer_load_dwordx4 v[240:243], v4, s[56:59], s1 offen sc1
    buffer_load_dwordx4 v[244:247], v4, s[60:63], s1 offen sc1
    s_add_u32 s1, s82, 81920
    buffer_load_dwordx4 v[248:251], v4, s[56:59], s1 offen sc1
    buffer_load_dwordx4 v[252:255], v4, s[60:63], s1 offen sc1
    s_barrier
    v_mov_b32 v16, 16777216
    v_mov_b32 v17, s36
    s_lshl_b32 s5, s2, 8
    v_or_b32 v18, s5, v0
    v_cmp_eq_u32 vcc, 0, v18
    s_nop 1
    v_cndmask_b32 v16, v16, 0, vcc
    s_mov_b32 s5, 153600
    buffer_store_dword v17, v16, s[96:99], s5 offen sc1
    buffer_load_dword v2, v119, s[96:99], 0 offen sc1
    s_add_u32 s6, s36, 1
    s_waitcnt vmcnt(0)
    v_subrev_u32 v2, s6, v2
    v_cmp_le_u32 vcc, 8, v2
    s_cbranch_vccnz pslow_68
pback_67:
    s_waitcnt vmcnt(0)
L_g20:
    s_nop 1
    s_mov_b32 s79, 0
    buffer_load_dwordx4 v[120:123], v14, s[16:19], s79 offen offset:0 sc1
    buffer_load_dwordx4 v[124:127], v14, s[16:19], s79 offen offset:128 sc1
    s_mov_b32 s79, 8192
    buffer_load_dwordx4 v[128:131], v14, s[16:19], s79 offen offset:0 sc1
    buffer_load_dwordx4 v[132:135], v14, s[16:19], s79 offen offset:128 sc1
    s_mov_b32 s79, 16384
    buffer_load_dwordx4 v[136:139], v14, s[16:19], s79 offen offset:0 sc1
    buffer_load_dwordx4 v[140:143], v14, s[16:19], s79 offen offset:128 sc1
    s_mov_b32 s79, 24576
    buffer_load_dwordx4 v[144:147], v14, s[16:19], s79 offen offset:0 sc1
    buffer_load_dwordx4 v[148:151], v14, s[16:19], s79 offen offset:128 sc1
    s_mov_b32 s79, 32768
    buffer_load_dwordx4 v[152:155], v14, s[16:19], s79 offen offset:0 sc1
    buffer_load_dwordx4 v[156:159], v14, s[16:19], s79 offen offset:128 sc1
    s_waitcnt vmcnt(9)
    v_mfma_f32_16x16x32_bf16 v[40:43], v[120:123], a[128:131], 0
    s_add_u32 s12, s34, 7356416
    s_addc_u32 s13, s35, 0
    s_mov_b32 s14, 32768
    s_mov_b32 s15, 0x20000
    s_mov_b32 s80, 0xcccccccc
    s_mov_b32 s81, s80
    s_mov_b32 s79, 40960
    buffer_load_dwordx4 v[160:163], v14, s[16:19], s79 offen offset:0 sc1
    v_mfma_f32_16x16x32_bf16 v[48:51], v[120:123], a[136:139], 0
    v_mfma_f32_16x16x32_bf16 v[56:59], v[120:123], a[132:135], 0
    buffer_load_dwordx4 v[164:167], v14, s[16:19], s79 offen offset:128 sc1
    v_mfma_f32_16x16x32_bf16 v[64:67], v[120:123], a[140:143], 0
    s_waitcnt vmcnt(10)
    v_mfma_f32_16x16x32_bf16 v[44:47], v[124:127], a[128:131], 0
    s_mov_b32 s79, 49152
    buffer_load_dwordx4 v[168:171], v14, s[16:19], s79 offen offset:0 sc1
    v_mfma_f32_16x16x32_bf16 v[52:55], v[124:127], a[136:139], 0
    v_mfma_f32_16x16x32_bf16 v[60:63], v[124:127], a[132:135], 0
    buffer_load_dwordx4 v[172:175], v14, s[16:19], s79 offen offset:128 sc1
    v_mfma_f32_16x16x32_bf16 v[68:71], v[124:127], a[140:143], 0
    s_waitcnt vmcnt(11)
    v_mfma_f32_16x16x32_bf16 v[40:43], v[128:131], a[144:147], v[40:43]
    s_mov_b32 s79, 57344
    buffer_load_dwordx4 v[176:179], v14, s[16:19], s79 offen offset:0 sc1
    v_mfma_f32_16x16x32_bf16 v[48:51], v[128:131], a[152:155], v[48:51]
    v_mfma_f32_16x16x32_bf16 v[56:59], v[128:131], a[148:151], v[56:59]
    buffer_load_dwordx4 v[180:183], v14, s[16:19], s79 offen offset:128 sc1
    v_mfma_f32_16x16x32_bf16 v[64:67], v[128:131], a[156:159], v[64:67]
    s_waitcnt vmcnt(12)
    v_mfma_f32_16x16x32_bf16 v[44:47], v[132:135], a[144:147], v[44:47]
    s_mov_b32 s79, 65536
    buffer_load_dwordx4 v[184:187], v14, s[16:19], s79 offen offset:0 sc1
    v_mfma_f32_16x16x32_bf16 v[52:55], v[132:135], a[152:155], v[52:55]
    v_mfma_f32_16x16x32_bf16 v[60:63], v[132:135], a[148:151], v[60:63]
    buffer_load_dwordx4 v[188:191], v14, s[16:19], s79 offen offset:128 sc1
    v_mfma_f32_16x16x32_bf16 v[68:71], v[132:135], a[156:159], v[68:71]
    s_waitcnt vmcnt(13)
    v_mfma_f32_16x16x32_bf16 v[40:43], v[136:139], a[160:163], v[40:43]
    s_mov_b32 s79, 73728
    buffer_load_dwordx4 v[192:195], v14, s[16:19], s79 offen offset:0 sc1
    v_mfma_f32_16x16x32_bf16 v[48:51], v[136:139], a[168:171], v[48:51]
    v_mfma_f32_16x16x32_bf16 v[56:59], v[136:139], a[164:167], v[56:59]
    buffer_load_dwordx4 v[196:199], v14, s[16:19], s79 offen offset:128 sc1
    v_mfma_f32_16x16x32_bf16 v[64:67], v[136:139], a[172:175], v[64:67]
    s_waitcnt vmcnt(14)
    v_mfma_f32_16x16x32_bf16 v[44:47], v[140:143], a[160:163], v[44:47]
    s_mov_b32 s79, 81920
    buffer_load_dwordx4 v[200:203], v14, s[16:19], s79 offen offset:0 sc1
    v_mfma_f32_16x16x32_bf16 v[52:55], v[140:143], a[168:171], v[52:55]
    v_mfma_f32_16x16x32_bf16 v[60:63], v[140:143], a[164:167], v[60:63]
    buffer_load_dwordx4 v[204:207], v14, s[16:19], s79 offen offset:128 sc1
    v_mfma_f32_16x16x32_bf16 v[68:71], v[140:143], a[172:175], v[68:71]
    s_waitcnt vmcnt(15)
    v_mfma_f32_16x16x32_bf16 v[40:43], v[144:147], a[176:179], v[40:43]
    v_mfma_f32_16x16x32_bf16 v[48:51], v[144:147], a[184:187], v[48:51]
    v_mfma_f32_16x16x32_bf16 v[56:59], v[144:147], a[180:183], v[56:59]
    v_mfma_f32_16x16x32_bf16 v[64:67], v[144:147], a[188:191], v[64:67]
    s_waitcnt vmcnt(14)
    v_mfma_f32_16x16x32_bf16 v[44:47], v[148:151], a[176:179], v[44:47]
    buffer_load_dwordx4 v[32:35], v113, s[8:11], s74 offen sc1
    buffer_load_dwordx4 v[36:39], v113, s[8:11], s75 offen sc1
    buffer_load_dwordx4 v[16:19], v114, s[68:71], s28 offen offset:0 sc1
    buffer_load_dwordx4 v[20:23], v114, s[68:71], s28 offen offset:16 sc1
    buffer_load_dwordx4 v[24:27], v114, s[68:71], s29 offen offset:0 sc1
    buffer_load_dwordx4 v[28:31], v114, s[68:71], s29 offen offset:16 sc1
    v_mfma_f32_16x16x32_bf16 v[52:55], v[148:151], a[184:187], v[52:55]
    v_mfma_f32_16x16x32_bf16 v[60:63], v[148:151], a[180:183], v[60:63]
    v_mfma_f32_16x16x32_bf16 v[68:71], v[148:151], a[188:191], v[68:71]
    s_waitcnt vmcnt(19)
    v_mfma_f32_16x16x32_bf16 v[40:43], v[152:155], a[192:195], v[40:43]
    v_mfma_f32_16x16x32_bf16 v[48:51], v[152:155], a[200:203], v[48:51]
    v_mfma_f32_16x16x32_bf16 v[56:59], v[152:155], a[196:199], v[56:59]
    v_mfma_f32_16x16x32_bf16 v[64:67], v[152:155], a[204:207], v[64:67]
    s_waitcnt vmcnt(18)
    v_mfma_f32_16x16x32_bf16 v[44:47], v[156:159], a[192:195], v[44:47]
    v_mfma_f32_16x16x32_bf16 v[52:55], v[156:159], a[200:203], v[52:55]
    v_mfma_f32_16x16x32_bf16 v[60:63], v[156:159], a[196:199], v[60:63]
    v_mfma_f32_16x16x32_bf16 v[68:71], v[156:159], a[204:207], v[68:71]
    s_waitcnt vmcnt(17)
    v_mfma_f32_16x16x32_bf16 v[40:43], v[160:163], a[208:211], v[40:43]
    v_mfma_f32_16x16x32_bf16 v[48:51], v[160:163], a[216:219], v[48:51]
    v_mfma_f32_16x16x32_bf16 v[56:59], v[160:163], a[212:215], v[56:59]
    s_mov_b32 s79, 0
    buffer_load_dwordx4 v[120:123], v14, s[20:23], s79 offen offset:0 sc1
    v_mfma_f32_16x16x32_bf16 v[64:67], v[160:163], a[220:223], v[64:67]
    s_waitcnt vmcnt(17)
    v_mfma_f32_16x16x32_bf16 v[44:47], v[164:167], a[208:211], v[44:47]
    v_mfma_f32_16x16x32_bf16 v[52:55], v[164:167], a[216:219], v[52:55]
    v_mfma_f32_16x16x32_bf16 v[60:63], v[164:167], a[212:215], v[60:63]
    buffer_load_dwordx4 v[124:127], v14, s[20:23], s79 offen offset:128 sc1
    v_mfma_f32_16x16x32_bf16 v[68:71], v[164:167], a[220:223], v[68:71]
    s_waitcnt vmcnt(17)
    v_mfma_f32_16x16x32_bf16 v[40:43], v[168:171], a[224:227], v[40:43]
    v_mfma_f32_16x16x32_bf16 v[48:51], v[168:171], a[232:235], v[48:51]
    v_mfma_f32_16x16x32_bf16 v[56:59], v[168:171], a[228:231], v[56:59]
    s_mov_b32 s79, 8192
    buffer_load_dwordx4 v[128:131], v14, s[20:23], s79 offen offset:0 sc1
    v_mfma_f32_16x16x32_bf16 v[64:67], v[168:171], a[236:239], v[64:67]
    s_waitcnt vmcnt(17)
    v_mfma_f32_16x16x32_bf16 v[44:47], v[172:175], a[224:227], v[44:47]
    v_mfma_f32_16x16x32_bf16 v[52:55], v[172:175], a[232:235], v[52:55]
    v_mfma_f32_16x16x32_bf16 v[60:63], v[172:175], a[228:231], v[60:63]
    buffer_load_dwordx4 v[132:135], v14, s[20:23], s79 offen offset:128 sc1
    v_mfma_f32_16x16x32_bf16 v[68:71], v[172:175], a[236:239], v[68:71]
    s_waitcnt vmcnt(17)
    v_mfma_f32_16x16x32_bf16 v[40:43], v[176:179], a[240:243], v[40:43]
    v_mfma_f32_16x16x32_bf16 v[48:51], v[176:179], a[248:251], v[48:51]
    v_mfma_f32_16x16x32_bf16 v[56:59], v[176:179], a[244:247], v[56:59]
    s_mov_b32 s79, 16384
    buffer_load_dwordx4 v[136:139], v14, s[20:23], s79 offen offset:0 sc1
    v_mfma_f32_16x16x32_bf16 v[64:67], v[176:179], a[252:255], v[64:67]
    s_waitcnt vmcnt(17)
    v_mfma_f32_16x16x32_bf16 v[44:47], v[180:183], a[240:243], v[44:47]
    v_mfma_f32_16x16x32_bf16 v[52:55], v[180:183], a[248:251], v[52:55]
    v_mfma_f32_16x16x32_bf16 v[60:63], v[180:183], a[244:247], v[60:63]
    buffer_load_dwordx4 v[140:143], v14, s[20:23], s79 offen offset:128 sc1
    v_mfma_f32_16x16x32_bf16 v[68:71], v[180:183], a[252:255], v[68:71]
    s_waitcnt vmcnt(17)
    v_mfma_f32_16x16x32_bf16 v[40:43], v[184:187], v[208:211], v[40:43]
    v_mfma_f32_16x16x32_bf16 v[48:51], v[184:187], v[216:219], v[48:51]
    v_mfma_f32_16x16x32_bf16 v[56:59], v[184:187], v[212:215], v[56:59]
    s_mov_b32 s79, 24576
    buffer_load_dwordx4 v[144:147], v14, s[20:23], s79 offen offset:0 sc1
    v_mfma_f32_16x16x32_bf16 v[64:67], v[184:187], v[220:223], v[64:67]
    s_waitcnt vmcnt(17)
    v_mfma_f32_16x16x32_bf16 v[44:47], v[188:191], v[208:211], v[44:47]
    v_mfma_f32_16x16x32_bf16 v[52:55], v[188:191], v[216:219], v[52:55]
    v_mfma_f32_16x16x32_bf16 v[60:63], v[188:191], v[212:215], v[60:63]
    buffer_load_dwordx4 v[148:151], v14, s[20:23], s79 offen offset:128 sc1
    v_mfma_f32_16x16x32_bf16 v[68:71], v[188:191], v[220:223], v[68:71]
    s_waitcnt vmcnt(17)
    v_mfma_f32_16x16x32_bf16 v[40:43], v[192:195], v[224:227], v[40:43]
    v_mfma_f32_16x16x32_bf16 v[48:51], v[192:195], v[232:235], v[48:51]
    v_mfma_f32_16x16x32_bf16 v[56:59], v[192:195], v[228:231], v[56:59]
    s_mov_b32 s79, 32768
    buffer_load_dwordx4 v[152:155], v14, s[20:23], s79 offen offset:0 sc1
    v_mfma_f32_16x16x32_bf16 v[64:67], v[192:195], v[236:239], v[64:67]
    s_waitcnt vmcnt(17)
    v_mfma_f32_16x16x32_bf16 v[44:47], v[196:199], v[224:227], v[44:47]
    v_mfma_f32_16x16x32_bf16 v[52:55], v[196:199], v[232:235], v[52:55]
    v_mfma_f32_16x16x32_bf16 v[60:63], v[196:199], v[228:231], v[60:63]
    buffer_load_dwordx4 v[156:159], v14, s[20:23], s79 offen offset:128 sc1
    v_mfma_f32_16x16x32_bf16 v[68:71], v[196:199], v[236:239], v[68:71]
    s_waitcnt vmcnt(17)
    v_mfma_f32_16x16x32_bf16 v[40:43], v[200:203], v[240:243], v[40:43]
    v_mfma_f32_16x16x32_bf16 v[48:51], v[200:203], v[248:251], v[48:51]
    v_mfma_f32_16x16x32_bf16 v[56:59], v[200:203], v[244:247], v[56:59]
    s_mov_b32 s79, 40960
    buffer_load_dwordx4 v[160:163], v14, s[20:23], s79 offen offset:0 sc1
    v_mfma_f32_16x16x32_bf16 v[64:67], v[200:203], v[252:255], v[64:67]
    s_waitcnt vmcnt(17)
    v_mfma_f32_16x16x32_bf16 v[44:47], v[204:207], v[240:243], v[44:47]
    v_mfma_f32_16x16x32_bf16 v[52:55], v[204:207], v[248:251], v[52:55]
    v_mfma_f32_16x16x32_bf16 v[60:63], v[204:207], v[244:247], v[60:63]
    buffer_load_dwordx4 v[164:167], v14, s[20:23], s79 offen offset:128 sc1
    v_mfma_f32_16x16x32_bf16 v[68:71], v[204:207], v[252:255], v[68:71]
    s_waitcnt vmcnt(15)
    v_max3_u32 v3, v16, v17, v18
    s_waitcnt vmcnt(14)
    v_max3_u32 v3, v3, v19, v20
    v_max3_u32 v3, v3, v21, v22
    s_waitcnt vmcnt(13)
    v_max3_u32 v3, v3, v23, v24
    v_max3_u32 v3, v3, v25, v26
    s_waitcnt vmcnt(12)
    v_max3_u32 v3, v3, v27, v28
    v_max3_u32 v3, v3, v29, v30
    v_max_u32 v3, v3, v31
    v_cmp_eq_u32 vcc, -1, v3
    s_nop 0
    s_mov_b64 s[6:7], vcc
    v_and_b32 v3, v32, v36
    v_and_b32 v3, s40, v3
    v_cmp_ne_u32 vcc, s40, v3
    s_nop 0
    s_or_b64 vcc, vcc, s[6:7]
    s_cbranch_vccnz cslow_70
cback_69:
    s_waitcnt vmcnt(10)
    v_or_b32 v3, v120, v124
    v_and_b32 v3, 1, v3
    v_cmp_ne_u32 s[6:7], 0, v3
    s_nop 0
    s_mov_b64 vcc, s[6:7]
    s_cbranch_vccnz cslow_72
cback_71:
    v_mfma_f32_16x16x32_bf16 v[72:75], v[120:123], a[128:131], 0
    v_mfma_f32_16x16x32_bf16 v[80:83], v[120:123], a[136:139], 0
    s_mov_b32 s79, 49152
    buffer_load_dwordx4 v[168:171], v14, s[20:23], s79 offen offset:0 sc1
    v_mfma_f32_16x16x32_bf16 v[88:91], v[120:123], a[132:135], 0
    v_mfma_f32_16x16x32_bf16 v[96:99], v[120:123], a[140:143], 0
    v_mfma_f32_16x16x32_bf16 v[76:79], v[124:127], a[128:131], 0
    s_waitcnt vmcnt(8)
    v_or3_b32 v3, v128, v132, v136
    s_waitcnt vmcnt(7)
    v_or_b32 v3, v3, v140
    buffer_load_dwordx4 v[172:175], v14, s[20:23], s79 offen offset:128 sc1
    v_mfma_f32_16x16x32_bf16 v[84:87], v[124:127], a[136:139], 0
    v_and_b32 v3, 1, v3
    v_cmp_ne_u32 s[6:7], 0, v3
    v_mfma_f32_16x16x32_bf16 v[92:95], v[124:127], a[132:135], 0
    v_mfma_f32_16x16x32_bf16 v[100:103], v[124:127], a[140:143], 0
    s_mov_b32 s79, 57344
    buffer_load_dwordx4 v[176:179], v14, s[20:23], s79 offen offset:0 sc1
    s_mov_b64 vcc, s[6:7]
    s_cbranch_vccnz cslow_74
cback_73:
    v_mfma_f32_16x16x32_bf16 v[72:75], v[128:131], a[144:147], v[72:75]
    ds_write_b128 v11, v[48:51] offset:0
    v_mfma_f32_16x16x32_bf16 v[80:83], v[128:131], a[152:155], v[80:83]
    ds_write_b128 v11, v[52:55] offset:1024
    v_mfma_f32_16x16x32_bf16 v[88:91], v[128:131], a[148:151], v[88:91]
    buffer_load_dwordx4 v[180:183], v14, s[20:23], s79 offen offset:128 sc1
    ds_write_b128 v12, v[56:59] offset:2048
    v_mfma_f32_16x16x32_bf16 v[96:99], v[128:131], a[156:159], v[96:99]
    ds_write_b128 v12, v[60:63] offset:3072
    v_mfma_f32_16x16x32_bf16 v[76:79], v[132:135], a[144:147], v[76:79]
    ds_write_b128 v13, v[64:67] offset:4096
    s_mov_b32 s79, 65536
    buffer_load_dwordx4 v[184:187], v14, s[20:23], s79 offen offset:0 sc1
    v_mfma_f32_16x16x32_bf16 v[84:87], v[132:135], a[152:155], v[84:87]
    ds_write_b128 v13, v[68:71] offset:5120
    v_mfma_f32_16x16x32_bf16 v[92:95], v[132:135], a[148:151], v[92:95]
    v_lshlrev_b32 v104, 16, v32
    v_and_b32 v105, s38, v32
    v_mfma_f32_16x16x32_bf16 v[100:103], v[132:135], a[156:159], v[100:103]
    buffer_load_dwordx4 v[188:191], v14, s[20:23], s79 offen offset:128 sc1
    v_lshlrev_b32 v106, 16, v33
    v_mfma_f32_16x16x32_bf16 v[72:75], v[136:139], a[160:163], v[72:75]
    v_and_b32 v107, s38, v33
    v_lshlrev_b32 v108, 16, v34
    v_mfma_f32_16x16x32_bf16 v[80:83], v[136:139], a[168:171], v[80:83]
    v_and_b32 v109, s38, v34
    v_lshlrev_b32 v110, 16, v35
    v_mfma_f32_16x16x32_bf16 v[88:91], v[136:139], a[164:167], v[88:91]
    s_mov_b32 s79, 73728
    buffer_load_dwordx4 v[192:195], v14, s[20:23], s79 offen offset:0 sc1
    v_mfma_f32_16x16x32_bf16 v[96:99], v[136:139], a[172:175], v[96:99]
    v_and_b32 v111, s38, v35
    v_mfma_f32_16x16x32_bf16 v[76:79], v[140:143], a[160:163], v[76:79]
    s_waitcnt vmcnt(10)
    v_or3_b32 v3, v144, v148, v152
    s_waitcnt vmcnt(9)
    v_or_b32 v3, v3, v156
    v_mfma_f32_16x16x32_bf16 v[84:87], v[140:143], a[168:171], v[84:87]
    buffer_load_dwordx4 v[196:199], v14, s[20:23], s79 offen offset:128 sc1
    v_and_b32 v3, 1, v3
    v_cmp_ne_u32 s[6:7], 0, v3
    v_mfma_f32_16x16x32_bf16 v[92:95], v[140:143], a[164:167], v[92:95]
    v_mfma_f32_16x16x32_bf16 v[100:103], v[140:143], a[172:175], v[100:103]
    s_mov_b64 vcc, s[6:7]
    s_cbranch_vccnz cslow_76
cback_75:
    v_mfma_f32_16x16x32_bf16 v[72:75], v[144:147], a[176:179], v[72:75]
    s_mov_b32 s79, 81920
    buffer_load_dwordx4 v[200:203], v14, s[20:23], s79 offen offset:0 sc1
    v_mfma_f32_16x16x32_bf16 v[80:83], v[144:147], a[184:187], v[80:83]
    v_mfma_f32_16x16x32_bf16 v[88:91], v[144:147], a[180:183], v[88:91]
    v_mfma_f32_16x16x32_bf16 v[96:99], v[144:147], a[188:191], v[96:99]
    v_mfma_f32_16x16x32_bf16 v[76:79], v[148:151], a[176:179], v[76:79]
    buffer_load_dwordx4 v[204:207], v14, s[20:23], s79 offen offset:128 sc1
    v_mfma_f32_16x16x32_bf16 v[84:87], v[148:151], a[184:187], v[84:87]
    v_mfma_f32_16x16x32_bf16 v[92:95], v[148:151], a[180:183], v[92:95]
    v_mfma_f32_16x16x32_bf16 v[100:103], v[148:151], a[188:191], v[100:103]
    v_mfma_f32_16x16x32_bf16 v[72:75], v[152:155], a[192:195], v[72:75]
    v_mfma_f32_16x16x32_bf16 v[80:83], v[152:155], a[200:203], v[80:83]
    v_mfma_f32_16x16x32_bf16 v[88:91], v[152:155], a[196:199], v[88:91]
    s_waitcnt lgkmcnt(0)
    s_barrier
    v_mfma_f32_16x16x32_bf16 v[96:99], v[152:155], a[204:207], v[96:99]
    ds_read_b128 v[48:51], v112 offset:0
    ds_read_b128 v[52:55], v112 offset:1024
    v_mfma_f32_16x16x32_bf16 v[76:79], v[156:159], a[192:195], v[76:79]
    s_waitcnt vmcnt(9)
    v_or3_b32 v3, v160, v164, v168
    s_waitcnt vmcnt(8)
    v_or_b32 v3, v3, v172
    v_mfma_f32_16x16x32_bf16 v[84:87], v[156:159], a[200:203], v[84:87]
    v_and_b32 v3, 1, v3
    v_cmp_ne_u32 s[6:7], 0, v3
    v_mfma_f32_16x16x32_bf16 v[92:95], v[156:159], a[196:199], v[92:95]
    v_mfma_f32_16x16x32_bf16 v[100:103], v[156:159], a[204:207], v[100:103]
    s_mov_b64 vcc, s[6:7]
    s_cbranch_vccnz cslow_78
cback_77:
    v_mfma_f32_16x16x32_bf16 v[72:75], v[160:163], a[208:211], v[72:75]
    ds_read_b128 v[56:59], v112 offset:2048
    ds_read_b128 v[60:63], v112 offset:3072
    v_mfma_f32_16x16x32_bf16 v[80:83], v[160:163], a[216:219], v[80:83]
    ds_read_b128 v[64:67], v112 offset:4096
    ds_read_b128 v[68:71], v112 offset:5120
    v_mfma_f32_16x16x32_bf16 v[88:91], v[160:163], a[212:215], v[88:91]
    v_mfma_f32_16x16x32_bf16 v[96:99], v[160:163], a[220:223], v[96:99]
    v_mfma_f32_16x16x32_bf16 v[76:79], v[164:167], a[208:211], v[76:79]
    v_mfma_f32_16x16x32_bf16 v[84:87], v[164:167], a[216:219], v[84:87]
    v_mfma_f32_16x16x32_bf16 v[92:95], v[164:167], a[212:215], v[92:95]
    v_mfma_f32_16x16x32_bf16 v[100:103], v[164:167], a[220:223], v[100:103]
    v_mfma_f32_16x16x32_bf16 v[72:75], v[168:171], a[224:227], v[72:75]
    s_waitcnt lgkmcnt(5)
    v_add_f32 v40, v40, v48
    v_mfma_f32_16x16x32_bf16 v[80:83], v[168:171], a[232:235], v[80:83]
    v_add_f32 v41, v41, v49
    v_add_f32 v42, v42, v50
    v_mfma_f32_16x16x32_bf16 v[88:91], v[168:171], a[228:231], v[88:91]
    v_add_f32 v43, v43, v51
    s_waitcnt lgkmcnt(4)
    v_add_f32 v44, v44, v52
    v_mfma_f32_16x16x32_bf16 v[96:99], v[168:171], a[236:239], v[96:99]
    v_add_f32 v45, v45, v53
    v_add_f32 v46, v46, v54
    v_mfma_f32_16x16x32_bf16 v[76:79], v[172:175], a[224:227], v[76:79]
    s_waitcnt vmcnt(5)
    v_or3_b32 v3, v176, v180, v184
    s_waitcnt vmcnt(4)
    v_or_b32 v3, v3, v188
    v_mfma_f32_16x16x32_bf16 v[84:87], v[172:175], a[232:235], v[84:87]
    v_and_b32 v3, 1, v3
    v_cmp_ne_u32 s[6:7], 0, v3
    v_mfma_f32_16x16x32_bf16 v[92:95], v[172:175], a[228:231], v[92:95]
    v_mfma_f32_16x16x32_bf16 v[100:103], v[172:175], a[236:239], v[100:103]
    s_mov_b64 vcc, s[6:7]
    s_cbranch_vccnz cslow_80
cback_79:
    v_mfma_f32_16x16x32_bf16 v[72:75], v[176:179], a[240:243], v[72:75]
    v_add_f32 v47, v47, v55
    s_waitcnt lgkmcnt(3)
    v_add_f32 v40, v40, v56
    v_mfma_f32_16x16x32_bf16 v[80:83], v[176:179], a[248:251], v[80:83]
    v_add_f32 v41, v41, v57
    v_add_f32 v42, v42, v58
    v_mfma_f32_16x16x32_bf16 v[88:91], v[176:179], a[244:247], v[88:91]
    v_add_f32 v43, v43, v59
    s_waitcnt lgkmcnt(2)
    v_add_f32 v44, v44, v60
    v_mfma_f32_16x16x32_bf16 v[96:99], v[176:179], a[252:255], v[96:99]
    v_add_f32 v45, v45, v61
    v_add_f32 v46, v46, v62
    v_mfma_f32_16x16x32_bf16 v[76:79], v[180:183], a[240:243], v[76:79]
    v_add_f32 v47, v47, v63
    s_waitcnt lgkmcnt(1)
    v_add_f32 v40, v40, v64
    v_mfma_f32_16x16x32_bf16 v[84:87], v[180:183], a[248:251], v[84:87]
    v_add_f32 v41, v41, v65
    v_add_f32 v42, v42, v66
    v_mfma_f32_16x16x32_bf16 v[92:95], v[180:183], a[244:247], v[92:95]
    v_add_f32 v43, v43, v67
    s_waitcnt lgkmcnt(0)
    v_add_f32 v44, v44, v68
    v_mfma_f32_16x16x32_bf16 v[100:103], v[180:183], a[252:255], v[100:103]
    v_add_f32 v45, v45, v69
    v_add_f32 v46, v46, v70
    v_mfma_f32_16x16x32_bf16 v[72:75], v[184:187], v[208:211], v[72:75]
    v_add_f32 v47, v47, v71
    v_fmac_f32 v104, v40, v16
    v_mfma_f32_16x16x32_bf16 v[80:83], v[184:187], v[216:219], v[80:83]
    v_fmac_f32 v105, v41, v17
    v_fmac_f32 v106, v42, v18
    v_mfma_f32_16x16x32_bf16 v[88:91], v[184:187], v[212:215], v[88:91]
    v_fmac_f32 v107, v43, v19
    v_fmac_f32 v108, v44, v20
    v_mfma_f32_16x16x32_bf16 v[96:99], v[184:187], v[220:223], v[96:99]
    v_fmac_f32 v109, v45, v21
    v_fmac_f32 v110, v46, v22
    v_mfma_f32_16x16x32_bf16 v[76:79], v[188:191], v[208:211], v[76:79]
    s_waitcnt vmcnt(1)
    v_or3_b32 v3, v192, v196, v200
    s_waitcnt vmcnt(0)
    v_or_b32 v3, v3, v204
    v_mfma_f32_16x16x32_bf16 v[84:87], v[188:191], v[216:219], v[84:87]
    v_and_b32 v3, 1, v3
    v_cmp_ne_u32 s[6:7], 0, v3
    v_mfma_f32_16x16x32_bf16 v[92:95], v[188:191], v[212:215], v[92:95]
    v_mfma_f32_16x16x32_bf16 v[100:103], v[188:191], v[220:223], v[100:103]
    s_mov_b64 vcc, s[6:7]
    s_cbranch_vccnz cslow_82
cback_81:
    v_mfma_f32_16x16x32_bf16 v[72:75], v[192:195], v[224:227], v[72:75]
    v_fmac_f32 v111, v47, v23
    v_mul_f32 v56, v116, v104
    v_mfma_f32_16x16x32_bf16 v[80:83], v[192:195], v[232:235], v[80:83]
    v_mul_f32 v57, v116, v105
    v_mul_f32 v58, v116, v106
    v_mfma_f32_16x16x32_bf16 v[88:91], v[192:195], v[228:231], v[88:91]
    v_mul_f32 v59, v116, v107
    v_mul_f32 v60, v116, v108
    v_mfma_f32_16x16x32_bf16 v[96:99], v[192:195], v[236:239], v[96:99]
    v_mul_f32 v61, v116, v109
    v_mul_f32 v62, v116, v110
    v_mfma_f32_16x16x32_bf16 v[76:79], v[196:199], v[224:227], v[76:79]
    v_mul_f32 v63, v116, v111
    v_mul_f32 v56, v56, v104
    v_mfma_f32_16x16x32_bf16 v[84:87], v[196:199], v[232:235], v[84:87]
    v_mul_f32 v57, v57, v105
    v_mul_f32 v58, v58, v106
    v_mfma_f32_16x16x32_bf16 v[92:95], v[196:199], v[228:231], v[92:95]
    v_mul_f32 v59, v59, v107
    v_mul_f32 v60, v60, v108
    v_mfma_f32_16x16x32_bf16 v[100:103], v[196:199], v[236:239], v[100:103]
    v_mul_f32 v61, v61, v109
    v_mul_f32 v62, v62, v110
    v_mfma_f32_16x16x32_bf16 v[72:75], v[200:203], v[240:243], v[72:75]
    v_mul_f32 v63, v63, v111
    v_add_f32_dpp v64, v56, v56 row_mirror row_mask:0xf bank_mask:0x3
    v_mfma_f32_16x16x32_bf16 v[80:83], v[200:203], v[248:251], v[80:83]
    v_add_f32_dpp v65, v57, v57 row_mirror row_mask:0xf bank_mask:0x3
    v_add_f32_dpp v66, v58, v58 row_mirror row_mask:0xf bank_mask:0x3
    v_mfma_f32_16x16x32_bf16 v[88:91], v[200:203], v[244:247], v[88:91]
    v_add_f32_dpp v67, v59, v59 row_mirror row_mask:0xf bank_mask:0x3
    v_add_f32_dpp v64, v60, v60 row_mirror row_mask:0xf bank_mask:0xc
    v_mfma_f32_16x16x32_bf16 v[96:99], v[200:203], v[252:255], v[96:99]
    v_add_f32_dpp v65, v61, v61 row_mirror row_mask:0xf bank_mask:0xc
    v_add_f32_dpp v66, v62, v62 row_mirror row_mask:0xf bank_mask:0xc
    v_mfma_f32_16x16x32_bf16 v[76:79], v[204:207], v[240:243], v[76:79]
    v_add_f32_dpp v67, v63, v63 row_mirror row_mask:0xf bank_mask:0xc
    v_add_f32_dpp v56, v64, v64 row_half_mirror row_mask:0xf bank_mask:0x5
    v_mfma_f32_16x16x32_bf16 v[84:87], v[204:207], v[248:251], v[84:87]
    v_add_f32_dpp v57, v65, v65 row_half_mirror row_mask:0xf bank_mask:0x5
    v_cvt_pk_bf16_f32 v48, v104, v105
    v_mfma_f32_16x16x32_bf16 v[92:95], v[204:207], v[244:247], v[92:95]
    v_add_f32_dpp v56, v66, v66 row_half_mirror row_mask:0xf bank_mask:0xa
    v_add_f32_dpp v57, v67, v67 row_half_mirror row_mask:0xf bank_mask:0xa
    v_mfma_f32_16x16x32_bf16 v[100:103], v[204:207], v[252:255], v[100:103]
    v_cvt_pk_bf16_f32 v49, v106, v107
    v_add_f32_dpp v56, v56, v56 quad_perm:[2,3,0,1] row_mask:0xf bank_mask:0xf
    v_add_f32_dpp v57, v57, v57 quad_perm:[2,3,0,1] row_mask:0xf bank_mask:0xf
    v_cndmask_b32 v56, v56, v57, s[80:81]
    v_cvt_pk_bf16_f32 v50, v108, v109
    v_cvt_pk_bf16_f32 v51, v110, v111
    v_add_f32_dpp v56, v56, v56 quad_perm:[1,0,3,2] row_mask:0xf bank_mask:0xf
    ds_write_b32 v115, v56 offset:0
    v_and_or_b32 v48, v48, s41, 1
    buffer_store_dwordx4 v[48:51], v113, s[8:11], s74 offen sc1
    ds_write_b128 v11, v[80:83] offset:24576
    ds_write_b128 v11, v[84:87] offset:25600
    ds_write_b128 v12, v[88:91] offset:26624
    ds_write_b128 v12, v[92:95] offset:27648
    ds_write_b128 v13, v[96:99] offset:28672
    ds_write_b128 v13, v[100:103] offset:29696
    v_lshlrev_b32 v104, 16, v36
    v_and_b32 v105, s38, v36
    v_lshlrev_b32 v106, 16, v37
    v_and_b32 v107, s38, v37
    v_lshlrev_b32 v108, 16, v38
    v_and_b32 v109, s38, v38
    v_lshlrev_b32 v110, 16, v39
    v_and_b32 v111, s38, v39
    s_lshr_b32 s5, s3, 1
    s_lshl_b32 s5, s5, 3
    s_add_u32 s42, s53, s5
    s_xor_b32 s6, s42, 0
    s_mul_i32 s6, s6, 120832
    s_add_u32 s6, s6, 15040512
    s_add_u32 s56, s34, s6
    s_addc_u32 s57, s35, 0
    s_mov_b32 s58, 120832
    s_mov_b32 s59, 0x20000
    s_xor_b32 s6, s42, 8
    s_mul_i32 s6, s6, 120832
    s_add_u32 s6, s6, 15040512
    s_add_u32 s60, s34, s6
    s_addc_u32 s61, s35, 0
    s_mov_b32 s62, 120832
    s_mov_b32 s63, 0x20000
    s_mov_b32 s1, 0
    buffer_load_dwordx4 a[128:131], v14, s[56:59], s1 offen offset:0 sc1
    buffer_load_dwordx4 a[132:135], v14, s[60:63], s1 offen offset:0 sc1
    buffer_load_dwordx4 a[136:139], v14, s[56:59], s1 offen offset:128 sc1
    buffer_load_dwordx4 a[140:143], v14, s[60:63], s1 offen offset:128 sc1
    s_mov_b32 s1, 8192
    buffer_load_dwordx4 a[144:147], v14, s[56:59], s1 offen offset:0 sc1
    buffer_load_dwordx4 a[148:151], v14, s[60:63], s1 offen offset:0 sc1
    buffer_load_dwordx4 a[152:155], v14, s[56:59], s1 offen offset:128 sc1
    buffer_load_dwordx4 a[156:159], v14, s[60:63], s1 offen offset:128 sc1
    s_mov_b32 s1, 16384
    buffer_load_dwordx4 a[160:163], v14, s[56:59], s1 offen offset:0 sc1
    buffer_load_dwordx4 a[164:167], v14, s[60:63], s1 offen offset:0 sc1
    s_waitcnt lgkmcnt(0)
    s_barrier
    ds_read_b128 v[80:83], v112 offset:24576
    ds_read_b128 v[84:87], v112 offset:25600
    ds_read_b128 v[88:91], v112 offset:26624
    ds_read_b128 v[92:95], v112 offset:27648
    ds_read_b128 v[96:99], v112 offset:28672
    ds_read_b128 v[100:103], v112 offset:29696
    s_waitcnt lgkmcnt(5)
    v_pk_add_f32 v[72:73], v[72:73], v[80:81]
    v_pk_add_f32 v[74:75], v[74:75], v[82:83]
    s_waitcnt lgkmcnt(4)
    v_pk_add_f32 v[76:77], v[76:77], v[84:85]
    v_pk_add_f32 v[78:79], v[78:79], v[86:87]
    s_waitcnt lgkmcnt(3)
    v_pk_add_f32 v[72:73], v[72:73], v[88:89]
    v_pk_add_f32 v[74:75], v[74:75], v[90:91]
    s_waitcnt lgkmcnt(2)
    v_pk_add_f32 v[76:77], v[76:77], v[92:93]
    v_pk_add_f32 v[78:79], v[78:79], v[94:95]
    s_waitcnt lgkmcnt(1)
    v_pk_add_f32 v[72:73], v[72:73], v[96:97]
    v_pk_add_f32 v[74:75], v[74:75], v[98:99]
    s_waitcnt lgkmcnt(0)
    v_pk_add_f32 v[76:77], v[76:77], v[100:101]
    v_pk_add_f32 v[78:79], v[78:79], v[102:103]
    v_pk_fma_f32 v[104:105], v[72:73], v[24:25], v[104:105]
    v_pk_fma_f32 v[106:107], v[74:75], v[26:27], v[106:107]
    v_pk_fma_f32 v[108:109], v[76:77], v[28:29], v[108:109]
    v_pk_fma_f32 v[110:111], v[78:79], v[30:31], v[110:111]
    v_pk_mul_f32 v[88:89], v[104:105], v[104:105]
    v_pk_mul_f32 v[90:91], v[106:107], v[106:107]
    v_pk_mul_f32 v[92:93], v[108:109], v[108:109]
    v_pk_mul_f32 v[94:95], v[110:111], v[110:111]
    v_pk_mul_f32 v[88:89], v[88:89], v[116:117] op_sel_hi:[1,0]
    v_pk_mul_f32 v[90:91], v[90:91], v[116:117] op_sel_hi:[1,0]
    v_pk_mul_f32 v[92:93], v[92:93], v[116:117] op_sel_hi:[1,0]
    v_pk_mul_f32 v[94:95], v[94:95], v[116:117] op_sel_hi:[1,0]
    v_add_f32_dpp v96, v88, v88 row_mirror row_mask:0xf bank_mask:0x3
    v_add_f32_dpp v97, v89, v89 row_mirror row_mask:0xf bank_mask:0x3
    v_add_f32_dpp v98, v90, v90 row_mirror row_mask:0xf bank_mask:0x3
    v_add_f32_dpp v99, v91, v91 row_mirror row_mask:0xf bank_mask:0x3
    v_add_f32_dpp v96, v92, v92 row_mirror row_mask:0xf bank_mask:0xc
    v_add_f32_dpp v97, v93, v93 row_mirror row_mask:0xf bank_mask:0xc
    v_add_f32_dpp v98, v94, v94 row_mirror row_mask:0xf bank_mask:0xc
    v_add_f32_dpp v99, v95, v95 row_mirror row_mask:0xf bank_mask:0xc
    v_add_f32_dpp v88, v96, v96 row_half_mirror row_mask:0xf bank_mask:0x5
    v_add_f32_dpp v89, v97, v97 row_half_mirror row_mask:0xf bank_mask:0x5
    v_cvt_pk_bf16_f32 v80, v104, v105
    v_add_f32_dpp v88, v98, v98 row_half_mirror row_mask:0xf bank_mask:0xa
    v_add_f32_dpp v89, v99, v99 row_half_mirror row_mask:0xf bank_mask:0xa
    v_cvt_pk_bf16_f32 v81, v106, v107
    v_add_f32_dpp v88, v88, v88 quad_perm:[2,3,0,1] row_mask:0xf bank_mask:0xf
    v_add_f32_dpp v89, v89, v89 quad_perm:[2,3,0,1] row_mask:0xf bank_mask:0xf
    v_cndmask_b32 v88, v88, v89, s[80:81]
    v_cvt_pk_bf16_f32 v82, v108, v109
    v_cvt_pk_bf16_f32 v83, v110, v111
    v_add_f32_dpp v88, v88, v88 quad_perm:[1,0,3,2] row_mask:0xf bank_mask:0xf
    ds_write_b32 v115, v88 offset:512
    v_and_or_b32 v80, v80, s41, 1
    buffer_store_dwordx4 v[80:83], v113, s[8:11], s75 offen sc1
    s_waitcnt lgkmcnt(0)
    s_barrier
    s_cmp_ge_u32 s3, 2
    s_cbranch_scc1 ssskip_83
    ds_read_b128 v[56:59], v117 offset:0
    ds_read_b128 v[60:63], v117 offset:16
    s_waitcnt lgkmcnt(1)
    v_add_f32_dpp v56, v56, v56 row_ror:4 row_mask:0xf bank_mask:0xf
    v_add_f32_dpp v57, v57, v57 row_ror:4 row_mask:0xf bank_mask:0xf
    v_add_f32_dpp v58, v58, v58 row_ror:4 row_mask:0xf bank_mask:0xf
    v_add_f32_dpp v59, v59, v59 row_ror:4 row_mask:0xf bank_mask:0xf
    s_waitcnt lgkmcnt(0)
    v_add_f32_dpp v60, v60, v60 row_ror:4 row_mask:0xf bank_mask:0xf
    v_add_f32_dpp v61, v61, v61 row_ror:4 row_mask:0xf bank_mask:0xf
    v_add_f32_dpp v62, v62, v62 row_ror:4 row_mask:0xf bank_mask:0xf
    v_add_f32_dpp v63, v63, v63 row_ror:4 row_mask:0xf bank_mask:0xf
    v_add_f32_dpp v56, v56, v56 row_ror:8 row_mask:0xf bank_mask:0xf
    v_add_f32_dpp v57, v57, v57 row_ror:8 row_mask:0xf bank_mask:0xf
    v_add_f32_dpp v58, v58, v58 row_ror:8 row_mask:0xf bank_mask:0xf
    v_add_f32_dpp v59, v59, v59 row_ror:8 row_mask:0xf bank_mask:0xf
    v_add_f32_dpp v60, v60, v60 row_ror:8 row_mask:0xf bank_mask:0xf
    v_add_f32_dpp v61, v61, v61 row_ror:8 row_mask:0xf bank_mask:0xf
    v_add_f32_dpp v62, v62, v62 row_ror:8 row_mask:0xf bank_mask:0xf
    v_add_f32_dpp v63, v63, v63 row_ror:8 row_mask:0xf bank_mask:0xf
    v_cvt_pk_bf16_f32 v64, v56, v57
    v_cvt_pk_bf16_f32 v65, v58, v59
    v_cvt_pk_bf16_f32 v66, v60, v61
    v_cvt_pk_bf16_f32 v67, v62, v63
    v_min_u32 v64, -2, v64
    buffer_store_dwordx4 v[64:67], v118, s[12:15], s65 offen sc1
ssskip_83:
    v_mov_b32 v155, v14
    v_lshlrev_b32 v9, 4, v1
    v_add_u32 v10, 114688, v9
    v_lshrrev_b32 v8, 2, v1
    v_lshlrev_b32 v8, 11, v8
    v_and_or_b32 v8, v1, 3, v8
    v_lshlrev_b32 v8, 4, v8
    s_and_b32 s6, s3, 1
    s_lshr_b32 s7, s3, 1
    s_lshl_b32 s7, s7, 10
    s_lshl_b32 s66, s6, 11
    s_add_u32 s66, s66, s7
    s_lshl_b32 s65, s4, 7
    s_lshl_b32 s6, s66, 9
    s_add_u32 s65, s65, s6
    s_mul_i32 s67, s4, 8576
    s_lshl_b32 s6, s3, 11
    s_add_u32 s67, s67, s6
    s_mov_b32 s8, s34
    s_mov_b32 s9, s35
    s_mov_b32 s10, 2097152
    s_mov_b32 s11, 0x20000
    s_add_u32 s12, s34, 7356416
    s_addc_u32 s13, s35, 0
    s_mov_b32 s14, 32768
    s_mov_b32 s15, 0x20000
    s_add_u32 s68, s34, 2097152
    s_addc_u32 s69, s35, 0
    s_mov_b32 s70, 2195456
    s_mov_b32 s71, 0x20000
    buffer_load_dwordx4 v[24:27], v9, s[68:71], s67 offen sc1
    buffer_load_dwordx4 v[28:31], v9, s[68:71], s67 offen offset:1024 sc1
    s_lshl_b32 s5, s3, 11
    v_add_u32 v7, s5, v10
    ds_read_b128 v[32:35], v7 offset:16384
    ds_read_b128 v[36:39], v7 offset:17408
    ds_read_b128 v[40:43], v7 offset:24576
    ds_read_b128 v[44:47], v7 offset:25600
    ds_read_b128 v[48:51], v7 offset:32768
    ds_read_b128 v[52:55], v7 offset:33792
    ds_read_b128 v[56:59], v10 offset:40960
    ds_read_b128 v[60:63], v10 offset:41984
    ds_read_b128 v[64:67], v10 offset:43008
    ds_read_b128 v[68:71], v10 offset:44032
    ds_read_b128 v[72:75], v10 offset:45056
    ds_read_b128 v[76:79], v10 offset:46080
    v_and_b32 v168, 15, v1
    v_lshrrev_b32 v169, 4, v1
    v_lshrrev_b32 v170, 2, v168
    v_and_b32 v171, 3, v168
    v_lshl_add_u32 v170, v170, 3, v171
    v_add_u32 v170, s43, v170
    v_cvt_f32_u32 v170, v170
    v_cvt_f32_u32 v171, v169
    v_cvt_f32_u32 v172, v168
    v_mul_f32 v171, 4.0, v171
    s_mov_b32 s5, 0x3a000000
    v_mul_f32 v160, s5, v170
    v_mul_f32 v80, v171, v160
    v_mul_f32 v162, 0x41800000, v160
    v_add_f32 v81, v80, v160
    v_add_f32 v82, v81, v160
    v_add_f32 v83, v82, v160
    v_sin_f32 v88, v80
    v_sin_f32 v89, v81
    v_sin_f32 v90, v82
    v_sin_f32 v91, v83
    v_cos_f32 v80, v80
    v_cos_f32 v81, v81
    v_cos_f32 v82, v82
    v_cos_f32 v83, v83
    v_sin_f32 v164, v162
    v_cos_f32 v162, v162
    v_lshl_add_u32 v166, v169, 3, s43
    v_cvt_f32_u32 v166, v166
    v_pk_mul_f32 v[84:85], v[80:81], v[162:163] op_sel_hi:[1,0]
    v_pk_mul_f32 v[92:93], v[88:89], v[162:163] op_sel_hi:[1,0]
    v_pk_mul_f32 v[86:87], v[82:83], v[162:163] op_sel_hi:[1,0]
    v_pk_mul_f32 v[94:95], v[90:91], v[162:163] op_sel_hi:[1,0]
    v_pk_fma_f32 v[84:85], v[88:89], v[164:165], v[84:85] op_sel_hi:[1,0,1] neg_lo:[1,0,0] neg_hi:[1,0,0]
    v_pk_fma_f32 v[92:93], v[80:81], v[164:165], v[92:93] op_sel_hi:[1,0,1]
    v_pk_fma_f32 v[86:87], v[90:91], v[164:165], v[86:87] op_sel_hi:[1,0,1] neg_lo:[1,0,0] neg_hi:[1,0,0]
    v_pk_fma_f32 v[94:95], v[82:83], v[164:165], v[94:95] op_sel_hi:[1,0,1]
    v_mul_f32 v160, s5, v172
    v_add_f32 v161, 0x3c000000, v160
    v_mul_f32 v96, v166, v160
    v_add_f32 v97, v96, v160
    v_add_f32 v98, v97, v160
    v_add_f32 v99, v98, v160
    v_sin_f32 v104, v96
    v_sin_f32 v105, v97
    v_sin_f32 v106, v98
    v_sin_f32 v107, v99
    v_cos_f32 v96, v96
    v_cos_f32 v97, v97
    v_cos_f32 v98, v98
    v_cos_f32 v99, v99
    v_mul_f32 v100, v166, v161
    v_add_f32 v101, v100, v161
    v_add_f32 v102, v101, v161
    v_add_f32 v103, v102, v161
    v_sin_f32 v108, v100
    v_sin_f32 v109, v101
    v_sin_f32 v110, v102
    v_sin_f32 v111, v103
    v_cos_f32 v100, v100
    v_cos_f32 v101, v101
    v_cos_f32 v102, v102
    v_cos_f32 v103, v103
    v_and_b32 v160, 1, v168
    v_lshlrev_b32 v160, 4, v160
    v_mov_b32 v161, 0x3f80
    v_lshlrev_b32 v160, v160, v161
    v_lshrrev_b32 v161, 1, v168
    v_lshlrev_b32 v162, 1, v169
    v_cmp_eq_u32 vcc, v161, v162
    v_add_u32 v162, 1, v162
    v_mov_b32 v146, 0
    v_mov_b32 v147, 0
    v_mov_b32 v148, 0
    v_mov_b32 v149, 0
    v_cndmask_b32 v144, 0, v160, vcc
    v_cndmask_b32 v150, 0, v160, vcc
    v_cmp_eq_u32 vcc, v161, v162
    s_nop 1
    v_cndmask_b32 v145, 0, v160, vcc
    v_cndmask_b32 v151, 0, v160, vcc
    s_and_b32 s6, s3, 1
    s_lshr_b32 s7, s3, 1
    s_lshl_b32 s5, s6, 2
    s_add_u32 s5, s5, s7
    s_lshl_b32 s5, s5, 10
    v_add_u32 v7, s5, v10
    s_lshl_b32 s5, s7, 7
    s_add_u32 s5, s5, s6
    s_lshl_b32 s5, s5, 3
    v_add_u32 v11, s5, v10
    s_lshl_b32 s5, s6, 12
    v_add_u32 v12, s5, v10
    s_lshl_b32 s5, s7, 12
    v_add_u32 v13, s5, v10
    v_mov_b32 v2, 0x4227c5ac
    v_mov_b32 v3, v2
    v_mov_b32 v4, 0x46000000
    v_mov_b32 v5, v4
    s_cmp_eq_u32 s4, 0
    s_cselect_b32 s73, 0, -1
    buffer_load_dwordx4 a[168:171], v155, s[56:59], s1 offen offset:128 sc1
    buffer_load_dwordx4 a[172:175], v155, s[60:63], s1 offen offset:128 sc1
    s_mov_b32 s1, 24576
    buffer_load_dwordx4 a[176:179], v155, s[56:59], s1 offen offset:0 sc1
    buffer_load_dwordx4 a[180:183], v155, s[60:63], s1 offen offset:0 sc1
    buffer_load_dwordx4 a[184:187], v155, s[56:59], s1 offen offset:128 sc1
    buffer_load_dwordx4 a[188:191], v155, s[60:63], s1 offen offset:128 sc1
    s_mov_b32 s1, 32768
    buffer_load_dwordx4 a[192:195], v155, s[56:59], s1 offen offset:0 sc1
    buffer_load_dwordx4 a[196:199], v155, s[60:63], s1 offen offset:0 sc1
    buffer_load_dwordx4 a[200:203], v155, s[56:59], s1 offen offset:128 sc1
    buffer_load_dwordx4 a[204:207], v155, s[60:63], s1 offen offset:128 sc1
    s_waitcnt vmcnt(0)
    buffer_load_dwordx4 v[16:19], v8, s[8:11], s65 offen sc1
    buffer_load_dwordx4 v[20:23], v8, s[8:11], s65 offen offset:64 sc1
    buffer_load_dwordx4 v[176:179], v9, s[12:15], s66 offen sc1
    s_add_u32 s7, s66, 4096
    buffer_load_dwordx4 v[180:183], v9, s[12:15], s7 offen sc1
    s_add_u32 s7, s66, 8192
    buffer_load_dwordx4 v[184:187], v9, s[12:15], s7 offen sc1
    s_add_u32 s7, s66, 12288
    buffer_load_dwordx4 v[188:191], v9, s[12:15], s7 offen sc1
    s_add_u32 s7, s66, 16384
    buffer_load_dwordx4 v[192:195], v9, s[12:15], s7 offen sc1
    s_add_u32 s7, s66, 20480
    buffer_load_dwordx4 v[196:199], v9, s[12:15], s7 offen sc1
    s_add_u32 s7, s66, 24576
    buffer_load_dwordx4 v[200:203], v9, s[12:15], s7 offen sc1
    s_add_u32 s7, s66, 28672
    buffer_load_dwordx4 v[204:207], v9, s[12:15], s7 offen sc1
    s_waitcnt vmcnt(9)
    v_lshlrev_b32 v160, 16, v16
    v_and_b32 v161, s38, v16
    v_lshlrev_b32 v162, 16, v17
    v_and_b32 v163, s38, v17
    v_lshlrev_b32 v164, 16, v18
    v_and_b32 v165, s38, v18
    v_lshlrev_b32 v166, 16, v19
    v_and_b32 v167, s38, v19
    s_waitcnt vmcnt(8)
    v_lshlrev_b32 v168, 16, v20
    v_and_b32 v169, s38, v20
    v_lshlrev_b32 v170, 16, v21
    v_and_b32 v171, s38, v21
    v_lshlrev_b32 v172, 16, v22
    v_and_b32 v173, s38, v22
    v_lshlrev_b32 v174, 16, v23
    v_and_b32 v175, s38, v23
    s_waitcnt vmcnt(7)
    v_mfma_f32_16x16x32_bf16 v[112:115], v[144:147], v[176:179], 0
    v_mfma_f32_16x16x32_bf16 v[116:119], v[148:151], v[176:179], 0
    s_waitcnt vmcnt(6)
    v_mfma_f32_16x16x32_bf16 v[112:115], v[144:147], v[180:183], v[112:115]
    v_mfma_f32_16x16x32_bf16 v[116:119], v[148:151], v[180:183], v[116:119]
    s_waitcnt vmcnt(5)
    v_mfma_f32_16x16x32_bf16 v[112:115], v[144:147], v[184:187], v[112:115]
    v_mfma_f32_16x16x32_bf16 v[116:119], v[148:151], v[184:187], v[116:119]
    s_waitcnt vmcnt(4)
    v_mfma_f32_16x16x32_bf16 v[112:115], v[144:147], v[188:191], v[112:115]
    v_mfma_f32_16x16x32_bf16 v[116:119], v[148:151], v[188:191], v[116:119]
    s_waitcnt vmcnt(3)
    v_mfma_f32_16x16x32_bf16 v[112:115], v[144:147], v[192:195], v[112:115]
    v_mfma_f32_16x16x32_bf16 v[116:119], v[148:151], v[192:195], v[116:119]
    s_waitcnt vmcnt(2)
    v_mfma_f32_16x16x32_bf16 v[112:115], v[144:147], v[196:199], v[112:115]
    v_mfma_f32_16x16x32_bf16 v[116:119], v[148:151], v[196:199], v[116:119]
    s_waitcnt vmcnt(1)
    v_mfma_f32_16x16x32_bf16 v[112:115], v[144:147], v[200:203], v[112:115]
    v_mfma_f32_16x16x32_bf16 v[116:119], v[148:151], v[200:203], v[116:119]
    s_waitcnt vmcnt(0)
    v_mfma_f32_16x16x32_bf16 v[112:115], v[144:147], v[204:207], v[112:115]
    v_mfma_f32_16x16x32_bf16 v[116:119], v[148:151], v[204:207], v[116:119]
    v_max3_u32 v14, v176, v180, v184
    v_max3_u32 v14, v14, v188, v192
    v_max3_u32 v14, v14, v196, v200
    v_max_u32 v14, v14, v204
    v_bitop3_b32 v128, v16, v20, 1 bitop3:0x7e
    v_cmp_eq_u32 s[6:7], -1, v14
    v_and_b32 v128, s40, v128
    v_cmp_ne_u32 vcc, 0, v128
    s_nop 0
    s_or_b64 vcc, vcc, s[6:7]
    s_cbranch_vccnz cslow_85
cback_84:
    v_pk_fma_f32 v[112:113], v[112:113], v[4:5], v[2:3]
    v_pk_fma_f32 v[114:115], v[114:115], v[4:5], v[2:3]
    v_pk_fma_f32 v[116:117], v[116:117], v[4:5], v[2:3]
    v_pk_fma_f32 v[118:119], v[118:119], v[4:5], v[2:3]
    v_rsq_f32 v112, v112
    v_rsq_f32 v113, v113
    v_rsq_f32 v114, v114
    v_rsq_f32 v115, v115
    v_rsq_f32 v116, v116
    v_rsq_f32 v117, v117
    v_rsq_f32 v118, v118
    v_rsq_f32 v119, v119
    v_pk_mul_f32 v[128:129], v[112:113], v[160:161]
    v_pk_mul_f32 v[130:131], v[114:115], v[162:163]
    v_pk_mul_f32 v[132:133], v[116:117], v[164:165]
    v_pk_mul_f32 v[134:135], v[118:119], v[166:167]
    v_cvt_pk_bf16_f32 v16, v128, v129
    v_cvt_pk_bf16_f32 v17, v130, v131
    v_cvt_pk_bf16_f32 v18, v132, v133
    v_cvt_pk_bf16_f32 v19, v134, v135
    ds_write_b128 v7, v[16:19] offset:0
    v_pk_mul_f32 v[136:137], v[112:113], v[168:169]
    v_pk_mul_f32 v[138:139], v[114:115], v[170:171]
    v_pk_mul_f32 v[140:141], v[116:117], v[172:173]
    v_pk_mul_f32 v[142:143], v[118:119], v[174:175]
    v_cvt_pk_bf16_f32 v20, v136, v137
    v_cvt_pk_bf16_f32 v21, v138, v139
    v_cvt_pk_bf16_f32 v22, v140, v141
    v_cvt_pk_bf16_f32 v23, v142, v143
    v_and_b32 v20, s73, v20
    v_and_b32 v21, s73, v21
    v_and_b32 v22, s73, v22
    v_and_b32 v23, s73, v23
    ds_write_b128 v7, v[20:23] offset:2048
    s_mov_b32 s1, 40960
    buffer_load_dwordx4 a[208:211], v155, s[56:59], s1 offen offset:0 sc1
    buffer_load_dwordx4 a[212:215], v155, s[60:63], s1 offen offset:0 sc1
    buffer_load_dwordx4 a[216:219], v155, s[56:59], s1 offen offset:128 sc1
    s_waitcnt lgkmcnt(0)
    s_barrier
    ds_read_b128 v[176:179], v10 offset:0
    ds_read_b128 v[180:183], v10 offset:1024
    ds_read_b128 v[184:187], v10 offset:2048
    ds_read_b128 v[188:191], v10 offset:3072
    ds_read_b128 v[192:195], v10 offset:4096
    ds_read_b128 v[196:199], v10 offset:5120
    ds_read_b128 v[200:203], v10 offset:6144
    ds_read_b128 v[204:207], v10 offset:7168
    buffer_load_dwordx4 a[220:223], v155, s[60:63], s1 offen offset:128 sc1
    s_mov_b32 s1, 49152
    buffer_load_dwordx4 a[224:227], v155, s[56:59], s1 offen offset:0 sc1
    buffer_load_dwordx4 a[228:231], v155, s[60:63], s1 offen offset:0 sc1
    s_waitcnt lgkmcnt(7)
    v_mfma_f32_16x16x32_bf16 v[112:115], v[176:179], v[32:35], 0
    v_mfma_f32_16x16x32_bf16 v[120:123], v[176:179], v[48:51], 0
    s_waitcnt lgkmcnt(6)
    v_mfma_f32_16x16x32_bf16 v[112:115], v[180:183], v[36:39], v[112:115]
    v_mfma_f32_16x16x32_bf16 v[120:123], v[180:183], v[52:55], v[120:123]
    s_waitcnt lgkmcnt(5)
    v_mfma_f32_16x16x32_bf16 v[112:115], v[184:187], v[40:43], v[112:115]
    v_mfma_f32_16x16x32_bf16 v[120:123], v[184:187], v[32:35], v[120:123]
    s_waitcnt lgkmcnt(4)
    v_mfma_f32_16x16x32_bf16 v[112:115], v[188:191], v[44:47], v[112:115]
    v_mfma_f32_16x16x32_bf16 v[120:123], v[188:191], v[36:39], v[120:123]
    s_waitcnt lgkmcnt(3)
    v_mfma_f32_16x16x32_bf16 v[116:119], v[192:195], v[32:35], 0
    v_mfma_f32_16x16x32_bf16 v[124:127], v[192:195], v[48:51], 0
    s_waitcnt lgkmcnt(2)
    v_mfma_f32_16x16x32_bf16 v[116:119], v[196:199], v[36:39], v[116:119]
    v_mfma_f32_16x16x32_bf16 v[124:127], v[196:199], v[52:55], v[124:127]
    s_waitcnt lgkmcnt(1)
    v_mfma_f32_16x16x32_bf16 v[116:119], v[200:203], v[40:43], v[116:119]
    v_mfma_f32_16x16x32_bf16 v[124:127], v[200:203], v[32:35], v[124:127]
    s_waitcnt lgkmcnt(0)
    v_mfma_f32_16x16x32_bf16 v[116:119], v[204:207], v[44:47], v[116:119]
    v_mfma_f32_16x16x32_bf16 v[124:127], v[204:207], v[36:39], v[124:127]
    buffer_load_dwordx4 a[232:235], v155, s[56:59], s1 offen offset:128 sc1
    buffer_load_dwordx4 a[236:239], v155, s[60:63], s1 offen offset:128 sc1
    s_mov_b32 s1, 57344
    buffer_load_dwordx4 a[240:243], v155, s[56:59], s1 offen offset:0 sc1
    v_pk_mul_f32 v[128:129], v[112:113], v[80:81]
    v_pk_mul_f32 v[136:137], v[120:121], v[80:81]
    v_pk_mul_f32 v[130:131], v[114:115], v[82:83]
    v_pk_mul_f32 v[138:139], v[122:123], v[82:83]
    v_pk_mul_f32 v[132:133], v[116:117], v[84:85]
    v_pk_mul_f32 v[140:141], v[124:125], v[84:85]
    v_pk_mul_f32 v[134:135], v[118:119], v[86:87]
    v_pk_mul_f32 v[142:143], v[126:127], v[86:87]
    v_pk_fma_f32 v[128:129], v[120:121], v[88:89], v[128:129]
    v_pk_fma_f32 v[130:131], v[122:123], v[90:91], v[130:131]
    v_pk_fma_f32 v[132:133], v[124:125], v[92:93], v[132:133]
    v_pk_fma_f32 v[134:135], v[126:127], v[94:95], v[134:135]
    v_cvt_pk_bf16_f32 v16, v128, v129
    v_cvt_pk_bf16_f32 v17, v130, v131
    v_cvt_pk_bf16_f32 v18, v132, v133
    v_cvt_pk_bf16_f32 v19, v134, v135
    v_pk_fma_f32 v[136:137], v[112:113], v[88:89], v[136:137] neg_lo:[1,0,0] neg_hi:[1,0,0]
    v_pk_fma_f32 v[138:139], v[114:115], v[90:91], v[138:139] neg_lo:[1,0,0] neg_hi:[1,0,0]
    v_pk_fma_f32 v[140:141], v[116:117], v[92:93], v[140:141] neg_lo:[1,0,0] neg_hi:[1,0,0]
    v_pk_fma_f32 v[142:143], v[118:119], v[94:95], v[142:143] neg_lo:[1,0,0] neg_hi:[1,0,0]
    v_cvt_pk_bf16_f32 v20, v136, v137
    v_cvt_pk_bf16_f32 v21, v138, v139
    v_cvt_pk_bf16_f32 v22, v140, v141
    v_cvt_pk_bf16_f32 v23, v142, v143
    v_mfma_f32_16x16x32_bf16 v[112:115], v[56:59], v[16:19], 0
    ds_read_b128 v[32:35], v13 offset:16384
    ds_read_b128 v[36:39], v13 offset:17408
    v_mfma_f32_16x16x32_bf16 v[120:123], v[72:75], v[16:19], 0
    ds_read_b128 v[40:43], v13 offset:18432
    ds_read_b128 v[44:47], v13 offset:19456
    v_mfma_f32_16x16x32_bf16 v[116:119], v[60:63], v[16:19], 0
    ds_read_b128 v[48:51], v13 offset:24576
    ds_read_b128 v[52:55], v13 offset:25600
    v_mfma_f32_16x16x32_bf16 v[124:127], v[76:79], v[16:19], 0
    ds_read_b128 v[80:83], v13 offset:26624
    ds_read_b128 v[84:87], v13 offset:27648
    v_mfma_f32_16x16x32_bf16 v[112:115], v[64:67], v[20:23], v[112:115]
    v_lshlrev_b32 v176, 16, v24
    v_and_b32 v184, s38, v24
    v_mfma_f32_16x16x32_bf16 v[120:123], v[56:59], v[20:23], v[120:123]
    v_lshlrev_b32 v177, 16, v25
    v_and_b32 v185, s38, v25
    v_mfma_f32_16x16x32_bf16 v[116:119], v[68:71], v[20:23], v[116:119]
    v_lshlrev_b32 v178, 16, v26
    v_and_b32 v186, s38, v26
    v_mfma_f32_16x16x32_bf16 v[124:127], v[60:63], v[20:23], v[124:127]
    v_lshlrev_b32 v179, 16, v27
    v_and_b32 v187, s38, v27
    v_lshlrev_b32 v180, 16, v28
    v_and_b32 v188, s38, v28
    v_lshlrev_b32 v181, 16, v29
    v_and_b32 v189, s38, v29
    v_lshlrev_b32 v182, 16, v30
    v_and_b32 v190, s38, v30
    v_lshlrev_b32 v183, 16, v31
    v_and_b32 v191, s38, v31
    v_pk_mul_f32 v[128:129], v[112:113], v[176:177]
    v_pk_mul_f32 v[136:137], v[120:121], v[176:177]
    v_pk_mul_f32 v[130:131], v[114:115], v[178:179]
    v_pk_mul_f32 v[138:139], v[122:123], v[178:179]
    v_pk_mul_f32 v[132:133], v[116:117], v[180:181]
    v_pk_mul_f32 v[140:141], v[124:125], v[180:181]
    v_pk_mul_f32 v[134:135], v[118:119], v[182:183]
    v_pk_mul_f32 v[142:143], v[126:127], v[182:183]
    v_pk_fma_f32 v[128:129], v[120:121], v[184:185], v[128:129] neg_lo:[1,0,0] neg_hi:[1,0,0]
    v_pk_fma_f32 v[130:131], v[122:123], v[186:187], v[130:131] neg_lo:[1,0,0] neg_hi:[1,0,0]
    v_pk_fma_f32 v[132:133], v[124:125], v[188:189], v[132:133] neg_lo:[1,0,0] neg_hi:[1,0,0]
    v_pk_fma_f32 v[134:135], v[126:127], v[190:191], v[134:135] neg_lo:[1,0,0] neg_hi:[1,0,0]
    v_cvt_pk_bf16_f32 v16, v128, v129
    v_cvt_pk_bf16_f32 v17, v130, v131
    v_cvt_pk_bf16_f32 v18, v132, v133
    v_cvt_pk_bf16_f32 v19, v134, v135
    v_pk_fma_f32 v[136:137], v[112:113], v[184:185], v[136:137]
    v_pk_fma_f32 v[138:139], v[114:115], v[186:187], v[138:139]
    v_pk_fma_f32 v[140:141], v[116:117], v[188:189], v[140:141]
    v_pk_fma_f32 v[142:143], v[118:119], v[190:191], v[142:143]
    v_cvt_pk_bf16_f32 v20, v136, v137
    v_cvt_pk_bf16_f32 v21, v138, v139
    v_cvt_pk_bf16_f32 v22, v140, v141
    v_cvt_pk_bf16_f32 v23, v142, v143
    v_mfma_f32_16x16x32_bf16 v[112:115], v[16:19], v[56:59], 0
    ds_read_b128 v[88:91], v13 offset:32768
    v_mfma_f32_16x16x32_bf16 v[120:123], v[16:19], v[64:67], 0
    ds_read_b128 v[92:95], v13 offset:33792
    v_mfma_f32_16x16x32_bf16 v[116:119], v[16:19], v[60:63], 0
    ds_read_b128 v[144:147], v13 offset:34816
    v_mfma_f32_16x16x32_bf16 v[124:127], v[16:19], v[68:71], 0
    ds_read_b128 v[148:151], v13 offset:35840
    v_mfma_f32_16x16x32_bf16 v[112:115], v[20:23], v[72:75], v[112:115]
    v_mfma_f32_16x16x32_bf16 v[120:123], v[20:23], v[56:59], v[120:123]
    v_mfma_f32_16x16x32_bf16 v[116:119], v[20:23], v[76:79], v[116:119]
    v_mfma_f32_16x16x32_bf16 v[124:127], v[20:23], v[60:63], v[124:127]
    buffer_load_dwordx4 a[244:247], v155, s[60:63], s1 offen offset:0 sc1
    buffer_load_dwordx4 a[248:251], v155, s[56:59], s1 offen offset:128 sc1
    buffer_load_dwordx4 a[252:255], v155, s[60:63], s1 offen offset:128 sc1
    s_nop 1
    v_pk_mul_f32 v[128:129], v[112:113], v[96:97]
    v_pk_mul_f32 v[136:137], v[120:121], v[96:97]
    v_pk_mul_f32 v[130:131], v[114:115], v[98:99]
    v_pk_mul_f32 v[138:139], v[122:123], v[98:99]
    v_pk_mul_f32 v[132:133], v[116:117], v[100:101]
    v_pk_mul_f32 v[140:141], v[124:125], v[100:101]
    v_pk_mul_f32 v[134:135], v[118:119], v[102:103]
    v_pk_mul_f32 v[142:143], v[126:127], v[102:103]
    v_pk_fma_f32 v[128:129], v[120:121], v[104:105], v[128:129] neg_lo:[1,0,0] neg_hi:[1,0,0]
    v_pk_fma_f32 v[130:131], v[122:123], v[106:107], v[130:131] neg_lo:[1,0,0] neg_hi:[1,0,0]
    v_pk_fma_f32 v[132:133], v[124:125], v[108:109], v[132:133] neg_lo:[1,0,0] neg_hi:[1,0,0]
    v_pk_fma_f32 v[134:135], v[126:127], v[110:111], v[134:135] neg_lo:[1,0,0] neg_hi:[1,0,0]
    v_cvt_pk_bf16_f32 v16, v128, v129
    v_cvt_pk_bf16_f32 v17, v130, v131
    v_cvt_pk_bf16_f32 v18, v132, v133
    v_cvt_pk_bf16_f32 v19, v134, v135
    ds_write_b64 v11, v[16:17] offset:8192
    ds_write_b64 v11, v[18:19] offset:12288
    v_pk_fma_f32 v[136:137], v[112:113], v[104:105], v[136:137]
    v_pk_fma_f32 v[138:139], v[114:115], v[106:107], v[138:139]
    v_pk_fma_f32 v[140:141], v[116:117], v[108:109], v[140:141]
    v_pk_fma_f32 v[142:143], v[118:119], v[110:111], v[142:143]
    v_cvt_pk_bf16_f32 v20, v136, v137
    v_cvt_pk_bf16_f32 v21, v138, v139
    v_cvt_pk_bf16_f32 v22, v140, v141
    v_cvt_pk_bf16_f32 v23, v142, v143
    ds_write_b64 v11, v[20:21] offset:10240
    ds_write_b64 v11, v[22:23] offset:14336
    s_waitcnt lgkmcnt(0)
    s_barrier
    ds_read_b128 v[176:179], v12 offset:8192
    ds_read_b128 v[180:183], v12 offset:9216
    ds_read_b128 v[184:187], v12 offset:10240
    ds_read_b128 v[188:191], v12 offset:11264
    s_cmp_eq_u32 s4, 0
    s_cbranch_scc1 colskip_86
    s_waitcnt lgkmcnt(3)
    v_mfma_f32_16x16x32_bf16 v[168:171], v[48:51], v[176:179], v[168:171]
    v_mfma_f32_16x16x32_bf16 v[172:175], v[80:83], v[176:179], v[172:175]
    s_waitcnt lgkmcnt(2)
    v_mfma_f32_16x16x32_bf16 v[168:171], v[52:55], v[180:183], v[168:171]
    v_mfma_f32_16x16x32_bf16 v[172:175], v[84:87], v[180:183], v[172:175]
    s_waitcnt lgkmcnt(1)
    v_mfma_f32_16x16x32_bf16 v[168:171], v[32:35], v[184:187], v[168:171]
    v_mfma_f32_16x16x32_bf16 v[172:175], v[40:43], v[184:187], v[172:175]
    s_waitcnt lgkmcnt(0)
    v_mfma_f32_16x16x32_bf16 v[168:171], v[36:39], v[188:191], v[168:171]
    v_mfma_f32_16x16x32_bf16 v[172:175], v[44:47], v[188:191], v[172:175]
colskip_86:
    s_waitcnt lgkmcnt(3)
    v_mfma_f32_16x16x32_bf16 v[160:163], v[32:35], v[176:179], v[160:163]
    v_mfma_f32_16x16x32_bf16 v[164:167], v[40:43], v[176:179], v[164:167]
    s_waitcnt lgkmcnt(2)
    v_mfma_f32_16x16x32_bf16 v[160:163], v[36:39], v[180:183], v[160:163]
    v_mfma_f32_16x16x32_bf16 v[164:167], v[44:47], v[180:183], v[164:167]
    s_waitcnt lgkmcnt(1)
    v_mfma_f32_16x16x32_bf16 v[160:163], v[88:91], v[184:187], v[160:163]
    v_mfma_f32_16x16x32_bf16 v[164:167], v[144:147], v[184:187], v[164:167]
    s_waitcnt lgkmcnt(0)
    v_mfma_f32_16x16x32_bf16 v[160:163], v[92:95], v[188:191], v[160:163]
    v_mfma_f32_16x16x32_bf16 v[164:167], v[148:151], v[188:191], v[164:167]
    v_cvt_pk_bf16_f32 v20, v168, v169
    v_cvt_pk_bf16_f32 v21, v170, v171
    v_cvt_pk_bf16_f32 v22, v172, v173
    v_cvt_pk_bf16_f32 v23, v174, v175
    v_and_b32 v20, s41, v20
    buffer_store_dwordx4 v[20:23], v8, s[8:11], s65 offen offset:64 sc1
    s_nop 0
    v_cvt_pk_bf16_f32 v16, v160, v161
    v_cvt_pk_bf16_f32 v17, v162, v163
    v_cvt_pk_bf16_f32 v18, v164, v165
    v_cvt_pk_bf16_f32 v19, v166, v167
    v_and_b32 v16, s41, v16
    buffer_store_dwordx4 v[16:19], v8, s[8:11], s65 offen offset:0 sc1
    v_lshlrev_b32 v5, 4, v1
    v_lshrrev_b32 v8, 5, v1
    v_lshlrev_b32 v8, 10, v8
    v_bfe_u32 v2, v1, 4, 1
    v_mul_u32_u24 v3, 288, v2
    v_add_u32 v8, v8, v3
    v_lshl_add_u32 v95, v2, 5, 0
    v_xor_b32 v95, v95, v5
    v_bfe_u32 v2, v1, 2, 2
    v_lshl_add_u32 v8, v2, 6, v8
    v_and_b32 v2, 1, v1
    v_lshl_add_u32 v8, v2, 4, v8
    v_bfe_u32 v2, v1, 1, 1
    v_lshl_add_u32 v8, v2, 3, v8
    v_xor_b32 v92, 32, v8
    v_add_u32 v9, 65536, v8
    v_add_u32 v93, 65536, v92
    v_add_u32 v10, 131072, v8
    v_add_u32 v94, 131072, v92
    s_lshl_b32 s49, s3, 12
    v_add_u32 v3, s49, v5
    v_add_u32 v6, 65536, v3
    v_add_u32 v7, 131072, v3
    s_mul_i32 s48, s44, 196608
    s_lshr_b32 s5, s3, 1
    s_lshl_b32 s5, s5, 15
    s_add_u32 s50, s48, s5
    s_and_b32 s5, s3, 1
    s_lshl_b32 s5, s5, 12
    s_add_u32 s50, s50, s5
    s_add_u32 s48, s48, s49
    s_add_u32 s12, s34, 7389184
    s_addc_u32 s13, s35, 0
    s_mov_b32 s14, 5767168
    s_mov_b32 s15, 0x20000
    s_mul_i32 s47, s44, 540672
    s_lshl_b32 s5, s46, 10
    s_add_u32 s47, s47, s5
    s_cmp_eq_u32 s44, 10
    s_cselect_b32 s73, 0, s40
    s_cmp_ge_u32 s3, 2
    s_cselect_b32 s78, s73, s40
    v_lshrrev_b32 v4, 5, v1
    v_lshlrev_b32 v4, 12, v4
    v_bfe_u32 v40, v1, 4, 1
    v_lshl_add_u32 v4, v40, 9, v4
    s_lshl_b32 s5, s3, 10
    v_and_b32 v40, 15, v1
    v_lshl_add_u32 v40, v40, 4, s5
    v_add_u32 v4, v4, v40
    v_and_b32 v40, 8, v1
    v_lshl_add_u32 v14, v40, 4, v4
    s_mul_i32 s6, s3, 6144
    s_add_u32 s6, s6, 0
    v_add_u32 v112, s6, v5
    s_xor_b32 s5, s3, 1
    s_mul_i32 s5, s5, 6144
    s_add_u32 s5, s5, 0
    v_add_u32 v11, s5, v5
    s_xor_b32 s5, s3, 2
    s_mul_i32 s5, s5, 6144
    s_add_u32 s5, s5, 0
    v_add_u32 v12, s5, v5
    s_xor_b32 s5, s3, 3
    s_mul_i32 s5, s5, 6144
    s_add_u32 s5, s5, 0
    v_add_u32 v13, s5, v5
    s_add_u32 s68, s34, 7348224
    s_addc_u32 s69, s35, 0
    s_mov_b32 s70, 8192
    s_mov_b32 s71, 0x20000
    s_and_b32 s5, s3, 1
    v_lshrrev_b32 v40, 4, v1
    v_and_b32 v42, 3, v1
    v_lshl_add_u32 v42, s5, 4, v42
    v_bfe_u32 v41, v1, 3, 1
    v_lshl_add_u32 v42, v41, 2, v42
    v_bfe_u32 v41, v1, 2, 1
    v_lshl_add_u32 v42, v41, 3, v42
    v_lshlrev_b32 v114, 2, v42
    v_xor_b32 v118, 64, v114
    v_and_b32 v113, 7, v42
    v_lshlrev_b32 v113, 15, v113
    v_lshrrev_b32 v42, 3, v42
    v_lshl_add_u32 v113, v42, 10, v113
    v_lshl_add_u32 v113, v40, 4, v113
    s_lshl_b32 s6, s5, 5
    s_lshl_b32 s5, s3, 12
    s_add_u32 s67, s5, 65536
    v_xor_b32 v115, s6, v8
    v_add_u32 v115, s67, v115
    v_xor_b32 v119, 32, v115
    v_mov_b32 v2, v95
    v_lshrrev_b32 v41, 5, v1
    v_mul_u32_u24 v41, 3072, v41
    v_sub_u32 v39, v14, v41
    s_bfe_u32 s74, s54, 0x30002
    s_lshl_b32 s74, s74, 18
    s_lshr_b32 s6, s54, 5
    s_lshl_b32 s6, s6, 14
    s_add_u32 s74, s74, s6
    s_and_b32 s6, s54, 3
    s_lshl_b32 s6, s6, 12
    s_add_u32 s74, s74, s6
    s_lshl_b32 s5, s42, 6
    s_add_u32 s74, s74, s5
    s_lshl_b32 s5, s3, 13
    s_lshl_b32 s65, s54, 15
    s_add_u32 s65, s65, s5
    s_bfe_u32 s75, s55, 0x30002
    s_lshl_b32 s75, s75, 18
    s_lshr_b32 s6, s55, 5
    s_lshl_b32 s6, s6, 14
    s_add_u32 s75, s75, s6
    s_and_b32 s6, s55, 3
    s_lshl_b32 s6, s6, 12
    s_add_u32 s75, s75, s6
    s_lshl_b32 s5, s42, 6
    s_add_u32 s75, s75, s5
    s_lshl_b32 s5, s3, 13
    s_lshl_b32 s66, s55, 15
    s_add_u32 s66, s66, s5
    s_mul_i32 s72, s3, 7168
    s_lshl_b32 s77, s3, 13
    s_add_u32 s77, s77, 32768
    v_add_u32 v116, s77, v5
    s_mov_b32 s24, s30
    s_mov_b32 s25, s31
    s_mov_b32 s26, 2097152
    s_mov_b32 s27, 0x20000
    v_and_b32 v42, 10, v1
    v_cmp_eq_u32 vcc, 0, v42
    v_mov_b32 v42, s40
    s_nop 0
    v_cndmask_b32 v117, 0, v42, vcc
    s_mov_b32 s1, 65536
    buffer_load_dwordx4 v[208:211], v14, s[56:59], s1 offen offset:0 sc1
    buffer_load_dwordx4 v[212:215], v14, s[60:63], s1 offen offset:0 sc1
    buffer_load_dwordx4 v[216:219], v14, s[56:59], s1 offen offset:128 sc1
    buffer_load_dwordx4 v[220:223], v14, s[60:63], s1 offen offset:128 sc1
    s_waitcnt vmcnt(0)
    s_barrier
    s_cmp_eq_u32 s45, 22
    s_cbranch_scc1 L_g1stats1
    s_add_u32 m0, s49, 0
    s_add_u32 s52, s48, 0
    buffer_load_dwordx4 v95, s[8:11], s52 offen offset:0 sc1 lds
    buffer_load_dwordx4 v95, s[8:11], s52 offen offset:1024 sc1 lds
    buffer_load_dwordx4 v95, s[8:11], s52 offen offset:2048 sc1 lds
    buffer_load_dwordx4 v95, s[8:11], s52 offen offset:3072 sc1 lds
    s_add_u32 m0, s49, 16384
    s_add_u32 s52, s48, 16384
    buffer_load_dwordx4 v95, s[8:11], s52 offen offset:0 sc1 lds
    buffer_load_dwordx4 v95, s[8:11], s52 offen offset:1024 sc1 lds
    buffer_load_dwordx4 v95, s[8:11], s52 offen offset:2048 sc1 lds
    buffer_load_dwordx4 v95, s[8:11], s52 offen offset:3072 sc1 lds
    s_waitcnt vmcnt(4)
    ds_read2st64_b32 v[88:89], v3 offset0:0 offset1:4
    ds_read2st64_b32 v[90:91], v3 offset0:8 offset1:12
    s_waitcnt lgkmcnt(0)
    v_or3_b32 v88, v88, v89, v90
    v_bitop3_b32 v88, v88, v91, s40 bitop3:0xa8
    v_cmp_ne_u32 vcc, 0, v88
    s_cbranch_vccnz cslow_88
cback_87:
    s_barrier
    ds_read_b64_tr_b16 v[176:177], v8 offset:0
    ds_read_b64_tr_b16 v[178:179], v8 offset:512
    ds_read_b64_tr_b16 v[180:181], v92 offset:0
    ds_read_b64_tr_b16 v[182:183], v92 offset:512
    ds_read_b64_tr_b16 v[184:185], v8 offset:2048
    ds_read_b64_tr_b16 v[186:187], v8 offset:2560
    ds_read_b64_tr_b16 v[188:189], v92 offset:2048
    ds_read_b64_tr_b16 v[190:191], v92 offset:2560
    ds_read_b64_tr_b16 v[192:193], v8 offset:4096
    ds_read_b64_tr_b16 v[194:195], v8 offset:4608
    s_waitcnt lgkmcnt(6)
    v_mfma_f32_16x16x32_bf16 v[40:43], a[0:3], v[176:179], 0
    ds_read_b64_tr_b16 v[196:197], v92 offset:4096
    ds_read_b64_tr_b16 v[198:199], v92 offset:4608
    v_mfma_f32_16x16x32_bf16 v[48:51], a[4:7], v[176:179], 0
    s_add_u32 m0, s49, 32768
    s_add_u32 s52, s48, 32768
    v_mfma_f32_16x16x32_bf16 v[44:47], a[0:3], v[180:183], 0
    ds_read_b64_tr_b16 v[176:177], v8 offset:6144
    ds_read_b64_tr_b16 v[178:179], v8 offset:6656
    v_mfma_f32_16x16x32_bf16 v[52:55], a[4:7], v[180:183], 0
    buffer_load_dwordx4 v95, s[8:11], s52 offen offset:0 sc1 lds
    s_waitcnt lgkmcnt(6)
    v_mfma_f32_16x16x32_bf16 v[40:43], a[8:11], v[184:187], v[40:43]
    ds_read_b64_tr_b16 v[180:181], v92 offset:6144
    ds_read_b64_tr_b16 v[182:183], v92 offset:6656
    v_mfma_f32_16x16x32_bf16 v[48:51], a[12:15], v[184:187], v[48:51]
    buffer_load_dwordx4 v95, s[8:11], s52 offen offset:1024 sc1 lds
    v_mfma_f32_16x16x32_bf16 v[44:47], a[8:11], v[188:191], v[44:47]
    ds_read_b64_tr_b16 v[184:185], v8 offset:8192
    ds_read_b64_tr_b16 v[186:187], v8 offset:8704
    v_mfma_f32_16x16x32_bf16 v[52:55], a[12:15], v[188:191], v[52:55]
    s_waitcnt lgkmcnt(6)
    v_mfma_f32_16x16x32_bf16 v[40:43], a[16:19], v[192:195], v[40:43]
    ds_read_b64_tr_b16 v[188:189], v92 offset:8192
    ds_read_b64_tr_b16 v[190:191], v92 offset:8704
    v_mfma_f32_16x16x32_bf16 v[48:51], a[20:23], v[192:195], v[48:51]
    s_waitcnt vmcnt(2)
    ds_read2st64_b32 v[88:89], v3 offset0:64 offset1:68
    v_mfma_f32_16x16x32_bf16 v[44:47], a[16:19], v[196:199], v[44:47]
    ds_read_b64_tr_b16 v[192:193], v8 offset:10240
    ds_read_b64_tr_b16 v[194:195], v8 offset:10752
    v_mfma_f32_16x16x32_bf16 v[52:55], a[20:23], v[196:199], v[52:55]
    buffer_load_dwordx4 v95, s[8:11], s52 offen offset:2048 sc1 lds
    s_waitcnt lgkmcnt(7)
    v_mfma_f32_16x16x32_bf16 v[40:43], a[24:27], v[176:179], v[40:43]
    ds_read_b64_tr_b16 v[196:197], v92 offset:10240
    ds_read_b64_tr_b16 v[198:199], v92 offset:10752
    v_mfma_f32_16x16x32_bf16 v[48:51], a[28:31], v[176:179], v[48:51]
    buffer_load_dwordx4 v95, s[8:11], s52 offen offset:3072 sc1 lds
    ds_read2st64_b32 v[90:91], v3 offset0:72 offset1:76
    v_mfma_f32_16x16x32_bf16 v[44:47], a[24:27], v[180:183], v[44:47]
    ds_read_b64_tr_b16 v[176:177], v8 offset:12288
    ds_read_b64_tr_b16 v[178:179], v8 offset:12800
    v_mfma_f32_16x16x32_bf16 v[52:55], a[28:31], v[180:183], v[52:55]
    s_add_u32 m0, s49, 49152
    s_add_u32 s52, s48, 49152
    s_waitcnt lgkmcnt(8)
    v_mfma_f32_16x16x32_bf16 v[40:43], a[32:35], v[184:187], v[40:43]
    ds_read_b64_tr_b16 v[180:181], v92 offset:12288
    ds_read_b64_tr_b16 v[182:183], v92 offset:12800
    v_mfma_f32_16x16x32_bf16 v[48:51], a[36:39], v[184:187], v[48:51]
    buffer_load_dwordx4 v95, s[8:11], s52 offen offset:0 sc1 lds
    v_mfma_f32_16x16x32_bf16 v[44:47], a[32:35], v[188:191], v[44:47]
    ds_read_b64_tr_b16 v[184:185], v8 offset:14336
    ds_read_b64_tr_b16 v[186:187], v8 offset:14848
    v_mfma_f32_16x16x32_bf16 v[52:55], a[36:39], v[188:191], v[52:55]
    s_waitcnt lgkmcnt(6)
    v_or3_b32 v88, v88, v89, v90
    v_mfma_f32_16x16x32_bf16 v[40:43], a[40:43], v[192:195], v[40:43]
    ds_read_b64_tr_b16 v[188:189], v92 offset:14336
    ds_read_b64_tr_b16 v[190:191], v92 offset:14848
    v_mfma_f32_16x16x32_bf16 v[48:51], a[44:47], v[192:195], v[48:51]
    v_bitop3_b32 v88, v88, v91, s40 bitop3:0xa8
    v_cmp_ne_u32 vcc, 0, v88
    v_mfma_f32_16x16x32_bf16 v[44:47], a[40:43], v[196:199], v[44:47]
    s_cbranch_vccnz cslow_90
cback_89:
    s_barrier
    v_mfma_f32_16x16x32_bf16 v[52:55], a[44:47], v[196:199], v[52:55]
    ds_read_b64_tr_b16 v[192:193], v8 offset:16384
    ds_read_b64_tr_b16 v[194:195], v8 offset:16896
    s_waitcnt lgkmcnt(6)
    v_mfma_f32_16x16x32_bf16 v[40:43], a[48:51], v[176:179], v[40:43]
    ds_read_b64_tr_b16 v[196:197], v92 offset:16384
    ds_read_b64_tr_b16 v[198:199], v92 offset:16896
    v_mfma_f32_16x16x32_bf16 v[48:51], a[52:55], v[176:179], v[48:51]
    buffer_load_dwordx4 v95, s[8:11], s52 offen offset:1024 sc1 lds
    v_mfma_f32_16x16x32_bf16 v[44:47], a[48:51], v[180:183], v[44:47]
    ds_read_b64_tr_b16 v[176:177], v8 offset:18432
    ds_read_b64_tr_b16 v[178:179], v8 offset:18944
    v_mfma_f32_16x16x32_bf16 v[52:55], a[52:55], v[180:183], v[52:55]
    buffer_load_dwordx4 v95, s[8:11], s52 offen offset:2048 sc1 lds
    s_waitcnt lgkmcnt(6)
    v_mfma_f32_16x16x32_bf16 v[40:43], a[56:59], v[184:187], v[40:43]
    ds_read_b64_tr_b16 v[180:181], v92 offset:18432
    ds_read_b64_tr_b16 v[182:183], v92 offset:18944
    v_mfma_f32_16x16x32_bf16 v[48:51], a[60:63], v[184:187], v[48:51]
    v_mfma_f32_16x16x32_bf16 v[44:47], a[56:59], v[188:191], v[44:47]
    ds_read_b64_tr_b16 v[184:185], v8 offset:20480
    ds_read_b64_tr_b16 v[186:187], v8 offset:20992
    v_mfma_f32_16x16x32_bf16 v[52:55], a[60:63], v[188:191], v[52:55]
    buffer_load_dwordx4 v95, s[8:11], s52 offen offset:3072 sc1 lds
    s_waitcnt lgkmcnt(6)
    v_mfma_f32_16x16x32_bf16 v[40:43], a[64:67], v[192:195], v[40:43]
    ds_read_b64_tr_b16 v[188:189], v92 offset:20480
    ds_read_b64_tr_b16 v[190:191], v92 offset:20992
    v_mfma_f32_16x16x32_bf16 v[48:51], a[68:71], v[192:195], v[48:51]
    s_add_u32 m0, s49, 65536
    s_add_u32 s52, s48, 65536
    v_mfma_f32_16x16x32_bf16 v[44:47], a[64:67], v[196:199], v[44:47]
    ds_read_b64_tr_b16 v[192:193], v8 offset:22528
    ds_read_b64_tr_b16 v[194:195], v8 offset:23040
    v_mfma_f32_16x16x32_bf16 v[52:55], a[68:71], v[196:199], v[52:55]
    buffer_load_dwordx4 v95, s[8:11], s52 offen offset:0 sc1 lds
    s_waitcnt lgkmcnt(6)
    v_mfma_f32_16x16x32_bf16 v[40:43], a[72:75], v[176:179], v[40:43]
    ds_read_b64_tr_b16 v[196:197], v92 offset:22528
    ds_read_b64_tr_b16 v[198:199], v92 offset:23040
    v_mfma_f32_16x16x32_bf16 v[48:51], a[76:79], v[176:179], v[48:51]
    v_mfma_f32_16x16x32_bf16 v[44:47], a[72:75], v[180:183], v[44:47]
    ds_read_b64_tr_b16 v[176:177], v8 offset:24576
    ds_read_b64_tr_b16 v[178:179], v8 offset:25088
    v_mfma_f32_16x16x32_bf16 v[52:55], a[76:79], v[180:183], v[52:55]
    buffer_load_dwordx4 v95, s[8:11], s52 offen offset:1024 sc1 lds
    s_waitcnt lgkmcnt(6)
    v_mfma_f32_16x16x32_bf16 v[40:43], a[80:83], v[184:187], v[40:43]
    ds_read_b64_tr_b16 v[180:181], v92 offset:24576
    ds_read_b64_tr_b16 v[182:183], v92 offset:25088
    v_mfma_f32_16x16x32_bf16 v[48:51], a[84:87], v[184:187], v[48:51]
    s_waitcnt vmcnt(6)
    ds_read2st64_b32 v[88:89], v3 offset0:128 offset1:132
    v_mfma_f32_16x16x32_bf16 v[44:47], a[80:83], v[188:191], v[44:47]
    ds_read_b64_tr_b16 v[184:185], v8 offset:26624
    ds_read_b64_tr_b16 v[186:187], v8 offset:27136
    v_mfma_f32_16x16x32_bf16 v[52:55], a[84:87], v[188:191], v[52:55]
    buffer_load_dwordx4 v95, s[8:11], s52 offen offset:2048 sc1 lds
    s_waitcnt lgkmcnt(7)
    v_mfma_f32_16x16x32_bf16 v[40:43], a[88:91], v[192:195], v[40:43]
    ds_read_b64_tr_b16 v[188:189], v92 offset:26624
    ds_read_b64_tr_b16 v[190:191], v92 offset:27136
    v_mfma_f32_16x16x32_bf16 v[48:51], a[92:95], v[192:195], v[48:51]
    ds_read2st64_b32 v[90:91], v3 offset0:136 offset1:140
    v_mfma_f32_16x16x32_bf16 v[44:47], a[88:91], v[196:199], v[44:47]
    ds_read_b64_tr_b16 v[192:193], v8 offset:28672
    ds_read_b64_tr_b16 v[194:195], v8 offset:29184
    v_mfma_f32_16x16x32_bf16 v[52:55], a[92:95], v[196:199], v[52:55]
    buffer_load_dwordx4 v95, s[8:11], s52 offen offset:3072 sc1 lds
    s_waitcnt lgkmcnt(8)
    v_mfma_f32_16x16x32_bf16 v[40:43], a[96:99], v[176:179], v[40:43]
    ds_read_b64_tr_b16 v[196:197], v92 offset:28672
    ds_read_b64_tr_b16 v[198:199], v92 offset:29184
    v_mfma_f32_16x16x32_bf16 v[48:51], a[100:103], v[176:179], v[48:51]
    s_mov_b32 s1, 73728
    v_mfma_f32_16x16x32_bf16 v[44:47], a[96:99], v[180:183], v[44:47]
    ds_read_b64_tr_b16 v[176:177], v8 offset:30720
    ds_read_b64_tr_b16 v[178:179], v8 offset:31232
    v_mfma_f32_16x16x32_bf16 v[52:55], a[100:103], v[180:183], v[52:55]
    buffer_load_dwordx4 v[224:227], v14, s[56:59], s1 offen offset:0 sc1
    s_waitcnt lgkmcnt(6)
    v_or3_b32 v88, v88, v89, v90
    v_mfma_f32_16x16x32_bf16 v[40:43], a[104:107], v[184:187], v[40:43]
    ds_read_b64_tr_b16 v[180:181], v92 offset:30720
    ds_read_b64_tr_b16 v[182:183], v92 offset:31232
    v_mfma_f32_16x16x32_bf16 v[48:51], a[108:111], v[184:187], v[48:51]
    v_bitop3_b32 v88, v88, v91, s40 bitop3:0xa8
    v_cmp_ne_u32 vcc, 0, v88
    v_mfma_f32_16x16x32_bf16 v[44:47], a[104:107], v[188:191], v[44:47]
    s_cbranch_vccnz cslow_92
cback_91:
    s_barrier
    v_mfma_f32_16x16x32_bf16 v[52:55], a[108:111], v[188:191], v[52:55]
    ds_read_b64_tr_b16 v[184:185], v8 offset:32768
    ds_read_b64_tr_b16 v[186:187], v8 offset:33280
    s_waitcnt lgkmcnt(6)
    v_mfma_f32_16x16x32_bf16 v[40:43], a[112:115], v[192:195], v[40:43]
    ds_read_b64_tr_b16 v[188:189], v92 offset:32768
    ds_read_b64_tr_b16 v[190:191], v92 offset:33280
    v_mfma_f32_16x16x32_bf16 v[48:51], a[116:119], v[192:195], v[48:51]
    buffer_load_dwordx4 v[228:231], v14, s[60:63], s1 offen offset:0 sc1
    v_mfma_f32_16x16x32_bf16 v[44:47], a[112:115], v[196:199], v[44:47]
    ds_read_b64_tr_b16 v[192:193], v8 offset:34816
    ds_read_b64_tr_b16 v[194:195], v8 offset:35328
    v_mfma_f32_16x16x32_bf16 v[52:55], a[116:119], v[196:199], v[52:55]
    buffer_load_dwordx4 v[232:235], v14, s[56:59], s1 offen offset:128 sc1
    s_waitcnt lgkmcnt(6)
    v_mfma_f32_16x16x32_bf16 v[40:43], a[120:123], v[176:179], v[40:43]
    ds_read_b64_tr_b16 v[196:197], v92 offset:34816
    ds_read_b64_tr_b16 v[198:199], v92 offset:35328
    v_mfma_f32_16x16x32_bf16 v[48:51], a[124:127], v[176:179], v[48:51]
    v_mfma_f32_16x16x32_bf16 v[44:47], a[120:123], v[180:183], v[44:47]
    ds_read_b64_tr_b16 v[176:177], v8 offset:36864
    ds_read_b64_tr_b16 v[178:179], v8 offset:37376
    v_mfma_f32_16x16x32_bf16 v[52:55], a[124:127], v[180:183], v[52:55]
    buffer_load_dwordx4 v[236:239], v14, s[60:63], s1 offen offset:128 sc1
    s_waitcnt lgkmcnt(6)
    v_mfma_f32_16x16x32_bf16 v[56:59], a[0:3], v[184:187], 0
    ds_read_b64_tr_b16 v[180:181], v92 offset:36864
    ds_read_b64_tr_b16 v[182:183], v92 offset:37376
    v_mfma_f32_16x16x32_bf16 v[64:67], a[4:7], v[184:187], 0
    s_add_u32 m0, s49, 81920
    s_add_u32 s52, s48, 81920
    v_mfma_f32_16x16x32_bf16 v[60:63], a[0:3], v[188:191], 0
    ds_read_b64_tr_b16 v[184:185], v8 offset:38912
    ds_read_b64_tr_b16 v[186:187], v8 offset:39424
    v_mfma_f32_16x16x32_bf16 v[68:71], a[4:7], v[188:191], 0
    buffer_load_dwordx4 v95, s[8:11], s52 offen offset:0 sc1 lds
    s_waitcnt lgkmcnt(6)
    v_mfma_f32_16x16x32_bf16 v[56:59], a[8:11], v[192:195], v[56:59]
    ds_read_b64_tr_b16 v[188:189], v92 offset:38912
    ds_read_b64_tr_b16 v[190:191], v92 offset:39424
    v_mfma_f32_16x16x32_bf16 v[64:67], a[12:15], v[192:195], v[64:67]
    v_max_f32 v40, 0, v40
    v_max_f32 v41, 0, v41
    v_mfma_f32_16x16x32_bf16 v[60:63], a[8:11], v[196:199], v[60:63]
    ds_read_b64_tr_b16 v[192:193], v8 offset:40960
    ds_read_b64_tr_b16 v[194:195], v8 offset:41472
    v_mfma_f32_16x16x32_bf16 v[68:71], a[12:15], v[196:199], v[68:71]
    buffer_load_dwordx4 v95, s[8:11], s52 offen offset:1024 sc1 lds
    v_max_f32 v42, 0, v42
    v_max_f32 v43, 0, v43
    s_waitcnt lgkmcnt(6)
    v_mfma_f32_16x16x32_bf16 v[56:59], a[16:19], v[176:179], v[56:59]
    ds_read_b64_tr_b16 v[196:197], v92 offset:40960
    ds_read_b64_tr_b16 v[198:199], v92 offset:41472
    v_mfma_f32_16x16x32_bf16 v[64:67], a[20:23], v[176:179], v[64:67]
    s_waitcnt vmcnt(10)
    ds_read2st64_b32 v[88:89], v3 offset0:192 offset1:196
    v_max_f32 v44, 0, v44
    v_max_f32 v45, 0, v45
    v_mfma_f32_16x16x32_bf16 v[60:63], a[16:19], v[180:183], v[60:63]
    ds_read_b64_tr_b16 v[176:177], v8 offset:43008
    ds_read_b64_tr_b16 v[178:179], v8 offset:43520
    v_mfma_f32_16x16x32_bf16 v[68:71], a[20:23], v[180:183], v[68:71]
    buffer_load_dwordx4 v95, s[8:11], s52 offen offset:2048 sc1 lds
    v_max_f32 v46, 0, v46
    v_max_f32 v47, 0, v47
    s_waitcnt lgkmcnt(7)
    v_mfma_f32_16x16x32_bf16 v[56:59], a[24:27], v[184:187], v[56:59]
    ds_read_b64_tr_b16 v[180:181], v92 offset:43008
    ds_read_b64_tr_b16 v[182:183], v92 offset:43520
    v_mfma_f32_16x16x32_bf16 v[64:67], a[28:31], v[184:187], v[64:67]
    ds_read2st64_b32 v[90:91], v3 offset0:200 offset1:204
    v_mul_f32 v40, v40, v48
    v_mul_f32 v41, v41, v49
    v_mfma_f32_16x16x32_bf16 v[60:63], a[24:27], v[188:191], v[60:63]
    ds_read_b64_tr_b16 v[184:185], v8 offset:45056
    ds_read_b64_tr_b16 v[186:187], v8 offset:45568
    v_mfma_f32_16x16x32_bf16 v[68:71], a[28:31], v[188:191], v[68:71]
    buffer_load_dwordx4 v95, s[8:11], s52 offen offset:3072 sc1 lds
    v_cvt_pk_bf16_f32 v104, v40, v41
    v_mul_f32 v44, v44, v52
    s_waitcnt lgkmcnt(8)
    v_mfma_f32_16x16x32_bf16 v[56:59], a[32:35], v[192:195], v[56:59]
    ds_read_b64_tr_b16 v[188:189], v92 offset:45056
    ds_read_b64_tr_b16 v[190:191], v92 offset:45568
    v_mfma_f32_16x16x32_bf16 v[64:67], a[36:39], v[192:195], v[64:67]
    v_mul_f32 v45, v45, v53
    s_mov_b32 s1, 81920
    v_cvt_pk_bf16_f32 v106, v44, v45
    v_mfma_f32_16x16x32_bf16 v[60:63], a[32:35], v[196:199], v[60:63]
    ds_read_b64_tr_b16 v[192:193], v8 offset:47104
    ds_read_b64_tr_b16 v[194:195], v8 offset:47616
    v_mfma_f32_16x16x32_bf16 v[68:71], a[36:39], v[196:199], v[68:71]
    buffer_load_dwordx4 v[240:243], v14, s[56:59], s1 offen offset:0 sc1
    s_waitcnt lgkmcnt(6)
    v_or3_b32 v88, v88, v89, v90
    v_mfma_f32_16x16x32_bf16 v[56:59], a[40:43], v[176:179], v[56:59]
    ds_read_b64_tr_b16 v[196:197], v92 offset:47104
    ds_read_b64_tr_b16 v[198:199], v92 offset:47616
    v_mfma_f32_16x16x32_bf16 v[64:67], a[44:47], v[176:179], v[64:67]
    v_bitop3_b32 v88, v88, v91, s40 bitop3:0xa8
    v_cmp_ne_u32 vcc, 0, v88
    v_mul_f32 v42, v42, v50
    v_mul_f32 v43, v43, v51
    v_mfma_f32_16x16x32_bf16 v[60:63], a[40:43], v[180:183], v[60:63]
    s_cbranch_vccnz cslow_94
cback_93:
    s_barrier
    v_mfma_f32_16x16x32_bf16 v[68:71], a[44:47], v[180:183], v[68:71]
    ds_read_b64_tr_b16 v[176:177], v8 offset:49152
    ds_read_b64_tr_b16 v[178:179], v8 offset:49664
    v_cvt_pk_bf16_f32 v105, v42, v43
    s_waitcnt lgkmcnt(6)
    v_mfma_f32_16x16x32_bf16 v[56:59], a[48:51], v[184:187], v[56:59]
    ds_read_b64_tr_b16 v[180:181], v92 offset:49152
    ds_read_b64_tr_b16 v[182:183], v92 offset:49664
    v_mfma_f32_16x16x32_bf16 v[64:67], a[52:55], v[184:187], v[64:67]
    buffer_load_dwordx4 v[244:247], v14, s[60:63], s1 offen offset:0 sc1
    v_mul_f32 v46, v46, v54
    v_mul_f32 v47, v47, v55
    v_mfma_f32_16x16x32_bf16 v[60:63], a[48:51], v[188:191], v[60:63]
    ds_read_b64_tr_b16 v[184:185], v8 offset:51200
    ds_read_b64_tr_b16 v[186:187], v8 offset:51712
    v_mfma_f32_16x16x32_bf16 v[68:71], a[52:55], v[188:191], v[68:71]
    buffer_load_dwordx4 v[248:251], v14, s[56:59], s1 offen offset:128 sc1
    v_cvt_pk_bf16_f32 v107, v46, v47
    v_permlane16_swap_b32 v104, v106
    s_waitcnt lgkmcnt(6)
    v_mfma_f32_16x16x32_bf16 v[56:59], a[56:59], v[192:195], v[56:59]
    ds_read_b64_tr_b16 v[188:189], v92 offset:51200
    ds_read_b64_tr_b16 v[190:191], v92 offset:51712
    v_mfma_f32_16x16x32_bf16 v[64:67], a[60:63], v[192:195], v[64:67]
    v_permlane16_swap_b32 v105, v107
    v_or_b32 v104, 1, v104
    v_mfma_f32_16x16x32_bf16 v[60:63], a[56:59], v[196:199], v[60:63]
    ds_read_b64_tr_b16 v[192:193], v8 offset:53248
    ds_read_b64_tr_b16 v[194:195], v8 offset:53760
    v_mfma_f32_16x16x32_bf16 v[68:71], a[60:63], v[196:199], v[68:71]
    buffer_load_dwordx4 v[252:255], v14, s[60:63], s1 offen offset:128 sc1
    s_add_u32 s51, s47, 0
    s_waitcnt lgkmcnt(6)
    v_mfma_f32_16x16x32_bf16 v[56:59], a[64:67], v[176:179], v[56:59]
    ds_read_b64_tr_b16 v[196:197], v92 offset:53248
    ds_read_b64_tr_b16 v[198:199], v92 offset:53760
    v_mfma_f32_16x16x32_bf16 v[64:67], a[68:71], v[176:179], v[64:67]
    buffer_store_dwordx4 v[104:107], v5, s[12:15], s51 offen sc1
    v_mfma_f32_16x16x32_bf16 v[60:63], a[64:67], v[180:183], v[60:63]
    ds_read_b64_tr_b16 v[176:177], v8 offset:55296
    ds_read_b64_tr_b16 v[178:179], v8 offset:55808
    v_mfma_f32_16x16x32_bf16 v[68:71], a[68:71], v[180:183], v[68:71]
    s_add_u32 m0, s49, 98304
    s_add_u32 s52, s48, 98304
    s_waitcnt lgkmcnt(6)
    v_mfma_f32_16x16x32_bf16 v[56:59], a[72:75], v[184:187], v[56:59]
    ds_read_b64_tr_b16 v[180:181], v92 offset:55296
    ds_read_b64_tr_b16 v[182:183], v92 offset:55808
    v_mfma_f32_16x16x32_bf16 v[64:67], a[76:79], v[184:187], v[64:67]
    buffer_load_dwordx4 v95, s[8:11], s52 offen offset:0 sc1 lds
    v_mfma_f32_16x16x32_bf16 v[60:63], a[72:75], v[188:191], v[60:63]
    ds_read_b64_tr_b16 v[184:185], v8 offset:57344
    ds_read_b64_tr_b16 v[186:187], v8 offset:57856
    v_mfma_f32_16x16x32_bf16 v[68:71], a[76:79], v[188:191], v[68:71]
    s_waitcnt lgkmcnt(6)
    v_mfma_f32_16x16x32_bf16 v[56:59], a[80:83], v[192:195], v[56:59]
    ds_read_b64_tr_b16 v[188:189], v92 offset:57344
    ds_read_b64_tr_b16 v[190:191], v92 offset:57856
    v_mfma_f32_16x16x32_bf16 v[64:67], a[84:87], v[192:195], v[64:67]
    s_waitcnt vmcnt(14)
    ds_read2st64_b32 v[88:89], v6 offset0:0 offset1:4
    v_mfma_f32_16x16x32_bf16 v[60:63], a[80:83], v[196:199], v[60:63]
    ds_read_b64_tr_b16 v[192:193], v8 offset:59392
    ds_read_b64_tr_b16 v[194:195], v8 offset:59904
    v_mfma_f32_16x16x32_bf16 v[68:71], a[84:87], v[196:199], v[68:71]
    buffer_load_dwordx4 v95, s[8:11], s52 offen offset:1024 sc1 lds
    s_waitcnt lgkmcnt(7)
    v_mfma_f32_16x16x32_bf16 v[56:59], a[88:91], v[176:179], v[56:59]
    ds_read_b64_tr_b16 v[196:197], v92 offset:59392
    ds_read_b64_tr_b16 v[198:199], v92 offset:59904
    v_mfma_f32_16x16x32_bf16 v[64:67], a[92:95], v[176:179], v[64:67]
    buffer_load_dwordx4 v95, s[8:11], s52 offen offset:2048 sc1 lds
    ds_read2st64_b32 v[90:91], v6 offset0:8 offset1:12
    v_mfma_f32_16x16x32_bf16 v[60:63], a[88:91], v[180:183], v[60:63]
    ds_read_b64_tr_b16 v[176:177], v8 offset:61440
    ds_read_b64_tr_b16 v[178:179], v8 offset:61952
    v_mfma_f32_16x16x32_bf16 v[68:71], a[92:95], v[180:183], v[68:71]
    s_waitcnt lgkmcnt(8)
    v_mfma_f32_16x16x32_bf16 v[56:59], a[96:99], v[184:187], v[56:59]
    ds_read_b64_tr_b16 v[180:181], v92 offset:61440
    ds_read_b64_tr_b16 v[182:183], v92 offset:61952
    v_mfma_f32_16x16x32_bf16 v[64:67], a[100:103], v[184:187], v[64:67]
    buffer_load_dwordx4 v95, s[8:11], s52 offen offset:3072 sc1 lds
    v_mfma_f32_16x16x32_bf16 v[60:63], a[96:99], v[188:191], v[60:63]
    ds_read_b64_tr_b16 v[184:185], v8 offset:63488
    ds_read_b64_tr_b16 v[186:187], v8 offset:64000
    v_mfma_f32_16x16x32_bf16 v[68:71], a[100:103], v[188:191], v[68:71]
    s_waitcnt lgkmcnt(6)
    v_or3_b32 v88, v88, v89, v90
    v_mfma_f32_16x16x32_bf16 v[56:59], a[104:107], v[192:195], v[56:59]
    ds_read_b64_tr_b16 v[188:189], v92 offset:63488
    ds_read_b64_tr_b16 v[190:191], v92 offset:64000
    v_mfma_f32_16x16x32_bf16 v[64:67], a[108:111], v[192:195], v[64:67]
    v_bitop3_b32 v88, v88, v91, s40 bitop3:0xa8
    v_cmp_ne_u32 vcc, 0, v88
    v_mfma_f32_16x16x32_bf16 v[60:63], a[104:107], v[196:199], v[60:63]
    s_cbranch_vccnz cslow_96
cback_95:
    s_barrier
    v_mfma_f32_16x16x32_bf16 v[68:71], a[108:111], v[196:199], v[68:71]
    ds_read_b64_tr_b16 v[192:193], v9 offset:0
    ds_read_b64_tr_b16 v[194:195], v9 offset:512
    s_waitcnt lgkmcnt(6)
    v_mfma_f32_16x16x32_bf16 v[56:59], a[112:115], v[176:179], v[56:59]
    ds_read_b64_tr_b16 v[196:197], v93 offset:0
    ds_read_b64_tr_b16 v[198:199], v93 offset:512
    v_mfma_f32_16x16x32_bf16 v[64:67], a[116:119], v[176:179], v[64:67]
    s_add_u32 m0, s49, 114688
    s_add_u32 s52, s48, 114688
    v_mfma_f32_16x16x32_bf16 v[60:63], a[112:115], v[180:183], v[60:63]
    ds_read_b64_tr_b16 v[176:177], v9 offset:2048
    ds_read_b64_tr_b16 v[178:179], v9 offset:2560
    v_mfma_f32_16x16x32_bf16 v[68:71], a[116:119], v[180:183], v[68:71]
    buffer_load_dwordx4 v95, s[8:11], s52 offen offset:0 sc1 lds
    s_waitcnt lgkmcnt(6)
    v_mfma_f32_16x16x32_bf16 v[56:59], a[120:123], v[184:187], v[56:59]
    ds_read_b64_tr_b16 v[180:181], v93 offset:2048
    ds_read_b64_tr_b16 v[182:183], v93 offset:2560
    v_mfma_f32_16x16x32_bf16 v[64:67], a[124:127], v[184:187], v[64:67]
    buffer_load_dwordx4 v95, s[8:11], s52 offen offset:1024 sc1 lds
    v_mfma_f32_16x16x32_bf16 v[60:63], a[120:123], v[188:191], v[60:63]
    ds_read_b64_tr_b16 v[184:185], v9 offset:4096
    ds_read_b64_tr_b16 v[186:187], v9 offset:4608
    v_mfma_f32_16x16x32_bf16 v[68:71], a[124:127], v[188:191], v[68:71]
    s_waitcnt lgkmcnt(6)
    v_mfma_f32_16x16x32_bf16 v[72:75], a[0:3], v[192:195], 0
    ds_read_b64_tr_b16 v[188:189], v93 offset:4096
    ds_read_b64_tr_b16 v[190:191], v93 offset:4608
    v_mfma_f32_16x16x32_bf16 v[80:83], a[4:7], v[192:195], 0
    buffer_load_dwordx4 v95, s[8:11], s52 offen offset:2048 sc1 lds
    v_mfma_f32_16x16x32_bf16 v[76:79], a[0:3], v[196:199], 0
    ds_read_b64_tr_b16 v[192:193], v9 offset:6144
    ds_read_b64_tr_b16 v[194:195], v9 offset:6656
    v_mfma_f32_16x16x32_bf16 v[84:87], a[4:7], v[196:199], 0
    s_waitcnt lgkmcnt(6)
    v_mfma_f32_16x16x32_bf16 v[72:75], a[8:11], v[176:179], v[72:75]
    ds_read_b64_tr_b16 v[196:197], v93 offset:6144
    ds_read_b64_tr_b16 v[198:199], v93 offset:6656
    v_mfma_f32_16x16x32_bf16 v[80:83], a[12:15], v[176:179], v[80:83]
    buffer_load_dwordx4 v95, s[8:11], s52 offen offset:3072 sc1 lds
    v_max_f32 v56, 0, v56
    v_max_f32 v57, 0, v57
    v_mfma_f32_16x16x32_bf16 v[76:79], a[8:11], v[180:183], v[76:79]
    ds_read_b64_tr_b16 v[176:177], v9 offset:8192
    ds_read_b64_tr_b16 v[178:179], v9 offset:8704
    v_mfma_f32_16x16x32_bf16 v[84:87], a[12:15], v[180:183], v[84:87]
    v_max_f32 v58, 0, v58
    v_max_f32 v59, 0, v59
    s_waitcnt lgkmcnt(6)
    v_mfma_f32_16x16x32_bf16 v[72:75], a[16:19], v[184:187], v[72:75]
    ds_read_b64_tr_b16 v[180:181], v93 offset:8192
    ds_read_b64_tr_b16 v[182:183], v93 offset:8704
    v_mfma_f32_16x16x32_bf16 v[80:83], a[20:23], v[184:187], v[80:83]
    s_waitcnt vmcnt(13)
    ds_read2st64_b32 v[88:89], v6 offset0:64 offset1:68
    v_max_f32 v60, 0, v60
    v_max_f32 v61, 0, v61
    v_mfma_f32_16x16x32_bf16 v[76:79], a[16:19], v[188:191], v[76:79]
    ds_read_b64_tr_b16 v[184:185], v9 offset:10240
    ds_read_b64_tr_b16 v[186:187], v9 offset:10752
    v_mfma_f32_16x16x32_bf16 v[84:87], a[20:23], v[188:191], v[84:87]
    v_max_f32 v62, 0, v62
    s_add_u32 m0, s49, 131072
    s_add_u32 s52, s48, 131072
    s_waitcnt lgkmcnt(7)
    v_mfma_f32_16x16x32_bf16 v[72:75], a[24:27], v[192:195], v[72:75]
    ds_read_b64_tr_b16 v[188:189], v93 offset:10240
    ds_read_b64_tr_b16 v[190:191], v93 offset:10752
    v_mfma_f32_16x16x32_bf16 v[80:83], a[28:31], v[192:195], v[80:83]
    buffer_load_dwordx4 v95, s[8:11], s52 offen offset:0 sc1 lds
    ds_read2st64_b32 v[90:91], v6 offset0:72 offset1:76
    v_max_f32 v63, 0, v63
    v_mul_f32 v56, v56, v64
    v_mfma_f32_16x16x32_bf16 v[76:79], a[24:27], v[196:199], v[76:79]
    ds_read_b64_tr_b16 v[192:193], v9 offset:12288
    ds_read_b64_tr_b16 v[194:195], v9 offset:12800
    v_mfma_f32_16x16x32_bf16 v[84:87], a[28:31], v[196:199], v[84:87]
    buffer_load_dwordx4 v95, s[8:11], s52 offen offset:1024 sc1 lds
    v_mul_f32 v57, v57, v65
    v_cvt_pk_bf16_f32 v108, v56, v57
    s_waitcnt lgkmcnt(8)
    v_mfma_f32_16x16x32_bf16 v[72:75], a[32:35], v[176:179], v[72:75]
    ds_read_b64_tr_b16 v[196:197], v93 offset:12288
    ds_read_b64_tr_b16 v[198:199], v93 offset:12800
    v_mfma_f32_16x16x32_bf16 v[80:83], a[36:39], v[176:179], v[80:83]
    v_mul_f32 v60, v60, v68
    v_mul_f32 v61, v61, v69
    v_mfma_f32_16x16x32_bf16 v[76:79], a[32:35], v[180:183], v[76:79]
    ds_read_b64_tr_b16 v[176:177], v9 offset:14336
    ds_read_b64_tr_b16 v[178:179], v9 offset:14848
    v_mfma_f32_16x16x32_bf16 v[84:87], a[36:39], v[180:183], v[84:87]
    buffer_load_dwordx4 v95, s[8:11], s52 offen offset:2048 sc1 lds
    s_waitcnt lgkmcnt(6)
    v_or3_b32 v88, v88, v89, v90
    v_mfma_f32_16x16x32_bf16 v[72:75], a[40:43], v[184:187], v[72:75]
    ds_read_b64_tr_b16 v[180:181], v93 offset:14336
    ds_read_b64_tr_b16 v[182:183], v93 offset:14848
    v_mfma_f32_16x16x32_bf16 v[80:83], a[44:47], v[184:187], v[80:83]
    v_bitop3_b32 v88, v88, v91, s40 bitop3:0xa8
    v_cmp_ne_u32 vcc, 0, v88
    v_cvt_pk_bf16_f32 v110, v60, v61
    v_mul_f32 v58, v58, v66
    v_mfma_f32_16x16x32_bf16 v[76:79], a[40:43], v[188:191], v[76:79]
    s_cbranch_vccnz cslow_98
cback_97:
    s_barrier
    v_mfma_f32_16x16x32_bf16 v[84:87], a[44:47], v[188:191], v[84:87]
    ds_read_b64_tr_b16 v[184:185], v9 offset:16384
    ds_read_b64_tr_b16 v[186:187], v9 offset:16896
    v_mul_f32 v59, v59, v67
    s_waitcnt lgkmcnt(6)
    v_mfma_f32_16x16x32_bf16 v[72:75], a[48:51], v[192:195], v[72:75]
    ds_read_b64_tr_b16 v[188:189], v93 offset:16384
    ds_read_b64_tr_b16 v[190:191], v93 offset:16896
    v_mfma_f32_16x16x32_bf16 v[80:83], a[52:55], v[192:195], v[80:83]
    buffer_load_dwordx4 v95, s[8:11], s52 offen offset:3072 sc1 lds
    v_cvt_pk_bf16_f32 v109, v58, v59
    s_add_u32 m0, s77, 0
    s_add_u32 s64, s72, 88064
    v_mfma_f32_16x16x32_bf16 v[76:79], a[48:51], v[196:199], v[76:79]
    ds_read_b64_tr_b16 v[192:193], v9 offset:18432
    ds_read_b64_tr_b16 v[194:195], v9 offset:18944
    v_mfma_f32_16x16x32_bf16 v[84:87], a[52:55], v[196:199], v[84:87]
    buffer_load_dwordx4 v39, s[56:59], s64 offen offset:0 sc1 lds
    v_mul_f32 v62, v62, v70
    v_mul_f32 v63, v63, v71
    s_waitcnt lgkmcnt(6)
    v_mfma_f32_16x16x32_bf16 v[72:75], a[56:59], v[176:179], v[72:75]
    ds_read_b64_tr_b16 v[196:197], v93 offset:18432
    ds_read_b64_tr_b16 v[198:199], v93 offset:18944
    v_mfma_f32_16x16x32_bf16 v[80:83], a[60:63], v[176:179], v[80:83]
    v_cvt_pk_bf16_f32 v111, v62, v63
    v_permlane16_swap_b32 v108, v110
    v_mfma_f32_16x16x32_bf16 v[76:79], a[56:59], v[180:183], v[76:79]
    ds_read_b64_tr_b16 v[176:177], v9 offset:20480
    ds_read_b64_tr_b16 v[178:179], v9 offset:20992
    v_mfma_f32_16x16x32_bf16 v[84:87], a[60:63], v[180:183], v[84:87]
    buffer_load_dwordx4 v39, s[56:59], s64 offen offset:2048 sc1 lds
    v_permlane16_swap_b32 v109, v111
    v_or_b32 v108, 1, v108
    s_waitcnt lgkmcnt(6)
    v_mfma_f32_16x16x32_bf16 v[72:75], a[64:67], v[184:187], v[72:75]
    ds_read_b64_tr_b16 v[180:181], v93 offset:20480
    ds_read_b64_tr_b16 v[182:183], v93 offset:20992
    v_mfma_f32_16x16x32_bf16 v[80:83], a[68:71], v[184:187], v[80:83]
    s_add_u32 s51, s47, 90112
    v_mfma_f32_16x16x32_bf16 v[76:79], a[64:67], v[188:191], v[76:79]
    ds_read_b64_tr_b16 v[184:185], v9 offset:22528
    ds_read_b64_tr_b16 v[186:187], v9 offset:23040
    v_mfma_f32_16x16x32_bf16 v[84:87], a[68:71], v[188:191], v[84:87]
    buffer_store_dwordx4 v[108:111], v5, s[12:15], s51 offen sc1
    s_waitcnt lgkmcnt(6)
    v_mfma_f32_16x16x32_bf16 v[72:75], a[72:75], v[192:195], v[72:75]
    ds_read_b64_tr_b16 v[188:189], v93 offset:22528
    ds_read_b64_tr_b16 v[190:191], v93 offset:23040
    v_mfma_f32_16x16x32_bf16 v[80:83], a[76:79], v[192:195], v[80:83]
    s_add_u32 m0, s77, 1024
    s_add_u32 s64, s72, 88192
    v_mfma_f32_16x16x32_bf16 v[76:79], a[72:75], v[196:199], v[76:79]
    ds_read_b64_tr_b16 v[192:193], v9 offset:24576
    ds_read_b64_tr_b16 v[194:195], v9 offset:25088
    v_mfma_f32_16x16x32_bf16 v[84:87], a[76:79], v[196:199], v[84:87]
    buffer_load_dwordx4 v39, s[56:59], s64 offen offset:0 sc1 lds
    s_waitcnt lgkmcnt(6)
    v_mfma_f32_16x16x32_bf16 v[72:75], a[80:83], v[176:179], v[72:75]
    ds_read_b64_tr_b16 v[196:197], v93 offset:24576
    ds_read_b64_tr_b16 v[198:199], v93 offset:25088
    v_mfma_f32_16x16x32_bf16 v[80:83], a[84:87], v[176:179], v[80:83]
    s_waitcnt vmcnt(12)
    ds_read2st64_b32 v[88:89], v6 offset0:128 offset1:132
    v_mfma_f32_16x16x32_bf16 v[76:79], a[80:83], v[180:183], v[76:79]
    ds_read_b64_tr_b16 v[176:177], v9 offset:26624
    ds_read_b64_tr_b16 v[178:179], v9 offset:27136
    v_mfma_f32_16x16x32_bf16 v[84:87], a[84:87], v[180:183], v[84:87]
    buffer_load_dwordx4 v39, s[56:59], s64 offen offset:2048 sc1 lds
    s_waitcnt lgkmcnt(7)
    v_mfma_f32_16x16x32_bf16 v[72:75], a[88:91], v[184:187], v[72:75]
    ds_read_b64_tr_b16 v[180:181], v93 offset:26624
    ds_read_b64_tr_b16 v[182:183], v93 offset:27136
    v_mfma_f32_16x16x32_bf16 v[80:83], a[92:95], v[184:187], v[80:83]
    ds_read2st64_b32 v[90:91], v6 offset0:136 offset1:140
    s_add_u32 m0, s77, 4096
    s_add_u32 s64, s72, 92160
    v_mfma_f32_16x16x32_bf16 v[76:79], a[88:91], v[188:191], v[76:79]
    ds_read_b64_tr_b16 v[184:185], v9 offset:28672
    ds_read_b64_tr_b16 v[186:187], v9 offset:29184
    v_mfma_f32_16x16x32_bf16 v[84:87], a[92:95], v[188:191], v[84:87]
    buffer_load_dwordx4 v39, s[56:59], s64 offen offset:0 sc1 lds
    s_waitcnt lgkmcnt(8)
    v_mfma_f32_16x16x32_bf16 v[72:75], a[96:99], v[192:195], v[72:75]
    ds_read_b64_tr_b16 v[188:189], v93 offset:28672
    ds_read_b64_tr_b16 v[190:191], v93 offset:29184
    v_mfma_f32_16x16x32_bf16 v[80:83], a[100:103], v[192:195], v[80:83]
    v_mfma_f32_16x16x32_bf16 v[76:79], a[96:99], v[196:199], v[76:79]
    ds_read_b64_tr_b16 v[192:193], v9 offset:30720
    ds_read_b64_tr_b16 v[194:195], v9 offset:31232
    v_mfma_f32_16x16x32_bf16 v[84:87], a[100:103], v[196:199], v[84:87]
    buffer_load_dwordx4 v39, s[56:59], s64 offen offset:2048 sc1 lds
    s_waitcnt lgkmcnt(6)
    v_or3_b32 v88, v88, v89, v90
    v_mfma_f32_16x16x32_bf16 v[72:75], a[104:107], v[176:179], v[72:75]
    ds_read_b64_tr_b16 v[196:197], v93 offset:30720
    ds_read_b64_tr_b16 v[198:199], v93 offset:31232
    v_mfma_f32_16x16x32_bf16 v[80:83], a[108:111], v[176:179], v[80:83]
    v_bitop3_b32 v88, v88, v91, s40 bitop3:0xa8
    v_cmp_ne_u32 vcc, 0, v88
    v_mfma_f32_16x16x32_bf16 v[76:79], a[104:107], v[180:183], v[76:79]
    s_cbranch_vccnz cslow_100
cback_99:
    s_barrier
    v_mfma_f32_16x16x32_bf16 v[84:87], a[108:111], v[180:183], v[84:87]
    ds_read_b64_tr_b16 v[176:177], v9 offset:32768
    ds_read_b64_tr_b16 v[178:179], v9 offset:33280
    s_waitcnt lgkmcnt(6)
    v_mfma_f32_16x16x32_bf16 v[72:75], a[112:115], v[184:187], v[72:75]
    ds_read_b64_tr_b16 v[180:181], v93 offset:32768
    ds_read_b64_tr_b16 v[182:183], v93 offset:33280
    v_mfma_f32_16x16x32_bf16 v[80:83], a[116:119], v[184:187], v[80:83]
    s_add_u32 m0, s77, 5120
    s_add_u32 s64, s72, 92288
    v_mfma_f32_16x16x32_bf16 v[76:79], a[112:115], v[188:191], v[76:79]
    ds_read_b64_tr_b16 v[184:185], v9 offset:34816
    ds_read_b64_tr_b16 v[186:187], v9 offset:35328
    v_mfma_f32_16x16x32_bf16 v[84:87], a[116:119], v[188:191], v[84:87]
    buffer_load_dwordx4 v39, s[56:59], s64 offen offset:0 sc1 lds
    s_waitcnt lgkmcnt(6)
    v_mfma_f32_16x16x32_bf16 v[72:75], a[120:123], v[192:195], v[72:75]
    ds_read_b64_tr_b16 v[188:189], v93 offset:34816
    ds_read_b64_tr_b16 v[190:191], v93 offset:35328
    v_mfma_f32_16x16x32_bf16 v[80:83], a[124:127], v[192:195], v[80:83]
    buffer_load_dwordx4 v39, s[56:59], s64 offen offset:2048 sc1 lds
    v_mfma_f32_16x16x32_bf16 v[76:79], a[120:123], v[196:199], v[76:79]
    ds_read_b64_tr_b16 v[192:193], v9 offset:36864
    ds_read_b64_tr_b16 v[194:195], v9 offset:37376
    v_mfma_f32_16x16x32_bf16 v[84:87], a[124:127], v[196:199], v[84:87]
    s_add_u32 m0, s49, 147456
    s_add_u32 s52, s48, 147456
    s_waitcnt lgkmcnt(6)
    v_mfma_f32_16x16x32_bf16 v[40:43], a[0:3], v[176:179], 0
    ds_read_b64_tr_b16 v[196:197], v93 offset:36864
    ds_read_b64_tr_b16 v[198:199], v93 offset:37376
    v_mfma_f32_16x16x32_bf16 v[48:51], a[4:7], v[176:179], 0
    buffer_load_dwordx4 v95, s[8:11], s52 offen offset:0 sc1 lds
    v_mfma_f32_16x16x32_bf16 v[44:47], a[0:3], v[180:183], 0
    ds_read_b64_tr_b16 v[176:177], v9 offset:38912
    ds_read_b64_tr_b16 v[178:179], v9 offset:39424
    v_mfma_f32_16x16x32_bf16 v[52:55], a[4:7], v[180:183], 0
    s_waitcnt lgkmcnt(6)
    v_mfma_f32_16x16x32_bf16 v[40:43], a[8:11], v[184:187], v[40:43]
    ds_read_b64_tr_b16 v[180:181], v93 offset:38912
    ds_read_b64_tr_b16 v[182:183], v93 offset:39424
    v_mfma_f32_16x16x32_bf16 v[48:51], a[12:15], v[184:187], v[48:51]
    buffer_load_dwordx4 v95, s[8:11], s52 offen offset:1024 sc1 lds
    v_max_f32 v72, 0, v72
    v_max_f32 v73, 0, v73
    v_mfma_f32_16x16x32_bf16 v[44:47], a[8:11], v[188:191], v[44:47]
    ds_read_b64_tr_b16 v[184:185], v9 offset:40960
    ds_read_b64_tr_b16 v[186:187], v9 offset:41472
    v_mfma_f32_16x16x32_bf16 v[52:55], a[12:15], v[188:191], v[52:55]
    v_max_f32 v74, 0, v74
    v_max_f32 v75, 0, v75
    s_waitcnt lgkmcnt(6)
    v_mfma_f32_16x16x32_bf16 v[40:43], a[16:19], v[192:195], v[40:43]
    ds_read_b64_tr_b16 v[188:189], v93 offset:40960
    ds_read_b64_tr_b16 v[190:191], v93 offset:41472
    v_mfma_f32_16x16x32_bf16 v[48:51], a[20:23], v[192:195], v[48:51]
    s_waitcnt vmcnt(15)
    ds_read2st64_b32 v[88:89], v6 offset0:192 offset1:196
    v_max_f32 v76, 0, v76
    v_max_f32 v77, 0, v77
    v_mfma_f32_16x16x32_bf16 v[44:47], a[16:19], v[196:199], v[44:47]
    ds_read_b64_tr_b16 v[192:193], v9 offset:43008
    ds_read_b64_tr_b16 v[194:195], v9 offset:43520
    v_mfma_f32_16x16x32_bf16 v[52:55], a[20:23], v[196:199], v[52:55]
    buffer_load_dwordx4 v95, s[8:11], s52 offen offset:2048 sc1 lds
    v_max_f32 v78, 0, v78
    v_max_f32 v79, 0, v79
    s_waitcnt lgkmcnt(7)
    v_mfma_f32_16x16x32_bf16 v[40:43], a[24:27], v[176:179], v[40:43]
    ds_read_b64_tr_b16 v[196:197], v93 offset:43008
    ds_read_b64_tr_b16 v[198:199], v93 offset:43520
    v_mfma_f32_16x16x32_bf16 v[48:51], a[28:31], v[176:179], v[48:51]
    buffer_load_dwordx4 v95, s[8:11], s52 offen offset:3072 sc1 lds
    ds_read2st64_b32 v[90:91], v6 offset0:200 offset1:204
    v_mul_f32 v72, v72, v80
    v_mul_f32 v73, v73, v81
    v_mfma_f32_16x16x32_bf16 v[44:47], a[24:27], v[180:183], v[44:47]
    ds_read_b64_tr_b16 v[176:177], v9 offset:45056
    ds_read_b64_tr_b16 v[178:179], v9 offset:45568
    v_mfma_f32_16x16x32_bf16 v[52:55], a[28:31], v[180:183], v[52:55]
    v_cvt_pk_bf16_f32 v104, v72, v73
    s_add_u32 m0, s67, 0
    s_add_u32 s83, s65, 0
    s_waitcnt lgkmcnt(8)
    v_mfma_f32_16x16x32_bf16 v[40:43], a[32:35], v[184:187], v[40:43]
    ds_read_b64_tr_b16 v[180:181], v93 offset:45056
    ds_read_b64_tr_b16 v[182:183], v93 offset:45568
    v_mfma_f32_16x16x32_bf16 v[48:51], a[36:39], v[184:187], v[48:51]
    buffer_load_dwordx4 v2, s[8:11], s83 offen offset:0 sc1 lds
    v_mul_f32 v76, v76, v84
    v_mul_f32 v77, v77, v85
    v_mfma_f32_16x16x32_bf16 v[44:47], a[32:35], v[188:191], v[44:47]
    ds_read_b64_tr_b16 v[184:185], v9 offset:47104
    ds_read_b64_tr_b16 v[186:187], v9 offset:47616
    v_mfma_f32_16x16x32_bf16 v[52:55], a[36:39], v[188:191], v[52:55]
    s_waitcnt lgkmcnt(6)
    v_or3_b32 v88, v88, v89, v90
    v_cvt_pk_bf16_f32 v106, v76, v77
    v_mfma_f32_16x16x32_bf16 v[40:43], a[40:43], v[192:195], v[40:43]
    ds_read_b64_tr_b16 v[188:189], v93 offset:47104
    ds_read_b64_tr_b16 v[190:191], v93 offset:47616
    v_mfma_f32_16x16x32_bf16 v[48:51], a[44:47], v[192:195], v[48:51]
    v_bitop3_b32 v88, v88, v91, s40 bitop3:0xa8
    v_cmp_ne_u32 vcc, 0, v88
    v_mul_f32 v74, v74, v82
    v_mul_f32 v75, v75, v83
    v_mfma_f32_16x16x32_bf16 v[44:47], a[40:43], v[196:199], v[44:47]
    s_cbranch_vccnz cslow_102
cback_101:
    s_barrier
    v_mfma_f32_16x16x32_bf16 v[52:55], a[44:47], v[196:199], v[52:55]
    ds_read_b64_tr_b16 v[192:193], v9 offset:49152
    ds_read_b64_tr_b16 v[194:195], v9 offset:49664
    v_cvt_pk_bf16_f32 v105, v74, v75
    s_waitcnt lgkmcnt(6)
    v_mfma_f32_16x16x32_bf16 v[40:43], a[48:51], v[176:179], v[40:43]
    ds_read_b64_tr_b16 v[196:197], v93 offset:49152
    ds_read_b64_tr_b16 v[198:199], v93 offset:49664
    v_mfma_f32_16x16x32_bf16 v[48:51], a[52:55], v[176:179], v[48:51]
    buffer_load_dwordx4 v2, s[8:11], s83 offen offset:1024 sc1 lds
    v_mul_f32 v78, v78, v86
    v_mul_f32 v79, v79, v87
    v_mfma_f32_16x16x32_bf16 v[44:47], a[48:51], v[180:183], v[44:47]
    ds_read_b64_tr_b16 v[176:177], v9 offset:51200
    ds_read_b64_tr_b16 v[178:179], v9 offset:51712
    v_mfma_f32_16x16x32_bf16 v[52:55], a[52:55], v[180:183], v[52:55]
    buffer_load_dwordx4 v2, s[8:11], s83 offen offset:2048 sc1 lds
    v_cvt_pk_bf16_f32 v107, v78, v79
    v_permlane16_swap_b32 v104, v106
    s_waitcnt lgkmcnt(6)
    v_mfma_f32_16x16x32_bf16 v[40:43], a[56:59], v[184:187], v[40:43]
    ds_read_b64_tr_b16 v[180:181], v93 offset:51200
    ds_read_b64_tr_b16 v[182:183], v93 offset:51712
    v_mfma_f32_16x16x32_bf16 v[48:51], a[60:63], v[184:187], v[48:51]
    v_permlane16_swap_b32 v105, v107
    v_or_b32 v104, 1, v104
    v_mfma_f32_16x16x32_bf16 v[44:47], a[56:59], v[188:191], v[44:47]
    ds_read_b64_tr_b16 v[184:185], v9 offset:53248
    ds_read_b64_tr_b16 v[186:187], v9 offset:53760
    v_mfma_f32_16x16x32_bf16 v[52:55], a[60:63], v[188:191], v[52:55]
    buffer_load_dwordx4 v2, s[8:11], s83 offen offset:3072 sc1 lds
    s_add_u32 s51, s47, 180224
    s_waitcnt lgkmcnt(6)
    v_mfma_f32_16x16x32_bf16 v[40:43], a[64:67], v[192:195], v[40:43]
    ds_read_b64_tr_b16 v[188:189], v93 offset:53248
    ds_read_b64_tr_b16 v[190:191], v93 offset:53760
    v_mfma_f32_16x16x32_bf16 v[48:51], a[68:71], v[192:195], v[48:51]
    buffer_store_dwordx4 v[104:107], v5, s[12:15], s51 offen sc1
    v_mfma_f32_16x16x32_bf16 v[44:47], a[64:67], v[196:199], v[44:47]
    ds_read_b64_tr_b16 v[192:193], v9 offset:55296
    ds_read_b64_tr_b16 v[194:195], v9 offset:55808
    v_mfma_f32_16x16x32_bf16 v[52:55], a[68:71], v[196:199], v[52:55]
    s_add_u32 m0, s49, 0
    s_add_u32 s52, s48, 163840
    s_waitcnt lgkmcnt(6)
    v_mfma_f32_16x16x32_bf16 v[40:43], a[72:75], v[176:179], v[40:43]
    ds_read_b64_tr_b16 v[196:197], v93 offset:55296
    ds_read_b64_tr_b16 v[198:199], v93 offset:55808
    v_mfma_f32_16x16x32_bf16 v[48:51], a[76:79], v[176:179], v[48:51]
    buffer_load_dwordx4 v95, s[8:11], s52 offen offset:0 sc1 lds
    v_mfma_f32_16x16x32_bf16 v[44:47], a[72:75], v[180:183], v[44:47]
    ds_read_b64_tr_b16 v[176:177], v9 offset:57344
    ds_read_b64_tr_b16 v[178:179], v9 offset:57856
    v_mfma_f32_16x16x32_bf16 v[52:55], a[76:79], v[180:183], v[52:55]
    s_waitcnt lgkmcnt(6)
    v_mfma_f32_16x16x32_bf16 v[40:43], a[80:83], v[184:187], v[40:43]
    ds_read_b64_tr_b16 v[180:181], v93 offset:57344
    ds_read_b64_tr_b16 v[182:183], v93 offset:57856
    v_mfma_f32_16x16x32_bf16 v[48:51], a[84:87], v[184:187], v[48:51]
    s_waitcnt vmcnt(19)
    ds_read2st64_b32 v[88:89], v7 offset0:0 offset1:4
    v_mfma_f32_16x16x32_bf16 v[44:47], a[80:83], v[188:191], v[44:47]
    ds_read_b64_tr_b16 v[184:185], v9 offset:59392
    ds_read_b64_tr_b16 v[186:187], v9 offset:59904
    v_mfma_f32_16x16x32_bf16 v[52:55], a[84:87], v[188:191], v[52:55]
    buffer_load_dwordx4 v95, s[8:11], s52 offen offset:1024 sc1 lds
    s_waitcnt lgkmcnt(7)
    v_mfma_f32_16x16x32_bf16 v[40:43], a[88:91], v[192:195], v[40:43]
    ds_read_b64_tr_b16 v[188:189], v93 offset:59392
    ds_read_b64_tr_b16 v[190:191], v93 offset:59904
    v_mfma_f32_16x16x32_bf16 v[48:51], a[92:95], v[192:195], v[48:51]
    buffer_load_dwordx4 v95, s[8:11], s52 offen offset:2048 sc1 lds
    ds_read2st64_b32 v[90:91], v7 offset0:8 offset1:12
    v_mfma_f32_16x16x32_bf16 v[44:47], a[88:91], v[196:199], v[44:47]
    ds_read_b64_tr_b16 v[192:193], v9 offset:61440
    ds_read_b64_tr_b16 v[194:195], v9 offset:61952
    v_mfma_f32_16x16x32_bf16 v[52:55], a[92:95], v[196:199], v[52:55]
    s_waitcnt lgkmcnt(8)
    v_mfma_f32_16x16x32_bf16 v[40:43], a[96:99], v[176:179], v[40:43]
    ds_read_b64_tr_b16 v[196:197], v93 offset:61440
    ds_read_b64_tr_b16 v[198:199], v93 offset:61952
    v_mfma_f32_16x16x32_bf16 v[48:51], a[100:103], v[176:179], v[48:51]
    buffer_load_dwordx4 v95, s[8:11], s52 offen offset:3072 sc1 lds
    v_mfma_f32_16x16x32_bf16 v[44:47], a[96:99], v[180:183], v[44:47]
    ds_read_b64_tr_b16 v[176:177], v9 offset:63488
    ds_read_b64_tr_b16 v[178:179], v9 offset:64000
    v_mfma_f32_16x16x32_bf16 v[52:55], a[100:103], v[180:183], v[52:55]
    s_waitcnt lgkmcnt(6)
    v_or3_b32 v88, v88, v89, v90
    v_mfma_f32_16x16x32_bf16 v[40:43], a[104:107], v[184:187], v[40:43]
    ds_read_b64_tr_b16 v[180:181], v93 offset:63488
    ds_read_b64_tr_b16 v[182:183], v93 offset:64000
    v_mfma_f32_16x16x32_bf16 v[48:51], a[108:111], v[184:187], v[48:51]
    v_bitop3_b32 v88, v88, v91, s73 bitop3:0xa8
    v_cmp_ne_u32 vcc, 0, v88
    v_mfma_f32_16x16x32_bf16 v[44:47], a[104:107], v[188:191], v[44:47]
    s_cbranch_vccnz cslow_104
cback_103:
    s_barrier
    v_mfma_f32_16x16x32_bf16 v[52:55], a[108:111], v[188:191], v[52:55]
    ds_read_b64_tr_b16 v[184:185], v10 offset:0
    ds_read_b64_tr_b16 v[186:187], v10 offset:512
    s_waitcnt lgkmcnt(6)
    v_mfma_f32_16x16x32_bf16 v[40:43], a[112:115], v[192:195], v[40:43]
    ds_read_b64_tr_b16 v[188:189], v94 offset:0
    ds_read_b64_tr_b16 v[190:191], v94 offset:512
    v_mfma_f32_16x16x32_bf16 v[48:51], a[116:119], v[192:195], v[48:51]
    s_add_u32 m0, s67, 16384
    s_add_u32 s83, s65, 4096
    v_mfma_f32_16x16x32_bf16 v[44:47], a[112:115], v[196:199], v[44:47]
    ds_read_b64_tr_b16 v[192:193], v10 offset:2048
    ds_read_b64_tr_b16 v[194:195], v10 offset:2560
    v_mfma_f32_16x16x32_bf16 v[52:55], a[116:119], v[196:199], v[52:55]
    buffer_load_dwordx4 v2, s[8:11], s83 offen offset:0 sc1 lds
    s_waitcnt lgkmcnt(6)
    v_mfma_f32_16x16x32_bf16 v[40:43], a[120:123], v[176:179], v[40:43]
    ds_read_b64_tr_b16 v[196:197], v94 offset:2048
    ds_read_b64_tr_b16 v[198:199], v94 offset:2560
    v_mfma_f32_16x16x32_bf16 v[48:51], a[124:127], v[176:179], v[48:51]
    buffer_load_dwordx4 v2, s[8:11], s83 offen offset:1024 sc1 lds
    v_mfma_f32_16x16x32_bf16 v[44:47], a[120:123], v[180:183], v[44:47]
    ds_read_b64_tr_b16 v[176:177], v10 offset:4096
    ds_read_b64_tr_b16 v[178:179], v10 offset:4608
    v_mfma_f32_16x16x32_bf16 v[52:55], a[124:127], v[180:183], v[52:55]
    s_waitcnt lgkmcnt(6)
    v_mfma_f32_16x16x32_bf16 v[56:59], a[0:3], v[184:187], 0
    ds_read_b64_tr_b16 v[180:181], v94 offset:4096
    ds_read_b64_tr_b16 v[182:183], v94 offset:4608
    v_mfma_f32_16x16x32_bf16 v[64:67], a[4:7], v[184:187], 0
    buffer_load_dwordx4 v2, s[8:11], s83 offen offset:2048 sc1 lds
    v_mfma_f32_16x16x32_bf16 v[60:63], a[0:3], v[188:191], 0
    ds_read_b64_tr_b16 v[184:185], v10 offset:6144
    ds_read_b64_tr_b16 v[186:187], v10 offset:6656
    v_mfma_f32_16x16x32_bf16 v[68:71], a[4:7], v[188:191], 0
    s_waitcnt lgkmcnt(6)
    v_mfma_f32_16x16x32_bf16 v[56:59], a[8:11], v[192:195], v[56:59]
    ds_read_b64_tr_b16 v[188:189], v94 offset:6144
    ds_read_b64_tr_b16 v[190:191], v94 offset:6656
    v_mfma_f32_16x16x32_bf16 v[64:67], a[12:15], v[192:195], v[64:67]
    buffer_load_dwordx4 v2, s[8:11], s83 offen offset:3072 sc1 lds
    v_max_f32 v40, 0, v40
    v_max_f32 v41, 0, v41
    v_mfma_f32_16x16x32_bf16 v[60:63], a[8:11], v[196:199], v[60:63]
    ds_read_b64_tr_b16 v[192:193], v10 offset:8192
    ds_read_b64_tr_b16 v[194:195], v10 offset:8704
    v_mfma_f32_16x16x32_bf16 v[68:71], a[12:15], v[196:199], v[68:71]
    v_max_f32 v42, 0, v42
    v_max_f32 v43, 0, v43
    s_waitcnt lgkmcnt(6)
    v_mfma_f32_16x16x32_bf16 v[56:59], a[16:19], v[176:179], v[56:59]
    ds_read_b64_tr_b16 v[196:197], v94 offset:8192
    ds_read_b64_tr_b16 v[198:199], v94 offset:8704
    v_mfma_f32_16x16x32_bf16 v[64:67], a[20:23], v[176:179], v[64:67]
    s_waitcnt vmcnt(13)
    ds_read2st64_b32 v[88:89], v7 offset0:64 offset1:68
    v_max_f32 v44, 0, v44
    v_max_f32 v45, 0, v45
    v_mfma_f32_16x16x32_bf16 v[60:63], a[16:19], v[180:183], v[60:63]
    ds_read_b64_tr_b16 v[176:177], v10 offset:10240
    ds_read_b64_tr_b16 v[178:179], v10 offset:10752
    v_mfma_f32_16x16x32_bf16 v[68:71], a[20:23], v[180:183], v[68:71]
    v_max_f32 v46, 0, v46
    s_add_u32 m0, s49, 16384
    s_add_u32 s52, s48, 180224
    s_waitcnt lgkmcnt(7)
    v_mfma_f32_16x16x32_bf16 v[56:59], a[24:27], v[184:187], v[56:59]
    ds_read_b64_tr_b16 v[180:181], v94 offset:10240
    ds_read_b64_tr_b16 v[182:183], v94 offset:10752
    v_mfma_f32_16x16x32_bf16 v[64:67], a[28:31], v[184:187], v[64:67]
    buffer_load_dwordx4 v95, s[8:11], s52 offen offset:0 sc1 lds
    ds_read2st64_b32 v[90:91], v7 offset0:72 offset1:76
    v_max_f32 v47, 0, v47
    v_mul_f32 v40, v40, v48
    v_mfma_f32_16x16x32_bf16 v[60:63], a[24:27], v[188:191], v[60:63]
    ds_read_b64_tr_b16 v[184:185], v10 offset:12288
    ds_read_b64_tr_b16 v[186:187], v10 offset:12800
    v_mfma_f32_16x16x32_bf16 v[68:71], a[28:31], v[188:191], v[68:71]
    buffer_load_dwordx4 v95, s[8:11], s52 offen offset:1024 sc1 lds
    v_mul_f32 v41, v41, v49
    v_cvt_pk_bf16_f32 v108, v40, v41
    s_waitcnt lgkmcnt(8)
    v_mfma_f32_16x16x32_bf16 v[56:59], a[32:35], v[192:195], v[56:59]
    ds_read_b64_tr_b16 v[188:189], v94 offset:12288
    ds_read_b64_tr_b16 v[190:191], v94 offset:12800
    v_mfma_f32_16x16x32_bf16 v[64:67], a[36:39], v[192:195], v[64:67]
    v_mul_f32 v44, v44, v52
    v_mul_f32 v45, v45, v53
    v_mfma_f32_16x16x32_bf16 v[60:63], a[32:35], v[196:199], v[60:63]
    ds_read_b64_tr_b16 v[192:193], v10 offset:14336
    ds_read_b64_tr_b16 v[194:195], v10 offset:14848
    v_mfma_f32_16x16x32_bf16 v[68:71], a[36:39], v[196:199], v[68:71]
    buffer_load_dwordx4 v95, s[8:11], s52 offen offset:2048 sc1 lds
    s_waitcnt lgkmcnt(6)
    v_or3_b32 v88, v88, v89, v90
    v_mfma_f32_16x16x32_bf16 v[56:59], a[40:43], v[176:179], v[56:59]
    ds_read_b64_tr_b16 v[196:197], v94 offset:14336
    ds_read_b64_tr_b16 v[198:199], v94 offset:14848
    v_mfma_f32_16x16x32_bf16 v[64:67], a[44:47], v[176:179], v[64:67]
    v_bitop3_b32 v88, v88, v91, s73 bitop3:0xa8
    v_cmp_ne_u32 vcc, 0, v88
    v_cvt_pk_bf16_f32 v110, v44, v45
    v_mul_f32 v42, v42, v50
    v_mfma_f32_16x16x32_bf16 v[60:63], a[40:43], v[180:183], v[60:63]
    s_cbranch_vccnz cslow_106
cback_105:
    s_barrier
    v_mfma_f32_16x16x32_bf16 v[68:71], a[44:47], v[180:183], v[68:71]
    ds_read_b64_tr_b16 v[176:177], v10 offset:16384
    ds_read_b64_tr_b16 v[178:179], v10 offset:16896
    v_mul_f32 v43, v43, v51
    s_waitcnt lgkmcnt(6)
    v_mfma_f32_16x16x32_bf16 v[56:59], a[48:51], v[184:187], v[56:59]
    ds_read_b64_tr_b16 v[180:181], v94 offset:16384
    ds_read_b64_tr_b16 v[182:183], v94 offset:16896
    v_mfma_f32_16x16x32_bf16 v[64:67], a[52:55], v[184:187], v[64:67]
    buffer_load_dwordx4 v95, s[8:11], s52 offen offset:3072 sc1 lds
    v_cvt_pk_bf16_f32 v109, v42, v43
    s_add_u32 m0, s67, 32768
    s_add_u32 s83, s66, 0
    v_mfma_f32_16x16x32_bf16 v[60:63], a[48:51], v[188:191], v[60:63]
    ds_read_b64_tr_b16 v[184:185], v10 offset:18432
    ds_read_b64_tr_b16 v[186:187], v10 offset:18944
    v_mfma_f32_16x16x32_bf16 v[68:71], a[52:55], v[188:191], v[68:71]
    buffer_load_dwordx4 v2, s[8:11], s83 offen offset:0 sc1 lds
    v_mul_f32 v46, v46, v54
    v_mul_f32 v47, v47, v55
    s_waitcnt lgkmcnt(6)
    v_mfma_f32_16x16x32_bf16 v[56:59], a[56:59], v[192:195], v[56:59]
    ds_read_b64_tr_b16 v[188:189], v94 offset:18432
    ds_read_b64_tr_b16 v[190:191], v94 offset:18944
    v_mfma_f32_16x16x32_bf16 v[64:67], a[60:63], v[192:195], v[64:67]
    v_cvt_pk_bf16_f32 v111, v46, v47
    v_permlane16_swap_b32 v108, v110
    v_mfma_f32_16x16x32_bf16 v[60:63], a[56:59], v[196:199], v[60:63]
    ds_read_b64_tr_b16 v[192:193], v10 offset:20480
    ds_read_b64_tr_b16 v[194:195], v10 offset:20992
    v_mfma_f32_16x16x32_bf16 v[68:71], a[60:63], v[196:199], v[68:71]
    buffer_load_dwordx4 v2, s[8:11], s83 offen offset:1024 sc1 lds
    v_permlane16_swap_b32 v109, v111
    v_or_b32 v108, 1, v108
    s_waitcnt lgkmcnt(6)
    v_mfma_f32_16x16x32_bf16 v[56:59], a[64:67], v[176:179], v[56:59]
    ds_read_b64_tr_b16 v[196:197], v94 offset:20480
    ds_read_b64_tr_b16 v[198:199], v94 offset:20992
    v_mfma_f32_16x16x32_bf16 v[64:67], a[68:71], v[176:179], v[64:67]
    s_add_u32 s51, s47, 270336
    v_mfma_f32_16x16x32_bf16 v[60:63], a[64:67], v[180:183], v[60:63]
    ds_read_b64_tr_b16 v[176:177], v10 offset:22528
    ds_read_b64_tr_b16 v[178:179], v10 offset:23040
    v_mfma_f32_16x16x32_bf16 v[68:71], a[68:71], v[180:183], v[68:71]
    buffer_store_dwordx4 v[108:111], v5, s[12:15], s51 offen sc1
    s_waitcnt lgkmcnt(6)
    v_mfma_f32_16x16x32_bf16 v[56:59], a[72:75], v[184:187], v[56:59]
    ds_read_b64_tr_b16 v[180:181], v94 offset:22528
    ds_read_b64_tr_b16 v[182:183], v94 offset:23040
    v_mfma_f32_16x16x32_bf16 v[64:67], a[76:79], v[184:187], v[64:67]
    v_mfma_f32_16x16x32_bf16 v[60:63], a[72:75], v[188:191], v[60:63]
    ds_read_b64_tr_b16 v[184:185], v10 offset:24576
    ds_read_b64_tr_b16 v[186:187], v10 offset:25088
    v_mfma_f32_16x16x32_bf16 v[68:71], a[76:79], v[188:191], v[68:71]
    buffer_load_dwordx4 v2, s[8:11], s83 offen offset:2048 sc1 lds
    s_waitcnt lgkmcnt(6)
    v_mfma_f32_16x16x32_bf16 v[56:59], a[80:83], v[192:195], v[56:59]
    ds_read_b64_tr_b16 v[188:189], v94 offset:24576
    ds_read_b64_tr_b16 v[190:191], v94 offset:25088
    v_mfma_f32_16x16x32_bf16 v[64:67], a[84:87], v[192:195], v[64:67]
    s_waitcnt vmcnt(12)
    ds_read2st64_b32 v[88:89], v3 offset0:0 offset1:4
    v_mfma_f32_16x16x32_bf16 v[60:63], a[80:83], v[196:199], v[60:63]
    ds_read_b64_tr_b16 v[192:193], v10 offset:26624
    ds_read_b64_tr_b16 v[194:195], v10 offset:27136
    v_mfma_f32_16x16x32_bf16 v[68:71], a[84:87], v[196:199], v[68:71]
    buffer_load_dwordx4 v2, s[8:11], s83 offen offset:3072 sc1 lds
    s_waitcnt lgkmcnt(7)
    v_mfma_f32_16x16x32_bf16 v[56:59], a[88:91], v[176:179], v[56:59]
    ds_read_b64_tr_b16 v[196:197], v94 offset:26624
    ds_read_b64_tr_b16 v[198:199], v94 offset:27136
    v_mfma_f32_16x16x32_bf16 v[64:67], a[92:95], v[176:179], v[64:67]
    ds_read2st64_b32 v[90:91], v3 offset0:8 offset1:12
    s_add_u32 m0, s67, 49152
    s_add_u32 s83, s66, 4096
    v_mfma_f32_16x16x32_bf16 v[60:63], a[88:91], v[180:183], v[60:63]
    ds_read_b64_tr_b16 v[176:177], v10 offset:28672
    ds_read_b64_tr_b16 v[178:179], v10 offset:29184
    v_mfma_f32_16x16x32_bf16 v[68:71], a[92:95], v[180:183], v[68:71]
    buffer_load_dwordx4 v2, s[8:11], s83 offen offset:0 sc1 lds
    s_waitcnt lgkmcnt(8)
    v_mfma_f32_16x16x32_bf16 v[56:59], a[96:99], v[184:187], v[56:59]
    ds_read_b64_tr_b16 v[180:181], v94 offset:28672
    ds_read_b64_tr_b16 v[182:183], v94 offset:29184
    v_mfma_f32_16x16x32_bf16 v[64:67], a[100:103], v[184:187], v[64:67]
    v_mfma_f32_16x16x32_bf16 v[60:63], a[96:99], v[188:191], v[60:63]
    ds_read_b64_tr_b16 v[184:185], v10 offset:30720
    ds_read_b64_tr_b16 v[186:187], v10 offset:31232
    v_mfma_f32_16x16x32_bf16 v[68:71], a[100:103], v[188:191], v[68:71]
    buffer_load_dwordx4 v2, s[8:11], s83 offen offset:1024 sc1 lds
    s_waitcnt lgkmcnt(6)
    v_or3_b32 v88, v88, v89, v90
    v_mfma_f32_16x16x32_bf16 v[56:59], a[104:107], v[192:195], v[56:59]
    ds_read_b64_tr_b16 v[188:189], v94 offset:30720
    ds_read_b64_tr_b16 v[190:191], v94 offset:31232
    v_mfma_f32_16x16x32_bf16 v[64:67], a[108:111], v[192:195], v[64:67]
    v_bitop3_b32 v88, v88, v91, s73 bitop3:0xa8
    v_cmp_ne_u32 vcc, 0, v88
    v_mfma_f32_16x16x32_bf16 v[60:63], a[104:107], v[196:199], v[60:63]
    s_cbranch_vccnz cslow_108
cback_107:
    s_barrier
    v_mfma_f32_16x16x32_bf16 v[68:71], a[108:111], v[196:199], v[68:71]
    ds_read_b64_tr_b16 v[192:193], v8 offset:0
    ds_read_b64_tr_b16 v[194:195], v8 offset:512
    s_waitcnt lgkmcnt(6)
    v_mfma_f32_16x16x32_bf16 v[56:59], a[112:115], v[176:179], v[56:59]
    ds_read_b64_tr_b16 v[196:197], v92 offset:0
    ds_read_b64_tr_b16 v[198:199], v92 offset:512
    v_mfma_f32_16x16x32_bf16 v[64:67], a[116:119], v[176:179], v[64:67]
    buffer_load_dwordx4 v2, s[8:11], s83 offen offset:2048 sc1 lds
    v_mfma_f32_16x16x32_bf16 v[60:63], a[112:115], v[180:183], v[60:63]
    ds_read_b64_tr_b16 v[176:177], v8 offset:2048
    ds_read_b64_tr_b16 v[178:179], v8 offset:2560
    v_mfma_f32_16x16x32_bf16 v[68:71], a[116:119], v[180:183], v[68:71]
    buffer_load_dwordx4 v2, s[8:11], s83 offen offset:3072 sc1 lds
    s_waitcnt lgkmcnt(6)
    v_mfma_f32_16x16x32_bf16 v[56:59], a[120:123], v[184:187], v[56:59]
    ds_read_b64_tr_b16 v[180:181], v92 offset:2048
    ds_read_b64_tr_b16 v[182:183], v92 offset:2560
    v_mfma_f32_16x16x32_bf16 v[64:67], a[124:127], v[184:187], v[64:67]
    v_mfma_f32_16x16x32_bf16 v[60:63], a[120:123], v[188:191], v[60:63]
    ds_read_b64_tr_b16 v[184:185], v8 offset:4096
    ds_read_b64_tr_b16 v[186:187], v8 offset:4608
    v_mfma_f32_16x16x32_bf16 v[68:71], a[124:127], v[188:191], v[68:71]
    buffer_load_dword v16, v114, s[68:71], s28 offen sc1
    s_waitcnt lgkmcnt(6)
    v_mfma_f32_16x16x32_bf16 v[72:75], a[0:3], v[192:195], 0
    ds_read_b64_tr_b16 v[188:189], v92 offset:4096
    ds_read_b64_tr_b16 v[190:191], v92 offset:4608
    v_mfma_f32_16x16x32_bf16 v[80:83], a[4:7], v[192:195], 0
    v_mfma_f32_16x16x32_bf16 v[76:79], a[0:3], v[196:199], 0
    ds_read_b64_tr_b16 v[192:193], v8 offset:6144
    ds_read_b64_tr_b16 v[194:195], v8 offset:6656
    v_mfma_f32_16x16x32_bf16 v[84:87], a[4:7], v[196:199], 0
    buffer_load_dword v17, v118, s[68:71], s28 offen sc1
    s_waitcnt lgkmcnt(6)
    v_mfma_f32_16x16x32_bf16 v[72:75], a[8:11], v[176:179], v[72:75]
    ds_read_b64_tr_b16 v[196:197], v92 offset:6144
    ds_read_b64_tr_b16 v[198:199], v92 offset:6656
    v_mfma_f32_16x16x32_bf16 v[80:83], a[12:15], v[176:179], v[80:83]
    v_max_f32 v56, 0, v56
    v_max_f32 v57, 0, v57
    v_mfma_f32_16x16x32_bf16 v[76:79], a[8:11], v[180:183], v[76:79]
    ds_read_b64_tr_b16 v[176:177], v8 offset:8192
    ds_read_b64_tr_b16 v[178:179], v8 offset:8704
    v_mfma_f32_16x16x32_bf16 v[84:87], a[12:15], v[180:183], v[84:87]
    buffer_load_dword v18, v114, s[68:71], s29 offen sc1
    v_max_f32 v58, 0, v58
    v_max_f32 v59, 0, v59
    s_waitcnt lgkmcnt(6)
    v_mfma_f32_16x16x32_bf16 v[72:75], a[16:19], v[184:187], v[72:75]
    ds_read_b64_tr_b16 v[180:181], v92 offset:8192
    ds_read_b64_tr_b16 v[182:183], v92 offset:8704
    v_mfma_f32_16x16x32_bf16 v[80:83], a[20:23], v[184:187], v[80:83]
    s_waitcnt vmcnt(12)
    ds_read2st64_b32 v[88:89], v3 offset0:64 offset1:68
    v_max_f32 v60, 0, v60
    v_max_f32 v61, 0, v61
    v_mfma_f32_16x16x32_bf16 v[76:79], a[16:19], v[188:191], v[76:79]
    ds_read_b64_tr_b16 v[184:185], v8 offset:10240
    ds_read_b64_tr_b16 v[186:187], v8 offset:10752
    v_mfma_f32_16x16x32_bf16 v[84:87], a[20:23], v[188:191], v[84:87]
    buffer_load_dword v19, v118, s[68:71], s29 offen sc1
    v_max_f32 v62, 0, v62
    v_max_f32 v63, 0, v63
    s_waitcnt lgkmcnt(7)
    v_mfma_f32_16x16x32_bf16 v[72:75], a[24:27], v[192:195], v[72:75]
    ds_read_b64_tr_b16 v[188:189], v92 offset:10240
    ds_read_b64_tr_b16 v[190:191], v92 offset:10752
    v_mfma_f32_16x16x32_bf16 v[80:83], a[28:31], v[192:195], v[80:83]
    ds_read2st64_b32 v[90:91], v3 offset0:72 offset1:76
    v_mul_f32 v56, v56, v64
    s_add_u32 s79, s76, 0
    v_mul_f32 v57, v57, v65
    v_mfma_f32_16x16x32_bf16 v[76:79], a[24:27], v[196:199], v[76:79]
    ds_read_b64_tr_b16 v[192:193], v8 offset:12288
    ds_read_b64_tr_b16 v[194:195], v8 offset:12800
    v_mfma_f32_16x16x32_bf16 v[84:87], a[28:31], v[196:199], v[84:87]
    buffer_load_dwordx4 v[120:123], v4, s[16:19], s79 offen sc1
    v_cvt_pk_bf16_f32 v104, v56, v57
    v_mul_f32 v60, v60, v68
    s_waitcnt lgkmcnt(8)
    v_mfma_f32_16x16x32_bf16 v[72:75], a[32:35], v[176:179], v[72:75]
    ds_read_b64_tr_b16 v[196:197], v92 offset:12288
    ds_read_b64_tr_b16 v[198:199], v92 offset:12800
    v_mfma_f32_16x16x32_bf16 v[80:83], a[36:39], v[176:179], v[80:83]
    v_mul_f32 v61, v61, v69
    s_add_u32 s79, s82, 0
    v_cvt_pk_bf16_f32 v106, v60, v61
    v_mfma_f32_16x16x32_bf16 v[76:79], a[32:35], v[180:183], v[76:79]
    ds_read_b64_tr_b16 v[176:177], v8 offset:14336
    ds_read_b64_tr_b16 v[178:179], v8 offset:14848
    v_mfma_f32_16x16x32_bf16 v[84:87], a[36:39], v[180:183], v[84:87]
    buffer_load_dwordx4 v[124:127], v4, s[16:19], s79 offen sc1
    s_waitcnt lgkmcnt(6)
    v_or3_b32 v88, v88, v89, v90
    v_mfma_f32_16x16x32_bf16 v[72:75], a[40:43], v[184:187], v[72:75]
    ds_read_b64_tr_b16 v[180:181], v92 offset:14336
    ds_read_b64_tr_b16 v[182:183], v92 offset:14848
    v_mfma_f32_16x16x32_bf16 v[80:83], a[44:47], v[184:187], v[80:83]
    v_bitop3_b32 v88, v88, v91, s73 bitop3:0xa8
    v_cmp_ne_u32 vcc, 0, v88
    v_mul_f32 v58, v58, v66
    v_mul_f32 v59, v59, v67
    v_mfma_f32_16x16x32_bf16 v[76:79], a[40:43], v[188:191], v[76:79]
    s_cbranch_vccnz cslow_110
cback_109:
    s_barrier
    v_mfma_f32_16x16x32_bf16 v[84:87], a[44:47], v[188:191], v[84:87]
    ds_read_b64_tr_b16 v[184:185], v8 offset:16384
    ds_read_b64_tr_b16 v[186:187], v8 offset:16896
    v_cvt_pk_bf16_f32 v105, v58, v59
    s_waitcnt lgkmcnt(6)
    v_mfma_f32_16x16x32_bf16 v[72:75], a[48:51], v[192:195], v[72:75]
    ds_read_b64_tr_b16 v[188:189], v92 offset:16384
    ds_read_b64_tr_b16 v[190:191], v92 offset:16896
    v_mfma_f32_16x16x32_bf16 v[80:83], a[52:55], v[192:195], v[80:83]
    v_mul_f32 v62, v62, v70
    s_add_u32 s79, s76, 8192
    v_mul_f32 v63, v63, v71
    v_mfma_f32_16x16x32_bf16 v[76:79], a[48:51], v[196:199], v[76:79]
    ds_read_b64_tr_b16 v[192:193], v8 offset:18432
    ds_read_b64_tr_b16 v[194:195], v8 offset:18944
    v_mfma_f32_16x16x32_bf16 v[84:87], a[52:55], v[196:199], v[84:87]
    buffer_load_dwordx4 v[128:131], v4, s[16:19], s79 offen sc1
    v_cvt_pk_bf16_f32 v107, v62, v63
    s_add_u32 s79, s82, 8192
    s_waitcnt lgkmcnt(6)
    v_mfma_f32_16x16x32_bf16 v[72:75], a[56:59], v[176:179], v[72:75]
    ds_read_b64_tr_b16 v[196:197], v92 offset:18432
    ds_read_b64_tr_b16 v[198:199], v92 offset:18944
    v_mfma_f32_16x16x32_bf16 v[80:83], a[60:63], v[176:179], v[80:83]
    buffer_load_dwordx4 v[132:135], v4, s[16:19], s79 offen sc1
    v_permlane16_swap_b32 v104, v106
    v_permlane16_swap_b32 v105, v107
    v_mfma_f32_16x16x32_bf16 v[76:79], a[56:59], v[180:183], v[76:79]
    ds_read_b64_tr_b16 v[176:177], v8 offset:20480
    ds_read_b64_tr_b16 v[178:179], v8 offset:20992
    v_mfma_f32_16x16x32_bf16 v[84:87], a[60:63], v[180:183], v[84:87]
    v_or_b32 v104, 1, v104
    s_add_u32 s51, s47, 360448
    s_waitcnt lgkmcnt(6)
    v_mfma_f32_16x16x32_bf16 v[72:75], a[64:67], v[184:187], v[72:75]
    ds_read_b64_tr_b16 v[180:181], v92 offset:20480
    ds_read_b64_tr_b16 v[182:183], v92 offset:20992
    v_mfma_f32_16x16x32_bf16 v[80:83], a[68:71], v[184:187], v[80:83]
    buffer_store_dwordx4 v[104:107], v5, s[12:15], s51 offen sc1
    v_mfma_f32_16x16x32_bf16 v[76:79], a[64:67], v[188:191], v[76:79]
    ds_read_b64_tr_b16 v[184:185], v8 offset:22528
    ds_read_b64_tr_b16 v[186:187], v8 offset:23040
    v_mfma_f32_16x16x32_bf16 v[84:87], a[68:71], v[188:191], v[84:87]
    s_add_u32 s79, s76, 16384
    s_waitcnt lgkmcnt(6)
    v_mfma_f32_16x16x32_bf16 v[72:75], a[72:75], v[192:195], v[72:75]
    ds_read_b64_tr_b16 v[188:189], v92 offset:22528
    ds_read_b64_tr_b16 v[190:191], v92 offset:23040
    v_mfma_f32_16x16x32_bf16 v[80:83], a[76:79], v[192:195], v[80:83]
    buffer_load_dwordx4 v[136:139], v4, s[16:19], s79 offen sc1
    v_mfma_f32_16x16x32_bf16 v[76:79], a[72:75], v[196:199], v[76:79]
    ds_read_b64_tr_b16 v[192:193], v8 offset:24576
    ds_read_b64_tr_b16 v[194:195], v8 offset:25088
    v_mfma_f32_16x16x32_bf16 v[84:87], a[76:79], v[196:199], v[84:87]
    s_add_u32 s79, s82, 16384
    s_waitcnt lgkmcnt(6)
    v_mfma_f32_16x16x32_bf16 v[72:75], a[80:83], v[176:179], v[72:75]
    ds_read_b64_tr_b16 v[196:197], v92 offset:24576
    ds_read_b64_tr_b16 v[198:199], v92 offset:25088
    v_mfma_f32_16x16x32_bf16 v[80:83], a[84:87], v[176:179], v[80:83]
    buffer_load_dwordx4 v[140:143], v4, s[16:19], s79 offen sc1
    v_mfma_f32_16x16x32_bf16 v[76:79], a[80:83], v[180:183], v[76:79]
    ds_read_b64_tr_b16 v[176:177], v8 offset:26624
    ds_read_b64_tr_b16 v[178:179], v8 offset:27136
    v_mfma_f32_16x16x32_bf16 v[84:87], a[84:87], v[180:183], v[84:87]
    s_add_u32 s79, s76, 24576
    s_waitcnt lgkmcnt(6)
    v_mfma_f32_16x16x32_bf16 v[72:75], a[88:91], v[184:187], v[72:75]
    ds_read_b64_tr_b16 v[180:181], v92 offset:26624
    ds_read_b64_tr_b16 v[182:183], v92 offset:27136
    v_mfma_f32_16x16x32_bf16 v[80:83], a[92:95], v[184:187], v[80:83]
    buffer_load_dwordx4 v[144:147], v4, s[16:19], s79 offen sc1
    v_mfma_f32_16x16x32_bf16 v[76:79], a[88:91], v[188:191], v[76:79]
    ds_read_b64_tr_b16 v[184:185], v8 offset:28672
    ds_read_b64_tr_b16 v[186:187], v8 offset:29184
    v_mfma_f32_16x16x32_bf16 v[84:87], a[92:95], v[188:191], v[84:87]
    s_add_u32 s79, s82, 24576
    s_waitcnt lgkmcnt(6)
    v_mfma_f32_16x16x32_bf16 v[72:75], a[96:99], v[192:195], v[72:75]
    ds_read_b64_tr_b16 v[188:189], v92 offset:28672
    ds_read_b64_tr_b16 v[190:191], v92 offset:29184
    v_mfma_f32_16x16x32_bf16 v[80:83], a[100:103], v[192:195], v[80:83]
    buffer_load_dwordx4 v[148:151], v4, s[16:19], s79 offen sc1
    v_mfma_f32_16x16x32_bf16 v[76:79], a[96:99], v[196:199], v[76:79]
    ds_read_b64_tr_b16 v[192:193], v8 offset:30720
    ds_read_b64_tr_b16 v[194:195], v8 offset:31232
    v_mfma_f32_16x16x32_bf16 v[84:87], a[100:103], v[196:199], v[84:87]
    s_add_u32 s79, s76, 32768
    s_waitcnt lgkmcnt(6)
    v_mfma_f32_16x16x32_bf16 v[72:75], a[104:107], v[176:179], v[72:75]
    ds_read_b64_tr_b16 v[196:197], v92 offset:30720
    ds_read_b64_tr_b16 v[198:199], v92 offset:31232
    v_mfma_f32_16x16x32_bf16 v[80:83], a[108:111], v[176:179], v[80:83]
    buffer_load_dwordx4 v[152:155], v4, s[16:19], s79 offen sc1
    v_mfma_f32_16x16x32_bf16 v[76:79], a[104:107], v[180:183], v[76:79]
    v_mfma_f32_16x16x32_bf16 v[84:87], a[108:111], v[180:183], v[84:87]
    s_add_u32 s79, s82, 32768
    s_waitcnt lgkmcnt(4)
    v_mfma_f32_16x16x32_bf16 v[72:75], a[112:115], v[184:187], v[72:75]
    v_mfma_f32_16x16x32_bf16 v[80:83], a[116:119], v[184:187], v[80:83]
    buffer_load_dwordx4 v[156:159], v4, s[16:19], s79 offen sc1
    v_mfma_f32_16x16x32_bf16 v[76:79], a[112:115], v[188:191], v[76:79]
    v_mfma_f32_16x16x32_bf16 v[84:87], a[116:119], v[188:191], v[84:87]
    s_add_u32 s79, s76, 40960
    s_waitcnt lgkmcnt(0)
    v_mfma_f32_16x16x32_bf16 v[72:75], a[120:123], v[192:195], v[72:75]
    v_mfma_f32_16x16x32_bf16 v[80:83], a[124:127], v[192:195], v[80:83]
    buffer_load_dwordx4 v[160:163], v4, s[16:19], s79 offen sc1
    v_mfma_f32_16x16x32_bf16 v[76:79], a[120:123], v[196:199], v[76:79]
    v_mfma_f32_16x16x32_bf16 v[84:87], a[124:127], v[196:199], v[84:87]
    s_nop 3
    v_max_f32 v72, 0, v72
    v_max_f32 v73, 0, v73
    v_max_f32 v74, 0, v74
    v_max_f32 v75, 0, v75
    v_max_f32 v76, 0, v76
    v_max_f32 v77, 0, v77
    v_max_f32 v78, 0, v78
    v_max_f32 v79, 0, v79
    v_pk_mul_f32 v[72:73], v[72:73], v[80:81]
    v_cvt_pk_bf16_f32 v108, v72, v73
    v_pk_mul_f32 v[76:77], v[76:77], v[84:85]
    v_cvt_pk_bf16_f32 v110, v76, v77
    v_pk_mul_f32 v[74:75], v[74:75], v[82:83]
    v_cvt_pk_bf16_f32 v109, v74, v75
    v_pk_mul_f32 v[78:79], v[78:79], v[86:87]
    v_cvt_pk_bf16_f32 v111, v78, v79
    v_permlane16_swap_b32 v108, v110
    s_nop 0
    v_permlane16_swap_b32 v109, v111
    v_or_b32 v108, 1, v108
    s_add_u32 s51, s47, 450560
    buffer_store_dwordx4 v[108:111], v5, s[12:15], s51 offen sc1
    s_branch L_g21
L_g1stats1:
    v_lshlrev_b32 v6, 4, v0
    s_mul_i32 s48, s44, 196608
    s_cmp_ge_u32 s44, 11
    s_cselect_b32 s48, 0, s48
    s_add_u32 s7, s48, 0
    buffer_load_dwordx4 v[40:43], v6, s[8:11], s7 offen sc1
    s_add_u32 s7, s48, 4096
    buffer_load_dwordx4 v[44:47], v6, s[8:11], s7 offen sc1
    s_add_u32 s7, s48, 8192
    buffer_load_dwordx4 v[48:51], v6, s[8:11], s7 offen sc1
    s_add_u32 s7, s48, 12288
    buffer_load_dwordx4 v[52:55], v6, s[8:11], s7 offen sc1
    s_add_u32 s7, s48, 16384
    buffer_load_dwordx4 v[56:59], v6, s[8:11], s7 offen sc1
    s_add_u32 s7, s48, 20480
    buffer_load_dwordx4 v[60:63], v6, s[8:11], s7 offen sc1
    s_add_u32 s7, s48, 24576
    buffer_load_dwordx4 v[64:67], v6, s[8:11], s7 offen sc1
    s_add_u32 s7, s48, 28672
    buffer_load_dwordx4 v[68:71], v6, s[8:11], s7 offen sc1
    s_add_u32 s7, s48, 32768
    buffer_load_dwordx4 v[72:75], v6, s[8:11], s7 offen sc1
    s_add_u32 s7, s48, 36864
    buffer_load_dwordx4 v[76:79], v6, s[8:11], s7 offen sc1
    s_add_u32 s7, s48, 40960
    buffer_load_dwordx4 v[80:83], v6, s[8:11], s7 offen sc1
    s_add_u32 s7, s48, 45056
    buffer_load_dwordx4 v[84:87], v6, s[8:11], s7 offen sc1
    v_lshrrev_b32 v3, 2, v0
    v_cmp_eq_u32 s[50:51], 1, v3
    v_mul_u32_u24 v8, 768, v3
    v_and_b32 v3, 3, v0
    v_lshl_add_u32 v8, v3, 5, v8
    s_waitcnt vmcnt(9)
    v_or3_b32 v9, v40, v44, v48
    s_waitcnt vmcnt(8)
    v_or_b32 v9, v9, v52
    v_and_b32 v9, s40, v9
    v_cmp_ne_u32 vcc, 0, v9
    s_cbranch_vccnz cslow_112
cback_111:
    s_add_u32 s7, s48, 49152
    buffer_load_dwordx4 v[88:91], v6, s[8:11], s7 offen sc1
    v_cndmask_b32 v40, v40, 0, s[50:51]
    v_lshlrev_b32 v104, 16, v40
    v_and_b32 v105, s38, v40
    v_pk_mul_f32 v[16:17], v[104:105], v[104:105]
    v_cndmask_b32 v41, v41, 0, s[50:51]
    v_lshlrev_b32 v104, 16, v41
    v_and_b32 v105, s38, v41
    v_pk_mul_f32 v[18:19], v[104:105], v[104:105]
    v_cndmask_b32 v42, v42, 0, s[50:51]
    v_lshlrev_b32 v104, 16, v42
    v_and_b32 v105, s38, v42
    v_pk_mul_f32 v[20:21], v[104:105], v[104:105]
    v_cndmask_b32 v43, v43, 0, s[50:51]
    v_lshlrev_b32 v104, 16, v43
    v_and_b32 v105, s38, v43
    v_pk_mul_f32 v[22:23], v[104:105], v[104:105]
    s_add_u32 s7, s48, 53248
    buffer_load_dwordx4 v[92:95], v6, s[8:11], s7 offen sc1
    v_lshlrev_b32 v104, 16, v44
    v_and_b32 v105, s38, v44
    v_pk_fma_f32 v[16:17], v[104:105], v[104:105], v[16:17]
    v_lshlrev_b32 v104, 16, v45
    v_and_b32 v105, s38, v45
    v_pk_fma_f32 v[18:19], v[104:105], v[104:105], v[18:19]
    v_lshlrev_b32 v104, 16, v46
    v_and_b32 v105, s38, v46
    v_pk_fma_f32 v[20:21], v[104:105], v[104:105], v[20:21]
    v_lshlrev_b32 v104, 16, v47
    v_and_b32 v105, s38, v47
    v_pk_fma_f32 v[22:23], v[104:105], v[104:105], v[22:23]
    s_add_u32 s7, s48, 57344
    buffer_load_dwordx4 v[96:99], v6, s[8:11], s7 offen sc1
    v_lshlrev_b32 v104, 16, v48
    v_and_b32 v105, s38, v48
    v_pk_fma_f32 v[16:17], v[104:105], v[104:105], v[16:17]
    v_lshlrev_b32 v104, 16, v49
    v_and_b32 v105, s38, v49
    v_pk_fma_f32 v[18:19], v[104:105], v[104:105], v[18:19]
    v_lshlrev_b32 v104, 16, v50
    v_and_b32 v105, s38, v50
    v_pk_fma_f32 v[20:21], v[104:105], v[104:105], v[20:21]
    v_lshlrev_b32 v104, 16, v51
    v_and_b32 v105, s38, v51
    v_pk_fma_f32 v[22:23], v[104:105], v[104:105], v[22:23]
    s_add_u32 s7, s48, 61440
    buffer_load_dwordx4 v[100:103], v6, s[8:11], s7 offen sc1
    v_lshlrev_b32 v104, 16, v52
    v_and_b32 v105, s38, v52
    v_pk_fma_f32 v[16:17], v[104:105], v[104:105], v[16:17]
    v_lshlrev_b32 v104, 16, v53
    v_and_b32 v105, s38, v53
    v_pk_fma_f32 v[18:19], v[104:105], v[104:105], v[18:19]
    v_lshlrev_b32 v104, 16, v54
    v_and_b32 v105, s38, v54
    v_pk_fma_f32 v[20:21], v[104:105], v[104:105], v[20:21]
    v_lshlrev_b32 v104, 16, v55
    v_and_b32 v105, s38, v55
    v_pk_fma_f32 v[22:23], v[104:105], v[104:105], v[22:23]
    s_waitcnt vmcnt(9)
    v_or3_b32 v9, v56, v60, v64
    s_waitcnt vmcnt(8)
    v_or_b32 v9, v9, v68
    v_and_b32 v9, s40, v9
    v_cmp_ne_u32 vcc, 0, v9
    s_cbranch_vccnz cslow_114
cback_113:
    s_add_u32 s7, s48, 65536
    buffer_load_dwordx4 v[40:43], v6, s[8:11], s7 offen sc1
    v_lshlrev_b32 v104, 16, v56
    v_and_b32 v105, s38, v56
    v_pk_fma_f32 v[16:17], v[104:105], v[104:105], v[16:17]
    v_lshlrev_b32 v104, 16, v57
    v_and_b32 v105, s38, v57
    v_pk_fma_f32 v[18:19], v[104:105], v[104:105], v[18:19]
    v_lshlrev_b32 v104, 16, v58
    v_and_b32 v105, s38, v58
    v_pk_fma_f32 v[20:21], v[104:105], v[104:105], v[20:21]
    v_lshlrev_b32 v104, 16, v59
    v_and_b32 v105, s38, v59
    v_pk_fma_f32 v[22:23], v[104:105], v[104:105], v[22:23]
    s_add_u32 s7, s48, 69632
    buffer_load_dwordx4 v[44:47], v6, s[8:11], s7 offen sc1
    v_lshlrev_b32 v104, 16, v60
    v_and_b32 v105, s38, v60
    v_pk_fma_f32 v[16:17], v[104:105], v[104:105], v[16:17]
    v_lshlrev_b32 v104, 16, v61
    v_and_b32 v105, s38, v61
    v_pk_fma_f32 v[18:19], v[104:105], v[104:105], v[18:19]
    v_lshlrev_b32 v104, 16, v62
    v_and_b32 v105, s38, v62
    v_pk_fma_f32 v[20:21], v[104:105], v[104:105], v[20:21]
    v_lshlrev_b32 v104, 16, v63
    v_and_b32 v105, s38, v63
    v_pk_fma_f32 v[22:23], v[104:105], v[104:105], v[22:23]
    s_add_u32 s7, s48, 73728
    buffer_load_dwordx4 v[48:51], v6, s[8:11], s7 offen sc1
    v_lshlrev_b32 v104, 16, v64
    v_and_b32 v105, s38, v64
    v_pk_fma_f32 v[16:17], v[104:105], v[104:105], v[16:17]
    v_lshlrev_b32 v104, 16, v65
    v_and_b32 v105, s38, v65
    v_pk_fma_f32 v[18:19], v[104:105], v[104:105], v[18:19]
    v_lshlrev_b32 v104, 16, v66
    v_and_b32 v105, s38, v66
    v_pk_fma_f32 v[20:21], v[104:105], v[104:105], v[20:21]
    v_lshlrev_b32 v104, 16, v67
    v_and_b32 v105, s38, v67
    v_pk_fma_f32 v[22:23], v[104:105], v[104:105], v[22:23]
    s_add_u32 s7, s48, 77824
    buffer_load_dwordx4 v[52:55], v6, s[8:11], s7 offen sc1
    v_lshlrev_b32 v104, 16, v68
    v_and_b32 v105, s38, v68
    v_pk_fma_f32 v[16:17], v[104:105], v[104:105], v[16:17]
    v_lshlrev_b32 v104, 16, v69
    v_and_b32 v105, s38, v69
    v_pk_fma_f32 v[18:19], v[104:105], v[104:105], v[18:19]
    v_lshlrev_b32 v104, 16, v70
    v_and_b32 v105, s38, v70
    v_pk_fma_f32 v[20:21], v[104:105], v[104:105], v[20:21]
    v_lshlrev_b32 v104, 16, v71
    v_and_b32 v105, s38, v71
    v_pk_fma_f32 v[22:23], v[104:105], v[104:105], v[22:23]
    ds_write_b128 v8, v[16:19] offset:0
    ds_write_b128 v8, v[20:23] offset:16
    s_waitcnt vmcnt(9)
    v_or3_b32 v9, v72, v76, v80
    s_waitcnt vmcnt(8)
    v_or_b32 v9, v9, v84
    v_and_b32 v9, s40, v9
    v_cmp_ne_u32 vcc, 0, v9
    s_cbranch_vccnz cslow_116
cback_115:
    s_add_u32 s7, s48, 81920
    buffer_load_dwordx4 v[56:59], v6, s[8:11], s7 offen sc1
    v_cndmask_b32 v72, v72, 0, s[50:51]
    v_lshlrev_b32 v104, 16, v72
    v_and_b32 v105, s38, v72
    v_pk_mul_f32 v[24:25], v[104:105], v[104:105]
    v_cndmask_b32 v73, v73, 0, s[50:51]
    v_lshlrev_b32 v104, 16, v73
    v_and_b32 v105, s38, v73
    v_pk_mul_f32 v[26:27], v[104:105], v[104:105]
    v_cndmask_b32 v74, v74, 0, s[50:51]
    v_lshlrev_b32 v104, 16, v74
    v_and_b32 v105, s38, v74
    v_pk_mul_f32 v[28:29], v[104:105], v[104:105]
    v_cndmask_b32 v75, v75, 0, s[50:51]
    v_lshlrev_b32 v104, 16, v75
    v_and_b32 v105, s38, v75
    v_pk_mul_f32 v[30:31], v[104:105], v[104:105]
    s_add_u32 s7, s48, 86016
    buffer_load_dwordx4 v[60:63], v6, s[8:11], s7 offen sc1
    v_lshlrev_b32 v104, 16, v76
    v_and_b32 v105, s38, v76
    v_pk_fma_f32 v[24:25], v[104:105], v[104:105], v[24:25]
    v_lshlrev_b32 v104, 16, v77
    v_and_b32 v105, s38, v77
    v_pk_fma_f32 v[26:27], v[104:105], v[104:105], v[26:27]
    v_lshlrev_b32 v104, 16, v78
    v_and_b32 v105, s38, v78
    v_pk_fma_f32 v[28:29], v[104:105], v[104:105], v[28:29]
    v_lshlrev_b32 v104, 16, v79
    v_and_b32 v105, s38, v79
    v_pk_fma_f32 v[30:31], v[104:105], v[104:105], v[30:31]
    s_add_u32 s7, s48, 90112
    buffer_load_dwordx4 v[64:67], v6, s[8:11], s7 offen sc1
    v_lshlrev_b32 v104, 16, v80
    v_and_b32 v105, s38, v80
    v_pk_fma_f32 v[24:25], v[104:105], v[104:105], v[24:25]
    v_lshlrev_b32 v104, 16, v81
    v_and_b32 v105, s38, v81
    v_pk_fma_f32 v[26:27], v[104:105], v[104:105], v[26:27]
    v_lshlrev_b32 v104, 16, v82
    v_and_b32 v105, s38, v82
    v_pk_fma_f32 v[28:29], v[104:105], v[104:105], v[28:29]
    v_lshlrev_b32 v104, 16, v83
    v_and_b32 v105, s38, v83
    v_pk_fma_f32 v[30:31], v[104:105], v[104:105], v[30:31]
    s_add_u32 s7, s48, 94208
    buffer_load_dwordx4 v[68:71], v6, s[8:11], s7 offen sc1
    v_lshlrev_b32 v104, 16, v84
    v_and_b32 v105, s38, v84
    v_pk_fma_f32 v[24:25], v[104:105], v[104:105], v[24:25]
    v_lshlrev_b32 v104, 16, v85
    v_and_b32 v105, s38, v85
    v_pk_fma_f32 v[26:27], v[104:105], v[104:105], v[26:27]
    v_lshlrev_b32 v104, 16, v86
    v_and_b32 v105, s38, v86
    v_pk_fma_f32 v[28:29], v[104:105], v[104:105], v[28:29]
    v_lshlrev_b32 v104, 16, v87
    v_and_b32 v105, s38, v87
    v_pk_fma_f32 v[30:31], v[104:105], v[104:105], v[30:31]
    s_waitcnt vmcnt(9)
    v_or3_b32 v9, v88, v92, v96
    s_waitcnt vmcnt(8)
    v_or_b32 v9, v9, v100
    v_and_b32 v9, s40, v9
    v_cmp_ne_u32 vcc, 0, v9
    s_cbranch_vccnz cslow_118
cback_117:
    s_add_u32 s7, s48, 98304
    buffer_load_dwordx4 v[72:75], v6, s[8:11], s7 offen sc1
    v_lshlrev_b32 v104, 16, v88
    v_and_b32 v105, s38, v88
    v_pk_fma_f32 v[24:25], v[104:105], v[104:105], v[24:25]
    v_lshlrev_b32 v104, 16, v89
    v_and_b32 v105, s38, v89
    v_pk_fma_f32 v[26:27], v[104:105], v[104:105], v[26:27]
    v_lshlrev_b32 v104, 16, v90
    v_and_b32 v105, s38, v90
    v_pk_fma_f32 v[28:29], v[104:105], v[104:105], v[28:29]
    v_lshlrev_b32 v104, 16, v91
    v_and_b32 v105, s38, v91
    v_pk_fma_f32 v[30:31], v[104:105], v[104:105], v[30:31]
    s_add_u32 s7, s48, 102400
    buffer_load_dwordx4 v[76:79], v6, s[8:11], s7 offen sc1
    v_lshlrev_b32 v104, 16, v92
    v_and_b32 v105, s38, v92
    v_pk_fma_f32 v[24:25], v[104:105], v[104:105], v[24:25]
    v_lshlrev_b32 v104, 16, v93
    v_and_b32 v105, s38, v93
    v_pk_fma_f32 v[26:27], v[104:105], v[104:105], v[26:27]
    v_lshlrev_b32 v104, 16, v94
    v_and_b32 v105, s38, v94
    v_pk_fma_f32 v[28:29], v[104:105], v[104:105], v[28:29]
    v_lshlrev_b32 v104, 16, v95
    v_and_b32 v105, s38, v95
    v_pk_fma_f32 v[30:31], v[104:105], v[104:105], v[30:31]
    s_add_u32 s7, s48, 106496
    buffer_load_dwordx4 v[80:83], v6, s[8:11], s7 offen sc1
    v_lshlrev_b32 v104, 16, v96
    v_and_b32 v105, s38, v96
    v_pk_fma_f32 v[24:25], v[104:105], v[104:105], v[24:25]
    v_lshlrev_b32 v104, 16, v97
    v_and_b32 v105, s38, v97
    v_pk_fma_f32 v[26:27], v[104:105], v[104:105], v[26:27]
    v_lshlrev_b32 v104, 16, v98
    v_and_b32 v105, s38, v98
    v_pk_fma_f32 v[28:29], v[104:105], v[104:105], v[28:29]
    v_lshlrev_b32 v104, 16, v99
    v_and_b32 v105, s38, v99
    v_pk_fma_f32 v[30:31], v[104:105], v[104:105], v[30:31]
    s_add_u32 s7, s48, 110592
    buffer_load_dwordx4 v[84:87], v6, s[8:11], s7 offen sc1
    v_lshlrev_b32 v104, 16, v100
    v_and_b32 v105, s38, v100
    v_pk_fma_f32 v[24:25], v[104:105], v[104:105], v[24:25]
    v_lshlrev_b32 v104, 16, v101
    v_and_b32 v105, s38, v101
    v_pk_fma_f32 v[26:27], v[104:105], v[104:105], v[26:27]
    v_lshlrev_b32 v104, 16, v102
    v_and_b32 v105, s38, v102
    v_pk_fma_f32 v[28:29], v[104:105], v[104:105], v[28:29]
    v_lshlrev_b32 v104, 16, v103
    v_and_b32 v105, s38, v103
    v_pk_fma_f32 v[30:31], v[104:105], v[104:105], v[30:31]
    ds_write_b128 v8, v[24:27] offset:128
    ds_write_b128 v8, v[28:31] offset:144
    s_waitcnt vmcnt(9)
    v_or3_b32 v9, v40, v44, v48
    s_waitcnt vmcnt(8)
    v_or_b32 v9, v9, v52
    v_and_b32 v9, s40, v9
    v_cmp_ne_u32 vcc, 0, v9
    s_cbranch_vccnz cslow_120
cback_119:
    s_add_u32 s7, s48, 114688
    buffer_load_dwordx4 v[88:91], v6, s[8:11], s7 offen sc1
    v_cndmask_b32 v40, v40, 0, s[50:51]
    v_lshlrev_b32 v104, 16, v40
    v_and_b32 v105, s38, v40
    v_pk_mul_f32 v[16:17], v[104:105], v[104:105]
    v_cndmask_b32 v41, v41, 0, s[50:51]
    v_lshlrev_b32 v104, 16, v41
    v_and_b32 v105, s38, v41
    v_pk_mul_f32 v[18:19], v[104:105], v[104:105]
    v_cndmask_b32 v42, v42, 0, s[50:51]
    v_lshlrev_b32 v104, 16, v42
    v_and_b32 v105, s38, v42
    v_pk_mul_f32 v[20:21], v[104:105], v[104:105]
    v_cndmask_b32 v43, v43, 0, s[50:51]
    v_lshlrev_b32 v104, 16, v43
    v_and_b32 v105, s38, v43
    v_pk_mul_f32 v[22:23], v[104:105], v[104:105]
    s_add_u32 s7, s48, 118784
    buffer_load_dwordx4 v[92:95], v6, s[8:11], s7 offen sc1
    v_lshlrev_b32 v104, 16, v44
    v_and_b32 v105, s38, v44
    v_pk_fma_f32 v[16:17], v[104:105], v[104:105], v[16:17]
    v_lshlrev_b32 v104, 16, v45
    v_and_b32 v105, s38, v45
    v_pk_fma_f32 v[18:19], v[104:105], v[104:105], v[18:19]
    v_lshlrev_b32 v104, 16, v46
    v_and_b32 v105, s38, v46
    v_pk_fma_f32 v[20:21], v[104:105], v[104:105], v[20:21]
    v_lshlrev_b32 v104, 16, v47
    v_and_b32 v105, s38, v47
    v_pk_fma_f32 v[22:23], v[104:105], v[104:105], v[22:23]
    s_add_u32 s7, s48, 122880
    buffer_load_dwordx4 v[96:99], v6, s[8:11], s7 offen sc1
    v_lshlrev_b32 v104, 16, v48
    v_and_b32 v105, s38, v48
    v_pk_fma_f32 v[16:17], v[104:105], v[104:105], v[16:17]
    v_lshlrev_b32 v104, 16, v49
    v_and_b32 v105, s38, v49
    v_pk_fma_f32 v[18:19], v[104:105], v[104:105], v[18:19]
    v_lshlrev_b32 v104, 16, v50
    v_and_b32 v105, s38, v50
    v_pk_fma_f32 v[20:21], v[104:105], v[104:105], v[20:21]
    v_lshlrev_b32 v104, 16, v51
    v_and_b32 v105, s38, v51
    v_pk_fma_f32 v[22:23], v[104:105], v[104:105], v[22:23]
    s_add_u32 s7, s48, 126976
    buffer_load_dwordx4 v[100:103], v6, s[8:11], s7 offen sc1
    v_lshlrev_b32 v104, 16, v52
    v_and_b32 v105, s38, v52
    v_pk_fma_f32 v[16:17], v[104:105], v[104:105], v[16:17]
    v_lshlrev_b32 v104, 16, v53
    v_and_b32 v105, s38, v53
    v_pk_fma_f32 v[18:19], v[104:105], v[104:105], v[18:19]
    v_lshlrev_b32 v104, 16, v54
    v_and_b32 v105, s38, v54
    v_pk_fma_f32 v[20:21], v[104:105], v[104:105], v[20:21]
    v_lshlrev_b32 v104, 16, v55
    v_and_b32 v105, s38, v55
    v_pk_fma_f32 v[22:23], v[104:105], v[104:105], v[22:23]
    s_waitcnt vmcnt(9)
    v_or3_b32 v9, v56, v60, v64
    s_waitcnt vmcnt(8)
    v_or_b32 v9, v9, v68
    v_and_b32 v9, s40, v9
    v_cmp_ne_u32 vcc, 0, v9
    s_cbranch_vccnz cslow_122
cback_121:
    s_add_u32 s7, s48, 131072
    buffer_load_dwordx4 v[40:43], v6, s[8:11], s7 offen sc1
    v_lshlrev_b32 v104, 16, v56
    v_and_b32 v105, s38, v56
    v_pk_fma_f32 v[16:17], v[104:105], v[104:105], v[16:17]
    v_lshlrev_b32 v104, 16, v57
    v_and_b32 v105, s38, v57
    v_pk_fma_f32 v[18:19], v[104:105], v[104:105], v[18:19]
    v_lshlrev_b32 v104, 16, v58
    v_and_b32 v105, s38, v58
    v_pk_fma_f32 v[20:21], v[104:105], v[104:105], v[20:21]
    v_lshlrev_b32 v104, 16, v59
    v_and_b32 v105, s38, v59
    v_pk_fma_f32 v[22:23], v[104:105], v[104:105], v[22:23]
    s_add_u32 s7, s48, 135168
    buffer_load_dwordx4 v[44:47], v6, s[8:11], s7 offen sc1
    v_lshlrev_b32 v104, 16, v60
    v_and_b32 v105, s38, v60
    v_pk_fma_f32 v[16:17], v[104:105], v[104:105], v[16:17]
    v_lshlrev_b32 v104, 16, v61
    v_and_b32 v105, s38, v61
    v_pk_fma_f32 v[18:19], v[104:105], v[104:105], v[18:19]
    v_lshlrev_b32 v104, 16, v62
    v_and_b32 v105, s38, v62
    v_pk_fma_f32 v[20:21], v[104:105], v[104:105], v[20:21]
    v_lshlrev_b32 v104, 16, v63
    v_and_b32 v105, s38, v63
    v_pk_fma_f32 v[22:23], v[104:105], v[104:105], v[22:23]
    s_add_u32 s7, s48, 139264
    buffer_load_dwordx4 v[48:51], v6, s[8:11], s7 offen sc1
    v_lshlrev_b32 v104, 16, v64
    v_and_b32 v105, s38, v64
    v_pk_fma_f32 v[16:17], v[104:105], v[104:105], v[16:17]
    v_lshlrev_b32 v104, 16, v65
    v_and_b32 v105, s38, v65
    v_pk_fma_f32 v[18:19], v[104:105], v[104:105], v[18:19]
    v_lshlrev_b32 v104, 16, v66
    v_and_b32 v105, s38, v66
    v_pk_fma_f32 v[20:21], v[104:105], v[104:105], v[20:21]
    v_lshlrev_b32 v104, 16, v67
    v_and_b32 v105, s38, v67
    v_pk_fma_f32 v[22:23], v[104:105], v[104:105], v[22:23]
    s_add_u32 s7, s48, 143360
    buffer_load_dwordx4 v[52:55], v6, s[8:11], s7 offen sc1
    v_lshlrev_b32 v104, 16, v68
    v_and_b32 v105, s38, v68
    v_pk_fma_f32 v[16:17], v[104:105], v[104:105], v[16:17]
    v_lshlrev_b32 v104, 16, v69
    v_and_b32 v105, s38, v69
    v_pk_fma_f32 v[18:19], v[104:105], v[104:105], v[18:19]
    v_lshlrev_b32 v104, 16, v70
    v_and_b32 v105, s38, v70
    v_pk_fma_f32 v[20:21], v[104:105], v[104:105], v[20:21]
    v_lshlrev_b32 v104, 16, v71
    v_and_b32 v105, s38, v71
    v_pk_fma_f32 v[22:23], v[104:105], v[104:105], v[22:23]
    ds_write_b128 v8, v[16:19] offset:256
    ds_write_b128 v8, v[20:23] offset:272
    s_waitcnt vmcnt(9)
    v_or3_b32 v9, v72, v76, v80
    s_waitcnt vmcnt(8)
    v_or_b32 v9, v9, v84
    v_and_b32 v9, s40, v9
    v_cmp_ne_u32 vcc, 0, v9
    s_cbranch_vccnz cslow_124
cback_123:
    s_add_u32 s7, s48, 147456
    buffer_load_dwordx4 v[56:59], v6, s[8:11], s7 offen sc1
    v_cndmask_b32 v72, v72, 0, s[50:51]
    v_lshlrev_b32 v104, 16, v72
    v_and_b32 v105, s38, v72
    v_pk_mul_f32 v[24:25], v[104:105], v[104:105]
    v_cndmask_b32 v73, v73, 0, s[50:51]
    v_lshlrev_b32 v104, 16, v73
    v_and_b32 v105, s38, v73
    v_pk_mul_f32 v[26:27], v[104:105], v[104:105]
    v_cndmask_b32 v74, v74, 0, s[50:51]
    v_lshlrev_b32 v104, 16, v74
    v_and_b32 v105, s38, v74
    v_pk_mul_f32 v[28:29], v[104:105], v[104:105]
    v_cndmask_b32 v75, v75, 0, s[50:51]
    v_lshlrev_b32 v104, 16, v75
    v_and_b32 v105, s38, v75
    v_pk_mul_f32 v[30:31], v[104:105], v[104:105]
    s_add_u32 s7, s48, 151552
    buffer_load_dwordx4 v[60:63], v6, s[8:11], s7 offen sc1
    v_lshlrev_b32 v104, 16, v76
    v_and_b32 v105, s38, v76
    v_pk_fma_f32 v[24:25], v[104:105], v[104:105], v[24:25]
    v_lshlrev_b32 v104, 16, v77
    v_and_b32 v105, s38, v77
    v_pk_fma_f32 v[26:27], v[104:105], v[104:105], v[26:27]
    v_lshlrev_b32 v104, 16, v78
    v_and_b32 v105, s38, v78
    v_pk_fma_f32 v[28:29], v[104:105], v[104:105], v[28:29]
    v_lshlrev_b32 v104, 16, v79
    v_and_b32 v105, s38, v79
    v_pk_fma_f32 v[30:31], v[104:105], v[104:105], v[30:31]
    s_add_u32 s7, s48, 155648
    buffer_load_dwordx4 v[64:67], v6, s[8:11], s7 offen sc1
    v_lshlrev_b32 v104, 16, v80
    v_and_b32 v105, s38, v80
    v_pk_fma_f32 v[24:25], v[104:105], v[104:105], v[24:25]
    v_lshlrev_b32 v104, 16, v81
    v_and_b32 v105, s38, v81
    v_pk_fma_f32 v[26:27], v[104:105], v[104:105], v[26:27]
    v_lshlrev_b32 v104, 16, v82
    v_and_b32 v105, s38, v82
    v_pk_fma_f32 v[28:29], v[104:105], v[104:105], v[28:29]
    v_lshlrev_b32 v104, 16, v83
    v_and_b32 v105, s38, v83
    v_pk_fma_f32 v[30:31], v[104:105], v[104:105], v[30:31]
    s_add_u32 s7, s48, 159744
    buffer_load_dwordx4 v[68:71], v6, s[8:11], s7 offen sc1
    v_lshlrev_b32 v104, 16, v84
    v_and_b32 v105, s38, v84
    v_pk_fma_f32 v[24:25], v[104:105], v[104:105], v[24:25]
    v_lshlrev_b32 v104, 16, v85
    v_and_b32 v105, s38, v85
    v_pk_fma_f32 v[26:27], v[104:105], v[104:105], v[26:27]
    v_lshlrev_b32 v104, 16, v86
    v_and_b32 v105, s38, v86
    v_pk_fma_f32 v[28:29], v[104:105], v[104:105], v[28:29]
    v_lshlrev_b32 v104, 16, v87
    v_and_b32 v105, s38, v87
    v_pk_fma_f32 v[30:31], v[104:105], v[104:105], v[30:31]
    s_waitcnt vmcnt(9)
    v_or3_b32 v9, v88, v92, v96
    s_waitcnt vmcnt(8)
    v_or_b32 v9, v9, v100
    v_and_b32 v9, s40, v9
    v_cmp_ne_u32 vcc, 0, v9
    s_cbranch_vccnz cslow_126
cback_125:
    s_add_u32 s7, s48, 163840
    buffer_load_dwordx4 v[72:75], v6, s[8:11], s7 offen sc1
    v_lshlrev_b32 v104, 16, v88
    v_and_b32 v105, s38, v88
    v_pk_fma_f32 v[24:25], v[104:105], v[104:105], v[24:25]
    v_lshlrev_b32 v104, 16, v89
    v_and_b32 v105, s38, v89
    v_pk_fma_f32 v[26:27], v[104:105], v[104:105], v[26:27]
    v_lshlrev_b32 v104, 16, v90
    v_and_b32 v105, s38, v90
    v_pk_fma_f32 v[28:29], v[104:105], v[104:105], v[28:29]
    v_lshlrev_b32 v104, 16, v91
    v_and_b32 v105, s38, v91
    v_pk_fma_f32 v[30:31], v[104:105], v[104:105], v[30:31]
    s_add_u32 s7, s48, 167936
    buffer_load_dwordx4 v[76:79], v6, s[8:11], s7 offen sc1
    v_lshlrev_b32 v104, 16, v92
    v_and_b32 v105, s38, v92
    v_pk_fma_f32 v[24:25], v[104:105], v[104:105], v[24:25]
    v_lshlrev_b32 v104, 16, v93
    v_and_b32 v105, s38, v93
    v_pk_fma_f32 v[26:27], v[104:105], v[104:105], v[26:27]
    v_lshlrev_b32 v104, 16, v94
    v_and_b32 v105, s38, v94
    v_pk_fma_f32 v[28:29], v[104:105], v[104:105], v[28:29]
    v_lshlrev_b32 v104, 16, v95
    v_and_b32 v105, s38, v95
    v_pk_fma_f32 v[30:31], v[104:105], v[104:105], v[30:31]
    s_add_u32 s7, s48, 172032
    buffer_load_dwordx4 v[80:83], v6, s[8:11], s7 offen sc1
    v_lshlrev_b32 v104, 16, v96
    v_and_b32 v105, s38, v96
    v_pk_fma_f32 v[24:25], v[104:105], v[104:105], v[24:25]
    v_lshlrev_b32 v104, 16, v97
    v_and_b32 v105, s38, v97
    v_pk_fma_f32 v[26:27], v[104:105], v[104:105], v[26:27]
    v_lshlrev_b32 v104, 16, v98
    v_and_b32 v105, s38, v98
    v_pk_fma_f32 v[28:29], v[104:105], v[104:105], v[28:29]
    v_lshlrev_b32 v104, 16, v99
    v_and_b32 v105, s38, v99
    v_pk_fma_f32 v[30:31], v[104:105], v[104:105], v[30:31]
    s_add_u32 s7, s48, 176128
    buffer_load_dwordx4 v[84:87], v6, s[8:11], s7 offen sc1
    v_lshlrev_b32 v104, 16, v100
    v_and_b32 v105, s38, v100
    v_pk_fma_f32 v[24:25], v[104:105], v[104:105], v[24:25]
    v_lshlrev_b32 v104, 16, v101
    v_and_b32 v105, s38, v101
    v_pk_fma_f32 v[26:27], v[104:105], v[104:105], v[26:27]
    v_lshlrev_b32 v104, 16, v102
    v_and_b32 v105, s38, v102
    v_pk_fma_f32 v[28:29], v[104:105], v[104:105], v[28:29]
    v_lshlrev_b32 v104, 16, v103
    v_and_b32 v105, s38, v103
    v_pk_fma_f32 v[30:31], v[104:105], v[104:105], v[30:31]
    ds_write_b128 v8, v[24:27] offset:384
    ds_write_b128 v8, v[28:31] offset:400
    s_waitcnt vmcnt(9)
    v_or3_b32 v9, v40, v44, v48
    s_waitcnt vmcnt(8)
    v_or_b32 v9, v9, v52
    v_and_b32 v9, s73, v9
    v_cmp_ne_u32 vcc, 0, v9
    s_cbranch_vccnz cslow_128
cback_127:
    s_add_u32 s7, s48, 180224
    buffer_load_dwordx4 v[88:91], v6, s[8:11], s7 offen sc1
    v_cndmask_b32 v40, v40, 0, s[50:51]
    v_lshlrev_b32 v104, 16, v40
    v_and_b32 v105, s38, v40
    v_pk_mul_f32 v[16:17], v[104:105], v[104:105]
    v_cndmask_b32 v41, v41, 0, s[50:51]
    v_lshlrev_b32 v104, 16, v41
    v_and_b32 v105, s38, v41
    v_pk_mul_f32 v[18:19], v[104:105], v[104:105]
    v_cndmask_b32 v42, v42, 0, s[50:51]
    v_lshlrev_b32 v104, 16, v42
    v_and_b32 v105, s38, v42
    v_pk_mul_f32 v[20:21], v[104:105], v[104:105]
    v_cndmask_b32 v43, v43, 0, s[50:51]
    v_lshlrev_b32 v104, 16, v43
    v_and_b32 v105, s38, v43
    v_pk_mul_f32 v[22:23], v[104:105], v[104:105]
    s_add_u32 s7, s48, 184320
    buffer_load_dwordx4 v[92:95], v6, s[8:11], s7 offen sc1
    v_lshlrev_b32 v104, 16, v44
    v_and_b32 v105, s38, v44
    v_pk_fma_f32 v[16:17], v[104:105], v[104:105], v[16:17]
    v_lshlrev_b32 v104, 16, v45
    v_and_b32 v105, s38, v45
    v_pk_fma_f32 v[18:19], v[104:105], v[104:105], v[18:19]
    v_lshlrev_b32 v104, 16, v46
    v_and_b32 v105, s38, v46
    v_pk_fma_f32 v[20:21], v[104:105], v[104:105], v[20:21]
    v_lshlrev_b32 v104, 16, v47
    v_and_b32 v105, s38, v47
    v_pk_fma_f32 v[22:23], v[104:105], v[104:105], v[22:23]
    s_add_u32 s7, s48, 188416
    buffer_load_dwordx4 v[96:99], v6, s[8:11], s7 offen sc1
    v_lshlrev_b32 v104, 16, v48
    v_and_b32 v105, s38, v48
    v_pk_fma_f32 v[16:17], v[104:105], v[104:105], v[16:17]
    v_lshlrev_b32 v104, 16, v49
    v_and_b32 v105, s38, v49
    v_pk_fma_f32 v[18:19], v[104:105], v[104:105], v[18:19]
    v_lshlrev_b32 v104, 16, v50
    v_and_b32 v105, s38, v50
    v_pk_fma_f32 v[20:21], v[104:105], v[104:105], v[20:21]
    v_lshlrev_b32 v104, 16, v51
    v_and_b32 v105, s38, v51
    v_pk_fma_f32 v[22:23], v[104:105], v[104:105], v[22:23]
    s_add_u32 s7, s48, 192512
    buffer_load_dwordx4 v[100:103], v6, s[8:11], s7 offen sc1
    v_lshlrev_b32 v104, 16, v52
    v_and_b32 v105, s38, v52
    v_pk_fma_f32 v[16:17], v[104:105], v[104:105], v[16:17]
    v_lshlrev_b32 v104, 16, v53
    v_and_b32 v105, s38, v53
    v_pk_fma_f32 v[18:19], v[104:105], v[104:105], v[18:19]
    v_lshlrev_b32 v104, 16, v54
    v_and_b32 v105, s38, v54
    v_pk_fma_f32 v[20:21], v[104:105], v[104:105], v[20:21]
    v_lshlrev_b32 v104, 16, v55
    v_and_b32 v105, s38, v55
    v_pk_fma_f32 v[22:23], v[104:105], v[104:105], v[22:23]
    s_waitcnt vmcnt(9)
    v_or3_b32 v9, v56, v60, v64
    s_waitcnt vmcnt(8)
    v_or_b32 v9, v9, v68
    v_and_b32 v9, s73, v9
    v_cmp_ne_u32 vcc, 0, v9
    s_cbranch_vccnz cslow_130
cback_129:
    s_mov_b32 s1, 73728
    buffer_load_dwordx4 v[224:227], v14, s[56:59], s1 offen offset:0 sc1
    buffer_load_dwordx4 v[228:231], v14, s[60:63], s1 offen offset:0 sc1
    v_lshlrev_b32 v104, 16, v56
    v_and_b32 v105, s38, v56
    v_pk_fma_f32 v[16:17], v[104:105], v[104:105], v[16:17]
    v_lshlrev_b32 v104, 16, v57
    v_and_b32 v105, s38, v57
    v_pk_fma_f32 v[18:19], v[104:105], v[104:105], v[18:19]
    v_lshlrev_b32 v104, 16, v58
    v_and_b32 v105, s38, v58
    v_pk_fma_f32 v[20:21], v[104:105], v[104:105], v[20:21]
    v_lshlrev_b32 v104, 16, v59
    v_and_b32 v105, s38, v59
    v_pk_fma_f32 v[22:23], v[104:105], v[104:105], v[22:23]
    buffer_load_dwordx4 v[232:235], v14, s[56:59], s1 offen offset:128 sc1
    buffer_load_dwordx4 v[236:239], v14, s[60:63], s1 offen offset:128 sc1
    v_lshlrev_b32 v104, 16, v60
    v_and_b32 v105, s38, v60
    v_pk_fma_f32 v[16:17], v[104:105], v[104:105], v[16:17]
    v_lshlrev_b32 v104, 16, v61
    v_and_b32 v105, s38, v61
    v_pk_fma_f32 v[18:19], v[104:105], v[104:105], v[18:19]
    v_lshlrev_b32 v104, 16, v62
    v_and_b32 v105, s38, v62
    v_pk_fma_f32 v[20:21], v[104:105], v[104:105], v[20:21]
    v_lshlrev_b32 v104, 16, v63
    v_and_b32 v105, s38, v63
    v_pk_fma_f32 v[22:23], v[104:105], v[104:105], v[22:23]
    s_mov_b32 s1, 81920
    buffer_load_dwordx4 v[240:243], v14, s[56:59], s1 offen offset:0 sc1
    buffer_load_dwordx4 v[244:247], v14, s[60:63], s1 offen offset:0 sc1
    v_lshlrev_b32 v104, 16, v64
    v_and_b32 v105, s38, v64
    v_pk_fma_f32 v[16:17], v[104:105], v[104:105], v[16:17]
    v_lshlrev_b32 v104, 16, v65
    v_and_b32 v105, s38, v65
    v_pk_fma_f32 v[18:19], v[104:105], v[104:105], v[18:19]
    v_lshlrev_b32 v104, 16, v66
    v_and_b32 v105, s38, v66
    v_pk_fma_f32 v[20:21], v[104:105], v[104:105], v[20:21]
    v_lshlrev_b32 v104, 16, v67
    v_and_b32 v105, s38, v67
    v_pk_fma_f32 v[22:23], v[104:105], v[104:105], v[22:23]
    buffer_load_dwordx4 v[248:251], v14, s[56:59], s1 offen offset:128 sc1
    buffer_load_dwordx4 v[252:255], v14, s[60:63], s1 offen offset:128 sc1
    v_lshlrev_b32 v104, 16, v68
    v_and_b32 v105, s38, v68
    v_pk_fma_f32 v[16:17], v[104:105], v[104:105], v[16:17]
    v_lshlrev_b32 v104, 16, v69
    v_and_b32 v105, s38, v69
    v_pk_fma_f32 v[18:19], v[104:105], v[104:105], v[18:19]
    v_lshlrev_b32 v104, 16, v70
    v_and_b32 v105, s38, v70
    v_pk_fma_f32 v[20:21], v[104:105], v[104:105], v[20:21]
    v_lshlrev_b32 v104, 16, v71
    v_and_b32 v105, s38, v71
    v_pk_fma_f32 v[22:23], v[104:105], v[104:105], v[22:23]
    ds_write_b128 v8, v[16:19] offset:512
    ds_write_b128 v8, v[20:23] offset:528
    s_waitcnt vmcnt(13)
    v_or3_b32 v9, v72, v76, v80
    s_waitcnt vmcnt(12)
    v_or_b32 v9, v9, v84
    v_and_b32 v9, s73, v9
    v_cmp_ne_u32 vcc, 0, v9
    s_cbranch_vccnz cslow_132
cback_131:
    v_cndmask_b32 v72, v72, 0, s[50:51]
    v_lshlrev_b32 v104, 16, v72
    v_and_b32 v105, s38, v72
    v_pk_mul_f32 v[24:25], v[104:105], v[104:105]
    v_cndmask_b32 v73, v73, 0, s[50:51]
    v_lshlrev_b32 v104, 16, v73
    v_and_b32 v105, s38, v73
    v_pk_mul_f32 v[26:27], v[104:105], v[104:105]
    v_cndmask_b32 v74, v74, 0, s[50:51]
    v_lshlrev_b32 v104, 16, v74
    v_and_b32 v105, s38, v74
    v_pk_mul_f32 v[28:29], v[104:105], v[104:105]
    v_cndmask_b32 v75, v75, 0, s[50:51]
    v_lshlrev_b32 v104, 16, v75
    v_and_b32 v105, s38, v75
    v_pk_mul_f32 v[30:31], v[104:105], v[104:105]
    v_lshlrev_b32 v104, 16, v76
    v_and_b32 v105, s38, v76
    v_pk_fma_f32 v[24:25], v[104:105], v[104:105], v[24:25]
    v_lshlrev_b32 v104, 16, v77
    v_and_b32 v105, s38, v77
    v_pk_fma_f32 v[26:27], v[104:105], v[104:105], v[26:27]
    v_lshlrev_b32 v104, 16, v78
    v_and_b32 v105, s38, v78
    v_pk_fma_f32 v[28:29], v[104:105], v[104:105], v[28:29]
    v_lshlrev_b32 v104, 16, v79
    v_and_b32 v105, s38, v79
    v_pk_fma_f32 v[30:31], v[104:105], v[104:105], v[30:31]
    v_lshlrev_b32 v104, 16, v80
    v_and_b32 v105, s38, v80
    v_pk_fma_f32 v[24:25], v[104:105], v[104:105], v[24:25]
    v_lshlrev_b32 v104, 16, v81
    v_and_b32 v105, s38, v81
    v_pk_fma_f32 v[26:27], v[104:105], v[104:105], v[26:27]
    v_lshlrev_b32 v104, 16, v82
    v_and_b32 v105, s38, v82
    v_pk_fma_f32 v[28:29], v[104:105], v[104:105], v[28:29]
    v_lshlrev_b32 v104, 16, v83
    v_and_b32 v105, s38, v83
    v_pk_fma_f32 v[30:31], v[104:105], v[104:105], v[30:31]
    v_lshlrev_b32 v104, 16, v84
    v_and_b32 v105, s38, v84
    v_pk_fma_f32 v[24:25], v[104:105], v[104:105], v[24:25]
    v_lshlrev_b32 v104, 16, v85
    v_and_b32 v105, s38, v85
    v_pk_fma_f32 v[26:27], v[104:105], v[104:105], v[26:27]
    v_lshlrev_b32 v104, 16, v86
    v_and_b32 v105, s38, v86
    v_pk_fma_f32 v[28:29], v[104:105], v[104:105], v[28:29]
    v_lshlrev_b32 v104, 16, v87
    v_and_b32 v105, s38, v87
    v_pk_fma_f32 v[30:31], v[104:105], v[104:105], v[30:31]
    s_waitcnt vmcnt(9)
    v_or3_b32 v9, v88, v92, v96
    s_waitcnt vmcnt(8)
    v_or_b32 v9, v9, v100
    v_and_b32 v9, s73, v9
    v_cmp_ne_u32 vcc, 0, v9
    s_cbranch_vccnz cslow_134
cback_133:
    v_lshlrev_b32 v104, 16, v88
    v_and_b32 v105, s38, v88
    v_pk_fma_f32 v[24:25], v[104:105], v[104:105], v[24:25]
    v_lshlrev_b32 v104, 16, v89
    v_and_b32 v105, s38, v89
    v_pk_fma_f32 v[26:27], v[104:105], v[104:105], v[26:27]
    v_lshlrev_b32 v104, 16, v90
    v_and_b32 v105, s38, v90
    v_pk_fma_f32 v[28:29], v[104:105], v[104:105], v[28:29]
    v_lshlrev_b32 v104, 16, v91
    v_and_b32 v105, s38, v91
    v_pk_fma_f32 v[30:31], v[104:105], v[104:105], v[30:31]
    v_lshlrev_b32 v104, 16, v92
    v_and_b32 v105, s38, v92
    v_pk_fma_f32 v[24:25], v[104:105], v[104:105], v[24:25]
    v_lshlrev_b32 v104, 16, v93
    v_and_b32 v105, s38, v93
    v_pk_fma_f32 v[26:27], v[104:105], v[104:105], v[26:27]
    v_lshlrev_b32 v104, 16, v94
    v_and_b32 v105, s38, v94
    v_pk_fma_f32 v[28:29], v[104:105], v[104:105], v[28:29]
    v_lshlrev_b32 v104, 16, v95
    v_and_b32 v105, s38, v95
    v_pk_fma_f32 v[30:31], v[104:105], v[104:105], v[30:31]
    v_lshlrev_b32 v104, 16, v96
    v_and_b32 v105, s38, v96
    v_pk_fma_f32 v[24:25], v[104:105], v[104:105], v[24:25]
    v_lshlrev_b32 v104, 16, v97
    v_and_b32 v105, s38, v97
    v_pk_fma_f32 v[26:27], v[104:105], v[104:105], v[26:27]
    v_lshlrev_b32 v104, 16, v98
    v_and_b32 v105, s38, v98
    v_pk_fma_f32 v[28:29], v[104:105], v[104:105], v[28:29]
    v_lshlrev_b32 v104, 16, v99
    v_and_b32 v105, s38, v99
    v_pk_fma_f32 v[30:31], v[104:105], v[104:105], v[30:31]
    v_lshlrev_b32 v104, 16, v100
    v_and_b32 v105, s38, v100
    v_pk_fma_f32 v[24:25], v[104:105], v[104:105], v[24:25]
    v_lshlrev_b32 v104, 16, v101
    v_and_b32 v105, s38, v101
    v_pk_fma_f32 v[26:27], v[104:105], v[104:105], v[26:27]
    v_lshlrev_b32 v104, 16, v102
    v_and_b32 v105, s38, v102
    v_pk_fma_f32 v[28:29], v[104:105], v[104:105], v[28:29]
    v_lshlrev_b32 v104, 16, v103
    v_and_b32 v105, s38, v103
    v_pk_fma_f32 v[30:31], v[104:105], v[104:105], v[30:31]
    ds_write_b128 v8, v[24:27] offset:640
    ds_write_b128 v8, v[28:31] offset:656
    s_waitcnt lgkmcnt(0)
    s_barrier
    v_lshlrev_b32 v6, 2, v0
    ds_read2st64_b32 v[40:41], v6 offset0:0 offset1:3
    ds_read2st64_b32 v[42:43], v6 offset0:6 offset1:9
    ds_read2st64_b32 v[44:45], v6 offset0:12 offset1:15
    ds_read2st64_b32 v[46:47], v6 offset0:18 offset1:21
    ds_read2st64_b32 v[48:49], v6 offset0:24 offset1:27
    ds_read2st64_b32 v[50:51], v6 offset0:30 offset1:33
    ds_read2st64_b32 v[52:53], v6 offset0:36 offset1:39
    ds_read2st64_b32 v[54:55], v6 offset0:42 offset1:45
    ds_read2st64_b32 v[56:57], v6 offset0:48 offset1:51
    ds_read2st64_b32 v[58:59], v6 offset0:54 offset1:57
    ds_read2st64_b32 v[60:61], v6 offset0:60 offset1:63
    ds_read2st64_b32 v[62:63], v6 offset0:66 offset1:69
    ds_read2st64_b32 v[64:65], v6 offset0:72 offset1:75
    ds_read2st64_b32 v[66:67], v6 offset0:78 offset1:81
    ds_read2st64_b32 v[68:69], v6 offset0:84 offset1:87
    ds_read2st64_b32 v[70:71], v6 offset0:90 offset1:93
    ds_read2st64_b32 v[72:73], v6 offset0:96 offset1:99
    ds_read2st64_b32 v[74:75], v6 offset0:102 offset1:105
    ds_read2st64_b32 v[76:77], v6 offset0:108 offset1:111
    ds_read2st64_b32 v[78:79], v6 offset0:114 offset1:117
    ds_read2st64_b32 v[80:81], v6 offset0:120 offset1:123
    ds_read2st64_b32 v[82:83], v6 offset0:126 offset1:129
    ds_read2st64_b32 v[84:85], v6 offset0:132 offset1:135
    ds_read2st64_b32 v[86:87], v6 offset0:138 offset1:141
    ds_read2st64_b32 v[88:89], v6 offset0:144 offset1:147
    ds_read2st64_b32 v[90:91], v6 offset0:150 offset1:153
    ds_read2st64_b32 v[92:93], v6 offset0:156 offset1:159
    ds_read2st64_b32 v[94:95], v6 offset0:162 offset1:165
    ds_read2st64_b32 v[96:97], v6 offset0:168 offset1:171
    ds_read2st64_b32 v[98:99], v6 offset0:174 offset1:177
    ds_read2st64_b32 v[100:101], v6 offset0:180 offset1:183
    ds_read2st64_b32 v[102:103], v6 offset0:186 offset1:189
    s_waitcnt lgkmcnt(15)
    v_pk_add_f32 v[40:41], v[40:41], v[72:73]
    s_waitcnt lgkmcnt(14)
    v_pk_add_f32 v[42:43], v[42:43], v[74:75]
    s_waitcnt lgkmcnt(13)
    v_pk_add_f32 v[44:45], v[44:45], v[76:77]
    s_waitcnt lgkmcnt(12)
    v_pk_add_f32 v[46:47], v[46:47], v[78:79]
    s_waitcnt lgkmcnt(11)
    v_pk_add_f32 v[48:49], v[48:49], v[80:81]
    s_waitcnt lgkmcnt(10)
    v_pk_add_f32 v[50:51], v[50:51], v[82:83]
    s_waitcnt lgkmcnt(9)
    v_pk_add_f32 v[52:53], v[52:53], v[84:85]
    s_waitcnt lgkmcnt(8)
    v_pk_add_f32 v[54:55], v[54:55], v[86:87]
    s_waitcnt lgkmcnt(7)
    v_pk_add_f32 v[56:57], v[56:57], v[88:89]
    s_waitcnt lgkmcnt(6)
    v_pk_add_f32 v[58:59], v[58:59], v[90:91]
    s_waitcnt lgkmcnt(5)
    v_pk_add_f32 v[60:61], v[60:61], v[92:93]
    s_waitcnt lgkmcnt(4)
    v_pk_add_f32 v[62:63], v[62:63], v[94:95]
    s_waitcnt lgkmcnt(3)
    v_pk_add_f32 v[64:65], v[64:65], v[96:97]
    s_waitcnt lgkmcnt(2)
    v_pk_add_f32 v[66:67], v[66:67], v[98:99]
    s_waitcnt lgkmcnt(1)
    v_pk_add_f32 v[68:69], v[68:69], v[100:101]
    s_waitcnt lgkmcnt(0)
    v_pk_add_f32 v[70:71], v[70:71], v[102:103]
    v_pk_add_f32 v[40:41], v[40:41], v[56:57]
    v_pk_add_f32 v[42:43], v[42:43], v[58:59]
    v_pk_add_f32 v[44:45], v[44:45], v[60:61]
    v_pk_add_f32 v[46:47], v[46:47], v[62:63]
    v_pk_add_f32 v[48:49], v[48:49], v[64:65]
    v_pk_add_f32 v[50:51], v[50:51], v[66:67]
    v_pk_add_f32 v[52:53], v[52:53], v[68:69]
    v_pk_add_f32 v[54:55], v[54:55], v[70:71]
    v_pk_add_f32 v[40:41], v[40:41], v[48:49]
    v_pk_add_f32 v[42:43], v[42:43], v[50:51]
    v_pk_add_f32 v[44:45], v[44:45], v[52:53]
    v_pk_add_f32 v[46:47], v[46:47], v[54:55]
    v_pk_add_f32 v[40:41], v[40:41], v[44:45]
    v_pk_add_f32 v[42:43], v[42:43], v[46:47]
    v_pk_add_f32 v[40:41], v[40:41], v[42:43]
    v_add_f32 v40, v40, v41
    v_mov_b32 v8, 0x3727c5ac
    v_fmamk_f32 v40, v40, 0x3b000000, v8
    v_rcp_f32 v40, v40
    s_add_u32 s12, s34, 7348224
    s_addc_u32 s13, s35, 0
    s_mov_b32 s14, 8192
    s_mov_b32 s15, 0x20000
    s_mul_i32 s5, s44, 768
    v_mov_b32 v8, 16777216
    v_min_u32 v40, -2, v40
    v_cmp_gt_u32 vcc, 192, v0
    s_nop 1
    v_cndmask_b32 v6, v8, v6, vcc
    buffer_store_dword v40, v6, s[12:15], s5 offen sc1
    s_barrier
    s_add_u32 m0, s77, 0
    s_add_u32 s64, s72, 88064
    buffer_load_dwordx4 v39, s[56:59], s64 offen offset:0 sc1 lds
    buffer_load_dwordx4 v39, s[56:59], s64 offen offset:2048 sc1 lds
    s_add_u32 m0, s77, 1024
    s_add_u32 s64, s72, 88192
    buffer_load_dwordx4 v39, s[56:59], s64 offen offset:0 sc1 lds
    buffer_load_dwordx4 v39, s[56:59], s64 offen offset:2048 sc1 lds
    s_add_u32 m0, s77, 4096
    s_add_u32 s64, s72, 92160
    buffer_load_dwordx4 v39, s[56:59], s64 offen offset:0 sc1 lds
    buffer_load_dwordx4 v39, s[56:59], s64 offen offset:2048 sc1 lds
    s_add_u32 m0, s77, 5120
    s_add_u32 s64, s72, 92288
    buffer_load_dwordx4 v39, s[56:59], s64 offen offset:0 sc1 lds
    buffer_load_dwordx4 v39, s[56:59], s64 offen offset:2048 sc1 lds
    s_add_u32 m0, s67, 0
    s_add_u32 s83, s65, 0
    buffer_load_dwordx4 v2, s[8:11], s83 offen offset:0 sc1 lds
    buffer_load_dwordx4 v2, s[8:11], s83 offen offset:1024 sc1 lds
    buffer_load_dwordx4 v2, s[8:11], s83 offen offset:2048 sc1 lds
    buffer_load_dwordx4 v2, s[8:11], s83 offen offset:3072 sc1 lds
    s_add_u32 m0, s67, 16384
    s_add_u32 s83, s65, 4096
    buffer_load_dwordx4 v2, s[8:11], s83 offen offset:0 sc1 lds
    buffer_load_dwordx4 v2, s[8:11], s83 offen offset:1024 sc1 lds
    buffer_load_dwordx4 v2, s[8:11], s83 offen offset:2048 sc1 lds
    buffer_load_dwordx4 v2, s[8:11], s83 offen offset:3072 sc1 lds
    s_add_u32 m0, s67, 32768
    s_add_u32 s83, s66, 0
    buffer_load_dwordx4 v2, s[8:11], s83 offen offset:0 sc1 lds
    buffer_load_dwordx4 v2, s[8:11], s83 offen offset:1024 sc1 lds
    buffer_load_dwordx4 v2, s[8:11], s83 offen offset:2048 sc1 lds
    buffer_load_dwordx4 v2, s[8:11], s83 offen offset:3072 sc1 lds
    s_add_u32 m0, s67, 49152
    s_add_u32 s83, s66, 4096
    buffer_load_dwordx4 v2, s[8:11], s83 offen offset:0 sc1 lds
    buffer_load_dwordx4 v2, s[8:11], s83 offen offset:1024 sc1 lds
    buffer_load_dwordx4 v2, s[8:11], s83 offen offset:2048 sc1 lds
    buffer_load_dwordx4 v2, s[8:11], s83 offen offset:3072 sc1 lds
    buffer_load_dword v16, v114, s[68:71], s28 offen sc1
    buffer_load_dword v17, v118, s[68:71], s28 offen sc1
    buffer_load_dword v18, v114, s[68:71], s29 offen sc1
    buffer_load_dword v19, v118, s[68:71], s29 offen sc1
    s_add_u32 s79, s76, 0
    buffer_load_dwordx4 v[120:123], v4, s[16:19], s79 offen sc1
    s_add_u32 s79, s82, 0
    buffer_load_dwordx4 v[124:127], v4, s[16:19], s79 offen sc1
    s_add_u32 s79, s76, 8192
    buffer_load_dwordx4 v[128:131], v4, s[16:19], s79 offen sc1
    s_add_u32 s79, s82, 8192
    buffer_load_dwordx4 v[132:135], v4, s[16:19], s79 offen sc1
    s_add_u32 s79, s76, 16384
    buffer_load_dwordx4 v[136:139], v4, s[16:19], s79 offen sc1
    s_add_u32 s79, s82, 16384
    buffer_load_dwordx4 v[140:143], v4, s[16:19], s79 offen sc1
    s_add_u32 s79, s76, 24576
    buffer_load_dwordx4 v[144:147], v4, s[16:19], s79 offen sc1
    s_add_u32 s79, s82, 24576
    buffer_load_dwordx4 v[148:151], v4, s[16:19], s79 offen sc1
    s_add_u32 s79, s76, 32768
    buffer_load_dwordx4 v[152:155], v4, s[16:19], s79 offen sc1
    s_add_u32 s79, s82, 32768
    buffer_load_dwordx4 v[156:159], v4, s[16:19], s79 offen sc1
    s_add_u32 s79, s76, 40960
    buffer_load_dwordx4 v[160:163], v4, s[16:19], s79 offen sc1
    s_waitcnt vmcnt(0)
L_g21:
    s_nop 1
    s_waitcnt vmcnt(14)
    v_max3_u32 v3, v16, v17, v18
    s_waitcnt vmcnt(13)
    v_max_u32 v3, v3, v19
    v_cmp_eq_u32 vcc, -1, v3
    s_cbranch_vccnz cslow_136
cback_135:
    v_rcp_f32 v104, v16
    v_rcp_f32 v106, v17
    v_rcp_f32 v108, v18
    v_rcp_f32 v110, v19
    s_mov_b32 s39, 0
ctredo_137:
    ds_read_b128 a[0:3], v116 offset:0
    ds_read_b128 a[4:7], v116 offset:1024
    ds_read_b64_tr_b16 v[24:25], v115 offset:0
    ds_read_b64_tr_b16 v[26:27], v115 offset:512
    ds_read_b64_tr_b16 v[28:29], v119 offset:0
    ds_read_b64_tr_b16 v[30:31], v119 offset:512
    ds_read_b128 a[8:11], v116 offset:2048
    ds_read_b128 a[12:15], v116 offset:3072
    ds_read_b64_tr_b16 v[32:33], v115 offset:2048
    s_add_u32 s79, s82, 40960
    buffer_load_dwordx4 v[164:167], v4, s[16:19], s79 offen sc1
    ds_read_b64_tr_b16 v[34:35], v115 offset:2560
    s_waitcnt lgkmcnt(6)
    v_mfma_f32_16x16x32_bf16 v[40:43], a[0:3], v[24:27], 0
    v_or3_b32 v20, v24, v25, 0
    v_mfma_f32_16x16x32_bf16 v[44:47], a[4:7], v[24:27], 0
    v_or3_b32 v20, v26, v27, v20
    ds_read_b64_tr_b16 v[36:37], v119 offset:2048
    ds_read_b64_tr_b16 v[38:39], v119 offset:2560
    s_waitcnt lgkmcnt(6)
    v_mfma_f32_16x16x32_bf16 v[48:51], a[0:3], v[28:31], 0
    s_add_u32 s79, s76, 49152
    buffer_load_dwordx4 v[168:171], v4, s[16:19], s79 offen sc1
    v_or3_b32 v20, v28, v29, v20
    v_mfma_f32_16x16x32_bf16 v[52:55], a[4:7], v[28:31], 0
    v_or3_b32 v20, v30, v31, v20
    ds_read_b128 a[16:19], v116 offset:4096
    ds_read_b128 a[20:23], v116 offset:5120
    ds_read_b64_tr_b16 v[24:25], v115 offset:16384
    ds_read_b64_tr_b16 v[26:27], v115 offset:16896
    s_waitcnt lgkmcnt(6)
    v_mfma_f32_16x16x32_bf16 v[56:59], a[8:11], v[32:35], 0
    v_or3_b32 v20, v32, v33, v20
    v_mfma_f32_16x16x32_bf16 v[60:63], a[12:15], v[32:35], 0
    s_add_u32 s79, s82, 49152
    buffer_load_dwordx4 v[172:175], v4, s[16:19], s79 offen sc1
    v_or3_b32 v20, v34, v35, v20
    ds_read_b64_tr_b16 v[28:29], v119 offset:16384
    ds_read_b64_tr_b16 v[30:31], v119 offset:16896
    s_waitcnt lgkmcnt(6)
    v_mfma_f32_16x16x32_bf16 v[64:67], a[8:11], v[36:39], 0
    v_or3_b32 v20, v36, v37, v20
    v_mfma_f32_16x16x32_bf16 v[68:71], a[12:15], v[36:39], 0
    v_or3_b32 v20, v38, v39, v20
    ds_read_b128 a[24:27], v116 offset:6144
    ds_read_b128 a[28:31], v116 offset:7168
    ds_read_b64_tr_b16 v[32:33], v115 offset:18432
    s_add_u32 s79, s76, 57344
    buffer_load_dwordx4 v[176:179], v4, s[16:19], s79 offen sc1
    ds_read_b64_tr_b16 v[34:35], v115 offset:18944
    s_waitcnt lgkmcnt(6)
    v_mfma_f32_16x16x32_bf16 v[40:43], a[16:19], v[24:27], v[40:43]
    v_or3_b32 v20, v24, v25, v20
    v_mfma_f32_16x16x32_bf16 v[44:47], a[20:23], v[24:27], v[44:47]
    v_or3_b32 v20, v26, v27, v20
    ds_read_b64_tr_b16 v[36:37], v119 offset:18432
    ds_read_b64_tr_b16 v[38:39], v119 offset:18944
    s_waitcnt lgkmcnt(6)
    v_mfma_f32_16x16x32_bf16 v[48:51], a[16:19], v[28:31], v[48:51]
    s_add_u32 s79, s82, 57344
    buffer_load_dwordx4 v[180:183], v4, s[16:19], s79 offen sc1
    v_or3_b32 v20, v28, v29, v20
    v_mfma_f32_16x16x32_bf16 v[52:55], a[20:23], v[28:31], v[52:55]
    v_or3_b32 v20, v30, v31, v20
    ds_read_b64_tr_b16 v[24:25], v115 offset:32768
    ds_read_b64_tr_b16 v[26:27], v115 offset:33280
    s_waitcnt lgkmcnt(4)
    v_mfma_f32_16x16x32_bf16 v[56:59], a[24:27], v[32:35], v[56:59]
    v_or3_b32 v20, v32, v33, v20
    v_mfma_f32_16x16x32_bf16 v[60:63], a[28:31], v[32:35], v[60:63]
    v_or3_b32 v20, v34, v35, v20
    s_add_u32 s79, s76, 65536
    buffer_load_dwordx4 v[184:187], v4, s[16:19], s79 offen sc1
    ds_read_b64_tr_b16 v[28:29], v119 offset:32768
    ds_read_b64_tr_b16 v[30:31], v119 offset:33280
    s_waitcnt lgkmcnt(4)
    v_mfma_f32_16x16x32_bf16 v[64:67], a[24:27], v[36:39], v[64:67]
    v_or3_b32 v20, v36, v37, v20
    v_mfma_f32_16x16x32_bf16 v[68:71], a[28:31], v[36:39], v[68:71]
    v_or3_b32 v20, v38, v39, v20
    ds_read_b64_tr_b16 v[32:33], v115 offset:34816
    ds_read_b64_tr_b16 v[34:35], v115 offset:35328
    s_waitcnt lgkmcnt(4)
    v_mfma_f32_16x16x32_bf16 v[72:75], a[0:3], v[24:27], 0
    s_add_u32 s79, s82, 65536
    buffer_load_dwordx4 v[188:191], v4, s[16:19], s79 offen sc1
    v_or3_b32 v20, v24, v25, v20
    v_mfma_f32_16x16x32_bf16 v[76:79], a[4:7], v[24:27], 0
    v_or3_b32 v20, v26, v27, v20
    ds_read_b64_tr_b16 v[36:37], v119 offset:34816
    ds_read_b64_tr_b16 v[38:39], v119 offset:35328
    s_waitcnt lgkmcnt(4)
    v_mfma_f32_16x16x32_bf16 v[80:83], a[0:3], v[28:31], 0
    v_or3_b32 v20, v28, v29, v20
    v_mfma_f32_16x16x32_bf16 v[84:87], a[4:7], v[28:31], 0
    v_or3_b32 v20, v30, v31, v20
    s_add_u32 s79, s76, 73728
    buffer_load_dwordx4 v[192:195], v4, s[16:19], s79 offen sc1
    ds_read_b64_tr_b16 v[24:25], v115 offset:49152
    ds_read_b64_tr_b16 v[26:27], v115 offset:49664
    s_waitcnt lgkmcnt(4)
    v_mfma_f32_16x16x32_bf16 v[88:91], a[8:11], v[32:35], 0
    v_or3_b32 v20, v32, v33, v20
    v_mfma_f32_16x16x32_bf16 v[92:95], a[12:15], v[32:35], 0
    v_or3_b32 v20, v34, v35, v20
    ds_read_b64_tr_b16 v[28:29], v119 offset:49152
    ds_read_b64_tr_b16 v[30:31], v119 offset:49664
    s_waitcnt lgkmcnt(4)
    v_mfma_f32_16x16x32_bf16 v[96:99], a[8:11], v[36:39], 0
    s_add_u32 s79, s82, 73728
    buffer_load_dwordx4 v[196:199], v4, s[16:19], s79 offen sc1
    v_or3_b32 v20, v36, v37, v20
    v_mfma_f32_16x16x32_bf16 v[100:103], a[12:15], v[36:39], 0
    v_or3_b32 v20, v38, v39, v20
    ds_read_b64_tr_b16 v[32:33], v115 offset:51200
    ds_read_b64_tr_b16 v[34:35], v115 offset:51712
    s_waitcnt lgkmcnt(4)
    v_mfma_f32_16x16x32_bf16 v[72:75], a[16:19], v[24:27], v[72:75]
    v_or3_b32 v20, v24, v25, v20
    v_mfma_f32_16x16x32_bf16 v[76:79], a[20:23], v[24:27], v[76:79]
    v_or3_b32 v20, v26, v27, v20
    s_add_u32 s79, s76, 81920
    buffer_load_dwordx4 v[200:203], v4, s[16:19], s79 offen sc1
    ds_read_b64_tr_b16 v[36:37], v119 offset:51200
    ds_read_b64_tr_b16 v[38:39], v119 offset:51712
    s_waitcnt lgkmcnt(4)
    v_mfma_f32_16x16x32_bf16 v[80:83], a[16:19], v[28:31], v[80:83]
    v_or3_b32 v20, v28, v29, v20
    v_mfma_f32_16x16x32_bf16 v[84:87], a[20:23], v[28:31], v[84:87]
    v_or3_b32 v20, v30, v31, v20
    s_waitcnt lgkmcnt(2)
    v_mfma_f32_16x16x32_bf16 v[88:91], a[24:27], v[32:35], v[88:91]
    v_or3_b32 v20, v32, v33, v20
    v_mfma_f32_16x16x32_bf16 v[92:95], a[28:31], v[32:35], v[92:95]
    s_add_u32 s79, s82, 81920
    buffer_load_dwordx4 v[204:207], v4, s[16:19], s79 offen sc1
    v_or3_b32 v20, v34, v35, v20
    s_waitcnt lgkmcnt(0)
    v_mfma_f32_16x16x32_bf16 v[96:99], a[24:27], v[36:39], v[96:99]
    v_or3_b32 v20, v36, v37, v20
    v_mfma_f32_16x16x32_bf16 v[100:103], a[28:31], v[36:39], v[100:103]
    v_or3_b32 v20, v38, v39, v20
    v_and_b32 v20, v117, v20
    v_cmp_ne_u32 vcc, 0, v20
    s_cbranch_vccnz ctslow_138
ctgo_139:
    v_pk_mul_f32 v[22:23], v[40:41], v[104:105] op_sel_hi:[1,0]
    v_pk_fma_f32 v[40:41], v[56:57], v[104:105], v[22:23] op_sel_hi:[1,0,1]
    v_pk_fma_f32 v[56:57], v[56:57], v[104:105], v[22:23] op_sel_hi:[1,0,1] neg_lo:[1,0,0] neg_hi:[1,0,0]
    v_pk_mul_f32 v[22:23], v[42:43], v[104:105] op_sel_hi:[1,0]
    v_pk_fma_f32 v[42:43], v[58:59], v[104:105], v[22:23] op_sel_hi:[1,0,1]
    v_pk_fma_f32 v[58:59], v[58:59], v[104:105], v[22:23] op_sel_hi:[1,0,1] neg_lo:[1,0,0] neg_hi:[1,0,0]
    v_pk_mul_f32 v[22:23], v[44:45], v[104:105] op_sel_hi:[1,0]
    v_pk_fma_f32 v[44:45], v[60:61], v[104:105], v[22:23] op_sel_hi:[1,0,1]
    v_pk_fma_f32 v[60:61], v[60:61], v[104:105], v[22:23] op_sel_hi:[1,0,1] neg_lo:[1,0,0] neg_hi:[1,0,0]
    v_pk_mul_f32 v[22:23], v[46:47], v[104:105] op_sel_hi:[1,0]
    v_pk_fma_f32 v[46:47], v[62:63], v[104:105], v[22:23] op_sel_hi:[1,0,1]
    v_pk_fma_f32 v[62:63], v[62:63], v[104:105], v[22:23] op_sel_hi:[1,0,1] neg_lo:[1,0,0] neg_hi:[1,0,0]
    v_pk_mul_f32 v[22:23], v[48:49], v[106:107] op_sel_hi:[1,0]
    v_pk_fma_f32 v[48:49], v[64:65], v[106:107], v[22:23] op_sel_hi:[1,0,1]
    v_pk_fma_f32 v[64:65], v[64:65], v[106:107], v[22:23] op_sel_hi:[1,0,1] neg_lo:[1,0,0] neg_hi:[1,0,0]
    v_pk_mul_f32 v[22:23], v[50:51], v[106:107] op_sel_hi:[1,0]
    v_pk_fma_f32 v[50:51], v[66:67], v[106:107], v[22:23] op_sel_hi:[1,0,1]
    v_pk_fma_f32 v[66:67], v[66:67], v[106:107], v[22:23] op_sel_hi:[1,0,1] neg_lo:[1,0,0] neg_hi:[1,0,0]
    v_pk_mul_f32 v[22:23], v[52:53], v[106:107] op_sel_hi:[1,0]
    v_pk_fma_f32 v[52:53], v[68:69], v[106:107], v[22:23] op_sel_hi:[1,0,1]
    v_pk_fma_f32 v[68:69], v[68:69], v[106:107], v[22:23] op_sel_hi:[1,0,1] neg_lo:[1,0,0] neg_hi:[1,0,0]
    v_pk_mul_f32 v[22:23], v[54:55], v[106:107] op_sel_hi:[1,0]
    v_pk_fma_f32 v[54:55], v[70:71], v[106:107], v[22:23] op_sel_hi:[1,0,1]
    v_pk_fma_f32 v[70:71], v[70:71], v[106:107], v[22:23] op_sel_hi:[1,0,1] neg_lo:[1,0,0] neg_hi:[1,0,0]
    s_waitcnt vmcnt(22)
    v_and_b32 v3, v120, v124
    v_and_b32 v3, 1, v3
    v_cmp_ne_u32 s[6:7], 1, v3
    s_nop 0
    s_mov_b64 vcc, s[6:7]
    s_cbranch_vccnz cslow_141
cback_140:
    v_mfma_f32_16x16x32_bf16 v[40:43], a[128:131], v[120:123], v[40:43]
    v_mul_f32 v22, v108, v72
    v_fma_f32 v72, v88, v108, v22
    v_mfma_f32_16x16x32_bf16 v[44:47], a[136:139], v[120:123], v[44:47]
    v_fma_f32 v88, -v88, v108, v22
    v_mul_f32 v23, v108, v73
    v_mfma_f32_16x16x32_bf16 v[56:59], a[132:135], v[120:123], v[56:59]
    v_fma_f32 v73, v89, v108, v23
    v_fma_f32 v89, -v89, v108, v23
    v_mfma_f32_16x16x32_bf16 v[60:63], a[140:143], v[120:123], v[60:63]
    v_mul_f32 v22, v108, v74
    v_fma_f32 v74, v90, v108, v22
    v_mfma_f32_16x16x32_bf16 v[48:51], a[128:131], v[124:127], v[48:51]
    s_waitcnt vmcnt(18)
    v_bitop3_b32 v3, v128, v132, v136 bitop3:0x80
    s_waitcnt vmcnt(17)
    v_and_b32 v3, v3, v140
    v_mfma_f32_16x16x32_bf16 v[52:55], a[136:139], v[124:127], v[52:55]
    v_and_b32 v3, 1, v3
    v_cmp_ne_u32 s[6:7], 1, v3
    v_mfma_f32_16x16x32_bf16 v[64:67], a[132:135], v[124:127], v[64:67]
    v_mfma_f32_16x16x32_bf16 v[68:71], a[140:143], v[124:127], v[68:71]
    s_mov_b64 vcc, s[6:7]
    s_cbranch_vccnz cslow_143
cback_142:
    v_mfma_f32_16x16x32_bf16 v[40:43], a[144:147], v[128:131], v[40:43]
    v_fma_f32 v90, -v90, v108, v22
    v_mul_f32 v23, v108, v75
    v_mfma_f32_16x16x32_bf16 v[44:47], a[152:155], v[128:131], v[44:47]
    v_fma_f32 v75, v91, v108, v23
    v_fma_f32 v91, -v91, v108, v23
    v_mfma_f32_16x16x32_bf16 v[56:59], a[148:151], v[128:131], v[56:59]
    v_mul_f32 v22, v108, v76
    v_fma_f32 v76, v92, v108, v22
    s_add_u32 s79, s76, 0
    buffer_load_dwordx4 v[120:123], v4, s[20:23], s79 offen sc1
    v_mfma_f32_16x16x32_bf16 v[60:63], a[156:159], v[128:131], v[60:63]
    v_fma_f32 v92, -v92, v108, v22
    v_mul_f32 v23, v108, v77
    v_mfma_f32_16x16x32_bf16 v[48:51], a[144:147], v[132:135], v[48:51]
    v_fma_f32 v77, v93, v108, v23
    v_fma_f32 v93, -v93, v108, v23
    v_mfma_f32_16x16x32_bf16 v[52:55], a[152:155], v[132:135], v[52:55]
    s_add_u32 s79, s82, 0
    buffer_load_dwordx4 v[124:127], v4, s[20:23], s79 offen sc1
    v_mfma_f32_16x16x32_bf16 v[64:67], a[148:151], v[132:135], v[64:67]
    v_mul_f32 v22, v108, v78
    v_fma_f32 v78, v94, v108, v22
    v_mfma_f32_16x16x32_bf16 v[68:71], a[156:159], v[132:135], v[68:71]
    v_fma_f32 v94, -v94, v108, v22
    v_mul_f32 v23, v108, v79
    v_mfma_f32_16x16x32_bf16 v[40:43], a[160:163], v[136:139], v[40:43]
    s_add_u32 s79, s76, 8192
    buffer_load_dwordx4 v[128:131], v4, s[20:23], s79 offen sc1
    v_mfma_f32_16x16x32_bf16 v[44:47], a[168:171], v[136:139], v[44:47]
    v_fma_f32 v79, v95, v108, v23
    v_fma_f32 v95, -v95, v108, v23
    v_mfma_f32_16x16x32_bf16 v[56:59], a[164:167], v[136:139], v[56:59]
    v_mul_f32 v22, v110, v80
    v_fma_f32 v80, v96, v110, v22
    v_mfma_f32_16x16x32_bf16 v[60:63], a[172:175], v[136:139], v[60:63]
    s_add_u32 s79, s82, 8192
    buffer_load_dwordx4 v[132:135], v4, s[20:23], s79 offen sc1
    v_mfma_f32_16x16x32_bf16 v[48:51], a[160:163], v[140:143], v[48:51]
    s_waitcnt vmcnt(18)
    v_bitop3_b32 v3, v144, v148, v152 bitop3:0x80
    s_waitcnt vmcnt(17)
    v_and_b32 v3, v3, v156
    v_mfma_f32_16x16x32_bf16 v[52:55], a[168:171], v[140:143], v[52:55]
    v_and_b32 v3, 1, v3
    v_cmp_ne_u32 s[6:7], 1, v3
    v_mfma_f32_16x16x32_bf16 v[64:67], a[164:167], v[140:143], v[64:67]
    s_add_u32 s79, s76, 16384
    buffer_load_dwordx4 v[136:139], v4, s[20:23], s79 offen sc1
    v_mfma_f32_16x16x32_bf16 v[68:71], a[172:175], v[140:143], v[68:71]
    s_mov_b64 vcc, s[6:7]
    s_cbranch_vccnz cslow_145
cback_144:
    v_mfma_f32_16x16x32_bf16 v[40:43], a[176:179], v[144:147], v[40:43]
    v_fma_f32 v96, -v96, v110, v22
    v_mul_f32 v23, v110, v81
    v_mfma_f32_16x16x32_bf16 v[44:47], a[184:187], v[144:147], v[44:47]
    s_add_u32 s79, s82, 16384
    buffer_load_dwordx4 v[140:143], v4, s[20:23], s79 offen sc1
    v_mfma_f32_16x16x32_bf16 v[56:59], a[180:183], v[144:147], v[56:59]
    v_fma_f32 v81, v97, v110, v23
    v_fma_f32 v97, -v97, v110, v23
    v_mfma_f32_16x16x32_bf16 v[60:63], a[188:191], v[144:147], v[60:63]
    v_mul_f32 v22, v110, v82
    v_fma_f32 v82, v98, v110, v22
    v_mfma_f32_16x16x32_bf16 v[48:51], a[176:179], v[148:151], v[48:51]
    v_fma_f32 v98, -v98, v110, v22
    v_mul_f32 v23, v110, v83
    v_mfma_f32_16x16x32_bf16 v[52:55], a[184:187], v[148:151], v[52:55]
    v_fma_f32 v83, v99, v110, v23
    v_fma_f32 v99, -v99, v110, v23
    v_mfma_f32_16x16x32_bf16 v[64:67], a[180:183], v[148:151], v[64:67]
    v_mul_f32 v22, v110, v84
    v_fma_f32 v84, v100, v110, v22
    s_add_u32 s79, s76, 24576
    buffer_load_dwordx4 v[144:147], v4, s[20:23], s79 offen sc1
    v_mfma_f32_16x16x32_bf16 v[68:71], a[188:191], v[148:151], v[68:71]
    v_fma_f32 v100, -v100, v110, v22
    v_mul_f32 v23, v110, v85
    v_mfma_f32_16x16x32_bf16 v[40:43], a[192:195], v[152:155], v[40:43]
    v_fma_f32 v85, v101, v110, v23
    v_fma_f32 v101, -v101, v110, v23
    v_mfma_f32_16x16x32_bf16 v[44:47], a[200:203], v[152:155], v[44:47]
    s_add_u32 s79, s82, 24576
    buffer_load_dwordx4 v[148:151], v4, s[20:23], s79 offen sc1
    v_mfma_f32_16x16x32_bf16 v[56:59], a[196:199], v[152:155], v[56:59]
    v_mul_f32 v22, v110, v86
    v_fma_f32 v86, v102, v110, v22
    v_mfma_f32_16x16x32_bf16 v[60:63], a[204:207], v[152:155], v[60:63]
    v_fma_f32 v102, -v102, v110, v22
    v_mul_f32 v23, v110, v87
    v_mfma_f32_16x16x32_bf16 v[48:51], a[192:195], v[156:159], v[48:51]
    s_waitcnt vmcnt(17)
    v_bitop3_b32 v3, v160, v164, v168 bitop3:0x80
    s_waitcnt vmcnt(16)
    v_and_b32 v3, v3, v172
    v_mfma_f32_16x16x32_bf16 v[52:55], a[200:203], v[156:159], v[52:55]
    v_and_b32 v3, 1, v3
    v_cmp_ne_u32 s[6:7], 1, v3
    v_mfma_f32_16x16x32_bf16 v[64:67], a[196:199], v[156:159], v[64:67]
    v_mfma_f32_16x16x32_bf16 v[68:71], a[204:207], v[156:159], v[68:71]
    s_add_u32 s79, s76, 32768
    buffer_load_dwordx4 v[152:155], v4, s[20:23], s79 offen sc1
    s_mov_b64 vcc, s[6:7]
    s_cbranch_vccnz cslow_147
cback_146:
    v_mfma_f32_16x16x32_bf16 v[40:43], a[208:211], v[160:163], v[40:43]
    v_fma_f32 v87, v103, v110, v23
    v_fma_f32 v103, -v103, v110, v23
    v_mfma_f32_16x16x32_bf16 v[44:47], a[216:219], v[160:163], v[44:47]
    s_barrier
    s_add_u32 s79, s82, 32768
    buffer_load_dwordx4 v[156:159], v4, s[20:23], s79 offen sc1
    v_mfma_f32_16x16x32_bf16 v[56:59], a[212:215], v[160:163], v[56:59]
    v_mfma_f32_16x16x32_bf16 v[60:63], a[220:223], v[160:163], v[60:63]
    v_mfma_f32_16x16x32_bf16 v[48:51], a[208:211], v[164:167], v[48:51]
    v_mfma_f32_16x16x32_bf16 v[52:55], a[216:219], v[164:167], v[52:55]
    s_add_u32 s79, s76, 40960
    buffer_load_dwordx4 v[160:163], v4, s[20:23], s79 offen sc1
    v_mfma_f32_16x16x32_bf16 v[64:67], a[212:215], v[164:167], v[64:67]
    v_mfma_f32_16x16x32_bf16 v[68:71], a[220:223], v[164:167], v[68:71]
    v_mfma_f32_16x16x32_bf16 v[40:43], a[224:227], v[168:171], v[40:43]
    v_mfma_f32_16x16x32_bf16 v[44:47], a[232:235], v[168:171], v[44:47]
    s_add_u32 s79, s82, 40960
    buffer_load_dwordx4 v[164:167], v4, s[20:23], s79 offen sc1
    v_mfma_f32_16x16x32_bf16 v[56:59], a[228:231], v[168:171], v[56:59]
    v_mfma_f32_16x16x32_bf16 v[60:63], a[236:239], v[168:171], v[60:63]
    v_mfma_f32_16x16x32_bf16 v[48:51], a[224:227], v[172:175], v[48:51]
    s_waitcnt vmcnt(17)
    v_bitop3_b32 v3, v176, v180, v184 bitop3:0x80
    s_waitcnt vmcnt(16)
    v_and_b32 v3, v3, v188
    s_add_u32 s79, s76, 49152
    buffer_load_dwordx4 v[168:171], v4, s[20:23], s79 offen sc1
    v_mfma_f32_16x16x32_bf16 v[52:55], a[232:235], v[172:175], v[52:55]
    v_and_b32 v3, 1, v3
    v_cmp_ne_u32 s[6:7], 1, v3
    v_mfma_f32_16x16x32_bf16 v[64:67], a[228:231], v[172:175], v[64:67]
    v_mfma_f32_16x16x32_bf16 v[68:71], a[236:239], v[172:175], v[68:71]
    s_mov_b64 vcc, s[6:7]
    s_cbranch_vccnz cslow_149
cback_148:
    v_mfma_f32_16x16x32_bf16 v[40:43], a[240:243], v[176:179], v[40:43]
    v_mfma_f32_16x16x32_bf16 v[44:47], a[248:251], v[176:179], v[44:47]
    v_mfma_f32_16x16x32_bf16 v[56:59], a[244:247], v[176:179], v[56:59]
    v_mfma_f32_16x16x32_bf16 v[60:63], a[252:255], v[176:179], v[60:63]
    s_add_u32 s79, s82, 49152
    buffer_load_dwordx4 v[172:175], v4, s[20:23], s79 offen sc1
    v_mfma_f32_16x16x32_bf16 v[48:51], a[240:243], v[180:183], v[48:51]
    v_mfma_f32_16x16x32_bf16 v[52:55], a[248:251], v[180:183], v[52:55]
    v_mfma_f32_16x16x32_bf16 v[64:67], a[244:247], v[180:183], v[64:67]
    v_mfma_f32_16x16x32_bf16 v[68:71], a[252:255], v[180:183], v[68:71]
    s_add_u32 s79, s76, 57344
    buffer_load_dwordx4 v[176:179], v4, s[20:23], s79 offen sc1
    v_mfma_f32_16x16x32_bf16 v[40:43], v[208:211], v[184:187], v[40:43]
    v_mfma_f32_16x16x32_bf16 v[44:47], v[216:219], v[184:187], v[44:47]
    v_mfma_f32_16x16x32_bf16 v[56:59], v[212:215], v[184:187], v[56:59]
    v_mfma_f32_16x16x32_bf16 v[60:63], v[220:223], v[184:187], v[60:63]
    s_add_u32 s79, s82, 57344
    buffer_load_dwordx4 v[180:183], v4, s[20:23], s79 offen sc1
    v_mfma_f32_16x16x32_bf16 v[48:51], v[208:211], v[188:191], v[48:51]
    s_waitcnt vmcnt(17)
    v_bitop3_b32 v3, v192, v196, v200 bitop3:0x80
    s_waitcnt vmcnt(16)
    v_and_b32 v3, v3, v204
    v_mfma_f32_16x16x32_bf16 v[52:55], v[216:219], v[188:191], v[52:55]
    v_and_b32 v3, 1, v3
    v_cmp_ne_u32 s[6:7], 1, v3
    v_mfma_f32_16x16x32_bf16 v[64:67], v[212:215], v[188:191], v[64:67]
    s_add_u32 s79, s76, 65536
    buffer_load_dwordx4 v[184:187], v4, s[20:23], s79 offen sc1
    v_mfma_f32_16x16x32_bf16 v[68:71], v[220:223], v[188:191], v[68:71]
    s_mov_b64 vcc, s[6:7]
    s_cbranch_vccnz cslow_151
cback_150:
    v_mfma_f32_16x16x32_bf16 v[40:43], v[224:227], v[192:195], v[40:43]
    v_mfma_f32_16x16x32_bf16 v[44:47], v[232:235], v[192:195], v[44:47]
    v_mfma_f32_16x16x32_bf16 v[56:59], v[228:231], v[192:195], v[56:59]
    s_add_u32 s79, s82, 65536
    buffer_load_dwordx4 v[188:191], v4, s[20:23], s79 offen sc1
    v_mfma_f32_16x16x32_bf16 v[60:63], v[236:239], v[192:195], v[60:63]
    v_mfma_f32_16x16x32_bf16 v[48:51], v[224:227], v[196:199], v[48:51]
    v_mfma_f32_16x16x32_bf16 v[52:55], v[232:235], v[196:199], v[52:55]
    v_mfma_f32_16x16x32_bf16 v[64:67], v[228:231], v[196:199], v[64:67]
    s_add_u32 s79, s76, 73728
    buffer_load_dwordx4 v[192:195], v4, s[20:23], s79 offen sc1
    v_mfma_f32_16x16x32_bf16 v[68:71], v[236:239], v[196:199], v[68:71]
    v_mfma_f32_16x16x32_bf16 v[40:43], v[240:243], v[200:203], v[40:43]
    v_mfma_f32_16x16x32_bf16 v[44:47], v[248:251], v[200:203], v[44:47]
    v_mfma_f32_16x16x32_bf16 v[56:59], v[244:247], v[200:203], v[56:59]
    s_add_u32 s79, s82, 73728
    buffer_load_dwordx4 v[196:199], v4, s[20:23], s79 offen sc1
    v_mfma_f32_16x16x32_bf16 v[60:63], v[252:255], v[200:203], v[60:63]
    v_mfma_f32_16x16x32_bf16 v[48:51], v[240:243], v[204:207], v[48:51]
    v_mfma_f32_16x16x32_bf16 v[52:55], v[248:251], v[204:207], v[52:55]
    v_mfma_f32_16x16x32_bf16 v[64:67], v[244:247], v[204:207], v[64:67]
    s_add_u32 s79, s76, 81920
    buffer_load_dwordx4 v[200:203], v4, s[20:23], s79 offen sc1
    v_mfma_f32_16x16x32_bf16 v[68:71], v[252:255], v[204:207], v[68:71]
    s_waitcnt vmcnt(19)
    v_and_b32 v3, v120, v124
    v_and_b32 v3, 1, v3
    v_cmp_ne_u32 s[6:7], 1, v3
    s_nop 0
    s_mov_b64 vcc, s[6:7]
    s_cbranch_vccnz cslow_153
cback_152:
    v_mfma_f32_16x16x32_bf16 v[72:75], a[128:131], v[120:123], v[72:75]
    v_mfma_f32_16x16x32_bf16 v[76:79], a[136:139], v[120:123], v[76:79]
    s_add_u32 s79, s82, 81920
    buffer_load_dwordx4 v[204:207], v4, s[20:23], s79 offen sc1
    v_mfma_f32_16x16x32_bf16 v[88:91], a[132:135], v[120:123], v[88:91]
    v_mfma_f32_16x16x32_bf16 v[92:95], a[140:143], v[120:123], v[92:95]
    v_mfma_f32_16x16x32_bf16 v[80:83], a[128:131], v[124:127], v[80:83]
    s_waitcnt vmcnt(17)
    v_bitop3_b32 v3, v128, v132, v136 bitop3:0x80
    s_waitcnt vmcnt(16)
    v_and_b32 v3, v3, v140
    v_mfma_f32_16x16x32_bf16 v[84:87], a[136:139], v[124:127], v[84:87]
    v_and_b32 v3, 1, v3
    v_cmp_ne_u32 s[6:7], 1, v3
    v_mfma_f32_16x16x32_bf16 v[96:99], a[132:135], v[124:127], v[96:99]
    v_mfma_f32_16x16x32_bf16 v[100:103], a[140:143], v[124:127], v[100:103]
    s_mov_b64 vcc, s[6:7]
    s_cbranch_vccnz cslow_155
cback_154:
    v_mfma_f32_16x16x32_bf16 v[72:75], a[144:147], v[128:131], v[72:75]
    ds_write_b128 v11, v[48:51] offset:0
    v_mfma_f32_16x16x32_bf16 v[76:79], a[152:155], v[128:131], v[76:79]
    ds_write_b128 v11, v[52:55] offset:1024
    v_mfma_f32_16x16x32_bf16 v[88:91], a[148:151], v[128:131], v[88:91]
    ds_write_b128 v12, v[56:59] offset:2048
    v_mfma_f32_16x16x32_bf16 v[92:95], a[156:159], v[128:131], v[92:95]
    ds_write_b128 v12, v[60:63] offset:3072
    v_mfma_f32_16x16x32_bf16 v[80:83], a[144:147], v[132:135], v[80:83]
    ds_write_b128 v13, v[64:67] offset:4096
    v_mfma_f32_16x16x32_bf16 v[84:87], a[152:155], v[132:135], v[84:87]
    ds_write_b128 v13, v[68:71] offset:5120
    v_mfma_f32_16x16x32_bf16 v[96:99], a[148:151], v[132:135], v[96:99]
    v_mfma_f32_16x16x32_bf16 v[100:103], a[156:159], v[132:135], v[100:103]
    v_mfma_f32_16x16x32_bf16 v[72:75], a[160:163], v[136:139], v[72:75]
    v_mfma_f32_16x16x32_bf16 v[76:79], a[168:171], v[136:139], v[76:79]
    v_mfma_f32_16x16x32_bf16 v[88:91], a[164:167], v[136:139], v[88:91]
    v_mfma_f32_16x16x32_bf16 v[92:95], a[172:175], v[136:139], v[92:95]
    v_mfma_f32_16x16x32_bf16 v[80:83], a[160:163], v[140:143], v[80:83]
    s_waitcnt vmcnt(13)
    v_bitop3_b32 v3, v144, v148, v152 bitop3:0x80
    s_waitcnt vmcnt(12)
    v_and_b32 v3, v3, v156
    v_mfma_f32_16x16x32_bf16 v[84:87], a[168:171], v[140:143], v[84:87]
    v_and_b32 v3, 1, v3
    v_cmp_ne_u32 s[6:7], 1, v3
    v_mfma_f32_16x16x32_bf16 v[96:99], a[164:167], v[140:143], v[96:99]
    v_mfma_f32_16x16x32_bf16 v[100:103], a[172:175], v[140:143], v[100:103]
    s_mov_b64 vcc, s[6:7]
    s_cbranch_vccnz cslow_157
cback_156:
    v_mfma_f32_16x16x32_bf16 v[72:75], a[176:179], v[144:147], v[72:75]
    v_mfma_f32_16x16x32_bf16 v[76:79], a[184:187], v[144:147], v[76:79]
    v_mfma_f32_16x16x32_bf16 v[88:91], a[180:183], v[144:147], v[88:91]
    v_mfma_f32_16x16x32_bf16 v[92:95], a[188:191], v[144:147], v[92:95]
    v_mfma_f32_16x16x32_bf16 v[80:83], a[176:179], v[148:151], v[80:83]
    s_waitcnt lgkmcnt(0)
    s_barrier
    v_mfma_f32_16x16x32_bf16 v[84:87], a[184:187], v[148:151], v[84:87]
    ds_read_b128 v[48:51], v112 offset:0
    ds_read_b128 v[52:55], v112 offset:1024
    v_mfma_f32_16x16x32_bf16 v[96:99], a[180:183], v[148:151], v[96:99]
    ds_read_b128 v[56:59], v112 offset:2048
    ds_read_b128 v[60:63], v112 offset:3072
    v_mfma_f32_16x16x32_bf16 v[100:103], a[188:191], v[148:151], v[100:103]
    ds_read_b128 v[64:67], v112 offset:4096
    ds_read_b128 v[68:71], v112 offset:5120
    v_mfma_f32_16x16x32_bf16 v[72:75], a[192:195], v[152:155], v[72:75]
    v_mfma_f32_16x16x32_bf16 v[76:79], a[200:203], v[152:155], v[76:79]
    v_mfma_f32_16x16x32_bf16 v[88:91], a[196:199], v[152:155], v[88:91]
    v_mfma_f32_16x16x32_bf16 v[92:95], a[204:207], v[152:155], v[92:95]
    v_mfma_f32_16x16x32_bf16 v[80:83], a[192:195], v[156:159], v[80:83]
    s_waitcnt vmcnt(9)
    v_bitop3_b32 v3, v160, v164, v168 bitop3:0x80
    s_waitcnt vmcnt(8)
    v_and_b32 v3, v3, v172
    v_mfma_f32_16x16x32_bf16 v[84:87], a[200:203], v[156:159], v[84:87]
    v_and_b32 v3, 1, v3
    v_cmp_ne_u32 s[6:7], 1, v3
    v_mfma_f32_16x16x32_bf16 v[96:99], a[196:199], v[156:159], v[96:99]
    v_mfma_f32_16x16x32_bf16 v[100:103], a[204:207], v[156:159], v[100:103]
    s_mov_b64 vcc, s[6:7]
    s_cbranch_vccnz cslow_159
cback_158:
    v_mfma_f32_16x16x32_bf16 v[72:75], a[208:211], v[160:163], v[72:75]
    v_mfma_f32_16x16x32_bf16 v[76:79], a[216:219], v[160:163], v[76:79]
    v_mfma_f32_16x16x32_bf16 v[88:91], a[212:215], v[160:163], v[88:91]
    s_waitcnt lgkmcnt(5)
    v_add_f32 v40, v40, v48
    v_mfma_f32_16x16x32_bf16 v[92:95], a[220:223], v[160:163], v[92:95]
    v_add_f32 v41, v41, v49
    v_add_f32 v42, v42, v50
    v_mfma_f32_16x16x32_bf16 v[80:83], a[208:211], v[164:167], v[80:83]
    v_add_f32 v43, v43, v51
    s_waitcnt lgkmcnt(4)
    v_add_f32 v44, v44, v52
    v_mfma_f32_16x16x32_bf16 v[84:87], a[216:219], v[164:167], v[84:87]
    v_add_f32 v45, v45, v53
    v_add_f32 v46, v46, v54
    v_mfma_f32_16x16x32_bf16 v[96:99], a[212:215], v[164:167], v[96:99]
    v_add_f32 v47, v47, v55
    s_waitcnt lgkmcnt(3)
    v_add_f32 v40, v40, v56
    v_mfma_f32_16x16x32_bf16 v[100:103], a[220:223], v[164:167], v[100:103]
    v_add_f32 v41, v41, v57
    v_add_f32 v42, v42, v58
    v_mfma_f32_16x16x32_bf16 v[72:75], a[224:227], v[168:171], v[72:75]
    v_add_f32 v43, v43, v59
    s_waitcnt lgkmcnt(2)
    v_add_f32 v44, v44, v60
    v_mfma_f32_16x16x32_bf16 v[76:79], a[232:235], v[168:171], v[76:79]
    v_add_f32 v45, v45, v61
    v_add_f32 v46, v46, v62
    v_mfma_f32_16x16x32_bf16 v[88:91], a[228:231], v[168:171], v[88:91]
    v_add_f32 v47, v47, v63
    s_waitcnt lgkmcnt(1)
    v_add_f32 v40, v40, v64
    v_mfma_f32_16x16x32_bf16 v[92:95], a[236:239], v[168:171], v[92:95]
    v_add_f32 v41, v41, v65
    v_add_f32 v42, v42, v66
    v_mfma_f32_16x16x32_bf16 v[80:83], a[224:227], v[172:175], v[80:83]
    s_waitcnt vmcnt(5)
    v_bitop3_b32 v3, v176, v180, v184 bitop3:0x80
    s_waitcnt vmcnt(4)
    v_and_b32 v3, v3, v188
    v_mfma_f32_16x16x32_bf16 v[84:87], a[232:235], v[172:175], v[84:87]
    v_and_b32 v3, 1, v3
    v_cmp_ne_u32 s[6:7], 1, v3
    v_mfma_f32_16x16x32_bf16 v[96:99], a[228:231], v[172:175], v[96:99]
    v_mfma_f32_16x16x32_bf16 v[100:103], a[236:239], v[172:175], v[100:103]
    s_mov_b64 vcc, s[6:7]
    s_cbranch_vccnz cslow_161
cback_160:
    v_mfma_f32_16x16x32_bf16 v[72:75], a[240:243], v[176:179], v[72:75]
    v_add_f32 v43, v43, v67
    s_waitcnt lgkmcnt(0)
    v_add_f32 v44, v44, v68
    v_mfma_f32_16x16x32_bf16 v[76:79], a[248:251], v[176:179], v[76:79]
    v_add_f32 v45, v45, v69
    v_add_f32 v46, v46, v70
    v_mfma_f32_16x16x32_bf16 v[88:91], a[244:247], v[176:179], v[88:91]
    v_add_f32 v47, v47, v71
    v_mul_f32 v40, v16, v40
    v_mfma_f32_16x16x32_bf16 v[92:95], a[252:255], v[176:179], v[92:95]
    v_mul_f32 v41, v16, v41
    v_mul_f32 v42, v16, v42
    v_mfma_f32_16x16x32_bf16 v[80:83], a[240:243], v[180:183], v[80:83]
    v_mul_f32 v43, v16, v43
    v_mul_f32 v44, v16, v44
    v_mfma_f32_16x16x32_bf16 v[84:87], a[248:251], v[180:183], v[84:87]
    v_mul_f32 v45, v16, v45
    v_mul_f32 v46, v16, v46
    v_mfma_f32_16x16x32_bf16 v[96:99], a[244:247], v[180:183], v[96:99]
    v_mul_f32 v47, v16, v47
    v_cvt_pk_bf16_f32 v48, v40, v41
    v_mfma_f32_16x16x32_bf16 v[100:103], a[252:255], v[180:183], v[100:103]
    v_cvt_pk_bf16_f32 v49, v42, v43
    v_cvt_pk_bf16_f32 v50, v44, v45
    v_mfma_f32_16x16x32_bf16 v[72:75], v[208:211], v[184:187], v[72:75]
    v_cvt_pk_bf16_f32 v51, v46, v47
    buffer_store_dwordx4 v[48:51], v113, s[24:27], s74 offen
    v_mfma_f32_16x16x32_bf16 v[76:79], v[216:219], v[184:187], v[76:79]
    v_mfma_f32_16x16x32_bf16 v[88:91], v[212:215], v[184:187], v[88:91]
    v_mfma_f32_16x16x32_bf16 v[92:95], v[220:223], v[184:187], v[92:95]
    v_mfma_f32_16x16x32_bf16 v[80:83], v[208:211], v[188:191], v[80:83]
    s_waitcnt vmcnt(2)
    v_bitop3_b32 v3, v192, v196, v200 bitop3:0x80
    s_waitcnt vmcnt(1)
    v_and_b32 v3, v3, v204
    v_mfma_f32_16x16x32_bf16 v[84:87], v[216:219], v[188:191], v[84:87]
    v_and_b32 v3, 1, v3
    v_cmp_ne_u32 s[6:7], 1, v3
    v_mfma_f32_16x16x32_bf16 v[96:99], v[212:215], v[188:191], v[96:99]
    v_mfma_f32_16x16x32_bf16 v[100:103], v[220:223], v[188:191], v[100:103]
    s_mov_b64 vcc, s[6:7]
    s_cbranch_vccnz cslow_163
cback_162:
    v_mfma_f32_16x16x32_bf16 v[72:75], v[224:227], v[192:195], v[72:75]
    v_mfma_f32_16x16x32_bf16 v[76:79], v[232:235], v[192:195], v[76:79]
    v_mfma_f32_16x16x32_bf16 v[88:91], v[228:231], v[192:195], v[88:91]
    v_mfma_f32_16x16x32_bf16 v[92:95], v[236:239], v[192:195], v[92:95]
    v_mfma_f32_16x16x32_bf16 v[80:83], v[224:227], v[196:199], v[80:83]
    v_mfma_f32_16x16x32_bf16 v[84:87], v[232:235], v[196:199], v[84:87]
    v_mfma_f32_16x16x32_bf16 v[96:99], v[228:231], v[196:199], v[96:99]
    v_mfma_f32_16x16x32_bf16 v[100:103], v[236:239], v[196:199], v[100:103]
    v_mfma_f32_16x16x32_bf16 v[72:75], v[240:243], v[200:203], v[72:75]
    v_mfma_f32_16x16x32_bf16 v[76:79], v[248:251], v[200:203], v[76:79]
    v_mfma_f32_16x16x32_bf16 v[88:91], v[244:247], v[200:203], v[88:91]
    v_mfma_f32_16x16x32_bf16 v[92:95], v[252:255], v[200:203], v[92:95]
    v_mfma_f32_16x16x32_bf16 v[80:83], v[240:243], v[204:207], v[80:83]
    v_mfma_f32_16x16x32_bf16 v[84:87], v[248:251], v[204:207], v[84:87]
    v_mfma_f32_16x16x32_bf16 v[96:99], v[244:247], v[204:207], v[96:99]
    v_mfma_f32_16x16x32_bf16 v[100:103], v[252:255], v[204:207], v[100:103]
    s_nop 4
    ds_write_b128 v11, v[80:83] offset:32768
    ds_write_b128 v11, v[84:87] offset:33792
    ds_write_b128 v12, v[88:91] offset:34816
    ds_write_b128 v12, v[92:95] offset:35840
    ds_write_b128 v13, v[96:99] offset:36864
    ds_write_b128 v13, v[100:103] offset:37888
    s_waitcnt lgkmcnt(0)
    s_barrier
    ds_read_b128 v[80:83], v112 offset:32768
    ds_read_b128 v[84:87], v112 offset:33792
    ds_read_b128 v[88:91], v112 offset:34816
    ds_read_b128 v[92:95], v112 offset:35840
    ds_read_b128 v[96:99], v112 offset:36864
    ds_read_b128 v[100:103], v112 offset:37888
    s_waitcnt lgkmcnt(5)
    v_pk_add_f32 v[72:73], v[72:73], v[80:81]
    v_pk_add_f32 v[74:75], v[74:75], v[82:83]
    s_waitcnt lgkmcnt(4)
    v_pk_add_f32 v[76:77], v[76:77], v[84:85]
    v_pk_add_f32 v[78:79], v[78:79], v[86:87]
    s_waitcnt lgkmcnt(3)
    v_pk_add_f32 v[72:73], v[72:73], v[88:89]
    v_pk_add_f32 v[74:75], v[74:75], v[90:91]
    s_waitcnt lgkmcnt(2)
    v_pk_add_f32 v[76:77], v[76:77], v[92:93]
    v_pk_add_f32 v[78:79], v[78:79], v[94:95]
    s_waitcnt lgkmcnt(1)
    v_pk_add_f32 v[72:73], v[72:73], v[96:97]
    v_pk_add_f32 v[74:75], v[74:75], v[98:99]
    s_waitcnt lgkmcnt(0)
    v_pk_add_f32 v[76:77], v[76:77], v[100:101]
    v_pk_add_f32 v[78:79], v[78:79], v[102:103]
    v_mul_f32 v72, v18, v72
    v_mul_f32 v73, v18, v73
    v_mul_f32 v74, v18, v74
    v_mul_f32 v75, v18, v75
    v_mul_f32 v76, v18, v76
    v_mul_f32 v77, v18, v77
    v_mul_f32 v78, v18, v78
    v_mul_f32 v79, v18, v79
    v_cvt_pk_bf16_f32 v80, v72, v73
    v_cvt_pk_bf16_f32 v81, v74, v75
    v_cvt_pk_bf16_f32 v82, v76, v77
    v_cvt_pk_bf16_f32 v83, v78, v79
    buffer_store_dwordx4 v[80:83], v113, s[24:27], s75 offen
L_exit:
    s_endpgm
pslow_9:
    s_mov_b32 s39, 0
ploop_164:
    s_mov_b64 exec, vcc
    buffer_load_dword v80, v81, s[96:99], 0 offen sc1
    s_add_u32 s39, s39, 1
    s_waitcnt vmcnt(0)
    v_subrev_u32 v80, s6, v80
    v_cmp_le_u32 vcc, 8, v80
    s_cbranch_vccz pout_165
    s_sleep 1
    s_cmp_lt_u32 s39, 131072
    s_cbranch_scc1 ploop_164
pout_165:
    s_mov_b64 exec, -1
    s_branch pback_8
cslow_11:
    s_mov_b32 s39, 0
    s_waitcnt vmcnt(0) lgkmcnt(0)
    s_nop 7
    s_nop 7
cloop_166:
    s_mov_b64 exec, vcc
    buffer_load_dwordx4 v[16:19], v8, s[8:11], s65 offen sc1
    buffer_load_dwordx4 v[20:23], v8, s[8:11], s65 offen offset:64 sc1
    buffer_load_dwordx4 v[176:179], v9, s[12:15], s66 offen offset:0 sc1
    buffer_load_dwordx4 v[180:183], v9, s[12:15], s66 offen offset:1024 sc1
    buffer_load_dwordx4 v[184:187], v9, s[12:15], s66 offen offset:2048 sc1
    buffer_load_dwordx4 v[188:191], v9, s[12:15], s66 offen offset:3072 sc1
    s_add_u32 s39, s39, 1
    s_waitcnt vmcnt(0)
    v_bitop3_b32 v128, v177, v179, s36 bitop3:0x7e
    v_bitop3_b32 v129, v181, v183, s36 bitop3:0x7e
    v_bitop3_b32 v130, v185, v187, s36 bitop3:0x7e
    v_bitop3_b32 v131, v189, v191, s36 bitop3:0x7e
    v_bitop3_b32 v14, v16, v20, 1 bitop3:0xa8
    v_or3_b32 v14, v14, v128, v129
    v_or3_b32 v14, v14, v130, v131
    v_cmp_ne_u32 vcc, 0, v14
    s_cbranch_vccz cout_167
    s_sleep 1
    s_cmp_lt_u32 s39, 131072
    s_cbranch_scc1 cloop_166
cout_167:
    s_mov_b64 exec, -1
    s_waitcnt lgkmcnt(0)
    s_nop 3
    v_lshlrev_b32 v160, 16, v16
    v_and_b32 v161, s38, v16
    v_lshlrev_b32 v162, 16, v17
    v_and_b32 v163, s38, v17
    v_lshlrev_b32 v164, 16, v18
    v_and_b32 v165, s38, v18
    v_lshlrev_b32 v166, 16, v19
    v_and_b32 v167, s38, v19
    v_lshlrev_b32 v168, 16, v20
    v_and_b32 v169, s38, v20
    v_lshlrev_b32 v170, 16, v21
    v_and_b32 v171, s38, v21
    v_lshlrev_b32 v172, 16, v22
    v_and_b32 v173, s38, v22
    v_lshlrev_b32 v174, 16, v23
    v_and_b32 v175, s38, v23
    s_nop 7
    s_branch cback_10
pslow_13:
    s_mov_b32 s39, 0
ploop_168:
    s_mov_b64 exec, vcc
    buffer_load_dword v84, v85, s[96:99], 0 offen sc1
    s_add_u32 s39, s39, 1
    s_waitcnt vmcnt(0)
    v_subrev_u32 v84, s6, v84
    v_cmp_le_u32 vcc, 8, v84
    s_cbranch_vccz pout_169
    s_sleep 1
    s_cmp_lt_u32 s39, 131072
    s_cbranch_scc1 ploop_168
pout_169:
    s_mov_b64 exec, -1
    s_branch pback_12
pslow_15:
    s_mov_b32 s39, 0
ploop_170:
    s_mov_b64 exec, vcc
    buffer_load_dword v86, v87, s[96:99], 0 offen sc1
    s_add_u32 s39, s39, 1
    s_waitcnt vmcnt(0)
    v_subrev_u32 v86, s6, v86
    v_cmp_le_u32 vcc, 8, v86
    s_cbranch_vccz pout_171
    s_sleep 1
    s_cmp_lt_u32 s39, 131072
    s_cbranch_scc1 ploop_170
pout_171:
    s_mov_b64 exec, -1
    s_branch pback_14
cslow_18:
    s_mov_b32 s39, 0
    s_waitcnt vmcnt(0) lgkmcnt(0)
    s_nop 7
    s_nop 7
cloop_172:
    s_mov_b32 s0, m0
    s_add_u32 m0, s49, 0
    s_add_u32 s7, s50, 0
    buffer_load_dwordx4 v95, s[8:11], s7 offen offset:0 sc1 lds
    buffer_load_dwordx4 v95, s[8:11], s7 offen offset:1024 sc1 lds
    buffer_load_dwordx4 v95, s[8:11], s7 offen offset:2048 sc1 lds
    buffer_load_dwordx4 v95, s[8:11], s7 offen offset:3072 sc1 lds
    s_add_u32 m0, s49, 16384
    s_add_u32 s7, s50, 8192
    buffer_load_dwordx4 v95, s[8:11], s7 offen offset:0 sc1 lds
    buffer_load_dwordx4 v95, s[8:11], s7 offen offset:1024 sc1 lds
    buffer_load_dwordx4 v95, s[8:11], s7 offen offset:2048 sc1 lds
    buffer_load_dwordx4 v95, s[8:11], s7 offen offset:3072 sc1 lds
    s_mov_b32 m0, s0
    s_add_u32 s39, s39, 1
    s_waitcnt vmcnt(0)
    ds_read2st64_b32 v[88:89], v3 offset0:0 offset1:4
    ds_read2st64_b32 v[90:91], v3 offset0:8 offset1:12
    s_waitcnt lgkmcnt(0)
    v_bitop3_b32 v88, v88, v89, v90 bitop3:0x80
    v_bitop3_b32 v88, v88, v91, s40 bitop3:0x80
    v_cmp_ne_u32 vcc, s40, v88
    s_cbranch_vccz cout_173
    s_sleep 1
    s_cmp_lt_u32 s39, 131072
    s_cbranch_scc1 cloop_172
cout_173:
    s_waitcnt lgkmcnt(0)
    s_nop 3
    s_branch cback_17
cslow_20:
    s_mov_b32 s39, 0
    s_waitcnt vmcnt(0) lgkmcnt(0)
    s_nop 7
    s_nop 7
cloop_174:
    s_mov_b32 s0, m0
    s_add_u32 m0, s49, 16384
    s_add_u32 s7, s50, 8192
    buffer_load_dwordx4 v95, s[8:11], s7 offen offset:0 sc1 lds
    buffer_load_dwordx4 v95, s[8:11], s7 offen offset:1024 sc1 lds
    buffer_load_dwordx4 v95, s[8:11], s7 offen offset:2048 sc1 lds
    buffer_load_dwordx4 v95, s[8:11], s7 offen offset:3072 sc1 lds
    s_add_u32 m0, s49, 32768
    s_add_u32 s7, s50, 16384
    buffer_load_dwordx4 v95, s[8:11], s7 offen offset:0 sc1 lds
    buffer_load_dwordx4 v95, s[8:11], s7 offen offset:1024 sc1 lds
    buffer_load_dwordx4 v95, s[8:11], s7 offen offset:2048 sc1 lds
    buffer_load_dwordx4 v95, s[8:11], s7 offen offset:3072 sc1 lds
    s_mov_b32 m0, s0
    s_add_u32 s39, s39, 1
    s_waitcnt vmcnt(0)
    ds_read2st64_b32 v[88:89], v3 offset0:64 offset1:68
    ds_read2st64_b32 v[90:91], v3 offset0:72 offset1:76
    s_waitcnt lgkmcnt(0)
    v_bitop3_b32 v88, v88, v89, v90 bitop3:0x80
    v_bitop3_b32 v88, v88, v91, s40 bitop3:0x80
    v_cmp_ne_u32 vcc, s40, v88
    s_cbranch_vccz cout_175
    s_sleep 1
    s_cmp_lt_u32 s39, 131072
    s_cbranch_scc1 cloop_174
cout_175:
    s_waitcnt lgkmcnt(0)
    s_nop 3
    s_branch cback_19
cslow_22:
    s_mov_b32 s39, 0
    s_waitcnt vmcnt(0) lgkmcnt(0)
    s_nop 7
    s_nop 7
cloop_176:
    s_mov_b32 s0, m0
    s_add_u32 m0, s49, 32768
    s_add_u32 s7, s50, 16384
    buffer_load_dwordx4 v95, s[8:11], s7 offen offset:0 sc1 lds
    buffer_load_dwordx4 v95, s[8:11], s7 offen offset:1024 sc1 lds
    buffer_load_dwordx4 v95, s[8:11], s7 offen offset:2048 sc1 lds
    buffer_load_dwordx4 v95, s[8:11], s7 offen offset:3072 sc1 lds
    s_add_u32 m0, s49, 49152
    s_add_u32 s7, s50, 24576
    buffer_load_dwordx4 v95, s[8:11], s7 offen offset:0 sc1 lds
    buffer_load_dwordx4 v95, s[8:11], s7 offen offset:1024 sc1 lds
    buffer_load_dwordx4 v95, s[8:11], s7 offen offset:2048 sc1 lds
    buffer_load_dwordx4 v95, s[8:11], s7 offen offset:3072 sc1 lds
    s_mov_b32 m0, s0
    s_add_u32 s39, s39, 1
    s_waitcnt vmcnt(0)
    ds_read2st64_b32 v[88:89], v3 offset0:128 offset1:132
    ds_read2st64_b32 v[90:91], v3 offset0:136 offset1:140
    s_waitcnt lgkmcnt(0)
    v_bitop3_b32 v88, v88, v89, v90 bitop3:0x80
    v_bitop3_b32 v88, v88, v91, s40 bitop3:0x80
    v_cmp_ne_u32 vcc, s40, v88
    s_cbranch_vccz cout_177
    s_sleep 1
    s_cmp_lt_u32 s39, 131072
    s_cbranch_scc1 cloop_176
cout_177:
    s_waitcnt lgkmcnt(0)
    s_nop 3
    s_branch cback_21
cslow_24:
    s_mov_b32 s39, 0
    s_waitcnt vmcnt(0) lgkmcnt(0)
    s_nop 7
    s_nop 7
cloop_178:
    s_mov_b32 s0, m0
    s_add_u32 m0, s49, 49152
    s_add_u32 s7, s50, 24576
    buffer_load_dwordx4 v95, s[8:11], s7 offen offset:0 sc1 lds
    buffer_load_dwordx4 v95, s[8:11], s7 offen offset:1024 sc1 lds
    buffer_load_dwordx4 v95, s[8:11], s7 offen offset:2048 sc1 lds
    buffer_load_dwordx4 v95, s[8:11], s7 offen offset:3072 sc1 lds
    s_mov_b32 m0, s0
    s_add_u32 s39, s39, 1
    s_waitcnt vmcnt(0)
    ds_read2st64_b32 v[88:89], v3 offset0:192 offset1:196
    ds_read2st64_b32 v[90:91], v3 offset0:200 offset1:204
    s_waitcnt lgkmcnt(0)
    v_bitop3_b32 v88, v88, v89, v90 bitop3:0x80
    v_bitop3_b32 v88, v88, v91, s40 bitop3:0x80
    v_cmp_ne_u32 vcc, s40, v88
    s_cbranch_vccz cout_179
    s_sleep 1
    s_cmp_lt_u32 s39, 131072
    s_cbranch_scc1 cloop_178
cout_179:
    s_waitcnt lgkmcnt(0)
    s_nop 3
    s_branch cback_23
cslow_26:
    s_mov_b32 s39, 0
    s_waitcnt vmcnt(0) lgkmcnt(0)
    s_nop 7
    s_nop 7
cloop_180:
    s_mov_b32 s0, m0
    s_add_u32 m0, s49, 65536
    s_add_u32 s7, s48, 65536
    buffer_load_dwordx4 v95, s[8:11], s7 offen offset:0 sc1 lds
    buffer_load_dwordx4 v95, s[8:11], s7 offen offset:1024 sc1 lds
    buffer_load_dwordx4 v95, s[8:11], s7 offen offset:2048 sc1 lds
    buffer_load_dwordx4 v95, s[8:11], s7 offen offset:3072 sc1 lds
    s_mov_b32 m0, s0
    s_add_u32 s39, s39, 1
    s_waitcnt vmcnt(0)
    ds_read2st64_b32 v[88:89], v6 offset0:0 offset1:4
    ds_read2st64_b32 v[90:91], v6 offset0:8 offset1:12
    s_waitcnt lgkmcnt(0)
    v_bitop3_b32 v88, v88, v89, v90 bitop3:0x80
    v_bitop3_b32 v88, v88, v91, s40 bitop3:0x80
    v_cmp_ne_u32 vcc, s40, v88
    s_cbranch_vccz cout_181
    s_sleep 1
    s_cmp_lt_u32 s39, 131072
    s_cbranch_scc1 cloop_180
cout_181:
    s_waitcnt lgkmcnt(0)
    s_nop 3
    s_branch cback_25
cslow_28:
    s_mov_b32 s39, 0
    s_waitcnt vmcnt(0) lgkmcnt(0)
    s_nop 7
    s_nop 7
cloop_182:
    s_mov_b32 s0, m0
    s_add_u32 m0, s49, 81920
    s_add_u32 s7, s48, 81920
    buffer_load_dwordx4 v95, s[8:11], s7 offen offset:0 sc1 lds
    buffer_load_dwordx4 v95, s[8:11], s7 offen offset:1024 sc1 lds
    buffer_load_dwordx4 v95, s[8:11], s7 offen offset:2048 sc1 lds
    buffer_load_dwordx4 v95, s[8:11], s7 offen offset:3072 sc1 lds
    s_mov_b32 m0, s0
    s_add_u32 s39, s39, 1
    s_waitcnt vmcnt(0)
    ds_read2st64_b32 v[88:89], v6 offset0:64 offset1:68
    ds_read2st64_b32 v[90:91], v6 offset0:72 offset1:76
    s_waitcnt lgkmcnt(0)
    v_bitop3_b32 v88, v88, v89, v90 bitop3:0x80
    v_bitop3_b32 v88, v88, v91, s40 bitop3:0x80
    v_cmp_ne_u32 vcc, s40, v88
    s_cbranch_vccz cout_183
    s_sleep 1
    s_cmp_lt_u32 s39, 131072
    s_cbranch_scc1 cloop_182
cout_183:
    s_waitcnt lgkmcnt(0)
    s_nop 3
    s_branch cback_27
cslow_30:
    s_mov_b32 s39, 0
    s_waitcnt vmcnt(0) lgkmcnt(0)
    s_nop 7
    s_nop 7
cloop_184:
    s_mov_b32 s0, m0
    s_add_u32 m0, s49, 98304
    s_add_u32 s7, s48, 98304
    buffer_load_dwordx4 v95, s[8:11], s7 offen offset:0 sc1 lds
    buffer_load_dwordx4 v95, s[8:11], s7 offen offset:1024 sc1 lds
    buffer_load_dwordx4 v95, s[8:11], s7 offen offset:2048 sc1 lds
    buffer_load_dwordx4 v95, s[8:11], s7 offen offset:3072 sc1 lds
    s_mov_b32 m0, s0
    s_add_u32 s39, s39, 1
    s_waitcnt vmcnt(0)
    ds_read2st64_b32 v[88:89], v6 offset0:128 offset1:132
    ds_read2st64_b32 v[90:91], v6 offset0:136 offset1:140
    s_waitcnt lgkmcnt(0)
    v_bitop3_b32 v88, v88, v89, v90 bitop3:0x80
    v_bitop3_b32 v88, v88, v91, s40 bitop3:0x80
    v_cmp_ne_u32 vcc, s40, v88
    s_cbranch_vccz cout_185
    s_sleep 1
    s_cmp_lt_u32 s39, 131072
    s_cbranch_scc1 cloop_184
cout_185:
    s_waitcnt lgkmcnt(0)
    s_nop 3
    s_branch cback_29
cslow_32:
    s_mov_b32 s39, 0
    s_waitcnt vmcnt(0) lgkmcnt(0)
    s_nop 7
    s_nop 7
cloop_186:
    s_mov_b32 s0, m0
    s_add_u32 m0, s49, 114688
    s_add_u32 s7, s48, 114688
    buffer_load_dwordx4 v95, s[8:11], s7 offen offset:0 sc1 lds
    buffer_load_dwordx4 v95, s[8:11], s7 offen offset:1024 sc1 lds
    buffer_load_dwordx4 v95, s[8:11], s7 offen offset:2048 sc1 lds
    buffer_load_dwordx4 v95, s[8:11], s7 offen offset:3072 sc1 lds
    s_mov_b32 m0, s0
    s_add_u32 s39, s39, 1
    s_waitcnt vmcnt(0)
    ds_read2st64_b32 v[88:89], v6 offset0:192 offset1:196
    ds_read2st64_b32 v[90:91], v6 offset0:200 offset1:204
    s_waitcnt lgkmcnt(0)
    v_bitop3_b32 v88, v88, v89, v90 bitop3:0x80
    v_bitop3_b32 v88, v88, v91, s40 bitop3:0x80
    v_cmp_ne_u32 vcc, s40, v88
    s_cbranch_vccz cout_187
    s_sleep 1
    s_cmp_lt_u32 s39, 131072
    s_cbranch_scc1 cloop_186
cout_187:
    s_waitcnt lgkmcnt(0)
    s_nop 3
    s_branch cback_31
cslow_34:
    s_mov_b32 s39, 0
    s_waitcnt vmcnt(0) lgkmcnt(0)
    s_nop 7
    s_nop 7
cloop_188:
    s_mov_b32 s0, m0
    s_add_u32 m0, s49, 0
    s_add_u32 s7, s48, 131072
    buffer_load_dwordx4 v95, s[8:11], s7 offen offset:0 sc1 lds
    buffer_load_dwordx4 v95, s[8:11], s7 offen offset:1024 sc1 lds
    buffer_load_dwordx4 v95, s[8:11], s7 offen offset:2048 sc1 lds
    buffer_load_dwordx4 v95, s[8:11], s7 offen offset:3072 sc1 lds
    s_mov_b32 m0, s0
    s_add_u32 s39, s39, 1
    s_waitcnt vmcnt(0)
    ds_read2st64_b32 v[88:89], v3 offset0:0 offset1:4
    ds_read2st64_b32 v[90:91], v3 offset0:8 offset1:12
    s_waitcnt lgkmcnt(0)
    v_bitop3_b32 v88, v88, v89, v90 bitop3:0x80
    v_bitop3_b32 v88, v88, v91, s73 bitop3:0x80
    v_cmp_ne_u32 vcc, s73, v88
    s_cbranch_vccz cout_189
    s_sleep 1
    s_cmp_lt_u32 s39, 131072
    s_cbranch_scc1 cloop_188
cout_189:
    s_waitcnt lgkmcnt(0)
    s_nop 3
    s_branch cback_33
cslow_36:
    s_mov_b32 s39, 0
    s_waitcnt vmcnt(0) lgkmcnt(0)
    s_nop 7
    s_nop 7
cloop_190:
    s_mov_b32 s0, m0
    s_add_u32 m0, s49, 16384
    s_add_u32 s7, s48, 147456
    buffer_load_dwordx4 v95, s[8:11], s7 offen offset:0 sc1 lds
    buffer_load_dwordx4 v95, s[8:11], s7 offen offset:1024 sc1 lds
    buffer_load_dwordx4 v95, s[8:11], s7 offen offset:2048 sc1 lds
    buffer_load_dwordx4 v95, s[8:11], s7 offen offset:3072 sc1 lds
    s_mov_b32 m0, s0
    s_add_u32 s39, s39, 1
    s_waitcnt vmcnt(0)
    ds_read2st64_b32 v[88:89], v3 offset0:64 offset1:68
    ds_read2st64_b32 v[90:91], v3 offset0:72 offset1:76
    s_waitcnt lgkmcnt(0)
    v_bitop3_b32 v88, v88, v89, v90 bitop3:0x80
    v_bitop3_b32 v88, v88, v91, s73 bitop3:0x80
    v_cmp_ne_u32 vcc, s73, v88
    s_cbranch_vccz cout_191
    s_sleep 1
    s_cmp_lt_u32 s39, 131072
    s_cbranch_scc1 cloop_190
cout_191:
    s_waitcnt lgkmcnt(0)
    s_nop 3
    s_branch cback_35
cslow_38:
    s_mov_b32 s39, 0
    s_waitcnt vmcnt(0) lgkmcnt(0)
    s_nop 7
    s_nop 7
cloop_192:
    s_mov_b32 s0, m0
    s_add_u32 m0, s49, 32768
    s_add_u32 s7, s48, 163840
    buffer_load_dwordx4 v95, s[8:11], s7 offen offset:0 sc1 lds
    buffer_load_dwordx4 v95, s[8:11], s7 offen offset:1024 sc1 lds
    buffer_load_dwordx4 v95, s[8:11], s7 offen offset:2048 sc1 lds
    buffer_load_dwordx4 v95, s[8:11], s7 offen offset:3072 sc1 lds
    s_mov_b32 m0, s0
    s_add_u32 s39, s39, 1
    s_waitcnt vmcnt(0)
    ds_read2st64_b32 v[88:89], v3 offset0:128 offset1:132
    ds_read2st64_b32 v[90:91], v3 offset0:136 offset1:140
    s_waitcnt lgkmcnt(0)
    v_bitop3_b32 v88, v88, v89, v90 bitop3:0x80
    v_bitop3_b32 v88, v88, v91, s73 bitop3:0x80
    v_cmp_ne_u32 vcc, s73, v88
    s_cbranch_vccz cout_193
    s_sleep 1
    s_cmp_lt_u32 s39, 131072
    s_cbranch_scc1 cloop_192
cout_193:
    s_waitcnt lgkmcnt(0)
    s_nop 3
    s_branch cback_37
cslow_40:
    s_mov_b32 s39, 0
    s_waitcnt vmcnt(0) lgkmcnt(0)
    s_nop 7
    s_nop 7
cloop_194:
    s_mov_b32 s0, m0
    s_add_u32 m0, s49, 49152
    s_add_u32 s7, s48, 180224
    buffer_load_dwordx4 v95, s[8:11], s7 offen offset:0 sc1 lds
    buffer_load_dwordx4 v95, s[8:11], s7 offen offset:1024 sc1 lds
    buffer_load_dwordx4 v95, s[8:11], s7 offen offset:2048 sc1 lds
    buffer_load_dwordx4 v95, s[8:11], s7 offen offset:3072 sc1 lds
    s_mov_b32 m0, s0
    s_add_u32 s39, s39, 1
    s_waitcnt vmcnt(0)
    ds_read2st64_b32 v[88:89], v3 offset0:192 offset1:196
    ds_read2st64_b32 v[90:91], v3 offset0:200 offset1:204
    s_waitcnt lgkmcnt(0)
    v_bitop3_b32 v88, v88, v89, v90 bitop3:0x80
    v_bitop3_b32 v88, v88, v91, s73 bitop3:0x80
    v_cmp_ne_u32 vcc, s73, v88
    s_cbranch_vccz cout_195
    s_sleep 1
    s_cmp_lt_u32 s39, 131072
    s_cbranch_scc1 cloop_194
cout_195:
    s_waitcnt lgkmcnt(0)
    s_nop 3
    s_branch cback_39
pslow_42:
    s_mov_b32 s39, 0
ploop_196:
    s_mov_b64 exec, vcc
    buffer_load_dword v2, v119, s[96:99], 0 offen sc1
    s_add_u32 s39, s39, 1
    s_waitcnt vmcnt(0)
    v_subrev_u32 v2, s6, v2
    v_cmp_le_u32 vcc, 8, v2
    s_cbranch_vccz pout_197
    s_sleep 1
    s_cmp_lt_u32 s39, 131072
    s_cbranch_scc1 ploop_196
pout_197:
    s_mov_b64 exec, -1
    s_branch pback_41
cslow_44:
    s_mov_b32 s39, 0
    s_waitcnt vmcnt(0) lgkmcnt(0)
    s_nop 7
    s_nop 7
cloop_198:
    s_mov_b64 exec, vcc
    s_add_u32 s7, s48, 0
    buffer_load_dwordx4 v[40:43], v6, s[8:11], s7 offen sc1
    s_add_u32 s7, s48, 4096
    buffer_load_dwordx4 v[44:47], v6, s[8:11], s7 offen sc1
    s_add_u32 s7, s48, 8192
    buffer_load_dwordx4 v[48:51], v6, s[8:11], s7 offen sc1
    s_add_u32 s7, s48, 12288
    buffer_load_dwordx4 v[52:55], v6, s[8:11], s7 offen sc1
    s_add_u32 s39, s39, 1
    s_waitcnt vmcnt(0)
    v_bitop3_b32 v9, v40, v44, v48 bitop3:0x80
    v_and_b32 v9, v9, v52
    v_and_b32 v9, s40, v9
    v_cmp_ne_u32 vcc, s40, v9
    s_cbranch_vccz cout_199
    s_sleep 1
    s_cmp_lt_u32 s39, 131072
    s_cbranch_scc1 cloop_198
cout_199:
    s_mov_b64 exec, -1
    s_waitcnt lgkmcnt(0)
    s_nop 3
    s_branch cback_43
cslow_46:
    s_mov_b32 s39, 0
    s_waitcnt vmcnt(0) lgkmcnt(0)
    s_nop 7
    s_nop 7
cloop_200:
    s_mov_b64 exec, vcc
    s_add_u32 s7, s48, 16384
    buffer_load_dwordx4 v[56:59], v6, s[8:11], s7 offen sc1
    s_add_u32 s7, s48, 20480
    buffer_load_dwordx4 v[60:63], v6, s[8:11], s7 offen sc1
    s_add_u32 s7, s48, 24576
    buffer_load_dwordx4 v[64:67], v6, s[8:11], s7 offen sc1
    s_add_u32 s7, s48, 28672
    buffer_load_dwordx4 v[68:71], v6, s[8:11], s7 offen sc1
    s_add_u32 s39, s39, 1
    s_waitcnt vmcnt(0)
    v_bitop3_b32 v9, v56, v60, v64 bitop3:0x80
    v_and_b32 v9, v9, v68
    v_and_b32 v9, s40, v9
    v_cmp_ne_u32 vcc, s40, v9
    s_cbranch_vccz cout_201
    s_sleep 1
    s_cmp_lt_u32 s39, 131072
    s_cbranch_scc1 cloop_200
cout_201:
    s_mov_b64 exec, -1
    s_waitcnt lgkmcnt(0)
    s_nop 3
    s_branch cback_45
cslow_48:
    s_mov_b32 s39, 0
    s_waitcnt vmcnt(0) lgkmcnt(0)
    s_nop 7
    s_nop 7
cloop_202:
    s_mov_b64 exec, vcc
    s_add_u32 s7, s48, 32768
    buffer_load_dwordx4 v[72:75], v6, s[8:11], s7 offen sc1
    s_add_u32 s7, s48, 36864
    buffer_load_dwordx4 v[76:79], v6, s[8:11], s7 offen sc1
    s_add_u32 s7, s48, 40960
    buffer_load_dwordx4 v[80:83], v6, s[8:11], s7 offen sc1
    s_add_u32 s7, s48, 45056
    buffer_load_dwordx4 v[84:87], v6, s[8:11], s7 offen sc1
    s_add_u32 s39, s39, 1
    s_waitcnt vmcnt(0)
    v_bitop3_b32 v9, v72, v76, v80 bitop3:0x80
    v_and_b32 v9, v9, v84
    v_and_b32 v9, s40, v9
    v_cmp_ne_u32 vcc, s40, v9
    s_cbranch_vccz cout_203
    s_sleep 1
    s_cmp_lt_u32 s39, 131072
    s_cbranch_scc1 cloop_202
cout_203:
    s_mov_b64 exec, -1
    s_waitcnt lgkmcnt(0)
    s_nop 3
    s_branch cback_47
cslow_50:
    s_mov_b32 s39, 0
    s_waitcnt vmcnt(0) lgkmcnt(0)
    s_nop 7
    s_nop 7
cloop_204:
    s_mov_b64 exec, vcc
    s_add_u32 s7, s48, 49152
    buffer_load_dwordx4 v[88:91], v6, s[8:11], s7 offen sc1
    s_add_u32 s7, s48, 53248
    buffer_load_dwordx4 v[92:95], v6, s[8:11], s7 offen sc1
    s_add_u32 s7, s48, 57344
    buffer_load_dwordx4 v[96:99], v6, s[8:11], s7 offen sc1
    s_add_u32 s7, s48, 61440
    buffer_load_dwordx4 v[100:103], v6, s[8:11], s7 offen sc1
    s_add_u32 s39, s39, 1
    s_waitcnt vmcnt(0)
    v_bitop3_b32 v9, v88, v92, v96 bitop3:0x80
    v_and_b32 v9, v9, v100
    v_and_b32 v9, s40, v9
    v_cmp_ne_u32 vcc, s40, v9
    s_cbranch_vccz cout_205
    s_sleep 1
    s_cmp_lt_u32 s39, 131072
    s_cbranch_scc1 cloop_204
cout_205:
    s_mov_b64 exec, -1
    s_waitcnt lgkmcnt(0)
    s_nop 3
    s_branch cback_49
cslow_52:
    s_mov_b32 s39, 0
    s_waitcnt vmcnt(0) lgkmcnt(0)
    s_nop 7
    s_nop 7
cloop_206:
    s_mov_b64 exec, vcc
    s_add_u32 s7, s48, 65536
    buffer_load_dwordx4 v[40:43], v6, s[8:11], s7 offen sc1
    s_add_u32 s7, s48, 69632
    buffer_load_dwordx4 v[44:47], v6, s[8:11], s7 offen sc1
    s_add_u32 s7, s48, 73728
    buffer_load_dwordx4 v[48:51], v6, s[8:11], s7 offen sc1
    s_add_u32 s7, s48, 77824
    buffer_load_dwordx4 v[52:55], v6, s[8:11], s7 offen sc1
    s_add_u32 s39, s39, 1
    s_waitcnt vmcnt(0)
    v_bitop3_b32 v9, v40, v44, v48 bitop3:0x80
    v_and_b32 v9, v9, v52
    v_and_b32 v9, s40, v9
    v_cmp_ne_u32 vcc, s40, v9
    s_cbranch_vccz cout_207
    s_sleep 1
    s_cmp_lt_u32 s39, 131072
    s_cbranch_scc1 cloop_206
cout_207:
    s_mov_b64 exec, -1
    s_waitcnt lgkmcnt(0)
    s_nop 3
    s_branch cback_51
cslow_54:
    s_mov_b32 s39, 0
    s_waitcnt vmcnt(0) lgkmcnt(0)
    s_nop 7
    s_nop 7
cloop_208:
    s_mov_b64 exec, vcc
    s_add_u32 s7, s48, 81920
    buffer_load_dwordx4 v[56:59], v6, s[8:11], s7 offen sc1
    s_add_u32 s7, s48, 86016
    buffer_load_dwordx4 v[60:63], v6, s[8:11], s7 offen sc1
    s_add_u32 s7, s48, 90112
    buffer_load_dwordx4 v[64:67], v6, s[8:11], s7 offen sc1
    s_add_u32 s7, s48, 94208
    buffer_load_dwordx4 v[68:71], v6, s[8:11], s7 offen sc1
    s_add_u32 s39, s39, 1
    s_waitcnt vmcnt(0)
    v_bitop3_b32 v9, v56, v60, v64 bitop3:0x80
    v_and_b32 v9, v9, v68
    v_and_b32 v9, s40, v9
    v_cmp_ne_u32 vcc, s40, v9
    s_cbranch_vccz cout_209
    s_sleep 1
    s_cmp_lt_u32 s39, 131072
    s_cbranch_scc1 cloop_208
cout_209:
    s_mov_b64 exec, -1
    s_waitcnt lgkmcnt(0)
    s_nop 3
    s_branch cback_53
cslow_56:
    s_mov_b32 s39, 0
    s_waitcnt vmcnt(0) lgkmcnt(0)
    s_nop 7
    s_nop 7
cloop_210:
    s_mov_b64 exec, vcc
    s_add_u32 s7, s48, 98304
    buffer_load_dwordx4 v[72:75], v6, s[8:11], s7 offen sc1
    s_add_u32 s7, s48, 102400
    buffer_load_dwordx4 v[76:79], v6, s[8:11], s7 offen sc1
    s_add_u32 s7, s48, 106496
    buffer_load_dwordx4 v[80:83], v6, s[8:11], s7 offen sc1
    s_add_u32 s7, s48, 110592
    buffer_load_dwordx4 v[84:87], v6, s[8:11], s7 offen sc1
    s_add_u32 s39, s39, 1
    s_waitcnt vmcnt(0)
    v_bitop3_b32 v9, v72, v76, v80 bitop3:0x80
    v_and_b32 v9, v9, v84
    v_and_b32 v9, s40, v9
    v_cmp_ne_u32 vcc, s40, v9
    s_cbranch_vccz cout_211
    s_sleep 1
    s_cmp_lt_u32 s39, 131072
    s_cbranch_scc1 cloop_210
cout_211:
    s_mov_b64 exec, -1
    s_waitcnt lgkmcnt(0)
    s_nop 3
    s_branch cback_55
cslow_58:
    s_mov_b32 s39, 0
    s_waitcnt vmcnt(0) lgkmcnt(0)
    s_nop 7
    s_nop 7
cloop_212:
    s_mov_b64 exec, vcc
    s_add_u32 s7, s48, 114688
    buffer_load_dwordx4 v[88:91], v6, s[8:11], s7 offen sc1
    s_add_u32 s7, s48, 118784
    buffer_load_dwordx4 v[92:95], v6, s[8:11], s7 offen sc1
    s_add_u32 s7, s48, 122880
    buffer_load_dwordx4 v[96:99], v6, s[8:11], s7 offen sc1
    s_add_u32 s7, s48, 126976
    buffer_load_dwordx4 v[100:103], v6, s[8:11], s7 offen sc1
    s_add_u32 s39, s39, 1
    s_waitcnt vmcnt(0)
    v_bitop3_b32 v9, v88, v92, v96 bitop3:0x80
    v_and_b32 v9, v9, v100
    v_and_b32 v9, s40, v9
    v_cmp_ne_u32 vcc, s40, v9
    s_cbranch_vccz cout_213
    s_sleep 1
    s_cmp_lt_u32 s39, 131072
    s_cbranch_scc1 cloop_212
cout_213:
    s_mov_b64 exec, -1
    s_waitcnt lgkmcnt(0)
    s_nop 3
    s_branch cback_57
cslow_60:
    s_mov_b32 s39, 0
    s_waitcnt vmcnt(0) lgkmcnt(0)
    s_nop 7
    s_nop 7
cloop_214:
    s_mov_b64 exec, vcc
    s_add_u32 s7, s48, 131072
    buffer_load_dwordx4 v[40:43], v6, s[8:11], s7 offen sc1
    s_add_u32 s7, s48, 135168
    buffer_load_dwordx4 v[44:47], v6, s[8:11], s7 offen sc1
    s_add_u32 s7, s48, 139264
    buffer_load_dwordx4 v[48:51], v6, s[8:11], s7 offen sc1
    s_add_u32 s7, s48, 143360
    buffer_load_dwordx4 v[52:55], v6, s[8:11], s7 offen sc1
    s_add_u32 s39, s39, 1
    s_waitcnt vmcnt(0)
    v_bitop3_b32 v9, v40, v44, v48 bitop3:0x80
    v_and_b32 v9, v9, v52
    v_and_b32 v9, s73, v9
    v_cmp_ne_u32 vcc, s73, v9
    s_cbranch_vccz cout_215
    s_sleep 1
    s_cmp_lt_u32 s39, 131072
    s_cbranch_scc1 cloop_214
cout_215:
    s_mov_b64 exec, -1
    s_waitcnt lgkmcnt(0)
    s_nop 3
    s_branch cback_59
cslow_62:
    s_mov_b32 s39, 0
    s_waitcnt vmcnt(0) lgkmcnt(0)
    s_nop 7
    s_nop 7
cloop_216:
    s_mov_b64 exec, vcc
    s_add_u32 s7, s48, 147456
    buffer_load_dwordx4 v[56:59], v6, s[8:11], s7 offen sc1
    s_add_u32 s7, s48, 151552
    buffer_load_dwordx4 v[60:63], v6, s[8:11], s7 offen sc1
    s_add_u32 s7, s48, 155648
    buffer_load_dwordx4 v[64:67], v6, s[8:11], s7 offen sc1
    s_add_u32 s7, s48, 159744
    buffer_load_dwordx4 v[68:71], v6, s[8:11], s7 offen sc1
    s_add_u32 s39, s39, 1
    s_waitcnt vmcnt(0)
    v_bitop3_b32 v9, v56, v60, v64 bitop3:0x80
    v_and_b32 v9, v9, v68
    v_and_b32 v9, s73, v9
    v_cmp_ne_u32 vcc, s73, v9
    s_cbranch_vccz cout_217
    s_sleep 1
    s_cmp_lt_u32 s39, 131072
    s_cbranch_scc1 cloop_216
cout_217:
    s_mov_b64 exec, -1
    s_waitcnt lgkmcnt(0)
    s_nop 3
    s_branch cback_61
cslow_64:
    s_mov_b32 s39, 0
    s_waitcnt vmcnt(0) lgkmcnt(0)
    s_nop 7
    s_nop 7
cloop_218:
    s_mov_b64 exec, vcc
    s_add_u32 s7, s48, 163840
    buffer_load_dwordx4 v[72:75], v6, s[8:11], s7 offen sc1
    s_add_u32 s7, s48, 167936
    buffer_load_dwordx4 v[76:79], v6, s[8:11], s7 offen sc1
    s_add_u32 s7, s48, 172032
    buffer_load_dwordx4 v[80:83], v6, s[8:11], s7 offen sc1
    s_add_u32 s7, s48, 176128
    buffer_load_dwordx4 v[84:87], v6, s[8:11], s7 offen sc1
    s_add_u32 s39, s39, 1
    s_waitcnt vmcnt(0)
    v_bitop3_b32 v9, v72, v76, v80 bitop3:0x80
    v_and_b32 v9, v9, v84
    v_and_b32 v9, s73, v9
    v_cmp_ne_u32 vcc, s73, v9
    s_cbranch_vccz cout_219
    s_sleep 1
    s_cmp_lt_u32 s39, 131072
    s_cbranch_scc1 cloop_218
cout_219:
    s_mov_b64 exec, -1
    s_waitcnt lgkmcnt(0)
    s_nop 3
    s_branch cback_63
cslow_66:
    s_mov_b32 s39, 0
    s_waitcnt vmcnt(0) lgkmcnt(0)
    s_nop 7
    s_nop 7
cloop_220:
    s_mov_b64 exec, vcc
    s_add_u32 s7, s48, 180224
    buffer_load_dwordx4 v[88:91], v6, s[8:11], s7 offen sc1
    s_add_u32 s7, s48, 184320
    buffer_load_dwordx4 v[92:95], v6, s[8:11], s7 offen sc1
    s_add_u32 s7, s48, 188416
    buffer_load_dwordx4 v[96:99], v6, s[8:11], s7 offen sc1
    s_add_u32 s7, s48, 192512
    buffer_load_dwordx4 v[100:103], v6, s[8:11], s7 offen sc1
    s_add_u32 s39, s39, 1
    s_waitcnt vmcnt(0)
    v_bitop3_b32 v9, v88, v92, v96 bitop3:0x80
    v_and_b32 v9, v9, v100
    v_and_b32 v9, s73, v9
    v_cmp_ne_u32 vcc, s73, v9
    s_cbranch_vccz cout_221
    s_sleep 1
    s_cmp_lt_u32 s39, 131072
    s_cbranch_scc1 cloop_220
cout_221:
    s_mov_b64 exec, -1
    s_waitcnt lgkmcnt(0)
    s_nop 3
    s_branch cback_65
pslow_68:
    s_mov_b32 s39, 0
ploop_222:
    s_mov_b64 exec, vcc
    buffer_load_dword v2, v119, s[96:99], 0 offen sc1
    s_add_u32 s39, s39, 1
    s_waitcnt vmcnt(0)
    v_subrev_u32 v2, s6, v2
    v_cmp_le_u32 vcc, 8, v2
    s_cbranch_vccz pout_223
    s_sleep 1
    s_cmp_lt_u32 s39, 131072
    s_cbranch_scc1 ploop_222
pout_223:
    s_mov_b64 exec, -1
    s_branch pback_67
cslow_70:
    s_mov_b32 s39, 0
    s_waitcnt vmcnt(0) lgkmcnt(0)
    s_nop 7
    s_nop 7
cloop_224:
    s_mov_b64 exec, vcc
    buffer_load_dwordx4 v[32:35], v113, s[8:11], s74 offen sc1
    buffer_load_dwordx4 v[36:39], v113, s[8:11], s75 offen sc1
    buffer_load_dwordx4 v[16:19], v114, s[68:71], s28 offen offset:0 sc1
    buffer_load_dwordx4 v[20:23], v114, s[68:71], s28 offen offset:16 sc1
    buffer_load_dwordx4 v[24:27], v114, s[68:71], s29 offen offset:0 sc1
    buffer_load_dwordx4 v[28:31], v114, s[68:71], s29 offen offset:16 sc1
    s_add_u32 s39, s39, 1
    s_waitcnt vmcnt(0)
    v_max3_u32 v3, v16, v17, v18
    v_max3_u32 v3, v3, v19, v20
    v_max3_u32 v3, v3, v21, v22
    v_max3_u32 v3, v3, v23, v24
    v_max3_u32 v3, v3, v25, v26
    v_max3_u32 v3, v3, v27, v28
    v_max3_u32 v3, v3, v29, v30
    v_max_u32 v3, v3, v31
    v_cmp_eq_u32 vcc, -1, v3
    s_nop 0
    s_mov_b64 s[6:7], vcc
    v_and_b32 v3, v32, v36
    v_and_b32 v3, s40, v3
    v_cmp_ne_u32 vcc, s40, v3
    s_nop 0
    s_or_b64 vcc, vcc, s[6:7]
    s_cbranch_vccz cout_225
    s_sleep 1
    s_cmp_lt_u32 s39, 131072
    s_cbranch_scc1 cloop_224
cout_225:
    s_mov_b64 exec, -1
    s_waitcnt lgkmcnt(0)
    s_nop 3
    s_branch cback_69
cslow_72:
    s_mov_b32 s39, 0
    s_waitcnt vmcnt(0) lgkmcnt(0)
    s_nop 7
    s_nop 7
cloop_226:
    s_mov_b64 exec, vcc
    s_mov_b32 s0, 0
    buffer_load_dwordx4 v[120:123], v14, s[20:23], s0 offen offset:0 sc1
    buffer_load_dwordx4 v[124:127], v14, s[20:23], s0 offen offset:128 sc1
    s_add_u32 s39, s39, 1
    s_waitcnt vmcnt(0)
    v_or_b32 v3, v120, v124
    v_and_b32 v3, 1, v3
    v_cmp_ne_u32 s[6:7], 0, v3
    s_nop 0
    s_mov_b64 vcc, s[6:7]
    s_cbranch_vccz cout_227
    s_sleep 1
    s_cmp_lt_u32 s39, 131072
    s_cbranch_scc1 cloop_226
cout_227:
    s_mov_b64 exec, -1
    s_waitcnt lgkmcnt(0)
    s_nop 3
    s_branch cback_71
cslow_74:
    s_mov_b32 s39, 0
    s_waitcnt vmcnt(0) lgkmcnt(0)
    s_nop 7
    s_nop 7
cloop_228:
    s_mov_b64 exec, vcc
    s_mov_b32 s0, 8192
    buffer_load_dwordx4 v[128:131], v14, s[20:23], s0 offen offset:0 sc1
    buffer_load_dwordx4 v[132:135], v14, s[20:23], s0 offen offset:128 sc1
    s_mov_b32 s0, 16384
    buffer_load_dwordx4 v[136:139], v14, s[20:23], s0 offen offset:0 sc1
    buffer_load_dwordx4 v[140:143], v14, s[20:23], s0 offen offset:128 sc1
    s_add_u32 s39, s39, 1
    s_waitcnt vmcnt(0)
    v_or3_b32 v3, v128, v132, v136
    v_or_b32 v3, v3, v140
    v_and_b32 v3, 1, v3
    v_cmp_ne_u32 s[6:7], 0, v3
    s_nop 0
    s_mov_b64 vcc, s[6:7]
    s_cbranch_vccz cout_229
    s_sleep 1
    s_cmp_lt_u32 s39, 131072
    s_cbranch_scc1 cloop_228
cout_229:
    s_mov_b64 exec, -1
    s_waitcnt lgkmcnt(0)
    s_nop 3
    s_branch cback_73
cslow_76:
    s_mov_b32 s39, 0
    s_waitcnt vmcnt(0) lgkmcnt(0)
    s_nop 7
    s_nop 7
cloop_230:
    s_mov_b64 exec, vcc
    s_mov_b32 s0, 24576
    buffer_load_dwordx4 v[144:147], v14, s[20:23], s0 offen offset:0 sc1
    buffer_load_dwordx4 v[148:151], v14, s[20:23], s0 offen offset:128 sc1
    s_mov_b32 s0, 32768
    buffer_load_dwordx4 v[152:155], v14, s[20:23], s0 offen offset:0 sc1
    buffer_load_dwordx4 v[156:159], v14, s[20:23], s0 offen offset:128 sc1
    s_add_u32 s39, s39, 1
    s_waitcnt vmcnt(0)
    v_or3_b32 v3, v144, v148, v152
    v_or_b32 v3, v3, v156
    v_and_b32 v3, 1, v3
    v_cmp_ne_u32 s[6:7], 0, v3
    s_nop 0
    s_mov_b64 vcc, s[6:7]
    s_cbranch_vccz cout_231
    s_sleep 1
    s_cmp_lt_u32 s39, 131072
    s_cbranch_scc1 cloop_230
cout_231:
    s_mov_b64 exec, -1
    s_waitcnt lgkmcnt(0)
    s_nop 3
    s_branch cback_75
cslow_78:
    s_mov_b32 s39, 0
    s_waitcnt vmcnt(0) lgkmcnt(0)
    s_nop 7
    s_nop 7
cloop_232:
    s_mov_b64 exec, vcc
    s_mov_b32 s0, 40960
    buffer_load_dwordx4 v[160:163], v14, s[20:23], s0 offen offset:0 sc1
    buffer_load_dwordx4 v[164:167], v14, s[20:23], s0 offen offset:128 sc1
    s_mov_b32 s0, 49152
    buffer_load_dwordx4 v[168:171], v14, s[20:23], s0 offen offset:0 sc1
    buffer_load_dwordx4 v[172:175], v14, s[20:23], s0 offen offset:128 sc1
    s_add_u32 s39, s39, 1
    s_waitcnt vmcnt(0)
    v_or3_b32 v3, v160, v164, v168
    v_or_b32 v3, v3, v172
    v_and_b32 v3, 1, v3
    v_cmp_ne_u32 s[6:7], 0, v3
    s_nop 0
    s_mov_b64 vcc, s[6:7]
    s_cbranch_vccz cout_233
    s_sleep 1
    s_cmp_lt_u32 s39, 131072
    s_cbranch_scc1 cloop_232
cout_233:
    s_mov_b64 exec, -1
    s_waitcnt lgkmcnt(0)
    s_nop 3
    s_branch cback_77
cslow_80:
    s_mov_b32 s39, 0
    s_waitcnt vmcnt(0) lgkmcnt(0)
    s_nop 7
    s_nop 7
cloop_234:
    s_mov_b64 exec, vcc
    s_mov_b32 s0, 57344
    buffer_load_dwordx4 v[176:179], v14, s[20:23], s0 offen offset:0 sc1
    buffer_load_dwordx4 v[180:183], v14, s[20:23], s0 offen offset:128 sc1
    s_mov_b32 s0, 65536
    buffer_load_dwordx4 v[184:187], v14, s[20:23], s0 offen offset:0 sc1
    buffer_load_dwordx4 v[188:191], v14, s[20:23], s0 offen offset:128 sc1
    s_add_u32 s39, s39, 1
    s_waitcnt vmcnt(0)
    v_or3_b32 v3, v176, v180, v184
    v_or_b32 v3, v3, v188
    v_and_b32 v3, 1, v3
    v_cmp_ne_u32 s[6:7], 0, v3
    s_nop 0
    s_mov_b64 vcc, s[6:7]
    s_cbranch_vccz cout_235
    s_sleep 1
    s_cmp_lt_u32 s39, 131072
    s_cbranch_scc1 cloop_234
cout_235:
    s_mov_b64 exec, -1
    s_waitcnt lgkmcnt(0)
    s_nop 3
    s_branch cback_79
cslow_82:
    s_mov_b32 s39, 0
    s_waitcnt vmcnt(0) lgkmcnt(0)
    s_nop 7
    s_nop 7
cloop_236:
    s_mov_b64 exec, vcc
    s_mov_b32 s0, 73728
    buffer_load_dwordx4 v[192:195], v14, s[20:23], s0 offen offset:0 sc1
    buffer_load_dwordx4 v[196:199], v14, s[20:23], s0 offen offset:128 sc1
    s_mov_b32 s0, 81920
    buffer_load_dwordx4 v[200:203], v14, s[20:23], s0 offen offset:0 sc1
    buffer_load_dwordx4 v[204:207], v14, s[20:23], s0 offen offset:128 sc1
    s_add_u32 s39, s39, 1
    s_waitcnt vmcnt(0)
    v_or3_b32 v3, v192, v196, v200
    v_or_b32 v3, v3, v204
    v_and_b32 v3, 1, v3
    v_cmp_ne_u32 s[6:7], 0, v3
    s_nop 0
    s_mov_b64 vcc, s[6:7]
    s_cbranch_vccz cout_237
    s_sleep 1
    s_cmp_lt_u32 s39, 131072
    s_cbranch_scc1 cloop_236
cout_237:
    s_mov_b64 exec, -1
    s_waitcnt lgkmcnt(0)
    s_nop 3
    s_branch cback_81
cslow_85:
    s_mov_b32 s39, 0
    s_waitcnt vmcnt(0) lgkmcnt(0)
    s_nop 7
    s_nop 7
cloop_238:
    s_mov_b64 exec, vcc
    buffer_load_dwordx4 v[16:19], v8, s[8:11], s65 offen sc1
    buffer_load_dwordx4 v[20:23], v8, s[8:11], s65 offen offset:64 sc1
    buffer_load_dwordx4 v[176:179], v9, s[12:15], s66 offen sc1
    s_add_u32 s7, s66, 4096
    buffer_load_dwordx4 v[180:183], v9, s[12:15], s7 offen sc1
    s_add_u32 s7, s66, 8192
    buffer_load_dwordx4 v[184:187], v9, s[12:15], s7 offen sc1
    s_add_u32 s7, s66, 12288
    buffer_load_dwordx4 v[188:191], v9, s[12:15], s7 offen sc1
    s_add_u32 s7, s66, 16384
    buffer_load_dwordx4 v[192:195], v9, s[12:15], s7 offen sc1
    s_add_u32 s7, s66, 20480
    buffer_load_dwordx4 v[196:199], v9, s[12:15], s7 offen sc1
    s_add_u32 s7, s66, 24576
    buffer_load_dwordx4 v[200:203], v9, s[12:15], s7 offen sc1
    s_add_u32 s7, s66, 28672
    buffer_load_dwordx4 v[204:207], v9, s[12:15], s7 offen sc1
    s_add_u32 s39, s39, 1
    s_waitcnt vmcnt(0)
    v_max3_u32 v14, v176, v180, v184
    v_max3_u32 v14, v14, v188, v192
    v_max3_u32 v14, v14, v196, v200
    v_max_u32 v14, v14, v204
    v_bitop3_b32 v128, v16, v20, 1 bitop3:0x7e
    v_cmp_eq_u32 s[6:7], -1, v14
    v_and_b32 v128, s40, v128
    v_cmp_ne_u32 vcc, 0, v128
    s_nop 0
    s_or_b64 vcc, vcc, s[6:7]
    s_cbranch_vccz cout_239
    s_sleep 1
    s_cmp_lt_u32 s39, 131072
    s_cbranch_scc1 cloop_238
cout_239:
    s_mov_b64 exec, -1
    s_waitcnt lgkmcnt(0)
    s_nop 3
    v_lshlrev_b32 v160, 16, v16
    v_and_b32 v161, s38, v16
    v_lshlrev_b32 v162, 16, v17
    v_and_b32 v163, s38, v17
    v_lshlrev_b32 v164, 16, v18
    v_and_b32 v165, s38, v18
    v_lshlrev_b32 v166, 16, v19
    v_and_b32 v167, s38, v19
    v_lshlrev_b32 v168, 16, v20
    v_and_b32 v169, s38, v20
    v_lshlrev_b32 v170, 16, v21
    v_and_b32 v171, s38, v21
    v_lshlrev_b32 v172, 16, v22
    v_and_b32 v173, s38, v22
    v_lshlrev_b32 v174, 16, v23
    v_and_b32 v175, s38, v23
    v_mfma_f32_16x16x32_bf16 v[112:115], v[144:147], v[176:179], 0
    v_mfma_f32_16x16x32_bf16 v[116:119], v[148:151], v[176:179], 0
    v_mfma_f32_16x16x32_bf16 v[112:115], v[144:147], v[180:183], v[112:115]
    v_mfma_f32_16x16x32_bf16 v[116:119], v[148:151], v[180:183], v[116:119]
    v_mfma_f32_16x16x32_bf16 v[112:115], v[144:147], v[184:187], v[112:115]
    v_mfma_f32_16x16x32_bf16 v[116:119], v[148:151], v[184:187], v[116:119]
    v_mfma_f32_16x16x32_bf16 v[112:115], v[144:147], v[188:191], v[112:115]
    v_mfma_f32_16x16x32_bf16 v[116:119], v[148:151], v[188:191], v[116:119]
    v_mfma_f32_16x16x32_bf16 v[112:115], v[144:147], v[192:195], v[112:115]
    v_mfma_f32_16x16x32_bf16 v[116:119], v[148:151], v[192:195], v[116:119]
    v_mfma_f32_16x16x32_bf16 v[112:115], v[144:147], v[196:199], v[112:115]
    v_mfma_f32_16x16x32_bf16 v[116:119], v[148:151], v[196:199], v[116:119]
    v_mfma_f32_16x16x32_bf16 v[112:115], v[144:147], v[200:203], v[112:115]
    v_mfma_f32_16x16x32_bf16 v[116:119], v[148:151], v[200:203], v[116:119]
    v_mfma_f32_16x16x32_bf16 v[112:115], v[144:147], v[204:207], v[112:115]
    v_mfma_f32_16x16x32_bf16 v[116:119], v[148:151], v[204:207], v[116:119]
    s_nop 7
    s_branch cback_84
cslow_88:
    s_mov_b32 s39, 0
    s_waitcnt vmcnt(0) lgkmcnt(0)
    s_nop 7
    s_nop 7
cloop_240:
    s_mov_b32 s0, m0
    s_add_u32 m0, s49, 0
    s_add_u32 s7, s48, 0
    buffer_load_dwordx4 v95, s[8:11], s7 offen offset:0 sc1 lds
    buffer_load_dwordx4 v95, s[8:11], s7 offen offset:1024 sc1 lds
    buffer_load_dwordx4 v95, s[8:11], s7 offen offset:2048 sc1 lds
    buffer_load_dwordx4 v95, s[8:11], s7 offen offset:3072 sc1 lds
    s_add_u32 m0, s49, 16384
    s_add_u32 s7, s48, 16384
    buffer_load_dwordx4 v95, s[8:11], s7 offen offset:0 sc1 lds
    buffer_load_dwordx4 v95, s[8:11], s7 offen offset:1024 sc1 lds
    buffer_load_dwordx4 v95, s[8:11], s7 offen offset:2048 sc1 lds
    buffer_load_dwordx4 v95, s[8:11], s7 offen offset:3072 sc1 lds
    s_mov_b32 m0, s0
    s_add_u32 s39, s39, 1
    s_waitcnt vmcnt(0)
    ds_read2st64_b32 v[88:89], v3 offset0:0 offset1:4
    ds_read2st64_b32 v[90:91], v3 offset0:8 offset1:12
    s_waitcnt lgkmcnt(0)
    v_or3_b32 v88, v88, v89, v90
    v_bitop3_b32 v88, v88, v91, s40 bitop3:0xa8
    v_cmp_ne_u32 vcc, 0, v88
    s_cbranch_vccz cout_241
    s_sleep 1
    s_cmp_lt_u32 s39, 131072
    s_cbranch_scc1 cloop_240
cout_241:
    s_waitcnt lgkmcnt(0)
    s_nop 3
    s_branch cback_87
cslow_90:
    s_mov_b32 s39, 0
    s_waitcnt vmcnt(0) lgkmcnt(0)
    s_nop 7
    s_nop 7
cloop_242:
    s_mov_b32 s0, m0
    s_add_u32 m0, s49, 16384
    s_add_u32 s7, s48, 16384
    buffer_load_dwordx4 v95, s[8:11], s7 offen offset:0 sc1 lds
    buffer_load_dwordx4 v95, s[8:11], s7 offen offset:1024 sc1 lds
    buffer_load_dwordx4 v95, s[8:11], s7 offen offset:2048 sc1 lds
    buffer_load_dwordx4 v95, s[8:11], s7 offen offset:3072 sc1 lds
    s_add_u32 m0, s49, 32768
    s_add_u32 s7, s48, 32768
    buffer_load_dwordx4 v95, s[8:11], s7 offen offset:0 sc1 lds
    buffer_load_dwordx4 v95, s[8:11], s7 offen offset:1024 sc1 lds
    buffer_load_dwordx4 v95, s[8:11], s7 offen offset:2048 sc1 lds
    buffer_load_dwordx4 v95, s[8:11], s7 offen offset:3072 sc1 lds
    s_mov_b32 m0, s0
    s_add_u32 s39, s39, 1
    s_waitcnt vmcnt(0)
    ds_read2st64_b32 v[88:89], v3 offset0:64 offset1:68
    ds_read2st64_b32 v[90:91], v3 offset0:72 offset1:76
    s_waitcnt lgkmcnt(0)
    v_or3_b32 v88, v88, v89, v90
    v_bitop3_b32 v88, v88, v91, s40 bitop3:0xa8
    v_cmp_ne_u32 vcc, 0, v88
    s_cbranch_vccz cout_243
    s_sleep 1
    s_cmp_lt_u32 s39, 131072
    s_cbranch_scc1 cloop_242
cout_243:
    s_waitcnt lgkmcnt(0)
    s_nop 3
    s_branch cback_89
cslow_92:
    s_mov_b32 s39, 0
    s_waitcnt vmcnt(0) lgkmcnt(0)
    s_nop 7
    s_nop 7
cloop_244:
    s_mov_b32 s0, m0
    s_add_u32 m0, s49, 32768
    s_add_u32 s7, s48, 32768
    buffer_load_dwordx4 v95, s[8:11], s7 offen offset:0 sc1 lds
    buffer_load_dwordx4 v95, s[8:11], s7 offen offset:1024 sc1 lds
    buffer_load_dwordx4 v95, s[8:11], s7 offen offset:2048 sc1 lds
    buffer_load_dwordx4 v95, s[8:11], s7 offen offset:3072 sc1 lds
    s_add_u32 m0, s49, 49152
    s_add_u32 s7, s48, 49152
    buffer_load_dwordx4 v95, s[8:11], s7 offen offset:0 sc1 lds
    buffer_load_dwordx4 v95, s[8:11], s7 offen offset:1024 sc1 lds
    buffer_load_dwordx4 v95, s[8:11], s7 offen offset:2048 sc1 lds
    buffer_load_dwordx4 v95, s[8:11], s7 offen offset:3072 sc1 lds
    s_mov_b32 m0, s0
    s_add_u32 s39, s39, 1
    s_waitcnt vmcnt(0)
    ds_read2st64_b32 v[88:89], v3 offset0:128 offset1:132
    ds_read2st64_b32 v[90:91], v3 offset0:136 offset1:140
    s_waitcnt lgkmcnt(0)
    v_or3_b32 v88, v88, v89, v90
    v_bitop3_b32 v88, v88, v91, s40 bitop3:0xa8
    v_cmp_ne_u32 vcc, 0, v88
    s_cbranch_vccz cout_245
    s_sleep 1
    s_cmp_lt_u32 s39, 131072
    s_cbranch_scc1 cloop_244
cout_245:
    s_waitcnt lgkmcnt(0)
    s_nop 3
    s_branch cback_91
cslow_94:
    s_mov_b32 s39, 0
    s_waitcnt vmcnt(0) lgkmcnt(0)
    s_nop 7
    s_nop 7
cloop_246:
    s_mov_b32 s0, m0
    s_add_u32 m0, s49, 49152
    s_add_u32 s7, s48, 49152
    buffer_load_dwordx4 v95, s[8:11], s7 offen offset:0 sc1 lds
    buffer_load_dwordx4 v95, s[8:11], s7 offen offset:1024 sc1 lds
    buffer_load_dwordx4 v95, s[8:11], s7 offen offset:2048 sc1 lds
    buffer_load_dwordx4 v95, s[8:11], s7 offen offset:3072 sc1 lds
    s_mov_b32 m0, s0
    s_add_u32 s39, s39, 1
    s_waitcnt vmcnt(0)
    ds_read2st64_b32 v[88:89], v3 offset0:192 offset1:196
    ds_read2st64_b32 v[90:91], v3 offset0:200 offset1:204
    s_waitcnt lgkmcnt(0)
    v_or3_b32 v88, v88, v89, v90
    v_bitop3_b32 v88, v88, v91, s40 bitop3:0xa8
    v_cmp_ne_u32 vcc, 0, v88
    s_cbranch_vccz cout_247
    s_sleep 1
    s_cmp_lt_u32 s39, 131072
    s_cbranch_scc1 cloop_246
cout_247:
    s_waitcnt lgkmcnt(0)
    s_nop 3
    s_branch cback_93
cslow_96:
    s_mov_b32 s39, 0
    s_waitcnt vmcnt(0) lgkmcnt(0)
    s_nop 7
    s_nop 7
cloop_248:
    s_mov_b32 s0, m0
    s_add_u32 m0, s49, 65536
    s_add_u32 s7, s48, 65536
    buffer_load_dwordx4 v95, s[8:11], s7 offen offset:0 sc1 lds
    buffer_load_dwordx4 v95, s[8:11], s7 offen offset:1024 sc1 lds
    buffer_load_dwordx4 v95, s[8:11], s7 offen offset:2048 sc1 lds
    buffer_load_dwordx4 v95, s[8:11], s7 offen offset:3072 sc1 lds
    s_mov_b32 m0, s0
    s_add_u32 s39, s39, 1
    s_waitcnt vmcnt(0)
    ds_read2st64_b32 v[88:89], v6 offset0:0 offset1:4
    ds_read2st64_b32 v[90:91], v6 offset0:8 offset1:12
    s_waitcnt lgkmcnt(0)
    v_or3_b32 v88, v88, v89, v90
    v_bitop3_b32 v88, v88, v91, s40 bitop3:0xa8
    v_cmp_ne_u32 vcc, 0, v88
    s_cbranch_vccz cout_249
    s_sleep 1
    s_cmp_lt_u32 s39, 131072
    s_cbranch_scc1 cloop_248
cout_249:
    s_waitcnt lgkmcnt(0)
    s_nop 3
    s_branch cback_95
cslow_98:
    s_mov_b32 s39, 0
    s_waitcnt vmcnt(0) lgkmcnt(0)
    s_nop 7
    s_nop 7
cloop_250:
    s_mov_b32 s0, m0
    s_add_u32 m0, s49, 81920
    s_add_u32 s7, s48, 81920
    buffer_load_dwordx4 v95, s[8:11], s7 offen offset:0 sc1 lds
    buffer_load_dwordx4 v95, s[8:11], s7 offen offset:1024 sc1 lds
    buffer_load_dwordx4 v95, s[8:11], s7 offen offset:2048 sc1 lds
    buffer_load_dwordx4 v95, s[8:11], s7 offen offset:3072 sc1 lds
    s_mov_b32 m0, s0
    s_add_u32 s39, s39, 1
    s_waitcnt vmcnt(0)
    ds_read2st64_b32 v[88:89], v6 offset0:64 offset1:68
    ds_read2st64_b32 v[90:91], v6 offset0:72 offset1:76
    s_waitcnt lgkmcnt(0)
    v_or3_b32 v88, v88, v89, v90
    v_bitop3_b32 v88, v88, v91, s40 bitop3:0xa8
    v_cmp_ne_u32 vcc, 0, v88
    s_cbranch_vccz cout_251
    s_sleep 1
    s_cmp_lt_u32 s39, 131072
    s_cbranch_scc1 cloop_250
cout_251:
    s_waitcnt lgkmcnt(0)
    s_nop 3
    s_branch cback_97
cslow_100:
    s_mov_b32 s39, 0
    s_waitcnt vmcnt(0) lgkmcnt(0)
    s_nop 7
    s_nop 7
cloop_252:
    s_mov_b32 s0, m0
    s_add_u32 m0, s49, 98304
    s_add_u32 s7, s48, 98304
    buffer_load_dwordx4 v95, s[8:11], s7 offen offset:0 sc1 lds
    buffer_load_dwordx4 v95, s[8:11], s7 offen offset:1024 sc1 lds
    buffer_load_dwordx4 v95, s[8:11], s7 offen offset:2048 sc1 lds
    buffer_load_dwordx4 v95, s[8:11], s7 offen offset:3072 sc1 lds
    s_mov_b32 m0, s0
    s_add_u32 s39, s39, 1
    s_waitcnt vmcnt(0)
    ds_read2st64_b32 v[88:89], v6 offset0:128 offset1:132
    ds_read2st64_b32 v[90:91], v6 offset0:136 offset1:140
    s_waitcnt lgkmcnt(0)
    v_or3_b32 v88, v88, v89, v90
    v_bitop3_b32 v88, v88, v91, s40 bitop3:0xa8
    v_cmp_ne_u32 vcc, 0, v88
    s_cbranch_vccz cout_253
    s_sleep 1
    s_cmp_lt_u32 s39, 131072
    s_cbranch_scc1 cloop_252
cout_253:
    s_waitcnt lgkmcnt(0)
    s_nop 3
    s_branch cback_99
cslow_102:
    s_mov_b32 s39, 0
    s_waitcnt vmcnt(0) lgkmcnt(0)
    s_nop 7
    s_nop 7
cloop_254:
    s_mov_b32 s0, m0
    s_add_u32 m0, s49, 114688
    s_add_u32 s7, s48, 114688
    buffer_load_dwordx4 v95, s[8:11], s7 offen offset:0 sc1 lds
    buffer_load_dwordx4 v95, s[8:11], s7 offen offset:1024 sc1 lds
    buffer_load_dwordx4 v95, s[8:11], s7 offen offset:2048 sc1 lds
    buffer_load_dwordx4 v95, s[8:11], s7 offen offset:3072 sc1 lds
    s_mov_b32 m0, s0
    s_add_u32 s39, s39, 1
    s_waitcnt vmcnt(0)
    ds_read2st64_b32 v[88:89], v6 offset0:192 offset1:196
    ds_read2st64_b32 v[90:91], v6 offset0:200 offset1:204
    s_waitcnt lgkmcnt(0)
    v_or3_b32 v88, v88, v89, v90
    v_bitop3_b32 v88, v88, v91, s40 bitop3:0xa8
    v_cmp_ne_u32 vcc, 0, v88
    s_cbranch_vccz cout_255
    s_sleep 1
    s_cmp_lt_u32 s39, 131072
    s_cbranch_scc1 cloop_254
cout_255:
    s_waitcnt lgkmcnt(0)
    s_nop 3
    s_branch cback_101
cslow_104:
    s_mov_b32 s39, 0
    s_waitcnt vmcnt(0) lgkmcnt(0)
    s_nop 7
    s_nop 7
cloop_256:
    s_mov_b32 s0, m0
    s_add_u32 m0, s49, 131072
    s_add_u32 s7, s48, 131072
    buffer_load_dwordx4 v95, s[8:11], s7 offen offset:0 sc1 lds
    buffer_load_dwordx4 v95, s[8:11], s7 offen offset:1024 sc1 lds
    buffer_load_dwordx4 v95, s[8:11], s7 offen offset:2048 sc1 lds
    buffer_load_dwordx4 v95, s[8:11], s7 offen offset:3072 sc1 lds
    s_mov_b32 m0, s0
    s_add_u32 s39, s39, 1
    s_waitcnt vmcnt(0)
    ds_read2st64_b32 v[88:89], v7 offset0:0 offset1:4
    ds_read2st64_b32 v[90:91], v7 offset0:8 offset1:12
    s_waitcnt lgkmcnt(0)
    v_or3_b32 v88, v88, v89, v90
    v_bitop3_b32 v88, v88, v91, s73 bitop3:0xa8
    v_cmp_ne_u32 vcc, 0, v88
    s_cbranch_vccz cout_257
    s_sleep 1
    s_cmp_lt_u32 s39, 131072
    s_cbranch_scc1 cloop_256
cout_257:
    s_waitcnt lgkmcnt(0)
    s_nop 3
    s_branch cback_103
cslow_106:
    s_mov_b32 s39, 0
    s_waitcnt vmcnt(0) lgkmcnt(0)
    s_nop 7
    s_nop 7
cloop_258:
    s_mov_b32 s0, m0
    s_add_u32 m0, s49, 147456
    s_add_u32 s7, s48, 147456
    buffer_load_dwordx4 v95, s[8:11], s7 offen offset:0 sc1 lds
    buffer_load_dwordx4 v95, s[8:11], s7 offen offset:1024 sc1 lds
    buffer_load_dwordx4 v95, s[8:11], s7 offen offset:2048 sc1 lds
    buffer_load_dwordx4 v95, s[8:11], s7 offen offset:3072 sc1 lds
    s_mov_b32 m0, s0
    s_add_u32 s39, s39, 1
    s_waitcnt vmcnt(0)
    ds_read2st64_b32 v[88:89], v7 offset0:64 offset1:68
    ds_read2st64_b32 v[90:91], v7 offset0:72 offset1:76
    s_waitcnt lgkmcnt(0)
    v_or3_b32 v88, v88, v89, v90
    v_bitop3_b32 v88, v88, v91, s73 bitop3:0xa8
    v_cmp_ne_u32 vcc, 0, v88
    s_cbranch_vccz cout_259
    s_sleep 1
    s_cmp_lt_u32 s39, 131072
    s_cbranch_scc1 cloop_258
cout_259:
    s_waitcnt lgkmcnt(0)
    s_nop 3
    s_branch cback_105
cslow_108:
    s_mov_b32 s39, 0
    s_waitcnt vmcnt(0) lgkmcnt(0)
    s_nop 7
    s_nop 7
cloop_260:
    s_mov_b32 s0, m0
    s_add_u32 m0, s49, 0
    s_add_u32 s7, s48, 163840
    buffer_load_dwordx4 v95, s[8:11], s7 offen offset:0 sc1 lds
    buffer_load_dwordx4 v95, s[8:11], s7 offen offset:1024 sc1 lds
    buffer_load_dwordx4 v95, s[8:11], s7 offen offset:2048 sc1 lds
    buffer_load_dwordx4 v95, s[8:11], s7 offen offset:3072 sc1 lds
    s_mov_b32 m0, s0
    s_add_u32 s39, s39, 1
    s_waitcnt vmcnt(0)
    ds_read2st64_b32 v[88:89], v3 offset0:0 offset1:4
    ds_read2st64_b32 v[90:91], v3 offset0:8 offset1:12
    s_waitcnt lgkmcnt(0)
    v_or3_b32 v88, v88, v89, v90
    v_bitop3_b32 v88, v88, v91, s73 bitop3:0xa8
    v_cmp_ne_u32 vcc, 0, v88
    s_cbranch_vccz cout_261
    s_sleep 1
    s_cmp_lt_u32 s39, 131072
    s_cbranch_scc1 cloop_260
cout_261:
    s_waitcnt lgkmcnt(0)
    s_nop 3
    s_branch cback_107
cslow_110:
    s_mov_b32 s39, 0
    s_waitcnt vmcnt(0) lgkmcnt(0)
    s_nop 7
    s_nop 7
cloop_262:
    s_mov_b32 s0, m0
    s_add_u32 m0, s49, 16384
    s_add_u32 s7, s48, 180224
    buffer_load_dwordx4 v95, s[8:11], s7 offen offset:0 sc1 lds
    buffer_load_dwordx4 v95, s[8:11], s7 offen offset:1024 sc1 lds
    buffer_load_dwordx4 v95, s[8:11], s7 offen offset:2048 sc1 lds
    buffer_load_dwordx4 v95, s[8:11], s7 offen offset:3072 sc1 lds
    s_mov_b32 m0, s0
    s_add_u32 s39, s39, 1
    s_waitcnt vmcnt(0)
    ds_read2st64_b32 v[88:89], v3 offset0:64 offset1:68
    ds_read2st64_b32 v[90:91], v3 offset0:72 offset1:76
    s_waitcnt lgkmcnt(0)
    v_or3_b32 v88, v88, v89, v90
    v_bitop3_b32 v88, v88, v91, s73 bitop3:0xa8
    v_cmp_ne_u32 vcc, 0, v88
    s_cbranch_vccz cout_263
    s_sleep 1
    s_cmp_lt_u32 s39, 131072
    s_cbranch_scc1 cloop_262
cout_263:
    s_waitcnt lgkmcnt(0)
    s_nop 3
    s_branch cback_109
cslow_112:
    s_mov_b32 s39, 0
    s_waitcnt vmcnt(0) lgkmcnt(0)
    s_nop 7
    s_nop 7
cloop_264:
    s_mov_b64 exec, vcc
    s_add_u32 s7, s48, 0
    buffer_load_dwordx4 v[40:43], v6, s[8:11], s7 offen sc1
    s_add_u32 s7, s48, 4096
    buffer_load_dwordx4 v[44:47], v6, s[8:11], s7 offen sc1
    s_add_u32 s7, s48, 8192
    buffer_load_dwordx4 v[48:51], v6, s[8:11], s7 offen sc1
    s_add_u32 s7, s48, 12288
    buffer_load_dwordx4 v[52:55], v6, s[8:11], s7 offen sc1
    s_add_u32 s39, s39, 1
    s_waitcnt vmcnt(0)
    v_or3_b32 v9, v40, v44, v48
    v_or_b32 v9, v9, v52
    v_and_b32 v9, s40, v9
    v_cmp_ne_u32 vcc, 0, v9
    s_cbranch_vccz cout_265
    s_sleep 1
    s_cmp_lt_u32 s39, 131072
    s_cbranch_scc1 cloop_264
cout_265:
    s_mov_b64 exec, -1
    s_waitcnt lgkmcnt(0)
    s_nop 3
    s_branch cback_111
cslow_114:
    s_mov_b32 s39, 0
    s_waitcnt vmcnt(0) lgkmcnt(0)
    s_nop 7
    s_nop 7
cloop_266:
    s_mov_b64 exec, vcc
    s_add_u32 s7, s48, 16384
    buffer_load_dwordx4 v[56:59], v6, s[8:11], s7 offen sc1
    s_add_u32 s7, s48, 20480
    buffer_load_dwordx4 v[60:63], v6, s[8:11], s7 offen sc1
    s_add_u32 s7, s48, 24576
    buffer_load_dwordx4 v[64:67], v6, s[8:11], s7 offen sc1
    s_add_u32 s7, s48, 28672
    buffer_load_dwordx4 v[68:71], v6, s[8:11], s7 offen sc1
    s_add_u32 s39, s39, 1
    s_waitcnt vmcnt(0)
    v_or3_b32 v9, v56, v60, v64
    v_or_b32 v9, v9, v68
    v_and_b32 v9, s40, v9
    v_cmp_ne_u32 vcc, 0, v9
    s_cbranch_vccz cout_267
    s_sleep 1
    s_cmp_lt_u32 s39, 131072
    s_cbranch_scc1 cloop_266
cout_267:
    s_mov_b64 exec, -1
    s_waitcnt lgkmcnt(0)
    s_nop 3
    s_branch cback_113
cslow_116:
    s_mov_b32 s39, 0
    s_waitcnt vmcnt(0) lgkmcnt(0)
    s_nop 7
    s_nop 7
cloop_268:
    s_mov_b64 exec, vcc
    s_add_u32 s7, s48, 32768
    buffer_load_dwordx4 v[72:75], v6, s[8:11], s7 offen sc1
    s_add_u32 s7, s48, 36864
    buffer_load_dwordx4 v[76:79], v6, s[8:11], s7 offen sc1
    s_add_u32 s7, s48, 40960
    buffer_load_dwordx4 v[80:83], v6, s[8:11], s7 offen sc1
    s_add_u32 s7, s48, 45056
    buffer_load_dwordx4 v[84:87], v6, s[8:11], s7 offen sc1
    s_add_u32 s39, s39, 1
    s_waitcnt vmcnt(0)
    v_or3_b32 v9, v72, v76, v80
    v_or_b32 v9, v9, v84
    v_and_b32 v9, s40, v9
    v_cmp_ne_u32 vcc, 0, v9
    s_cbranch_vccz cout_269
    s_sleep 1
    s_cmp_lt_u32 s39, 131072
    s_cbranch_scc1 cloop_268
cout_269:
    s_mov_b64 exec, -1
    s_waitcnt lgkmcnt(0)
    s_nop 3
    s_branch cback_115
cslow_118:
    s_mov_b32 s39, 0
    s_waitcnt vmcnt(0) lgkmcnt(0)
    s_nop 7
    s_nop 7
cloop_270:
    s_mov_b64 exec, vcc
    s_add_u32 s7, s48, 49152
    buffer_load_dwordx4 v[88:91], v6, s[8:11], s7 offen sc1
    s_add_u32 s7, s48, 53248
    buffer_load_dwordx4 v[92:95], v6, s[8:11], s7 offen sc1
    s_add_u32 s7, s48, 57344
    buffer_load_dwordx4 v[96:99], v6, s[8:11], s7 offen sc1
    s_add_u32 s7, s48, 61440
    buffer_load_dwordx4 v[100:103], v6, s[8:11], s7 offen sc1
    s_add_u32 s39, s39, 1
    s_waitcnt vmcnt(0)
    v_or3_b32 v9, v88, v92, v96
    v_or_b32 v9, v9, v100
    v_and_b32 v9, s40, v9
    v_cmp_ne_u32 vcc, 0, v9
    s_cbranch_vccz cout_271
    s_sleep 1
    s_cmp_lt_u32 s39, 131072
    s_cbranch_scc1 cloop_270
cout_271:
    s_mov_b64 exec, -1
    s_waitcnt lgkmcnt(0)
    s_nop 3
    s_branch cback_117
cslow_120:
    s_mov_b32 s39, 0
    s_waitcnt vmcnt(0) lgkmcnt(0)
    s_nop 7
    s_nop 7
cloop_272:
    s_mov_b64 exec, vcc
    s_add_u32 s7, s48, 65536
    buffer_load_dwordx4 v[40:43], v6, s[8:11], s7 offen sc1
    s_add_u32 s7, s48, 69632
    buffer_load_dwordx4 v[44:47], v6, s[8:11], s7 offen sc1
    s_add_u32 s7, s48, 73728
    buffer_load_dwordx4 v[48:51], v6, s[8:11], s7 offen sc1
    s_add_u32 s7, s48, 77824
    buffer_load_dwordx4 v[52:55], v6, s[8:11], s7 offen sc1
    s_add_u32 s39, s39, 1
    s_waitcnt vmcnt(0)
    v_or3_b32 v9, v40, v44, v48
    v_or_b32 v9, v9, v52
    v_and_b32 v9, s40, v9
    v_cmp_ne_u32 vcc, 0, v9
    s_cbranch_vccz cout_273
    s_sleep 1
    s_cmp_lt_u32 s39, 131072
    s_cbranch_scc1 cloop_272
cout_273:
    s_mov_b64 exec, -1
    s_waitcnt lgkmcnt(0)
    s_nop 3
    s_branch cback_119
cslow_122:
    s_mov_b32 s39, 0
    s_waitcnt vmcnt(0) lgkmcnt(0)
    s_nop 7
    s_nop 7
cloop_274:
    s_mov_b64 exec, vcc
    s_add_u32 s7, s48, 81920
    buffer_load_dwordx4 v[56:59], v6, s[8:11], s7 offen sc1
    s_add_u32 s7, s48, 86016
    buffer_load_dwordx4 v[60:63], v6, s[8:11], s7 offen sc1
    s_add_u32 s7, s48, 90112
    buffer_load_dwordx4 v[64:67], v6, s[8:11], s7 offen sc1
    s_add_u32 s7, s48, 94208
    buffer_load_dwordx4 v[68:71], v6, s[8:11], s7 offen sc1
    s_add_u32 s39, s39, 1
    s_waitcnt vmcnt(0)
    v_or3_b32 v9, v56, v60, v64
    v_or_b32 v9, v9, v68
    v_and_b32 v9, s40, v9
    v_cmp_ne_u32 vcc, 0, v9
    s_cbranch_vccz cout_275
    s_sleep 1
    s_cmp_lt_u32 s39, 131072
    s_cbranch_scc1 cloop_274
cout_275:
    s_mov_b64 exec, -1
    s_waitcnt lgkmcnt(0)
    s_nop 3
    s_branch cback_121
cslow_124:
    s_mov_b32 s39, 0
    s_waitcnt vmcnt(0) lgkmcnt(0)
    s_nop 7
    s_nop 7
cloop_276:
    s_mov_b64 exec, vcc
    s_add_u32 s7, s48, 98304
    buffer_load_dwordx4 v[72:75], v6, s[8:11], s7 offen sc1
    s_add_u32 s7, s48, 102400
    buffer_load_dwordx4 v[76:79], v6, s[8:11], s7 offen sc1
    s_add_u32 s7, s48, 106496
    buffer_load_dwordx4 v[80:83], v6, s[8:11], s7 offen sc1
    s_add_u32 s7, s48, 110592
    buffer_load_dwordx4 v[84:87], v6, s[8:11], s7 offen sc1
    s_add_u32 s39, s39, 1
    s_waitcnt vmcnt(0)
    v_or3_b32 v9, v72, v76, v80
    v_or_b32 v9, v9, v84
    v_and_b32 v9, s40, v9
    v_cmp_ne_u32 vcc, 0, v9
    s_cbranch_vccz cout_277
    s_sleep 1
    s_cmp_lt_u32 s39, 131072
    s_cbranch_scc1 cloop_276
cout_277:
    s_mov_b64 exec, -1
    s_waitcnt lgkmcnt(0)
    s_nop 3
    s_branch cback_123
cslow_126:
    s_mov_b32 s39, 0
    s_waitcnt vmcnt(0) lgkmcnt(0)
    s_nop 7
    s_nop 7
cloop_278:
    s_mov_b64 exec, vcc
    s_add_u32 s7, s48, 114688
    buffer_load_dwordx4 v[88:91], v6, s[8:11], s7 offen sc1
    s_add_u32 s7, s48, 118784
    buffer_load_dwordx4 v[92:95], v6, s[8:11], s7 offen sc1
    s_add_u32 s7, s48, 122880
    buffer_load_dwordx4 v[96:99], v6, s[8:11], s7 offen sc1
    s_add_u32 s7, s48, 126976
    buffer_load_dwordx4 v[100:103], v6, s[8:11], s7 offen sc1
    s_add_u32 s39, s39, 1
    s_waitcnt vmcnt(0)
    v_or3_b32 v9, v88, v92, v96
    v_or_b32 v9, v9, v100
    v_and_b32 v9, s40, v9
    v_cmp_ne_u32 vcc, 0, v9
    s_cbranch_vccz cout_279
    s_sleep 1
    s_cmp_lt_u32 s39, 131072
    s_cbranch_scc1 cloop_278
cout_279:
    s_mov_b64 exec, -1
    s_waitcnt lgkmcnt(0)
    s_nop 3
    s_branch cback_125
cslow_128:
    s_mov_b32 s39, 0
    s_waitcnt vmcnt(0) lgkmcnt(0)
    s_nop 7
    s_nop 7
cloop_280:
    s_mov_b64 exec, vcc
    s_add_u32 s7, s48, 131072
    buffer_load_dwordx4 v[40:43], v6, s[8:11], s7 offen sc1
    s_add_u32 s7, s48, 135168
    buffer_load_dwordx4 v[44:47], v6, s[8:11], s7 offen sc1
    s_add_u32 s7, s48, 139264
    buffer_load_dwordx4 v[48:51], v6, s[8:11], s7 offen sc1
    s_add_u32 s7, s48, 143360
    buffer_load_dwordx4 v[52:55], v6, s[8:11], s7 offen sc1
    s_add_u32 s39, s39, 1
    s_waitcnt vmcnt(0)
    v_or3_b32 v9, v40, v44, v48
    v_or_b32 v9, v9, v52
    v_and_b32 v9, s73, v9
    v_cmp_ne_u32 vcc, 0, v9
    s_cbranch_vccz cout_281
    s_sleep 1
    s_cmp_lt_u32 s39, 131072
    s_cbranch_scc1 cloop_280
cout_281:
    s_mov_b64 exec, -1
    s_waitcnt lgkmcnt(0)
    s_nop 3
    s_branch cback_127
cslow_130:
    s_mov_b32 s39, 0
    s_waitcnt vmcnt(0) lgkmcnt(0)
    s_nop 7
    s_nop 7
cloop_282:
    s_mov_b64 exec, vcc
    s_add_u32 s7, s48, 147456
    buffer_load_dwordx4 v[56:59], v6, s[8:11], s7 offen sc1
    s_add_u32 s7, s48, 151552
    buffer_load_dwordx4 v[60:63], v6, s[8:11], s7 offen sc1
    s_add_u32 s7, s48, 155648
    buffer_load_dwordx4 v[64:67], v6, s[8:11], s7 offen sc1
    s_add_u32 s7, s48, 159744
    buffer_load_dwordx4 v[68:71], v6, s[8:11], s7 offen sc1
    s_add_u32 s39, s39, 1
    s_waitcnt vmcnt(0)
    v_or3_b32 v9, v56, v60, v64
    v_or_b32 v9, v9, v68
    v_and_b32 v9, s73, v9
    v_cmp_ne_u32 vcc, 0, v9
    s_cbranch_vccz cout_283
    s_sleep 1
    s_cmp_lt_u32 s39, 131072
    s_cbranch_scc1 cloop_282
cout_283:
    s_mov_b64 exec, -1
    s_waitcnt lgkmcnt(0)
    s_nop 3
    s_branch cback_129
cslow_132:
    s_mov_b32 s39, 0
    s_waitcnt vmcnt(0) lgkmcnt(0)
    s_nop 7
    s_nop 7
cloop_284:
    s_mov_b64 exec, vcc
    s_add_u32 s7, s48, 163840
    buffer_load_dwordx4 v[72:75], v6, s[8:11], s7 offen sc1
    s_add_u32 s7, s48, 167936
    buffer_load_dwordx4 v[76:79], v6, s[8:11], s7 offen sc1
    s_add_u32 s7, s48, 172032
    buffer_load_dwordx4 v[80:83], v6, s[8:11], s7 offen sc1
    s_add_u32 s7, s48, 176128
    buffer_load_dwordx4 v[84:87], v6, s[8:11], s7 offen sc1
    s_add_u32 s39, s39, 1
    s_waitcnt vmcnt(0)
    v_or3_b32 v9, v72, v76, v80
    v_or_b32 v9, v9, v84
    v_and_b32 v9, s73, v9
    v_cmp_ne_u32 vcc, 0, v9
    s_cbranch_vccz cout_285
    s_sleep 1
    s_cmp_lt_u32 s39, 131072
    s_cbranch_scc1 cloop_284
cout_285:
    s_mov_b64 exec, -1
    s_waitcnt lgkmcnt(0)
    s_nop 3
    s_branch cback_131
cslow_134:
    s_mov_b32 s39, 0
    s_waitcnt vmcnt(0) lgkmcnt(0)
    s_nop 7
    s_nop 7
cloop_286:
    s_mov_b64 exec, vcc
    s_add_u32 s7, s48, 180224
    buffer_load_dwordx4 v[88:91], v6, s[8:11], s7 offen sc1
    s_add_u32 s7, s48, 184320
    buffer_load_dwordx4 v[92:95], v6, s[8:11], s7 offen sc1
    s_add_u32 s7, s48, 188416
    buffer_load_dwordx4 v[96:99], v6, s[8:11], s7 offen sc1
    s_add_u32 s7, s48, 192512
    buffer_load_dwordx4 v[100:103], v6, s[8:11], s7 offen sc1
    s_add_u32 s39, s39, 1
    s_waitcnt vmcnt(0)
    v_or3_b32 v9, v88, v92, v96
    v_or_b32 v9, v9, v100
    v_and_b32 v9, s73, v9
    v_cmp_ne_u32 vcc, 0, v9
    s_cbranch_vccz cout_287
    s_sleep 1
    s_cmp_lt_u32 s39, 131072
    s_cbranch_scc1 cloop_286
cout_287:
    s_mov_b64 exec, -1
    s_waitcnt lgkmcnt(0)
    s_nop 3
    s_branch cback_133
cslow_136:
    s_mov_b32 s39, 0
    s_waitcnt vmcnt(0) lgkmcnt(0)
    s_nop 7
    s_nop 7
cloop_288:
    s_mov_b64 exec, vcc
    buffer_load_dword v16, v114, s[68:71], s28 offen sc1
    buffer_load_dword v17, v118, s[68:71], s28 offen sc1
    buffer_load_dword v18, v114, s[68:71], s29 offen sc1
    buffer_load_dword v19, v118, s[68:71], s29 offen sc1
    s_add_u32 s39, s39, 1
    s_waitcnt vmcnt(0)
    v_max3_u32 v3, v16, v17, v18
    v_max_u32 v3, v3, v19
    v_cmp_eq_u32 vcc, -1, v3
    s_cbranch_vccz cout_289
    s_sleep 1
    s_cmp_lt_u32 s39, 131072
    s_cbranch_scc1 cloop_288
cout_289:
    s_mov_b64 exec, -1
    s_waitcnt lgkmcnt(0)
    s_nop 3
    s_branch cback_135
ctslow_138:
    s_add_u32 s39, s39, 1
    s_cmp_ge_u32 s39, 8192
    s_cbranch_scc1 ctgo_139
    s_add_u32 m0, s67, 0
    s_add_u32 s0, s65, 0
    buffer_load_dwordx4 v2, s[8:11], s0 offen offset:0 sc1 lds
    buffer_load_dwordx4 v2, s[8:11], s0 offen offset:1024 sc1 lds
    buffer_load_dwordx4 v2, s[8:11], s0 offen offset:2048 sc1 lds
    buffer_load_dwordx4 v2, s[8:11], s0 offen offset:3072 sc1 lds
    s_add_u32 m0, s67, 16384
    s_add_u32 s0, s65, 4096
    buffer_load_dwordx4 v2, s[8:11], s0 offen offset:0 sc1 lds
    buffer_load_dwordx4 v2, s[8:11], s0 offen offset:1024 sc1 lds
    buffer_load_dwordx4 v2, s[8:11], s0 offen offset:2048 sc1 lds
    buffer_load_dwordx4 v2, s[8:11], s0 offen offset:3072 sc1 lds
    s_add_u32 m0, s67, 32768
    s_add_u32 s0, s66, 0
    buffer_load_dwordx4 v2, s[8:11], s0 offen offset:0 sc1 lds
    buffer_load_dwordx4 v2, s[8:11], s0 offen offset:1024 sc1 lds
    buffer_load_dwordx4 v2, s[8:11], s0 offen offset:2048 sc1 lds
    buffer_load_dwordx4 v2, s[8:11], s0 offen offset:3072 sc1 lds
    s_add_u32 m0, s67, 49152
    s_add_u32 s0, s66, 4096
    buffer_load_dwordx4 v2, s[8:11], s0 offen offset:0 sc1 lds
    buffer_load_dwordx4 v2, s[8:11], s0 offen offset:1024 sc1 lds
    buffer_load_dwordx4 v2, s[8:11], s0 offen offset:2048 sc1 lds
    buffer_load_dwordx4 v2, s[8:11], s0 offen offset:3072 sc1 lds
    s_waitcnt vmcnt(0)
    s_nop 7
    s_nop 7
    s_branch ctredo_137
cslow_141:
    s_mov_b32 s39, 0
    s_waitcnt vmcnt(0) lgkmcnt(0)
    s_nop 7
    s_nop 7
cloop_290:
    s_mov_b64 exec, vcc
    s_add_u32 s0, s76, 0
    buffer_load_dwordx4 v[120:123], v4, s[16:19], s0 offen sc1
    s_add_u32 s0, s82, 0
    buffer_load_dwordx4 v[124:127], v4, s[16:19], s0 offen sc1
    s_add_u32 s39, s39, 1
    s_waitcnt vmcnt(0)
    v_and_b32 v3, v120, v124
    v_and_b32 v3, 1, v3
    v_cmp_ne_u32 s[6:7], 1, v3
    s_nop 0
    s_mov_b64 vcc, s[6:7]
    s_cbranch_vccz cout_291
    s_sleep 1
    s_cmp_lt_u32 s39, 131072
    s_cbranch_scc1 cloop_290
cout_291:
    s_mov_b64 exec, -1
    s_waitcnt lgkmcnt(0)
    s_nop 3
    s_branch cback_140
cslow_143:
    s_mov_b32 s39, 0
    s_waitcnt vmcnt(0) lgkmcnt(0)
    s_nop 7
    s_nop 7
cloop_292:
    s_mov_b64 exec, vcc
    s_add_u32 s0, s76, 8192
    buffer_load_dwordx4 v[128:131], v4, s[16:19], s0 offen sc1
    s_add_u32 s0, s82, 8192
    buffer_load_dwordx4 v[132:135], v4, s[16:19], s0 offen sc1
    s_add_u32 s0, s76, 16384
    buffer_load_dwordx4 v[136:139], v4, s[16:19], s0 offen sc1
    s_add_u32 s0, s82, 16384
    buffer_load_dwordx4 v[140:143], v4, s[16:19], s0 offen sc1
    s_add_u32 s39, s39, 1
    s_waitcnt vmcnt(0)
    v_bitop3_b32 v3, v128, v132, v136 bitop3:0x80
    v_and_b32 v3, v3, v140
    v_and_b32 v3, 1, v3
    v_cmp_ne_u32 s[6:7], 1, v3
    s_nop 0
    s_mov_b64 vcc, s[6:7]
    s_cbranch_vccz cout_293
    s_sleep 1
    s_cmp_lt_u32 s39, 131072
    s_cbranch_scc1 cloop_292
cout_293:
    s_mov_b64 exec, -1
    s_waitcnt lgkmcnt(0)
    s_nop 3
    s_branch cback_142
cslow_145:
    s_mov_b32 s39, 0
    s_waitcnt vmcnt(0) lgkmcnt(0)
    s_nop 7
    s_nop 7
cloop_294:
    s_mov_b64 exec, vcc
    s_add_u32 s0, s76, 24576
    buffer_load_dwordx4 v[144:147], v4, s[16:19], s0 offen sc1
    s_add_u32 s0, s82, 24576
    buffer_load_dwordx4 v[148:151], v4, s[16:19], s0 offen sc1
    s_add_u32 s0, s76, 32768
    buffer_load_dwordx4 v[152:155], v4, s[16:19], s0 offen sc1
    s_add_u32 s0, s82, 32768
    buffer_load_dwordx4 v[156:159], v4, s[16:19], s0 offen sc1
    s_add_u32 s39, s39, 1
    s_waitcnt vmcnt(0)
    v_bitop3_b32 v3, v144, v148, v152 bitop3:0x80
    v_and_b32 v3, v3, v156
    v_and_b32 v3, 1, v3
    v_cmp_ne_u32 s[6:7], 1, v3
    s_nop 0
    s_mov_b64 vcc, s[6:7]
    s_cbranch_vccz cout_295
    s_sleep 1
    s_cmp_lt_u32 s39, 131072
    s_cbranch_scc1 cloop_294
cout_295:
    s_mov_b64 exec, -1
    s_waitcnt lgkmcnt(0)
    s_nop 3
    s_branch cback_144
cslow_147:
    s_mov_b32 s39, 0
    s_waitcnt vmcnt(0) lgkmcnt(0)
    s_nop 7
    s_nop 7
cloop_296:
    s_mov_b64 exec, vcc
    s_add_u32 s0, s76, 40960
    buffer_load_dwordx4 v[160:163], v4, s[16:19], s0 offen sc1
    s_add_u32 s0, s82, 40960
    buffer_load_dwordx4 v[164:167], v4, s[16:19], s0 offen sc1
    s_add_u32 s0, s76, 49152
    buffer_load_dwordx4 v[168:171], v4, s[16:19], s0 offen sc1
    s_add_u32 s0, s82, 49152
    buffer_load_dwordx4 v[172:175], v4, s[16:19], s0 offen sc1
    s_add_u32 s39, s39, 1
    s_waitcnt vmcnt(0)
    v_bitop3_b32 v3, v160, v164, v168 bitop3:0x80
    v_and_b32 v3, v3, v172
    v_and_b32 v3, 1, v3
    v_cmp_ne_u32 s[6:7], 1, v3
    s_nop 0
    s_mov_b64 vcc, s[6:7]
    s_cbranch_vccz cout_297
    s_sleep 1
    s_cmp_lt_u32 s39, 131072
    s_cbranch_scc1 cloop_296
cout_297:
    s_mov_b64 exec, -1
    s_waitcnt lgkmcnt(0)
    s_nop 3
    s_branch cback_146
cslow_149:
    s_mov_b32 s39, 0
    s_waitcnt vmcnt(0) lgkmcnt(0)
    s_nop 7
    s_nop 7
cloop_298:
    s_mov_b64 exec, vcc
    s_add_u32 s0, s76, 57344
    buffer_load_dwordx4 v[176:179], v4, s[16:19], s0 offen sc1
    s_add_u32 s0, s82, 57344
    buffer_load_dwordx4 v[180:183], v4, s[16:19], s0 offen sc1
    s_add_u32 s0, s76, 65536
    buffer_load_dwordx4 v[184:187], v4, s[16:19], s0 offen sc1
    s_add_u32 s0, s82, 65536
    buffer_load_dwordx4 v[188:191], v4, s[16:19], s0 offen sc1
    s_add_u32 s39, s39, 1
    s_waitcnt vmcnt(0)
    v_bitop3_b32 v3, v176, v180, v184 bitop3:0x80
    v_and_b32 v3, v3, v188
    v_and_b32 v3, 1, v3
    v_cmp_ne_u32 s[6:7], 1, v3
    s_nop 0
    s_mov_b64 vcc, s[6:7]
    s_cbranch_vccz cout_299
    s_sleep 1
    s_cmp_lt_u32 s39, 131072
    s_cbranch_scc1 cloop_298
cout_299:
    s_mov_b64 exec, -1
    s_waitcnt lgkmcnt(0)
    s_nop 3
    s_branch cback_148
cslow_151:
    s_mov_b32 s39, 0
    s_waitcnt vmcnt(0) lgkmcnt(0)
    s_nop 7
    s_nop 7
cloop_300:
    s_mov_b64 exec, vcc
    s_add_u32 s0, s76, 73728
    buffer_load_dwordx4 v[192:195], v4, s[16:19], s0 offen sc1
    s_add_u32 s0, s82, 73728
    buffer_load_dwordx4 v[196:199], v4, s[16:19], s0 offen sc1
    s_add_u32 s0, s76, 81920
    buffer_load_dwordx4 v[200:203], v4, s[16:19], s0 offen sc1
    s_add_u32 s0, s82, 81920
    buffer_load_dwordx4 v[204:207], v4, s[16:19], s0 offen sc1
    s_add_u32 s39, s39, 1
    s_waitcnt vmcnt(0)
    v_bitop3_b32 v3, v192, v196, v200 bitop3:0x80
    v_and_b32 v3, v3, v204
    v_and_b32 v3, 1, v3
    v_cmp_ne_u32 s[6:7], 1, v3
    s_nop 0
    s_mov_b64 vcc, s[6:7]
    s_cbranch_vccz cout_301
    s_sleep 1
    s_cmp_lt_u32 s39, 131072
    s_cbranch_scc1 cloop_300
cout_301:
    s_mov_b64 exec, -1
    s_waitcnt lgkmcnt(0)
    s_nop 3
    s_branch cback_150
cslow_153:
    s_mov_b32 s39, 0
    s_waitcnt vmcnt(0) lgkmcnt(0)
    s_nop 7
    s_nop 7
cloop_302:
    s_mov_b64 exec, vcc
    s_add_u32 s0, s76, 0
    buffer_load_dwordx4 v[120:123], v4, s[20:23], s0 offen sc1
    s_add_u32 s0, s82, 0
    buffer_load_dwordx4 v[124:127], v4, s[20:23], s0 offen sc1
    s_add_u32 s39, s39, 1
    s_waitcnt vmcnt(0)
    v_and_b32 v3, v120, v124
    v_and_b32 v3, 1, v3
    v_cmp_ne_u32 s[6:7], 1, v3
    s_nop 0
    s_mov_b64 vcc, s[6:7]
    s_cbranch_vccz cout_303
    s_sleep 1
    s_cmp_lt_u32 s39, 131072
    s_cbranch_scc1 cloop_302
cout_303:
    s_mov_b64 exec, -1
    s_waitcnt lgkmcnt(0)
    s_nop 3
    s_branch cback_152
cslow_155:
    s_mov_b32 s39, 0
    s_waitcnt vmcnt(0) lgkmcnt(0)
    s_nop 7
    s_nop 7
cloop_304:
    s_mov_b64 exec, vcc
    s_add_u32 s0, s76, 8192
    buffer_load_dwordx4 v[128:131], v4, s[20:23], s0 offen sc1
    s_add_u32 s0, s82, 8192
    buffer_load_dwordx4 v[132:135], v4, s[20:23], s0 offen sc1
    s_add_u32 s0, s76, 16384
    buffer_load_dwordx4 v[136:139], v4, s[20:23], s0 offen sc1
    s_add_u32 s0, s82, 16384
    buffer_load_dwordx4 v[140:143], v4, s[20:23], s0 offen sc1
    s_add_u32 s39, s39, 1
    s_waitcnt vmcnt(0)
    v_bitop3_b32 v3, v128, v132, v136 bitop3:0x80
    v_and_b32 v3, v3, v140
    v_and_b32 v3, 1, v3
    v_cmp_ne_u32 s[6:7], 1, v3
    s_nop 0
    s_mov_b64 vcc, s[6:7]
    s_cbranch_vccz cout_305
    s_sleep 1
    s_cmp_lt_u32 s39, 131072
    s_cbranch_scc1 cloop_304
cout_305:
    s_mov_b64 exec, -1
    s_waitcnt lgkmcnt(0)
    s_nop 3
    s_branch cback_154
cslow_157:
    s_mov_b32 s39, 0
    s_waitcnt vmcnt(0) lgkmcnt(0)
    s_nop 7
    s_nop 7
cloop_306:
    s_mov_b64 exec, vcc
    s_add_u32 s0, s76, 24576
    buffer_load_dwordx4 v[144:147], v4, s[20:23], s0 offen sc1
    s_add_u32 s0, s82, 24576
    buffer_load_dwordx4 v[148:151], v4, s[20:23], s0 offen sc1
    s_add_u32 s0, s76, 32768
    buffer_load_dwordx4 v[152:155], v4, s[20:23], s0 offen sc1
    s_add_u32 s0, s82, 32768
    buffer_load_dwordx4 v[156:159], v4, s[20:23], s0 offen sc1
    s_add_u32 s39, s39, 1
    s_waitcnt vmcnt(0)
    v_bitop3_b32 v3, v144, v148, v152 bitop3:0x80
    v_and_b32 v3, v3, v156
    v_and_b32 v3, 1, v3
    v_cmp_ne_u32 s[6:7], 1, v3
    s_nop 0
    s_mov_b64 vcc, s[6:7]
    s_cbranch_vccz cout_307
    s_sleep 1
    s_cmp_lt_u32 s39, 131072
    s_cbranch_scc1 cloop_306
cout_307:
    s_mov_b64 exec, -1
    s_waitcnt lgkmcnt(0)
    s_nop 3
    s_branch cback_156
cslow_159:
    s_mov_b32 s39, 0
    s_waitcnt vmcnt(0) lgkmcnt(0)
    s_nop 7
    s_nop 7
cloop_308:
    s_mov_b64 exec, vcc
    s_add_u32 s0, s76, 40960
    buffer_load_dwordx4 v[160:163], v4, s[20:23], s0 offen sc1
    s_add_u32 s0, s82, 40960
    buffer_load_dwordx4 v[164:167], v4, s[20:23], s0 offen sc1
    s_add_u32 s0, s76, 49152
    buffer_load_dwordx4 v[168:171], v4, s[20:23], s0 offen sc1
    s_add_u32 s0, s82, 49152
    buffer_load_dwordx4 v[172:175], v4, s[20:23], s0 offen sc1
    s_add_u32 s39, s39, 1
    s_waitcnt vmcnt(0)
    v_bitop3_b32 v3, v160, v164, v168 bitop3:0x80
    v_and_b32 v3, v3, v172
    v_and_b32 v3, 1, v3
    v_cmp_ne_u32 s[6:7], 1, v3
    s_nop 0
    s_mov_b64 vcc, s[6:7]
    s_cbranch_vccz cout_309
    s_sleep 1
    s_cmp_lt_u32 s39, 131072
    s_cbranch_scc1 cloop_308
cout_309:
    s_mov_b64 exec, -1
    s_waitcnt lgkmcnt(0)
    s_nop 3
    s_branch cback_158
cslow_161:
    s_mov_b32 s39, 0
    s_waitcnt vmcnt(0) lgkmcnt(0)
    s_nop 7
    s_nop 7
cloop_310:
    s_mov_b64 exec, vcc
    s_add_u32 s0, s76, 57344
    buffer_load_dwordx4 v[176:179], v4, s[20:23], s0 offen sc1
    s_add_u32 s0, s82, 57344
    buffer_load_dwordx4 v[180:183], v4, s[20:23], s0 offen sc1
    s_add_u32 s0, s76, 65536
    buffer_load_dwordx4 v[184:187], v4, s[20:23], s0 offen sc1
    s_add_u32 s0, s82, 65536
    buffer_load_dwordx4 v[188:191], v4, s[20:23], s0 offen sc1
    s_add_u32 s39, s39, 1
    s_waitcnt vmcnt(0)
    v_bitop3_b32 v3, v176, v180, v184 bitop3:0x80
    v_and_b32 v3, v3, v188
    v_and_b32 v3, 1, v3
    v_cmp_ne_u32 s[6:7], 1, v3
    s_nop 0
    s_mov_b64 vcc, s[6:7]
    s_cbranch_vccz cout_311
    s_sleep 1
    s_cmp_lt_u32 s39, 131072
    s_cbranch_scc1 cloop_310
cout_311:
    s_mov_b64 exec, -1
    s_waitcnt lgkmcnt(0)
    s_nop 3
    s_branch cback_160
cslow_163:
    s_mov_b32 s39, 0
    s_waitcnt vmcnt(0) lgkmcnt(0)
    s_nop 7
    s_nop 7
cloop_312:
    s_mov_b64 exec, vcc
    s_add_u32 s0, s76, 73728
    buffer_load_dwordx4 v[192:195], v4, s[20:23], s0 offen sc1
    s_add_u32 s0, s82, 73728
    buffer_load_dwordx4 v[196:199], v4, s[20:23], s0 offen sc1
    s_add_u32 s0, s76, 81920
    buffer_load_dwordx4 v[200:203], v4, s[20:23], s0 offen sc1
    s_add_u32 s0, s82, 81920
    buffer_load_dwordx4 v[204:207], v4, s[20:23], s0 offen sc1
    s_add_u32 s39, s39, 1
    s_waitcnt vmcnt(0)
    v_bitop3_b32 v3, v192, v196, v200 bitop3:0x80
    v_and_b32 v3, v3, v204
    v_and_b32 v3, 1, v3
    v_cmp_ne_u32 s[6:7], 1, v3
    s_nop 0
    s_mov_b64 vcc, s[6:7]
    s_cbranch_vccz cout_313
    s_sleep 1
    s_cmp_lt_u32 s39, 131072
    s_cbranch_scc1 cloop_312
cout_313:
    s_mov_b64 exec, -1
    s_waitcnt lgkmcnt(0)
    s_nop 3
    s_branch cback_162
.p2align 6
.type L_tasks,@object
L_tasks:
.long 5632, 2826, 266, 3082, 522, 3338, 778, 3594, 10, 3850, 1290, 4106, 1546, 4362, 1802, 4618
.long 1034, 4874, 2314, 5130, 2570, 5386, 1287, 4103, 2058, 2816, 1538, 4098, 2564, 2565, 1543, 4359
.long 0, 3072, 1794, 4354, 5, 2821, 1799, 4615, 256, 3328, 2050, 4610, 261, 3077, 2055, 4871
.long 512, 3584, 2306, 4866, 517, 3333, 2311, 5127, 768, 3840, 2562, 5122, 773, 3589, 2567, 5383
.long 1024, 4096, 3, 5378, 1029, 3845, 8, 2568, 1280, 4352, 259, 2819, 1285, 4101, 264, 2824
.long 1536, 4608, 515, 3075, 1541, 4357, 520, 3080, 1792, 4864, 771, 3331, 1797, 4613, 776, 3336
.long 2048, 5120, 1027, 3587, 2053, 4869, 1032, 3592, 2304, 5376, 1283, 3843, 2309, 5125, 1288, 3848
.long 2560, 2561, 1539, 4099, 6, 5381, 1544, 4104, 1, 2817, 1795, 4355, 262, 2822, 1800, 4360
.long 257, 3073, 2051, 4611, 518, 3078, 2056, 4616, 513, 3329, 2307, 4867, 774, 3334, 2312, 4872
.long 769, 3585, 2563, 5123, 1030, 3590, 9, 5128, 1025, 3841, 4, 5379, 1286, 3846, 265, 5384
.long 1281, 4097, 260, 2820, 1542, 4102, 521, 2825, 1537, 4353, 516, 3076, 1798, 4358, 777, 3081
.long 1793, 4609, 772, 3332, 2054, 4614, 1033, 3337, 2049, 4865, 1028, 3588, 2310, 4870, 1289, 3593
.long 2305, 5121, 1284, 3844, 2566, 5126, 1545, 3849, 2, 5377, 1540, 4100, 7, 5382, 1801, 4105
.long 258, 2818, 1796, 4356, 263, 2823, 2057, 4361, 514, 3074, 2052, 4612, 519, 3079, 2313, 4617
.long 770, 3330, 2308, 4868, 775, 3335, 2569, 4873, 1026, 3586, 5634, 5124, 1031, 3591, 5639, 5129
.long 1282, 3842, 5635, 5380, 5636, 3847, 5640, 5385, 5633, 5642, 5643, 5644, 5637, 5638, 5641, 5645
.size L_tasks, 1024
L_codeend:
.fill (90112 + 256 - (L_codeend - interleave_layers__spectral_gfnet__glu_gated_reglu__prompt_kernel)) / 4, 4, 0xbf810000

.section .rodata,"a"
.p2align 6
.amdhsa_kernel interleave_layers__spectral_gfnet__glu_gated_reglu__prompt_kernel
  .amdhsa_next_free_vgpr 512
  .amdhsa_next_free_sgpr 102
  .amdhsa_accum_offset 256
  .amdhsa_group_segment_fixed_size 0
  .amdhsa_kernarg_size 80
  .amdhsa_user_sgpr_count 2
  .amdhsa_user_sgpr_kernarg_segment_ptr 1
  .amdhsa_system_sgpr_workgroup_id_x 1
  .amdhsa_float_denorm_mode_32 3
.end_amdhsa_kernel
```
